```python
import torch

def _softmax(x, axis=-1):
    return torch.softmax(x, dim=axis)
def _gelu(x):
    return torch.nn.functional.gelu(x, approximate="tanh")
def _silu(x):
    return torch.nn.functional.silu(x)
def _sigmoid(x):
    return torch.sigmoid(x)
def _layernorm(x, axis=-1, eps=1e-5):
    m = x.mean(dim=axis, keepdim=True)
    v = x.var(dim=axis, keepdim=True, unbiased=False)
    return (x - m) / torch.sqrt(v + eps)
def _scatter_add(tgt, idx, src, axis=0):
    return tgt.clone().index_add_(axis, idx, src)
def _segment_sum(src, seg, n):
    out = torch.zeros((n,) + src.shape[1:], dtype=src.dtype)
    return out.index_add_(0, seg, src)
def _pad(x, pw):
    flat = tuple(v for pair in reversed(pw) for v in pair)
    return torch.nn.functional.pad(x, flat)

kernel_name = 'concat_heads__mha_block_cached__gqa_block_cached__near_ridge'

def setup_inputs():

    _w = (lambda a: (lambda t: t.to(torch.bfloat16) if t.is_floating_point() else t)(torch.as_tensor(a)))
    def _A_setup():
        B, Sq, D = 16, 144, 640
        H, Sk, Dh = 32, 512, 192
        return {
            "x": _w((lambda *s: torch.randn(*s, dtype=torch.bfloat16) * 0.8)(B, Sq, D)),
            "k_cache": _w((lambda *s: torch.randn(*s, dtype=torch.bfloat16) * 0.8)(B, H, Sk, Dh)),
            "v_cache": _w((lambda *s: torch.randn(*s, dtype=torch.bfloat16) * 0.05)(B, H, Sk, Dh)),
            "wq": _w((lambda *s: torch.randn(*s, dtype=torch.bfloat16) * 0.8)(D, H * Dh) * (D ** -0.5)),
            "wo": _w((lambda *s: torch.randn(*s, dtype=torch.bfloat16) * 0.05)(H * Dh, D) * ((H * Dh) ** -0.5)),
        }
    _A_in = _A_setup()

    def _B_setup():
        B, Sq, D = 16, 144, 640
        Hq, Hkv, Sk, Dh = 32, 32, 512, 192
        assert Hq % Hkv == 0, (Hq, Hkv)
        return {
            "x": _w((lambda *s: torch.randn(*s, dtype=torch.bfloat16) * 0.8)(B, Sq, D)),
            "k_cache": _w((lambda *s: torch.randn(*s, dtype=torch.bfloat16) * 0.8)(B, Hkv, Sk, Dh)),
            "v_cache": _w((lambda *s: torch.randn(*s, dtype=torch.bfloat16) * 0.05)(B, Hkv, Sk, Dh)),
            "wq": _w((lambda *s: torch.randn(*s, dtype=torch.bfloat16) * 0.8)(D, Hq * Dh) * (D ** -0.5)),
            "wo": _w((lambda *s: torch.randn(*s, dtype=torch.bfloat16) * 0.05)(Hq * Dh, D) * ((Hq * Dh) ** -0.5)),
        }
    _B_in = _B_setup()

    return {
        "A_x": _A_in["x"],
        "A_k_cache": _A_in["k_cache"],
        "A_v_cache": _A_in["v_cache"],
        "A_wq": _A_in["wq"],
        "A_wo": _A_in["wo"],
        "B_x": _B_in["x"],
        "B_k_cache": _B_in["k_cache"],
        "B_v_cache": _B_in["v_cache"],
        "B_wq": _B_in["wq"],
        "B_wo": _B_in["wo"],
    }

def reference(A_x, A_k_cache, A_v_cache, A_wq, A_wo, B_x, B_k_cache, B_v_cache, B_wq, B_wo):
    def _A_ref(x, k_cache, v_cache, wq, wo):
        B, Sq, D = x.shape
        H, Dh = 32, 192
        q = (lambda x, *d: x.permute(*d))((x @ wq).reshape(B, Sq, H, Dh), 0, 2, 1, 3)
        scores = torch.einsum("bhqd,bhkd->bhqk", q, k_cache) * (Dh ** -0.5)
        p = _softmax(scores, axis=-1)
        o = torch.einsum("bhqk,bhkd->bhqd", p, v_cache)
        return (lambda x, *d: x.permute(*d))(o, 0, 2, 1, 3).reshape(B, Sq, H * Dh) @ wo

    def _B_ref(x, k_cache, v_cache, wq, wo):
        B, Sq, D = x.shape
        Hq, Dh = 32, 192
        Hkv = k_cache.shape[1]
        rep = Hq // Hkv
        q = (lambda x, *d: x.permute(*d))((x @ wq).reshape(B, Sq, Hq, Dh), 0, 2, 1, 3)
        k = (lambda x, n, axis: torch.repeat_interleave(x, n, dim=axis))(k_cache, rep, axis=1)
        v = (lambda x, n, axis: torch.repeat_interleave(x, n, dim=axis))(v_cache, rep, axis=1)
        scores = torch.einsum("bhqd,bhkd->bhqk", q, k) * (Dh ** -0.5)
        p = _softmax(scores, axis=-1)
        o = torch.einsum("bhqk,bhkd->bhqd", p, v)
        return (lambda x, *d: x.permute(*d))(o, 0, 2, 1, 3).reshape(B, Sq, Hq * Dh) @ wo

    a = _A_ref(A_x, A_k_cache, A_v_cache, A_wq, A_wo)
    b = _B_ref(B_x, B_k_cache, B_v_cache, B_wq, B_wo)
    return torch.concatenate([a, b], axis=-1)
```

```asm
; @launch grid=(256,1,1) block=(256,1,1) lds=163840
.amdgcn_target "amdgcn-amd-amdhsa--gfx950"
.text
.globl concat_heads__mha_block_cached__gqa_block_cached__near_ridge_kernel
.p2align 8
.type concat_heads__mha_block_cached__gqa_block_cached__near_ridge_kernel,@function
concat_heads__mha_block_cached__gqa_block_cached__near_ridge_kernel:
s_cmp_ge_u32 s2, 256
s_cbranch_scc1 L2_end
s_load_dwordx16 s[4:19], s[0:1], 0
s_load_dwordx4 s[20:23], s[0:1], 64
s_load_dwordx2 s[26:27], s[0:1], 96
s_load_dwordx2 s[72:73], s[0:1], 88
s_getpc_b64 s[60:61]
s_bfe_u32 s62, s2, 0x20003
s_lshl_b32 s62, s62, 13
v_lshrrev_b32 v80, 2, v0
v_lshl_add_u32 v80, v80, 7, s62
v_mov_b32 v81, s61
v_add_co_u32 v80, vcc, s60, v80
s_nop 1
v_addc_co_u32 v81, vcc, 0, v81, vcc
global_load_dword v82, v[80:81], off offset:3072
v_lshrrev_b32 v69, 6, v0
s_nop 0
v_readfirstlane_b32 s3, v69
v_and_b32 v64, 63, v0
v_and_b32 v65, 15, v64
v_lshrrev_b32 v66, 4, v64
v_lshrrev_b32 v67, 2, v65
v_and_b32 v68, 3, v64
s_and_b32 s51, s2, 1
s_lshl_b32 s51, s51, 3
s_lshr_b32 s52, s2, 5
s_add_u32 s50, s51, s52
s_bfe_u32 s51, s2, 0x10001
s_lshl_b32 s51, s51, 4
s_bfe_u32 s52, s2, 0x20003
s_add_u32 s51, s51, s52
s_lshl_b32 s49, s50, 5
s_add_u32 s49, s49, s51
s_mov_b32 s48, 0
s_mul_i32 s62, s3, 4608
s_mul_i32 s63, s3, 3072
s_add_u32 s63, s63, 104960
s_mul_i32 s64, s3, 6208
s_add_u32 s64, s64, 55296
s_mul_i32 s65, s3, 6144
s_mul_i32 s54, s3, 6144
v_add_u32 v69, 0, v64
v_mul_u32_u24 v70, 2731, v69
v_lshrrev_b32 v70, 16, v70
v_mul_u32_u24 v71, 24, v70
v_sub_u32 v69, v69, v71
v_bfe_u32 v71, v70, 1, 2
v_xor_b32 v71, v71, v69
v_mul_u32_u24 v72, 384, v70
v_add_u32 v72, s54, v72
v_subrev_u32 v72, 0, v72
v_lshl_add_u32 v9, v71, 4, v72
v_add_u32 v69, 64, v64
v_mul_u32_u24 v70, 2731, v69
v_lshrrev_b32 v70, 16, v70
v_mul_u32_u24 v71, 24, v70
v_sub_u32 v69, v69, v71
v_bfe_u32 v71, v70, 1, 2
v_xor_b32 v71, v71, v69
v_mul_u32_u24 v72, 384, v70
v_add_u32 v72, s54, v72
v_subrev_u32 v72, 1024, v72
v_lshl_add_u32 v10, v71, 4, v72
v_add_u32 v69, 128, v64
v_mul_u32_u24 v70, 2731, v69
v_lshrrev_b32 v70, 16, v70
v_mul_u32_u24 v71, 24, v70
v_sub_u32 v69, v69, v71
v_bfe_u32 v71, v70, 1, 2
v_xor_b32 v71, v71, v69
v_mul_u32_u24 v72, 384, v70
v_add_u32 v72, s54, v72
v_subrev_u32 v72, 2048, v72
v_lshl_add_u32 v11, v71, 4, v72
s_mov_b32 s39, 0x20000
s_mov_b32 s38, 196608
s_mul_i32 s52, s49, 196608
s_and_b32 s51, s2, 4
s_waitcnt lgkmcnt(0)
s_cmp_eq_u32 s51, 0
s_cselect_b64 s[6:7], s[6:7], s[16:17]
s_add_u32 s36, s6, s52
s_addc_u32 s37, s7, 0
s_mov_b32 s16, 0
s_add_u32 m0, s64, 0
s_add_u32 s57, s16, 0
buffer_load_dwordx4 v9, s[36:39], s57 offen nt lds
s_add_u32 m0, s64, 0
s_nop 0
buffer_load_dwordx4 v10, s[36:39], s57 offen offset:1024 nt lds
s_add_u32 m0, s64, 0
s_nop 0
buffer_load_dwordx4 v11, s[36:39], s57 offen offset:2048 nt lds
s_add_u32 m0, s64, 3136
s_add_u32 s57, s16, 3072
buffer_load_dwordx4 v9, s[36:39], s57 offen nt lds
s_add_u32 m0, s64, 3136
s_nop 0
buffer_load_dwordx4 v10, s[36:39], s57 offen offset:1024 nt lds
s_add_u32 m0, s64, 3136
s_nop 0
buffer_load_dwordx4 v11, s[36:39], s57 offen offset:2048 nt lds
s_mov_b32 s66, 0x3dd53b95
s_mov_b32 s67, 4096
s_mov_b32 s68, 8192
s_mov_b32 s31, 0x20000
s_mov_b32 s35, 0x20000
s_mov_b32 s39, 0x20000
s_mov_b32 s43, 0x20000
s_mov_b32 s47, 0x20000
s_mov_b32 s42, 196608
s_mov_b32 s46, 0
s_mul_i32 s51, s3, 36
v_lshrrev_b32 v69, 3, v64
v_add_u32 v69, s51, v69
v_bfe_u32 v70, v69, 1, 3
v_and_b32 v71, 7, v64
v_xor_b32 v70, v70, v71
v_mul_u32_u24 v69, 1280, v69
v_lshl_add_u32 v1, v70, 4, v69
v_lshrrev_b32 v69, 3, v64
v_add_u32 v69, s51, v69
v_add_u32 v69, 4, v69
v_bfe_u32 v70, v69, 1, 3
v_and_b32 v71, 7, v64
v_xor_b32 v70, v70, v71
v_mul_u32_u24 v69, 1280, v69
v_lshl_add_u32 v2, v70, 4, v69
v_subrev_u32 v2, 512, v2
v_lshrrev_b32 v69, 3, v64
v_add_u32 v69, s51, v69
v_add_u32 v69, 12, v69
v_bfe_u32 v70, v69, 1, 3
v_and_b32 v71, 7, v64
v_xor_b32 v70, v70, v71
v_mul_u32_u24 v69, 1280, v69
v_lshl_add_u32 v3, v70, 4, v69
v_subrev_u32 v3, 1536, v3
v_lshrrev_b32 v69, 3, v64
v_add_u32 v69, s51, v69
v_add_u32 v69, 20, v69
v_bfe_u32 v70, v69, 1, 3
v_and_b32 v71, 7, v64
v_xor_b32 v70, v70, v71
v_mul_u32_u24 v69, 1280, v69
v_lshl_add_u32 v4, v70, 4, v69
v_subrev_u32 v4, 2560, v4
v_lshrrev_b32 v69, 3, v64
v_add_u32 v69, s51, v69
v_add_u32 v69, 28, v69
v_bfe_u32 v70, v69, 1, 3
v_and_b32 v71, 7, v64
v_xor_b32 v70, v70, v71
v_mul_u32_u24 v69, 1280, v69
v_lshl_add_u32 v5, v70, 4, v69
v_subrev_u32 v5, 3584, v5
s_and_b32 s52, s3, 1
s_lshl_b32 s52, s52, 1
s_mul_i32 s53, s3, 98304
s_mul_i32 s54, s3, 6144
v_add_u32 v69, 0, v64
v_mul_u32_u24 v70, 2731, v69
v_lshrrev_b32 v70, 16, v70
v_mul_u32_u24 v71, 24, v70
v_sub_u32 v69, v69, v71
v_bfe_u32 v71, v70, 1, 1
v_or_b32 v71, s52, v71
v_lshlrev_b32 v71, 1, v71
v_xor_b32 v71, v71, v69
v_mul_u32_u24 v72, 12288, v70
v_lshl_add_u32 v72, v71, 4, v72
v_add_u32 v72, s53, v72
v_subrev_u32 v6, 0, v72
v_bfe_u32 v71, v70, 1, 2
v_xor_b32 v71, v71, v69
v_mul_u32_u24 v72, 384, v70
v_add_u32 v72, s54, v72
v_subrev_u32 v72, 0, v72
v_bfe_u32 v71, v70, 1, 2
v_lshlrev_b32 v71, 1, v71
v_xor_b32 v71, v71, v69
v_lshl_add_u32 v12, v71, 4, v72
v_add_u32 v69, 64, v64
v_mul_u32_u24 v70, 2731, v69
v_lshrrev_b32 v70, 16, v70
v_mul_u32_u24 v71, 24, v70
v_sub_u32 v69, v69, v71
v_bfe_u32 v71, v70, 1, 1
v_or_b32 v71, s52, v71
v_lshlrev_b32 v71, 1, v71
v_xor_b32 v71, v71, v69
v_mul_u32_u24 v72, 12288, v70
v_lshl_add_u32 v72, v71, 4, v72
v_add_u32 v72, s53, v72
v_subrev_u32 v7, 1024, v72
v_bfe_u32 v71, v70, 1, 2
v_xor_b32 v71, v71, v69
v_mul_u32_u24 v72, 384, v70
v_add_u32 v72, s54, v72
v_subrev_u32 v72, 1024, v72
v_bfe_u32 v71, v70, 1, 2
v_lshlrev_b32 v71, 1, v71
v_xor_b32 v71, v71, v69
v_lshl_add_u32 v13, v71, 4, v72
v_add_u32 v69, 128, v64
v_mul_u32_u24 v70, 2731, v69
v_lshrrev_b32 v70, 16, v70
v_mul_u32_u24 v71, 24, v70
v_sub_u32 v69, v69, v71
v_bfe_u32 v71, v70, 1, 1
v_or_b32 v71, s52, v71
v_lshlrev_b32 v71, 1, v71
v_xor_b32 v71, v71, v69
v_mul_u32_u24 v72, 12288, v70
v_lshl_add_u32 v72, v71, 4, v72
v_add_u32 v72, s53, v72
v_subrev_u32 v8, 2048, v72
v_bfe_u32 v71, v70, 1, 2
v_xor_b32 v71, v71, v69
v_mul_u32_u24 v72, 384, v70
v_add_u32 v72, s54, v72
v_subrev_u32 v72, 2048, v72
v_bfe_u32 v71, v70, 1, 2
v_lshlrev_b32 v71, 1, v71
v_xor_b32 v71, v71, v69
v_lshl_add_u32 v14, v71, 4, v72
v_bfe_u32 v69, v65, 1, 3
v_xor_b32 v69, v69, v66
v_lshlrev_b32 v69, 4, v69
v_lshl_add_u32 v15, v65, 7, v69
v_xor_b32 v16, 64, v15
s_mul_i32 s51, s3, 3
s_add_u32 s52, s51, 0
v_lshrrev_b32 v69, 1, v67
v_and_b32 v70, 1, v66
v_lshl_add_u32 v69, v70, 1, v69
v_xor_b32 v69, s52, v69
v_lshlrev_b32 v69, 5, v69
v_lshl_add_u32 v69, v68, 3, v69
v_lshl_add_u32 v70, v66, 3, v67
v_mul_u32_u24 v70, 384, v70
v_add_u32 v70, v69, v70
v_add_u32 v17, 104960, v70
s_lshl_b32 s52, s3, 1
s_add_u32 s52, s52, 0
v_lshrrev_b32 v69, 1, v67
v_and_b32 v70, 1, v66
v_lshl_add_u32 v69, v70, 1, v69
v_xor_b32 v69, s52, v69
v_lshlrev_b32 v69, 5, v69
v_lshl_add_u32 v69, v68, 3, v69
v_lshl_add_u32 v70, v66, 2, v67
v_mul_u32_u24 v70, 384, v70
v_add_u32 v70, v69, v70
v_add_u32 v20, 55296, v70
s_add_u32 s52, s51, 1
v_lshrrev_b32 v69, 1, v67
v_and_b32 v70, 1, v66
v_lshl_add_u32 v69, v70, 1, v69
v_xor_b32 v69, s52, v69
v_lshlrev_b32 v69, 5, v69
v_lshl_add_u32 v69, v68, 3, v69
v_lshl_add_u32 v70, v66, 3, v67
v_mul_u32_u24 v70, 384, v70
v_add_u32 v70, v69, v70
v_add_u32 v18, 104960, v70
s_lshl_b32 s52, s3, 1
s_add_u32 s52, s52, 1
v_lshrrev_b32 v69, 1, v67
v_and_b32 v70, 1, v66
v_lshl_add_u32 v69, v70, 1, v69
v_xor_b32 v69, s52, v69
v_lshlrev_b32 v69, 5, v69
v_lshl_add_u32 v69, v68, 3, v69
v_lshl_add_u32 v70, v66, 2, v67
v_mul_u32_u24 v70, 384, v70
v_add_u32 v70, v69, v70
v_add_u32 v21, 55296, v70
s_add_u32 s52, s51, 2
v_lshrrev_b32 v69, 1, v67
v_and_b32 v70, 1, v66
v_lshl_add_u32 v69, v70, 1, v69
v_xor_b32 v69, s52, v69
v_lshlrev_b32 v69, 5, v69
v_lshl_add_u32 v69, v68, 3, v69
v_lshl_add_u32 v70, v66, 3, v67
v_mul_u32_u24 v70, 384, v70
v_add_u32 v70, v69, v70
v_add_u32 v19, 104960, v70
s_add_u32 s52, s3, 8
v_lshrrev_b32 v69, 1, v67
v_and_b32 v70, 1, v66
v_lshl_add_u32 v69, v70, 1, v69
v_xor_b32 v69, s52, v69
v_lshlrev_b32 v69, 5, v69
v_lshl_add_u32 v69, v68, 3, v69
v_lshl_add_u32 v70, v66, 2, v67
v_mul_u32_u24 v70, 384, v70
v_add_u32 v70, v69, v70
v_add_u32 v22, 55296, v70
v_bfe_u32 v69, v65, 1, 2
v_xor_b32 v69, v69, v66
v_lshlrev_b32 v69, 4, v69
v_mul_u32_u24 v70, 384, v65
v_add_u32 v69, v69, v70
v_lshrrev_b32 v70, 3, v65
v_lshl_add_u32 v69, v70, 6, v69
v_add_u32 v23, s64, v69
v_lshrrev_b32 v69, 1, v66
v_lshlrev_b32 v69, 8, v69
v_lshl_add_u32 v69, v65, 4, v69
v_and_b32 v70, 1, v66
v_lshl_add_u32 v69, v70, 3, v69
s_mul_i32 s52, s3, 3
s_add_u32 s52, s52, 0
s_lshr_b32 s53, s52, 1
s_mul_i32 s53, s53, 9216
s_and_b32 s52, s52, 1
s_lshl_b32 s52, s52, 9
s_add_u32 s52, s52, s53
v_add_u32 v24, s52, v69
s_mul_i32 s52, s3, 3
s_add_u32 s52, s52, 1
s_lshr_b32 s53, s52, 1
s_mul_i32 s53, s53, 9216
s_and_b32 s52, s52, 1
s_lshl_b32 s52, s52, 9
s_add_u32 s52, s52, s53
v_add_u32 v53, s52, v69
s_mul_i32 s52, s3, 3
s_add_u32 s52, s52, 2
s_lshr_b32 s53, s52, 1
s_mul_i32 s53, s53, 9216
s_and_b32 s52, s52, 1
s_lshl_b32 s52, s52, 9
s_add_u32 s52, s52, s53
v_add_u32 v54, s52, v69
v_lshlrev_b32 v25, 4, v64
s_lshr_b32 s52, s3, 1
s_mul_i32 s52, s52, 9216
s_and_b32 s53, s3, 1
s_lshl_b32 s53, s53, 3
s_add_u32 s52, s52, s53
v_add_u32 v26, s52, v25
v_mul_u32_u24 v69, 48, v65
v_add_u32 v27, 154112, v69
s_lshl_b32 s52, s3, 2
s_add_u32 s52, s52, 154880
v_add_u32 v28, s52, v25
v_lshlrev_b32 v69, 4, v65
v_add_u32 v29, 154880, v69
s_mul_i32 s52, s3, 9216
v_add_u32 v30, s52, v25
s_lshr_b32 s52, s3, 1
s_and_b32 s53, s3, 1
s_mul_i32 s54, s52, 9216
s_add_u32 s54, s54, 36864
s_lshl_b32 s51, s53, 10
s_add_u32 s54, s54, s51
v_add_u32 v31, s54, v25
s_sub_u32 s100, 8192, s51
s_lshl_b32 s52, s52, 11
s_add_u32 s52, s52, 157952
s_add_u32 s54, s52, s51
v_add_u32 v55, s54, v25
s_lshl_b32 s53, s53, 3
s_add_u32 s52, s52, s53
v_add_u32 v0, s52, v25
v_mov_b32 v44, 0
v_mov_b32 v45, 0
v_mov_b32 v46, 0
v_mov_b32 v47, 0
v_mov_b32 v48, 0
v_mov_b32 v49, 0
v_mov_b32 v50, 0
v_mov_b32 v51, 0
v_mov_b32 v52, 0
s_waitcnt lgkmcnt(0)
s_and_b32 s51, s2, 4
s_cmp_eq_u32 s51, 0
s_cselect_b64 s[28:29], s[4:5], s[14:15]
s_cselect_b64 s[8:9], s[8:9], s[18:19]
s_cselect_b64 s[4:5], s[10:11], s[20:21]
s_cselect_b64 s[58:59], s[12:13], s[22:23]
s_cselect_b32 s51, 0, 28311552
s_add_u32 s14, s26, s51
s_addc_u32 s15, s27, 0
s_mul_i32 s52, s50, 184320
s_add_u32 s28, s28, s52
s_addc_u32 s29, s29, 0
s_and_b32 s52, s49, 31
s_mul_i32 s52, s52, 384
s_add_u32 s4, s4, s52
s_addc_u32 s5, s5, 0
s_sub_u32 s20, 7864320, s52
s_mov_b32 s101, 0
s_mov_b32 s16, 0
s_mov_b32 s18, 0
s_mov_b32 s19, 0
s_mov_b32 s74, 256
s_mov_b32 s75, 0x20000
s_and_b32 s51, s2, 7
s_lshl_b32 s51, s51, 5
s_cmp_eq_u32 s3, 0
s_cselect_b32 s10, s51, 0x40000000
s_mov_b32 s21, 0x40000000
s_mov_b32 s11, 1
s_mov_b32 s44, s26
s_mov_b32 s45, s27
s_mul_i32 s52, s48, 1536
s_add_u32 s32, s4, s52
s_addc_u32 s33, s5, 0
s_sub_u32 s53, s20, s52
s_lshl_b32 s51, s48, 2
s_add_u32 s51, s51, s49
s_mul_i32 s52, s51, 196608
s_add_u32 s36, s6, s52
s_addc_u32 s37, s7, 0
s_cmp_lt_u32 s48, 4
s_cselect_b32 s30, 184320, 0
s_cselect_b32 s34, s53, 0
s_cselect_b32 s38, 196608, 0
s_bfe_u32 s51, s2, 0x10001
s_mul_i32 s51, s51, 80
s_lshr_b32 s52, s2, 3
s_add_u32 s51, s51, s52
s_mul_i32 s51, s51, 49152
s_add_u32 s51, s58, s51
s_addc_u32 s52, s59, 0
s_cmp_lt_u32 s48, 4
s_cselect_b32 s36, s36, s51
s_cselect_b32 s37, s37, s52
s_cselect_b32 s38, s38, 49152
s_branch L1_entry
s_nop 7
L1_restart:
s_mul_i32 s52, s48, 1536
s_add_u32 s32, s4, s52
s_addc_u32 s33, s5, 0
s_sub_u32 s53, s20, s52
s_lshl_b32 s51, s48, 2
s_add_u32 s51, s51, s49
s_mul_i32 s52, s51, 196608
s_add_u32 s36, s6, s52
s_addc_u32 s37, s7, 0
s_cmp_lt_u32 s48, 4
s_cselect_b32 s30, 184320, 0
s_cselect_b32 s34, s53, 0
s_cselect_b32 s38, 196608, 0
s_bfe_u32 s51, s2, 0x10001
s_mul_i32 s51, s51, 80
s_lshr_b32 s52, s2, 3
s_add_u32 s51, s51, s52
s_mul_i32 s51, s51, 49152
s_add_u32 s51, s58, s51
s_addc_u32 s52, s59, 0
s_cmp_lt_u32 s48, 4
s_cselect_b32 s36, s36, s51
s_cselect_b32 s37, s37, s52
s_cselect_b32 s38, s38, 49152
s_add_u32 m0, s64, 0
s_add_u32 s57, s16, 0
buffer_load_dwordx4 v9, s[36:39], s57 offen nt lds
s_add_u32 m0, s64, 0
s_nop 0
buffer_load_dwordx4 v10, s[36:39], s57 offen offset:1024 nt lds
s_add_u32 m0, s64, 0
s_nop 0
buffer_load_dwordx4 v11, s[36:39], s57 offen offset:2048 nt lds
s_add_u32 m0, s64, 3136
s_add_u32 s57, s16, 3072
buffer_load_dwordx4 v9, s[36:39], s57 offen nt lds
s_add_u32 m0, s64, 3136
s_nop 0
buffer_load_dwordx4 v10, s[36:39], s57 offen offset:1024 nt lds
s_add_u32 m0, s64, 3136
s_nop 0
buffer_load_dwordx4 v11, s[36:39], s57 offen offset:2048 nt lds
L1_entry:
s_add_u32 s70, s50, s48
s_and_b32 s70, s70, 7
s_mul_i32 s70, s70, 5
s_add_u32 s70, s70, 2
s_lshr_b32 s70, s70, 2
s_and_b32 s71, s49, 3
s_mul_i32 s71, s71, 5
s_lshr_b32 s71, s71, 1
s_add_u32 s70, s70, s71
s_lshl_b32 s70, s70, 7
s_sub_u32 s71, s70, 1280
s_min_u32 s70, s70, s71
s_add_u32 s12, s70, 0
s_sub_u32 s71, s12, 1280
s_min_u32 s12, s12, s71
s_add_u32 m0, s63, 0
s_mul_i32 s56, s12, 6144
buffer_load_dwordx4 v6, s[32:35], s56 offen lds
s_add_u32 m0, s63, 0
s_nop 0
buffer_load_dwordx4 v7, s[32:35], s56 offen offset:1024 lds
s_add_u32 m0, s63, 0
s_nop 0
buffer_load_dwordx4 v8, s[32:35], s56 offen offset:2048 lds
s_add_u32 m0, s62, 36864
s_mov_b32 exec_hi, 0
buffer_load_dwordx4 v1, s[28:31], s12 offen lds
s_mov_b32 exec_hi, -1
s_add_u32 m0, s62, 36864
s_nop 0
buffer_load_dwordx4 v2, s[28:31], s12 offen offset:512 lds
s_add_u32 m0, s62, 36864
s_nop 0
buffer_load_dwordx4 v3, s[28:31], s12 offen offset:1536 lds
s_add_u32 m0, s62, 36864
s_nop 0
buffer_load_dwordx4 v4, s[28:31], s12 offen offset:2560 lds
s_add_u32 m0, s62, 36864
s_nop 0
buffer_load_dwordx4 v5, s[28:31], s12 offen offset:3584 lds
s_add_u32 m0, s63, 12288
s_mul_i32 s56, s12, 6144
s_add_u32 s56, s56, 393216
buffer_load_dwordx4 v6, s[32:35], s56 offen lds
s_add_u32 m0, s63, 12288
s_nop 0
buffer_load_dwordx4 v7, s[32:35], s56 offen offset:1024 lds
s_add_u32 m0, s63, 12288
s_nop 0
buffer_load_dwordx4 v8, s[32:35], s56 offen offset:2048 lds
s_add_u32 s13, s70, 128
s_sub_u32 s71, s13, 1280
s_min_u32 s13, s13, s71
s_add_u32 s22, s70, 256
s_sub_u32 s71, s22, 1280
s_min_u32 s22, s22, s71
s_add_u32 s23, s70, 384
s_sub_u32 s71, s23, 1280
s_min_u32 s23, s23, s71
s_add_u32 s24, s70, 512
s_sub_u32 s71, s24, 1280
s_min_u32 s24, s24, s71
s_add_u32 s25, s70, 640
s_sub_u32 s71, s25, 1280
s_min_u32 s25, s25, s71
s_add_u32 s55, s70, 768
s_sub_u32 s71, s55, 1280
s_min_u32 s55, s55, s71
s_add_u32 s60, s70, 896
s_sub_u32 s71, s60, 1280
s_min_u32 s60, s60, s71
s_add_u32 s61, s70, 1024
s_sub_u32 s71, s61, 1280
s_min_u32 s61, s61, s71
s_add_u32 s69, s70, 1152
s_sub_u32 s71, s69, 1280
s_min_u32 s69, s69, s71
s_add_u32 m0, s62, 0
s_mov_b32 exec_hi, 0
buffer_load_dwordx4 v1, s[28:31], s13 offen lds
s_mov_b32 exec_hi, -1
s_add_u32 m0, s62, 0
s_nop 0
buffer_load_dwordx4 v2, s[28:31], s13 offen offset:512 lds
s_add_u32 m0, s62, 0
s_nop 0
buffer_load_dwordx4 v3, s[28:31], s13 offen offset:1536 lds
s_add_u32 m0, s62, 0
s_nop 0
buffer_load_dwordx4 v4, s[28:31], s13 offen offset:2560 lds
s_add_u32 m0, s62, 0
s_nop 0
buffer_load_dwordx4 v5, s[28:31], s13 offen offset:3584 lds
s_add_u32 m0, s64, 24832
s_add_u32 s57, s16, 24576
buffer_load_dwordx4 v9, s[36:39], s57 offen nt lds
s_add_u32 m0, s64, 24832
s_nop 0
buffer_load_dwordx4 v10, s[36:39], s57 offen offset:1024 nt lds
s_add_u32 m0, s64, 24832
s_nop 0
buffer_load_dwordx4 v11, s[36:39], s57 offen offset:2048 nt lds
s_add_u32 m0, s64, 27968
s_add_u32 s57, s16, 27648
buffer_load_dwordx4 v9, s[36:39], s57 offen nt lds
s_add_u32 m0, s64, 27968
s_nop 0
buffer_load_dwordx4 v10, s[36:39], s57 offen offset:1024 nt lds
s_add_u32 m0, s64, 27968
s_nop 0
buffer_load_dwordx4 v11, s[36:39], s57 offen offset:2048 nt lds
s_add_u32 m0, s63, 24576
s_mul_i32 s56, s13, 6144
buffer_load_dwordx4 v6, s[32:35], s56 offen lds
s_add_u32 m0, s63, 24576
s_nop 0
buffer_load_dwordx4 v7, s[32:35], s56 offen offset:1024 lds
s_add_u32 m0, s63, 24576
s_nop 0
buffer_load_dwordx4 v8, s[32:35], s56 offen offset:2048 lds
s_add_u32 m0, s63, 36864
s_mul_i32 s56, s13, 6144
s_add_u32 s56, s56, 393216
buffer_load_dwordx4 v6, s[32:35], s56 offen lds
s_add_u32 m0, s63, 36864
s_nop 0
buffer_load_dwordx4 v7, s[32:35], s56 offen offset:1024 lds
s_add_u32 m0, s63, 36864
s_nop 0
buffer_load_dwordx4 v8, s[32:35], s56 offen offset:2048 lds
s_mov_b32 s54, s19
s_mov_b32 s19, 0
v_mov_b32 v56, 0xff800000
v_mov_b32 v57, 0xff800000
v_mov_b32 v58, 0xff800000
v_mov_b32 v59, 0xff800000
v_add_u32 v60, s19, v27
ds_write_b128 v60, v[56:59]
ds_write_b128 v60, v[56:59] offset:16
ds_write_b128 v60, v[56:59] offset:32
s_mov_b32 s19, s54
s_add_u32 s44, s26, 100663296
s_addc_u32 s45, s27, 0
s_mov_b32 s46, 65536
s_and_b32 s51, s2, 7
s_lshl_b32 s51, s51, 5
s_lshr_b32 s52, s2, 3
s_add_u32 s51, s51, s52
s_lshl_b32 s51, s51, 7
v_mov_b32 v69, 0
s_mov_b64 exec, 1
buffer_store_dword v69, v69, s[44:47], s51 offen sc1
s_mov_b64 exec, -1
s_mov_b32 s46, 0
s_waitcnt vmcnt(29)
ds_read_b128 a[24:27], v23
ds_read_b128 a[28:31], v23 offset:64
ds_read_b128 a[32:35], v23 offset:128
ds_read_b128 a[36:39], v23 offset:192
ds_read_b128 a[40:43], v23 offset:256
ds_read_b128 a[44:47], v23 offset:320
s_waitcnt vmcnt(21) lgkmcnt(0)
s_barrier
ds_read_b64_tr_b16 v[172:173], v17
ds_read_b64_tr_b16 v[174:175], v17 offset:1536
ds_read_b64_tr_b16 v[176:177], v18
ds_read_b64_tr_b16 v[178:179], v18 offset:1536
ds_read_b64_tr_b16 v[180:181], v19
ds_read_b64_tr_b16 v[182:183], v19 offset:1536
ds_read_b128 v[196:199], v15 offset:36864
ds_read_b128 v[200:203], v15 offset:38912
ds_read_b128 v[204:207], v15 offset:40960
ds_read_b128 v[208:211], v15 offset:43008
ds_read_b128 v[212:215], v15 offset:45056
ds_read_b128 v[216:219], v15 offset:47104
ds_read_b128 v[220:223], v15 offset:49152
ds_read_b128 v[224:227], v15 offset:51200
ds_read_b128 v[228:231], v15 offset:53248
s_nop 7
.p2align 3
L1_loop:
s_lshl_b32 s51, s48, 2
s_add_u32 s51, s51, s49
s_mul_i32 s52, s51, 196608
s_add_u32 s40, s8, s52
s_addc_u32 s41, s9, 0
s_mov_b32 s17, s16
s_waitcnt vmcnt(18) lgkmcnt(9)
s_barrier
s_waitcnt lgkmcnt(8)
v_mfma_f32_16x16x32_bf16 v[64:67], v[172:175], v[196:199], 0
ds_read_b64_tr_b16 v[184:185], v17 offset:12288
ds_read_b64_tr_b16 v[186:187], v17 offset:13824
v_accvgpr_read_b32 v60, a244
v_accvgpr_read_b32 v61, a245
v_mfma_f32_16x16x32_bf16 v[100:103], v[176:179], v[196:199], 0
s_add_u32 m0, s63, 0
s_mul_i32 s56, s22, 6144
buffer_load_dwordx4 v6, s[32:35], s56 offen lds
v_accvgpr_read_b32 v62, a246
v_mfma_f32_16x16x32_bf16 v[136:139], v[180:183], v[196:199], 0
s_waitcnt lgkmcnt(9)
ds_read_b64_tr_b16 v[188:189], v18 offset:12288
ds_read_b64_tr_b16 v[190:191], v18 offset:13824
v_accvgpr_read_b32 v63, a247
v_mfma_f32_16x16x32_bf16 v[68:71], v[172:175], v[200:203], 0
buffer_load_dwordx4 v7, s[32:35], s56 offen offset:1024 lds
v_mul_f32 v60, v60, v52
v_mfma_f32_16x16x32_bf16 v[104:107], v[176:179], v[200:203], 0
ds_read_b64_tr_b16 v[192:193], v19 offset:12288
ds_read_b64_tr_b16 v[194:195], v19 offset:13824
v_mul_f32 v61, v61, v52
v_mul_f32 v62, v62, v52
s_waitcnt vmcnt(8)
v_mfma_f32_16x16x32_bf16 v[140:143], v[180:183], v[200:203], 0
s_waitcnt lgkmcnt(12)
buffer_load_dwordx4 v8, s[32:35], s56 offen offset:2048 lds
v_mfma_f32_16x16x32_bf16 v[72:75], v[172:175], v[204:207], 0
ds_read_b128 v[232:235], v16 offset:36864
v_mul_f32 v63, v63, v52
v_cvt_pk_bf16_f32 v56, v60, v61
v_mfma_f32_16x16x32_bf16 v[108:111], v[176:179], v[204:207], 0
s_add_u32 m0, s62, 18432
s_mov_b32 exec_hi, 0
buffer_load_dwordx4 v1, s[28:31], s22 offen lds
s_mov_b32 exec_hi, -1
v_cvt_pk_bf16_f32 v57, v62, v63
v_mfma_f32_16x16x32_bf16 v[144:147], v[180:183], v[204:207], 0
s_waitcnt lgkmcnt(12)
ds_read_b128 v[236:239], v16 offset:38912
v_accvgpr_read_b32 v60, a248
v_accvgpr_read_b32 v61, a249
v_mfma_f32_16x16x32_bf16 v[76:79], v[172:175], v[208:211], 0
buffer_load_dwordx4 v2, s[28:31], s22 offen offset:512 lds
v_accvgpr_read_b32 v62, a250
v_mfma_f32_16x16x32_bf16 v[112:115], v[176:179], v[208:211], 0
ds_read_b128 v[240:243], v16 offset:40960
v_accvgpr_read_b32 v63, a251
v_mul_f32 v60, v60, v52
v_mfma_f32_16x16x32_bf16 v[148:151], v[180:183], v[208:211], 0
s_waitcnt lgkmcnt(13)
buffer_load_dwordx4 v3, s[28:31], s22 offen offset:1536 lds
v_mul_f32 v61, v61, v52
v_mfma_f32_16x16x32_bf16 v[80:83], v[172:175], v[212:215], 0
ds_read_b128 v[244:247], v16 offset:43008
v_mul_f32 v62, v62, v52
v_mul_f32 v63, v63, v52
v_cvt_pk_bf16_f32 v58, v60, v61
v_mfma_f32_16x16x32_bf16 v[116:119], v[176:179], v[212:215], 0
ds_read_b128 v[248:251], v16 offset:45056
v_cvt_pk_bf16_f32 v59, v62, v63
v_accvgpr_read_b32 v60, a252
v_mfma_f32_16x16x32_bf16 v[152:155], v[180:183], v[212:215], 0
s_waitcnt lgkmcnt(14)
s_add_u32 m0, s64, 0
s_add_u32 s57, s16, 49152
buffer_load_dwordx4 v9, s[36:39], s57 offen nt lds
v_accvgpr_read_b32 v61, a253
v_mfma_f32_16x16x32_bf16 v[84:87], v[172:175], v[216:219], 0
ds_read_b128 v[252:255], v16 offset:47104
v_accvgpr_read_b32 v62, a254
v_accvgpr_read_b32 v63, a255
v_mul_f32 v60, v60, v52
v_mfma_f32_16x16x32_bf16 v[120:123], v[176:179], v[216:219], 0
buffer_load_dwordx4 v10, s[36:39], s57 offen offset:1024 nt lds
v_mul_f32 v61, v61, v52
v_mfma_f32_16x16x32_bf16 v[156:159], v[180:183], v[216:219], 0
s_waitcnt lgkmcnt(14)
ds_read_b128 v[196:199], v16 offset:49152
v_mul_f32 v62, v62, v52
v_mul_f32 v63, v63, v52
v_cvt_pk_bf16_f32 v40, v60, v61
v_cvt_pk_bf16_f32 v41, v62, v63
v_mfma_f32_16x16x32_bf16 v[88:91], v[172:175], v[220:223], 0
buffer_load_dwordx4 v11, s[36:39], s57 offen offset:2048 nt lds
v_accvgpr_write_b32 a252, v56
v_mfma_f32_16x16x32_bf16 v[124:127], v[176:179], v[220:223], 0
ds_read_b128 v[200:203], v16 offset:51200
v_accvgpr_write_b32 a253, v57
v_accvgpr_write_b32 a254, v58
v_accvgpr_write_b32 a255, v59
v_mfma_f32_16x16x32_bf16 v[160:163], v[180:183], v[220:223], 0
s_waitcnt lgkmcnt(15)
s_add_u32 m0, s64, 3136
s_add_u32 s57, s16, 52224
buffer_load_dwordx4 v9, s[36:39], s57 offen nt lds
v_mfma_f32_16x16x32_bf16 v[92:95], v[172:175], v[224:227], 0
ds_read_b128 v[204:207], v16 offset:53248
ds_write_b64 v0, v[40:41]
ds_write_b64 v0, v[40:41] offset:1024
v_mfma_f32_16x16x32_bf16 v[128:131], v[176:179], v[224:227], 0
buffer_load_dwordx4 v10, s[36:39], s57 offen offset:1024 nt lds
v_mfma_f32_16x16x32_bf16 v[164:167], v[180:183], v[224:227], 0
s_waitcnt lgkmcnt(15)
v_mfma_f32_16x16x32_bf16 v[96:99], v[172:175], v[228:231], 0
buffer_load_dwordx4 v11, s[36:39], s57 offen offset:2048 nt lds
v_mfma_f32_16x16x32_bf16 v[132:135], v[176:179], v[228:231], 0
v_mfma_f32_16x16x32_bf16 v[168:171], v[180:183], v[228:231], 0
s_waitcnt vmcnt(15) lgkmcnt(0)
s_barrier
v_mfma_f32_16x16x32_bf16 v[64:67], v[184:187], v[232:235], v[64:67]
ds_read_b64_tr_b16 v[172:173], v17 offset:24576
v_mfma_f32_16x16x32_bf16 v[100:103], v[188:191], v[232:235], v[100:103]
s_add_u32 m0, s63, 12288
s_mul_i32 s56, s22, 6144
s_add_u32 s56, s56, 393216
buffer_load_dwordx4 v6, s[32:35], s56 offen lds
v_mfma_f32_16x16x32_bf16 v[136:139], v[192:195], v[232:235], v[136:139]
ds_read_b64_tr_b16 v[174:175], v17 offset:26112
v_mfma_f32_16x16x32_bf16 v[68:71], v[184:187], v[236:239], v[68:71]
ds_read_b64_tr_b16 v[176:177], v18 offset:24576
v_mfma_f32_16x16x32_bf16 v[104:107], v[188:191], v[236:239], v[104:107]
ds_read_b64_tr_b16 v[178:179], v18 offset:26112
v_mfma_f32_16x16x32_bf16 v[140:143], v[192:195], v[236:239], v[140:143]
ds_read_b64_tr_b16 v[180:181], v19 offset:24576
v_mfma_f32_16x16x32_bf16 v[72:75], v[184:187], v[240:243], v[72:75]
buffer_load_dwordx4 v7, s[32:35], s56 offen offset:1024 lds
v_mfma_f32_16x16x32_bf16 v[108:111], v[188:191], v[240:243], v[108:111]
ds_read_b64_tr_b16 v[182:183], v19 offset:26112
v_mfma_f32_16x16x32_bf16 v[144:147], v[192:195], v[240:243], v[144:147]
ds_read_b128 v[208:211], v15
v_mfma_f32_16x16x32_bf16 v[76:79], v[184:187], v[244:247], v[76:79]
ds_read_b128 v[212:215], v15 offset:2048
v_mfma_f32_16x16x32_bf16 v[112:115], v[188:191], v[244:247], v[112:115]
ds_read_b128 v[216:219], v15 offset:4096
v_mfma_f32_16x16x32_bf16 v[148:151], v[192:195], v[244:247], v[148:151]
buffer_load_dwordx4 v8, s[32:35], s56 offen offset:2048 lds
v_mfma_f32_16x16x32_bf16 v[80:83], v[184:187], v[248:251], v[80:83]
ds_read_b128 v[220:223], v15 offset:6144
v_mfma_f32_16x16x32_bf16 v[116:119], v[188:191], v[248:251], v[116:119]
ds_read_b128 v[224:227], v15 offset:8192
v_mfma_f32_16x16x32_bf16 v[152:155], v[192:195], v[248:251], v[152:155]
ds_read_b128 v[228:231], v15 offset:10240
v_mfma_f32_16x16x32_bf16 v[84:87], v[184:187], v[252:255], v[84:87]
s_add_u32 m0, s62, 18432
ds_read_b128 v[232:235], v15 offset:12288
v_mfma_f32_16x16x32_bf16 v[120:123], v[188:191], v[252:255], v[120:123]
buffer_load_dwordx4 v4, s[28:31], s22 offen offset:2560 lds
v_mfma_f32_16x16x32_bf16 v[156:159], v[192:195], v[252:255], v[156:159]
ds_read_b128 v[236:239], v15 offset:14336
v_mfma_f32_16x16x32_bf16 v[88:91], v[184:187], v[196:199], v[88:91]
ds_read_b128 v[240:243], v15 offset:16384
v_mfma_f32_16x16x32_bf16 v[124:127], v[188:191], v[196:199], v[124:127]
ds_read_b128 a[248:251], v55
v_mfma_f32_16x16x32_bf16 v[160:163], v[192:195], v[196:199], v[160:163]
v_mfma_f32_16x16x32_bf16 v[92:95], v[184:187], v[200:203], v[92:95]
buffer_load_dwordx4 v5, s[28:31], s22 offen offset:3584 lds
v_mfma_f32_16x16x32_bf16 v[128:131], v[188:191], v[200:203], v[128:131]
v_mfma_f32_16x16x32_bf16 v[164:167], v[192:195], v[200:203], v[164:167]
v_mfma_f32_16x16x32_bf16 v[96:99], v[184:187], v[204:207], v[96:99]
v_mfma_f32_16x16x32_bf16 v[132:135], v[188:191], v[204:207], v[132:135]
v_mfma_f32_16x16x32_bf16 v[168:171], v[192:195], v[204:207], v[168:171]
s_waitcnt vmcnt(17) lgkmcnt(0)
s_barrier
v_mfma_f32_16x16x32_bf16 v[64:67], v[172:175], v[208:211], v[64:67]
ds_read_b64_tr_b16 v[184:185], v17 offset:36864
v_accvgpr_read_b32 v36, a232
v_accvgpr_read_b32 v37, a233
v_mfma_f32_16x16x32_bf16 v[100:103], v[176:179], v[208:211], v[100:103]
s_add_u32 m0, s63, 24576
s_mul_i32 s56, s23, 6144
buffer_load_dwordx4 v6, s[32:35], s56 offen lds
v_mfma_f32_16x16x32_bf16 v[136:139], v[180:183], v[208:211], v[136:139]
ds_read_b64_tr_b16 v[186:187], v17 offset:38400
v_accvgpr_read_b32 v38, a234
v_mfma_f32_16x16x32_bf16 v[68:71], v[172:175], v[212:215], v[68:71]
ds_read_b64_tr_b16 v[188:189], v18 offset:36864
v_accvgpr_read_b32 v39, a235
v_mul_f32 v36, v36, v51
v_mfma_f32_16x16x32_bf16 v[104:107], v[176:179], v[212:215], v[104:107]
ds_read_b64_tr_b16 v[190:191], v18 offset:38400
v_mul_f32 v37, v37, v51
v_mfma_f32_16x16x32_bf16 v[140:143], v[180:183], v[212:215], v[140:143]
buffer_load_dwordx4 v7, s[32:35], s56 offen offset:1024 lds
v_mfma_f32_16x16x32_bf16 v[72:75], v[172:175], v[216:219], v[72:75]
ds_read_b64_tr_b16 v[192:193], v19 offset:36864
v_mul_f32 v38, v38, v51
v_mul_f32 v39, v39, v51
v_mfma_f32_16x16x32_bf16 v[108:111], v[176:179], v[216:219], v[108:111]
ds_read_b64_tr_b16 v[194:195], v19 offset:38400
v_cvt_pk_bf16_f32 v32, v36, v37
v_mfma_f32_16x16x32_bf16 v[144:147], v[180:183], v[216:219], v[144:147]
ds_read_b128 v[244:247], v16
v_cvt_pk_bf16_f32 v33, v38, v39
v_mfma_f32_16x16x32_bf16 v[76:79], v[172:175], v[220:223], v[76:79]
buffer_load_dwordx4 v8, s[32:35], s56 offen offset:2048 lds
v_accvgpr_read_b32 v36, a236
v_mfma_f32_16x16x32_bf16 v[112:115], v[176:179], v[220:223], v[112:115]
ds_read_b128 v[248:251], v16 offset:2048
v_accvgpr_read_b32 v37, a237
v_mfma_f32_16x16x32_bf16 v[148:151], v[180:183], v[220:223], v[148:151]
ds_read_b128 v[252:255], v16 offset:4096
v_accvgpr_read_b32 v38, a238
v_accvgpr_read_b32 v39, a239
v_mfma_f32_16x16x32_bf16 v[80:83], v[172:175], v[224:227], v[80:83]
ds_read_b128 v[196:199], v16 offset:6144
v_mul_f32 v36, v36, v51
v_mfma_f32_16x16x32_bf16 v[116:119], v[176:179], v[224:227], v[116:119]
ds_read_b128 v[200:203], v16 offset:8192
v_mul_f32 v37, v37, v51
v_mfma_f32_16x16x32_bf16 v[152:155], v[180:183], v[224:227], v[152:155]
s_add_u32 m0, s62, 36864
s_mov_b32 exec_hi, 0
buffer_load_dwordx4 v1, s[28:31], s23 offen lds
s_mov_b32 exec_hi, -1
v_mul_f32 v38, v38, v51
v_mfma_f32_16x16x32_bf16 v[84:87], v[172:175], v[228:231], v[84:87]
ds_read_b128 v[204:207], v16 offset:10240
v_mul_f32 v39, v39, v51
v_mfma_f32_16x16x32_bf16 v[120:123], v[176:179], v[228:231], v[120:123]
ds_read_b128 v[208:211], v16 offset:12288
v_cvt_pk_bf16_f32 v34, v36, v37
v_cvt_pk_bf16_f32 v35, v38, v39
v_mfma_f32_16x16x32_bf16 v[156:159], v[180:183], v[228:231], v[156:159]
ds_read_b128 v[212:215], v16 offset:14336
v_accvgpr_read_b32 v36, a240
v_mfma_f32_16x16x32_bf16 v[88:91], v[172:175], v[232:235], v[88:91]
buffer_load_dwordx4 v2, s[28:31], s23 offen offset:512 lds
v_accvgpr_read_b32 v37, a241
v_mfma_f32_16x16x32_bf16 v[124:127], v[176:179], v[232:235], v[124:127]
ds_read_b128 v[216:219], v16 offset:16384
v_accvgpr_read_b32 v38, a242
v_mfma_f32_16x16x32_bf16 v[160:163], v[180:183], v[232:235], v[160:163]
ds_read_b128 a[48:51], v23 offset:24832
v_accvgpr_read_b32 v39, a243
v_mul_f32 v36, v36, v51
v_mfma_f32_16x16x32_bf16 v[92:95], v[172:175], v[236:239], v[92:95]
ds_read_b128 a[52:55], v23 offset:24896
v_mul_f32 v37, v37, v51
v_mfma_f32_16x16x32_bf16 v[128:131], v[176:179], v[236:239], v[128:131]
buffer_load_dwordx4 v3, s[28:31], s23 offen offset:1536 lds
v_mul_f32 v38, v38, v51
v_mfma_f32_16x16x32_bf16 v[164:167], v[180:183], v[236:239], v[164:167]
ds_read_b128 a[56:59], v23 offset:24960
v_mul_f32 v39, v39, v51
v_mfma_f32_16x16x32_bf16 v[96:99], v[172:175], v[240:243], v[96:99]
ds_read_b128 a[60:63], v23 offset:25024
v_cvt_pk_bf16_f32 v42, v36, v37
v_cvt_pk_bf16_f32 v43, v38, v39
v_mfma_f32_16x16x32_bf16 v[132:135], v[176:179], v[240:243], v[132:135]
ds_read_b128 a[64:67], v23 offset:25088
v_accvgpr_write_b32 a244, v32
v_accvgpr_write_b32 a245, v33
v_mfma_f32_16x16x32_bf16 v[168:171], v[180:183], v[240:243], v[168:171]
ds_read_b128 a[68:71], v23 offset:25152
v_accvgpr_write_b32 a246, v34
s_waitcnt vmcnt(6) lgkmcnt(15)
s_barrier
s_waitcnt lgkmcnt(14)
v_mfma_f32_16x16x32_bf16 v[64:67], v[184:187], v[244:247], v[64:67]
ds_read_b64_tr_b16 v[172:173], v17
ds_read_b64_tr_b16 v[174:175], v17 offset:1536
v_accvgpr_write_b32 a247, v35
v_accvgpr_read_b32 v60, a220
v_mfma_f32_16x16x32_bf16 v[100:103], v[188:191], v[244:247], v[100:103]
s_add_u32 m0, s63, 36864
s_mul_i32 s56, s23, 6144
s_add_u32 s56, s56, 393216
buffer_load_dwordx4 v6, s[32:35], s56 offen lds
v_accvgpr_read_b32 v61, a221
v_mfma_f32_16x16x32_bf16 v[136:139], v[192:195], v[244:247], v[136:139]
s_waitcnt lgkmcnt(15)
ds_read_b64_tr_b16 v[176:177], v18
ds_read_b64_tr_b16 v[178:179], v18 offset:1536
v_accvgpr_read_b32 v62, a222
v_mfma_f32_16x16x32_bf16 v[68:71], v[184:187], v[248:251], v[68:71]
buffer_load_dwordx4 v7, s[32:35], s56 offen offset:1024 lds
v_accvgpr_read_b32 v63, a223
v_mfma_f32_16x16x32_bf16 v[104:107], v[188:191], v[248:251], v[104:107]
ds_read_b64_tr_b16 v[180:181], v19
ds_read_b64_tr_b16 v[182:183], v19 offset:1536
v_mul_f32 v60, v60, v50
v_mul_f32 v61, v61, v50
v_mfma_f32_16x16x32_bf16 v[140:143], v[192:195], v[248:251], v[140:143]
s_waitcnt lgkmcnt(15)
buffer_load_dwordx4 v8, s[32:35], s56 offen offset:2048 lds
v_mfma_f32_16x16x32_bf16 v[72:75], v[184:187], v[252:255], v[72:75]
ds_read_b128 v[220:223], v15 offset:18432
v_mul_f32 v62, v62, v50
v_mul_f32 v63, v63, v50
v_mfma_f32_16x16x32_bf16 v[108:111], v[188:191], v[252:255], v[108:111]
s_add_u32 m0, s62, 36864
ds_read_b128 v[224:227], v15 offset:20480
v_cvt_pk_bf16_f32 v56, v60, v61
v_cvt_pk_bf16_f32 v57, v62, v63
v_mfma_f32_16x16x32_bf16 v[144:147], v[192:195], v[252:255], v[144:147]
buffer_load_dwordx4 v4, s[28:31], s23 offen offset:2560 lds
v_accvgpr_read_b32 v60, a224
v_mfma_f32_16x16x32_bf16 v[76:79], v[184:187], v[196:199], v[76:79]
ds_read_b128 v[228:231], v15 offset:22528
v_accvgpr_read_b32 v61, a225
v_accvgpr_read_b32 v62, a226
v_mfma_f32_16x16x32_bf16 v[112:115], v[188:191], v[196:199], v[112:115]
buffer_load_dwordx4 v5, s[28:31], s23 offen offset:3584 lds
v_accvgpr_read_b32 v63, a227
v_mfma_f32_16x16x32_bf16 v[148:151], v[192:195], v[196:199], v[148:151]
ds_read_b128 v[232:235], v15 offset:24576
v_mul_f32 v60, v60, v50
v_mul_f32 v61, v61, v50
v_mfma_f32_16x16x32_bf16 v[80:83], v[184:187], v[200:203], v[80:83]
s_waitcnt lgkmcnt(10)
s_add_u32 m0, s64, 24832
s_add_u32 s57, s16, 73728
buffer_load_dwordx4 v9, s[36:39], s57 offen nt lds
v_mul_f32 v62, v62, v50
v_mfma_f32_16x16x32_bf16 v[116:119], v[188:191], v[200:203], v[116:119]
ds_read_b128 v[236:239], v15 offset:26624
v_mul_f32 v63, v63, v50
v_cvt_pk_bf16_f32 v58, v60, v61
v_cvt_pk_bf16_f32 v59, v62, v63
v_mfma_f32_16x16x32_bf16 v[152:155], v[192:195], v[200:203], v[152:155]
ds_read_b128 v[240:243], v15 offset:28672
v_accvgpr_read_b32 v60, a228
v_accvgpr_read_b32 v61, a229
v_mfma_f32_16x16x32_bf16 v[84:87], v[184:187], v[204:207], v[84:87]
buffer_load_dwordx4 v10, s[36:39], s57 offen offset:1024 nt lds
v_accvgpr_read_b32 v62, a230
v_mfma_f32_16x16x32_bf16 v[120:123], v[188:191], v[204:207], v[120:123]
ds_read_b128 v[244:247], v15 offset:30720
v_accvgpr_read_b32 v63, a231
v_mul_f32 v60, v60, v50
v_mul_f32 v61, v61, v50
v_mfma_f32_16x16x32_bf16 v[156:159], v[192:195], v[204:207], v[156:159]
buffer_load_dwordx4 v11, s[36:39], s57 offen offset:2048 nt lds
v_mul_f32 v62, v62, v50
v_mul_f32 v63, v63, v50
v_mfma_f32_16x16x32_bf16 v[88:91], v[184:187], v[208:211], v[88:91]
ds_read_b128 v[248:251], v15 offset:32768
v_cvt_pk_bf16_f32 v40, v60, v61
v_cvt_pk_bf16_f32 v41, v62, v63
v_accvgpr_write_b32 a240, v56
v_mfma_f32_16x16x32_bf16 v[124:127], v[188:191], v[208:211], v[124:127]
s_add_u32 m0, s64, 27968
s_add_u32 s57, s16, 76800
buffer_load_dwordx4 v9, s[36:39], s57 offen nt lds
v_accvgpr_write_b32 a241, v57
v_accvgpr_write_b32 a242, v58
v_accvgpr_write_b32 a243, v59
v_mfma_f32_16x16x32_bf16 v[160:163], v[192:195], v[208:211], v[160:163]
ds_read_b128 v[252:255], v15 offset:34816
v_mfma_f32_16x16x32_bf16 v[92:95], v[184:187], v[212:215], v[92:95]
ds_write_b64 v0, v[42:43] offset:1024
ds_write_b64 v0, v[40:41]
v_mfma_f32_16x16x32_bf16 v[128:131], v[188:191], v[212:215], v[128:131]
buffer_load_dwordx4 v10, s[36:39], s57 offen offset:1024 nt lds
v_mfma_f32_16x16x32_bf16 v[164:167], v[192:195], v[212:215], v[164:167]
v_mfma_f32_16x16x32_bf16 v[96:99], v[184:187], v[216:219], v[96:99]
buffer_load_dwordx4 v11, s[36:39], s57 offen offset:2048 nt lds
v_mfma_f32_16x16x32_bf16 v[132:135], v[188:191], v[216:219], v[132:135]
v_mfma_f32_16x16x32_bf16 v[168:171], v[192:195], v[216:219], v[168:171]
s_waitcnt lgkmcnt(0)
s_barrier
v_mfma_f32_16x16x32_bf16 v[64:67], v[172:175], v[220:223], v[64:67]
ds_read_b64_tr_b16 v[184:185], v17 offset:12288
v_mfma_f32_16x16x32_bf16 v[100:103], v[176:179], v[220:223], v[100:103]
s_add_u32 m0, s63, 0
s_mul_i32 s56, s24, 6144
buffer_load_dwordx4 v6, s[32:35], s56 offen lds
v_mfma_f32_16x16x32_bf16 v[136:139], v[180:183], v[220:223], v[136:139]
ds_read_b64_tr_b16 v[186:187], v17 offset:13824
v_mfma_f32_16x16x32_bf16 v[68:71], v[172:175], v[224:227], v[68:71]
ds_read_b64_tr_b16 v[188:189], v18 offset:12288
v_mfma_f32_16x16x32_bf16 v[104:107], v[176:179], v[224:227], v[104:107]
ds_read_b64_tr_b16 v[190:191], v18 offset:13824
v_mfma_f32_16x16x32_bf16 v[140:143], v[180:183], v[224:227], v[140:143]
buffer_load_dwordx4 v7, s[32:35], s56 offen offset:1024 lds
v_mfma_f32_16x16x32_bf16 v[72:75], v[172:175], v[228:231], v[72:75]
ds_read_b64_tr_b16 v[192:193], v19 offset:12288
v_mfma_f32_16x16x32_bf16 v[108:111], v[176:179], v[228:231], v[108:111]
ds_read_b64_tr_b16 v[194:195], v19 offset:13824
v_mfma_f32_16x16x32_bf16 v[144:147], v[180:183], v[228:231], v[144:147]
ds_read_b128 v[196:199], v16 offset:18432
v_mfma_f32_16x16x32_bf16 v[76:79], v[172:175], v[232:235], v[76:79]
buffer_load_dwordx4 v8, s[32:35], s56 offen offset:2048 lds
v_mfma_f32_16x16x32_bf16 v[112:115], v[176:179], v[232:235], v[112:115]
ds_read_b128 v[200:203], v16 offset:20480
v_mfma_f32_16x16x32_bf16 v[148:151], v[180:183], v[232:235], v[148:151]
ds_read_b128 v[204:207], v16 offset:22528
v_mfma_f32_16x16x32_bf16 v[80:83], v[172:175], v[236:239], v[80:83]
ds_read_b128 v[208:211], v16 offset:24576
v_mfma_f32_16x16x32_bf16 v[116:119], v[176:179], v[236:239], v[116:119]
ds_read_b128 v[212:215], v16 offset:26624
v_mfma_f32_16x16x32_bf16 v[152:155], v[180:183], v[236:239], v[152:155]
s_add_u32 m0, s62, 0
s_mov_b32 exec_hi, 0
buffer_load_dwordx4 v1, s[28:31], s24 offen lds
s_mov_b32 exec_hi, -1
v_mfma_f32_16x16x32_bf16 v[84:87], v[172:175], v[240:243], v[84:87]
ds_read_b128 v[216:219], v16 offset:28672
v_mfma_f32_16x16x32_bf16 v[120:123], v[176:179], v[240:243], v[120:123]
ds_read_b128 v[220:223], v16 offset:30720
v_mfma_f32_16x16x32_bf16 v[156:159], v[180:183], v[240:243], v[156:159]
ds_read_b128 v[224:227], v16 offset:32768
v_mfma_f32_16x16x32_bf16 v[88:91], v[172:175], v[244:247], v[88:91]
buffer_load_dwordx4 v2, s[28:31], s24 offen offset:512 lds
v_mfma_f32_16x16x32_bf16 v[124:127], v[176:179], v[244:247], v[124:127]
ds_read_b128 v[228:231], v16 offset:34816
v_mfma_f32_16x16x32_bf16 v[160:163], v[180:183], v[244:247], v[160:163]
ds_read_b128 a[236:239], v55
v_mfma_f32_16x16x32_bf16 v[92:95], v[172:175], v[248:251], v[92:95]
v_mfma_f32_16x16x32_bf16 v[128:131], v[176:179], v[248:251], v[128:131]
buffer_load_dwordx4 v3, s[28:31], s24 offen offset:1536 lds
v_mfma_f32_16x16x32_bf16 v[164:167], v[180:183], v[248:251], v[164:167]
v_mfma_f32_16x16x32_bf16 v[96:99], v[172:175], v[252:255], v[96:99]
v_mfma_f32_16x16x32_bf16 v[132:135], v[176:179], v[252:255], v[132:135]
v_mfma_f32_16x16x32_bf16 v[168:171], v[180:183], v[252:255], v[168:171]
s_waitcnt vmcnt(12) lgkmcnt(0)
s_barrier
v_mfma_f32_16x16x32_bf16 v[64:67], v[184:187], v[196:199], v[64:67]
ds_read_b64_tr_b16 v[172:173], v17 offset:24576
v_accvgpr_read_b32 v36, a208
v_accvgpr_read_b32 v37, a209
v_mfma_f32_16x16x32_bf16 v[100:103], v[188:191], v[196:199], v[100:103]
s_add_u32 m0, s63, 12288
s_mul_i32 s56, s24, 6144
s_add_u32 s56, s56, 393216
buffer_load_dwordx4 v6, s[32:35], s56 offen lds
v_mfma_f32_16x16x32_bf16 v[136:139], v[192:195], v[196:199], v[136:139]
ds_read_b64_tr_b16 v[174:175], v17 offset:26112
v_accvgpr_read_b32 v38, a210
v_mfma_f32_16x16x32_bf16 v[68:71], v[184:187], v[200:203], v[68:71]
ds_read_b64_tr_b16 v[176:177], v18 offset:24576
v_accvgpr_read_b32 v39, a211
v_mul_f32 v36, v36, v49
v_mfma_f32_16x16x32_bf16 v[104:107], v[188:191], v[200:203], v[104:107]
ds_read_b64_tr_b16 v[178:179], v18 offset:26112
v_mul_f32 v37, v37, v49
v_mfma_f32_16x16x32_bf16 v[140:143], v[192:195], v[200:203], v[140:143]
ds_read_b64_tr_b16 v[180:181], v19 offset:24576
v_mul_f32 v38, v38, v49
v_mfma_f32_16x16x32_bf16 v[72:75], v[184:187], v[204:207], v[72:75]
buffer_load_dwordx4 v7, s[32:35], s56 offen offset:1024 lds
v_mul_f32 v39, v39, v49
v_mfma_f32_16x16x32_bf16 v[108:111], v[188:191], v[204:207], v[108:111]
ds_read_b64_tr_b16 v[182:183], v19 offset:26112
v_cvt_pk_bf16_f32 v32, v36, v37
v_mfma_f32_16x16x32_bf16 v[144:147], v[192:195], v[204:207], v[144:147]
ds_read_b128 v[232:235], v15 offset:36864
v_cvt_pk_bf16_f32 v33, v38, v39
v_mfma_f32_16x16x32_bf16 v[76:79], v[184:187], v[208:211], v[76:79]
ds_read_b128 v[236:239], v15 offset:38912
v_accvgpr_read_b32 v36, a212
v_accvgpr_read_b32 v37, a213
v_mfma_f32_16x16x32_bf16 v[112:115], v[188:191], v[208:211], v[112:115]
ds_read_b128 v[240:243], v15 offset:40960
v_accvgpr_read_b32 v38, a214
v_mfma_f32_16x16x32_bf16 v[148:151], v[192:195], v[208:211], v[148:151]
buffer_load_dwordx4 v8, s[32:35], s56 offen offset:2048 lds
v_accvgpr_read_b32 v39, a215
v_mfma_f32_16x16x32_bf16 v[80:83], v[184:187], v[212:215], v[80:83]
ds_read_b128 v[244:247], v15 offset:43008
v_mul_f32 v36, v36, v49
v_mfma_f32_16x16x32_bf16 v[116:119], v[188:191], v[212:215], v[116:119]
ds_read_b128 v[248:251], v15 offset:45056
v_mul_f32 v37, v37, v49
v_mfma_f32_16x16x32_bf16 v[152:155], v[192:195], v[212:215], v[152:155]
ds_read_b128 v[252:255], v15 offset:47104
v_mul_f32 v38, v38, v49
v_mul_f32 v39, v39, v49
v_mfma_f32_16x16x32_bf16 v[84:87], v[184:187], v[216:219], v[84:87]
s_add_u32 m0, s62, 0
ds_read_b128 v[196:199], v15 offset:49152
v_cvt_pk_bf16_f32 v34, v36, v37
v_mfma_f32_16x16x32_bf16 v[120:123], v[188:191], v[216:219], v[120:123]
buffer_load_dwordx4 v4, s[28:31], s24 offen offset:2560 lds
v_cvt_pk_bf16_f32 v35, v38, v39
v_mfma_f32_16x16x32_bf16 v[156:159], v[192:195], v[216:219], v[156:159]
ds_read_b128 v[200:203], v15 offset:51200
v_accvgpr_read_b32 v36, a216
v_mfma_f32_16x16x32_bf16 v[88:91], v[184:187], v[220:223], v[88:91]
ds_read_b128 v[204:207], v15 offset:53248
v_accvgpr_read_b32 v37, a217
v_accvgpr_read_b32 v38, a218
v_mfma_f32_16x16x32_bf16 v[124:127], v[188:191], v[220:223], v[124:127]
ds_read_b128 a[72:75], v23
v_accvgpr_read_b32 v39, a219
v_mfma_f32_16x16x32_bf16 v[160:163], v[192:195], v[220:223], v[160:163]
ds_read_b128 a[76:79], v23 offset:64
v_mul_f32 v36, v36, v49
v_mul_f32 v37, v37, v49
v_mfma_f32_16x16x32_bf16 v[92:95], v[184:187], v[224:227], v[92:95]
buffer_load_dwordx4 v5, s[28:31], s24 offen offset:3584 lds
v_mfma_f32_16x16x32_bf16 v[128:131], v[188:191], v[224:227], v[128:131]
ds_read_b128 a[80:83], v23 offset:128
v_mul_f32 v38, v38, v49
v_mul_f32 v39, v39, v49
v_mfma_f32_16x16x32_bf16 v[164:167], v[192:195], v[224:227], v[164:167]
ds_read_b128 a[84:87], v23 offset:192
v_cvt_pk_bf16_f32 v42, v36, v37
v_mfma_f32_16x16x32_bf16 v[96:99], v[184:187], v[228:231], v[96:99]
ds_read_b128 a[88:91], v23 offset:256
v_cvt_pk_bf16_f32 v43, v38, v39
v_accvgpr_write_b32 a232, v32
v_mfma_f32_16x16x32_bf16 v[132:135], v[188:191], v[228:231], v[132:135]
ds_read_b128 a[92:95], v23 offset:320
v_accvgpr_write_b32 a233, v33
v_mfma_f32_16x16x32_bf16 v[168:171], v[192:195], v[228:231], v[168:171]
v_accvgpr_write_b32 a234, v34
v_accvgpr_write_b32 a235, v35
s_waitcnt lgkmcnt(15)
s_barrier
s_waitcnt lgkmcnt(14)
v_mfma_f32_16x16x32_bf16 v[64:67], v[172:175], v[232:235], v[64:67]
ds_read_b64_tr_b16 v[184:185], v17 offset:36864
ds_read_b64_tr_b16 v[186:187], v17 offset:38400
v_accvgpr_read_b32 v60, a196
v_accvgpr_read_b32 v61, a197
v_mfma_f32_16x16x32_bf16 v[100:103], v[176:179], v[232:235], v[100:103]
s_add_u32 m0, s63, 24576
s_mul_i32 s56, s25, 6144
buffer_load_dwordx4 v6, s[32:35], s56 offen lds
v_mfma_f32_16x16x32_bf16 v[136:139], v[180:183], v[232:235], v[136:139]
s_waitcnt lgkmcnt(15)
ds_read_b64_tr_b16 v[188:189], v18 offset:36864
ds_read_b64_tr_b16 v[190:191], v18 offset:38400
v_accvgpr_read_b32 v62, a198
v_accvgpr_read_b32 v63, a199
v_mfma_f32_16x16x32_bf16 v[68:71], v[172:175], v[236:239], v[68:71]
buffer_load_dwordx4 v7, s[32:35], s56 offen offset:1024 lds
v_mul_f32 v60, v60, v48
v_mfma_f32_16x16x32_bf16 v[104:107], v[176:179], v[236:239], v[104:107]
ds_read_b64_tr_b16 v[192:193], v19 offset:36864
ds_read_b64_tr_b16 v[194:195], v19 offset:38400
v_mul_f32 v61, v61, v48
v_mfma_f32_16x16x32_bf16 v[140:143], v[180:183], v[236:239], v[140:143]
s_waitcnt lgkmcnt(15)
buffer_load_dwordx4 v8, s[32:35], s56 offen offset:2048 lds
v_mul_f32 v62, v62, v48
v_mfma_f32_16x16x32_bf16 v[72:75], v[172:175], v[240:243], v[72:75]
ds_read_b128 v[208:211], v16 offset:36864
v_mul_f32 v63, v63, v48
v_cvt_pk_bf16_f32 v56, v60, v61
v_mfma_f32_16x16x32_bf16 v[108:111], v[176:179], v[240:243], v[108:111]
s_add_u32 m0, s62, 18432
s_mov_b32 exec_hi, 0
buffer_load_dwordx4 v1, s[28:31], s25 offen lds
s_mov_b32 exec_hi, -1
v_cvt_pk_bf16_f32 v57, v62, v63
v_mfma_f32_16x16x32_bf16 v[144:147], v[180:183], v[240:243], v[144:147]
ds_read_b128 v[212:215], v16 offset:38912
v_accvgpr_read_b32 v60, a200
v_accvgpr_read_b32 v61, a201
v_mfma_f32_16x16x32_bf16 v[76:79], v[172:175], v[244:247], v[76:79]
buffer_load_dwordx4 v2, s[28:31], s25 offen offset:512 lds
v_accvgpr_read_b32 v62, a202
v_mfma_f32_16x16x32_bf16 v[112:115], v[176:179], v[244:247], v[112:115]
ds_read_b128 v[216:219], v16 offset:40960
v_accvgpr_read_b32 v63, a203
v_mul_f32 v60, v60, v48
v_mfma_f32_16x16x32_bf16 v[148:151], v[180:183], v[244:247], v[148:151]
buffer_load_dwordx4 v3, s[28:31], s25 offen offset:1536 lds
v_mul_f32 v61, v61, v48
v_mfma_f32_16x16x32_bf16 v[80:83], v[172:175], v[248:251], v[80:83]
ds_read_b128 v[220:223], v16 offset:43008
v_mul_f32 v62, v62, v48
v_mul_f32 v63, v63, v48
v_mfma_f32_16x16x32_bf16 v[116:119], v[176:179], v[248:251], v[116:119]
ds_read_b128 v[224:227], v16 offset:45056
v_cvt_pk_bf16_f32 v58, v60, v61
v_cvt_pk_bf16_f32 v59, v62, v63
v_mfma_f32_16x16x32_bf16 v[152:155], v[180:183], v[248:251], v[152:155]
s_waitcnt lgkmcnt(11)
s_add_u32 m0, s64, 0
s_sub_u32 s57, 98304, s16
buffer_load_dwordx4 v9, s[36:39], s57 offen nt lds
v_accvgpr_read_b32 v60, a204
v_mfma_f32_16x16x32_bf16 v[84:87], v[172:175], v[252:255], v[84:87]
ds_read_b128 v[228:231], v16 offset:47104
v_accvgpr_read_b32 v61, a205
v_accvgpr_read_b32 v62, a206
v_accvgpr_read_b32 v63, a207
v_mfma_f32_16x16x32_bf16 v[120:123], v[176:179], v[252:255], v[120:123]
buffer_load_dwordx4 v10, s[36:39], s57 offen offset:1024 nt lds
v_mul_f32 v60, v60, v48
v_mfma_f32_16x16x32_bf16 v[156:159], v[180:183], v[252:255], v[156:159]
ds_read_b128 v[232:235], v16 offset:49152
v_mul_f32 v61, v61, v48
v_mul_f32 v62, v62, v48
v_mul_f32 v63, v63, v48
v_cvt_pk_bf16_f32 v40, v60, v61
v_mfma_f32_16x16x32_bf16 v[88:91], v[172:175], v[196:199], v[88:91]
buffer_load_dwordx4 v11, s[36:39], s57 offen offset:2048 nt lds
v_cvt_pk_bf16_f32 v41, v62, v63
v_mfma_f32_16x16x32_bf16 v[124:127], v[176:179], v[196:199], v[124:127]
ds_read_b128 v[236:239], v16 offset:51200
v_accvgpr_write_b32 a228, v56
v_accvgpr_write_b32 a229, v57
v_accvgpr_write_b32 a230, v58
v_accvgpr_write_b32 a231, v59
v_mfma_f32_16x16x32_bf16 v[160:163], v[180:183], v[196:199], v[160:163]
s_add_u32 m0, s64, 3136
s_sub_u32 s57, 101376, s16
buffer_load_dwordx4 v9, s[36:39], s57 offen nt lds
v_mfma_f32_16x16x32_bf16 v[92:95], v[172:175], v[200:203], v[92:95]
ds_read_b128 v[240:243], v16 offset:53248
ds_write_b64 v0, v[42:43] offset:1024
ds_write_b64 v0, v[40:41]
v_mfma_f32_16x16x32_bf16 v[128:131], v[176:179], v[200:203], v[128:131]
buffer_load_dwordx4 v10, s[36:39], s57 offen offset:1024 nt lds
v_mfma_f32_16x16x32_bf16 v[164:167], v[180:183], v[200:203], v[164:167]
v_mfma_f32_16x16x32_bf16 v[96:99], v[172:175], v[204:207], v[96:99]
buffer_load_dwordx4 v11, s[36:39], s57 offen offset:2048 nt lds
v_mfma_f32_16x16x32_bf16 v[132:135], v[176:179], v[204:207], v[132:135]
v_mfma_f32_16x16x32_bf16 v[168:171], v[180:183], v[204:207], v[168:171]
s_waitcnt vmcnt(12) lgkmcnt(0)
s_barrier
v_mfma_f32_16x16x32_bf16 v[64:67], v[184:187], v[208:211], v[64:67]
ds_read_b64_tr_b16 v[172:173], v17
v_mfma_f32_16x16x32_bf16 v[100:103], v[188:191], v[208:211], v[100:103]
s_add_u32 m0, s63, 36864
s_mul_i32 s56, s25, 6144
s_add_u32 s56, s56, 393216
buffer_load_dwordx4 v6, s[32:35], s56 offen lds
v_mfma_f32_16x16x32_bf16 v[136:139], v[192:195], v[208:211], v[136:139]
ds_read_b64_tr_b16 v[174:175], v17 offset:1536
v_mfma_f32_16x16x32_bf16 v[68:71], v[184:187], v[212:215], v[68:71]
ds_read_b64_tr_b16 v[176:177], v18
v_mfma_f32_16x16x32_bf16 v[104:107], v[188:191], v[212:215], v[104:107]
ds_read_b64_tr_b16 v[178:179], v18 offset:1536
v_mfma_f32_16x16x32_bf16 v[140:143], v[192:195], v[212:215], v[140:143]
ds_read_b64_tr_b16 v[180:181], v19
v_mfma_f32_16x16x32_bf16 v[72:75], v[184:187], v[216:219], v[72:75]
buffer_load_dwordx4 v7, s[32:35], s56 offen offset:1024 lds
v_mfma_f32_16x16x32_bf16 v[108:111], v[188:191], v[216:219], v[108:111]
ds_read_b64_tr_b16 v[182:183], v19 offset:1536
v_mfma_f32_16x16x32_bf16 v[144:147], v[192:195], v[216:219], v[144:147]
ds_read_b128 v[244:247], v15
v_mfma_f32_16x16x32_bf16 v[76:79], v[184:187], v[220:223], v[76:79]
ds_read_b128 v[248:251], v15 offset:2048
v_mfma_f32_16x16x32_bf16 v[112:115], v[188:191], v[220:223], v[112:115]
ds_read_b128 v[252:255], v15 offset:4096
v_mfma_f32_16x16x32_bf16 v[148:151], v[192:195], v[220:223], v[148:151]
buffer_load_dwordx4 v8, s[32:35], s56 offen offset:2048 lds
v_mfma_f32_16x16x32_bf16 v[80:83], v[184:187], v[224:227], v[80:83]
ds_read_b128 v[196:199], v15 offset:6144
v_mfma_f32_16x16x32_bf16 v[116:119], v[188:191], v[224:227], v[116:119]
ds_read_b128 v[200:203], v15 offset:8192
v_mfma_f32_16x16x32_bf16 v[152:155], v[192:195], v[224:227], v[152:155]
ds_read_b128 v[204:207], v15 offset:10240
v_mfma_f32_16x16x32_bf16 v[84:87], v[184:187], v[228:231], v[84:87]
s_add_u32 m0, s62, 18432
ds_read_b128 v[208:211], v15 offset:12288
v_mfma_f32_16x16x32_bf16 v[120:123], v[188:191], v[228:231], v[120:123]
buffer_load_dwordx4 v4, s[28:31], s25 offen offset:2560 lds
v_mfma_f32_16x16x32_bf16 v[156:159], v[192:195], v[228:231], v[156:159]
ds_read_b128 v[212:215], v15 offset:14336
v_mfma_f32_16x16x32_bf16 v[88:91], v[184:187], v[232:235], v[88:91]
ds_read_b128 v[216:219], v15 offset:16384
v_mfma_f32_16x16x32_bf16 v[124:127], v[188:191], v[232:235], v[124:127]
ds_read_b128 a[224:227], v55
v_mfma_f32_16x16x32_bf16 v[160:163], v[192:195], v[232:235], v[160:163]
v_mfma_f32_16x16x32_bf16 v[92:95], v[184:187], v[236:239], v[92:95]
buffer_load_dwordx4 v5, s[28:31], s25 offen offset:3584 lds
v_mfma_f32_16x16x32_bf16 v[128:131], v[188:191], v[236:239], v[128:131]
v_mfma_f32_16x16x32_bf16 v[164:167], v[192:195], v[236:239], v[164:167]
v_mfma_f32_16x16x32_bf16 v[96:99], v[184:187], v[240:243], v[96:99]
v_mfma_f32_16x16x32_bf16 v[132:135], v[188:191], v[240:243], v[132:135]
v_mfma_f32_16x16x32_bf16 v[168:171], v[192:195], v[240:243], v[168:171]
s_waitcnt lgkmcnt(0)
s_barrier
v_mfma_f32_16x16x32_bf16 v[64:67], v[172:175], v[244:247], v[64:67]
ds_read_b64_tr_b16 v[184:185], v17 offset:12288
v_accvgpr_read_b32 v36, a184
v_accvgpr_read_b32 v37, a185
v_mfma_f32_16x16x32_bf16 v[100:103], v[176:179], v[244:247], v[100:103]
s_add_u32 m0, s63, 0
s_mul_i32 s56, s55, 6144
buffer_load_dwordx4 v6, s[32:35], s56 offen lds
v_mfma_f32_16x16x32_bf16 v[136:139], v[180:183], v[244:247], v[136:139]
ds_read_b64_tr_b16 v[186:187], v17 offset:13824
v_accvgpr_read_b32 v38, a186
v_mfma_f32_16x16x32_bf16 v[68:71], v[172:175], v[248:251], v[68:71]
ds_read_b64_tr_b16 v[188:189], v18 offset:12288
v_accvgpr_read_b32 v39, a187
v_mul_f32 v36, v36, v47
v_mfma_f32_16x16x32_bf16 v[104:107], v[176:179], v[248:251], v[104:107]
ds_read_b64_tr_b16 v[190:191], v18 offset:13824
v_mul_f32 v37, v37, v47
v_mfma_f32_16x16x32_bf16 v[140:143], v[180:183], v[248:251], v[140:143]
buffer_load_dwordx4 v7, s[32:35], s56 offen offset:1024 lds
v_mfma_f32_16x16x32_bf16 v[72:75], v[172:175], v[252:255], v[72:75]
ds_read_b64_tr_b16 v[192:193], v19 offset:12288
v_mul_f32 v38, v38, v47
v_mul_f32 v39, v39, v47
v_mfma_f32_16x16x32_bf16 v[108:111], v[176:179], v[252:255], v[108:111]
ds_read_b64_tr_b16 v[194:195], v19 offset:13824
v_cvt_pk_bf16_f32 v32, v36, v37
v_mfma_f32_16x16x32_bf16 v[144:147], v[180:183], v[252:255], v[144:147]
ds_read_b128 v[220:223], v16
v_cvt_pk_bf16_f32 v33, v38, v39
v_mfma_f32_16x16x32_bf16 v[76:79], v[172:175], v[196:199], v[76:79]
buffer_load_dwordx4 v8, s[32:35], s56 offen offset:2048 lds
v_accvgpr_read_b32 v36, a188
v_mfma_f32_16x16x32_bf16 v[112:115], v[176:179], v[196:199], v[112:115]
ds_read_b128 v[224:227], v16 offset:2048
v_accvgpr_read_b32 v37, a189
v_mfma_f32_16x16x32_bf16 v[148:151], v[180:183], v[196:199], v[148:151]
ds_read_b128 v[228:231], v16 offset:4096
v_accvgpr_read_b32 v38, a190
v_accvgpr_read_b32 v39, a191
v_mfma_f32_16x16x32_bf16 v[80:83], v[172:175], v[200:203], v[80:83]
ds_read_b128 v[232:235], v16 offset:6144
v_mul_f32 v36, v36, v47
v_mfma_f32_16x16x32_bf16 v[116:119], v[176:179], v[200:203], v[116:119]
ds_read_b128 v[236:239], v16 offset:8192
v_mul_f32 v37, v37, v47
v_mfma_f32_16x16x32_bf16 v[152:155], v[180:183], v[200:203], v[152:155]
s_add_u32 m0, s62, 36864
s_mov_b32 exec_hi, 0
buffer_load_dwordx4 v1, s[28:31], s55 offen lds
s_mov_b32 exec_hi, -1
v_mul_f32 v38, v38, v47
v_mfma_f32_16x16x32_bf16 v[84:87], v[172:175], v[204:207], v[84:87]
ds_read_b128 v[240:243], v16 offset:10240
v_mul_f32 v39, v39, v47
v_mfma_f32_16x16x32_bf16 v[120:123], v[176:179], v[204:207], v[120:123]
ds_read_b128 v[244:247], v16 offset:12288
v_cvt_pk_bf16_f32 v34, v36, v37
v_cvt_pk_bf16_f32 v35, v38, v39
v_mfma_f32_16x16x32_bf16 v[156:159], v[180:183], v[204:207], v[156:159]
ds_read_b128 v[248:251], v16 offset:14336
v_accvgpr_read_b32 v36, a192
v_mfma_f32_16x16x32_bf16 v[88:91], v[172:175], v[208:211], v[88:91]
buffer_load_dwordx4 v2, s[28:31], s55 offen offset:512 lds
v_accvgpr_read_b32 v37, a193
v_mfma_f32_16x16x32_bf16 v[124:127], v[176:179], v[208:211], v[124:127]
ds_read_b128 v[252:255], v16 offset:16384
v_accvgpr_read_b32 v38, a194
v_mfma_f32_16x16x32_bf16 v[160:163], v[180:183], v[208:211], v[160:163]
ds_read_b128 a[0:3], v23 offset:24832
v_accvgpr_read_b32 v39, a195
v_mul_f32 v36, v36, v47
v_mfma_f32_16x16x32_bf16 v[92:95], v[172:175], v[212:215], v[92:95]
ds_read_b128 a[4:7], v23 offset:24896
v_mul_f32 v37, v37, v47
v_mfma_f32_16x16x32_bf16 v[128:131], v[176:179], v[212:215], v[128:131]
buffer_load_dwordx4 v3, s[28:31], s55 offen offset:1536 lds
v_mul_f32 v38, v38, v47
v_mfma_f32_16x16x32_bf16 v[164:167], v[180:183], v[212:215], v[164:167]
ds_read_b128 a[8:11], v23 offset:24960
v_mul_f32 v39, v39, v47
v_mfma_f32_16x16x32_bf16 v[96:99], v[172:175], v[216:219], v[96:99]
ds_read_b128 a[12:15], v23 offset:25024
v_cvt_pk_bf16_f32 v42, v36, v37
v_cvt_pk_bf16_f32 v43, v38, v39
v_mfma_f32_16x16x32_bf16 v[132:135], v[176:179], v[216:219], v[132:135]
ds_read_b128 a[16:19], v23 offset:25088
v_accvgpr_write_b32 a220, v32
v_accvgpr_write_b32 a221, v33
v_mfma_f32_16x16x32_bf16 v[168:171], v[180:183], v[216:219], v[168:171]
ds_read_b128 a[20:23], v23 offset:25152
v_accvgpr_write_b32 a222, v34
s_waitcnt vmcnt(6) lgkmcnt(15)
s_barrier
s_waitcnt lgkmcnt(14)
v_mfma_f32_16x16x32_bf16 v[64:67], v[184:187], v[220:223], v[64:67]
ds_read_b64_tr_b16 v[172:173], v17 offset:24576
ds_read_b64_tr_b16 v[174:175], v17 offset:26112
v_accvgpr_write_b32 a223, v35
v_accvgpr_read_b32 v60, a172
v_mfma_f32_16x16x32_bf16 v[100:103], v[188:191], v[220:223], v[100:103]
s_add_u32 m0, s63, 12288
s_mul_i32 s56, s55, 6144
s_add_u32 s56, s56, 393216
buffer_load_dwordx4 v6, s[32:35], s56 offen lds
v_accvgpr_read_b32 v61, a173
v_mfma_f32_16x16x32_bf16 v[136:139], v[192:195], v[220:223], v[136:139]
s_waitcnt lgkmcnt(15)
ds_read_b64_tr_b16 v[176:177], v18 offset:24576
ds_read_b64_tr_b16 v[178:179], v18 offset:26112
v_accvgpr_read_b32 v62, a174
v_mfma_f32_16x16x32_bf16 v[68:71], v[184:187], v[224:227], v[68:71]
buffer_load_dwordx4 v7, s[32:35], s56 offen offset:1024 lds
v_accvgpr_read_b32 v63, a175
v_mfma_f32_16x16x32_bf16 v[104:107], v[188:191], v[224:227], v[104:107]
ds_read_b64_tr_b16 v[180:181], v19 offset:24576
ds_read_b64_tr_b16 v[182:183], v19 offset:26112
v_mul_f32 v60, v60, v46
v_mul_f32 v61, v61, v46
v_mfma_f32_16x16x32_bf16 v[140:143], v[192:195], v[224:227], v[140:143]
s_waitcnt lgkmcnt(15)
buffer_load_dwordx4 v8, s[32:35], s56 offen offset:2048 lds
v_mfma_f32_16x16x32_bf16 v[72:75], v[184:187], v[228:231], v[72:75]
ds_read_b128 v[196:199], v15 offset:18432
v_mul_f32 v62, v62, v46
v_mul_f32 v63, v63, v46
v_mfma_f32_16x16x32_bf16 v[108:111], v[188:191], v[228:231], v[108:111]
s_add_u32 m0, s62, 36864
ds_read_b128 v[200:203], v15 offset:20480
v_cvt_pk_bf16_f32 v56, v60, v61
v_cvt_pk_bf16_f32 v57, v62, v63
v_mfma_f32_16x16x32_bf16 v[144:147], v[192:195], v[228:231], v[144:147]
buffer_load_dwordx4 v4, s[28:31], s55 offen offset:2560 lds
v_accvgpr_read_b32 v60, a176
v_mfma_f32_16x16x32_bf16 v[76:79], v[184:187], v[232:235], v[76:79]
ds_read_b128 v[204:207], v15 offset:22528
v_accvgpr_read_b32 v61, a177
v_accvgpr_read_b32 v62, a178
v_mfma_f32_16x16x32_bf16 v[112:115], v[188:191], v[232:235], v[112:115]
buffer_load_dwordx4 v5, s[28:31], s55 offen offset:3584 lds
v_accvgpr_read_b32 v63, a179
v_mfma_f32_16x16x32_bf16 v[148:151], v[192:195], v[232:235], v[148:151]
ds_read_b128 v[208:211], v15 offset:24576
v_mul_f32 v60, v60, v46
v_mul_f32 v61, v61, v46
v_mfma_f32_16x16x32_bf16 v[80:83], v[184:187], v[236:239], v[80:83]
s_waitcnt lgkmcnt(10)
s_add_u32 m0, s64, 24832
s_sub_u32 s57, 122880, s16
buffer_load_dwordx4 v9, s[36:39], s57 offen nt lds
v_mul_f32 v62, v62, v46
v_mfma_f32_16x16x32_bf16 v[116:119], v[188:191], v[236:239], v[116:119]
ds_read_b128 v[212:215], v15 offset:26624
v_mul_f32 v63, v63, v46
v_cvt_pk_bf16_f32 v58, v60, v61
v_cvt_pk_bf16_f32 v59, v62, v63
v_mfma_f32_16x16x32_bf16 v[152:155], v[192:195], v[236:239], v[152:155]
ds_read_b128 v[216:219], v15 offset:28672
v_accvgpr_read_b32 v60, a180
v_accvgpr_read_b32 v61, a181
v_mfma_f32_16x16x32_bf16 v[84:87], v[184:187], v[240:243], v[84:87]
buffer_load_dwordx4 v10, s[36:39], s57 offen offset:1024 nt lds
v_accvgpr_read_b32 v62, a182
v_mfma_f32_16x16x32_bf16 v[120:123], v[188:191], v[240:243], v[120:123]
ds_read_b128 v[220:223], v15 offset:30720
v_accvgpr_read_b32 v63, a183
v_mul_f32 v60, v60, v46
v_mul_f32 v61, v61, v46
v_mfma_f32_16x16x32_bf16 v[156:159], v[192:195], v[240:243], v[156:159]
buffer_load_dwordx4 v11, s[36:39], s57 offen offset:2048 nt lds
v_mul_f32 v62, v62, v46
v_mul_f32 v63, v63, v46
v_mfma_f32_16x16x32_bf16 v[88:91], v[184:187], v[244:247], v[88:91]
ds_read_b128 v[224:227], v15 offset:32768
v_cvt_pk_bf16_f32 v40, v60, v61
v_cvt_pk_bf16_f32 v41, v62, v63
v_accvgpr_write_b32 a216, v56
v_mfma_f32_16x16x32_bf16 v[124:127], v[188:191], v[244:247], v[124:127]
s_add_u32 m0, s64, 27968
s_sub_u32 s57, 125952, s16
buffer_load_dwordx4 v9, s[36:39], s57 offen nt lds
v_accvgpr_write_b32 a217, v57
v_accvgpr_write_b32 a218, v58
v_accvgpr_write_b32 a219, v59
v_mfma_f32_16x16x32_bf16 v[160:163], v[192:195], v[244:247], v[160:163]
ds_read_b128 v[228:231], v15 offset:34816
v_mfma_f32_16x16x32_bf16 v[92:95], v[184:187], v[248:251], v[92:95]
ds_write_b64 v0, v[42:43] offset:1024
ds_write_b64 v0, v[40:41]
v_mfma_f32_16x16x32_bf16 v[128:131], v[188:191], v[248:251], v[128:131]
buffer_load_dwordx4 v10, s[36:39], s57 offen offset:1024 nt lds
v_mfma_f32_16x16x32_bf16 v[164:167], v[192:195], v[248:251], v[164:167]
v_mfma_f32_16x16x32_bf16 v[96:99], v[184:187], v[252:255], v[96:99]
buffer_load_dwordx4 v11, s[36:39], s57 offen offset:2048 nt lds
v_mfma_f32_16x16x32_bf16 v[132:135], v[188:191], v[252:255], v[132:135]
v_mfma_f32_16x16x32_bf16 v[168:171], v[192:195], v[252:255], v[168:171]
s_waitcnt lgkmcnt(0)
s_barrier
v_mfma_f32_16x16x32_bf16 v[64:67], v[172:175], v[196:199], v[64:67]
ds_read_b64_tr_b16 v[184:185], v17 offset:36864
v_mfma_f32_16x16x32_bf16 v[100:103], v[176:179], v[196:199], v[100:103]
s_add_u32 m0, s63, 24576
s_mul_i32 s56, s60, 6144
buffer_load_dwordx4 v6, s[32:35], s56 offen lds
v_mfma_f32_16x16x32_bf16 v[136:139], v[180:183], v[196:199], v[136:139]
ds_read_b64_tr_b16 v[186:187], v17 offset:38400
v_mfma_f32_16x16x32_bf16 v[68:71], v[172:175], v[200:203], v[68:71]
ds_read_b64_tr_b16 v[188:189], v18 offset:36864
v_mfma_f32_16x16x32_bf16 v[104:107], v[176:179], v[200:203], v[104:107]
ds_read_b64_tr_b16 v[190:191], v18 offset:38400
v_mfma_f32_16x16x32_bf16 v[140:143], v[180:183], v[200:203], v[140:143]
buffer_load_dwordx4 v7, s[32:35], s56 offen offset:1024 lds
v_mfma_f32_16x16x32_bf16 v[72:75], v[172:175], v[204:207], v[72:75]
ds_read_b64_tr_b16 v[192:193], v19 offset:36864
v_mfma_f32_16x16x32_bf16 v[108:111], v[176:179], v[204:207], v[108:111]
ds_read_b64_tr_b16 v[194:195], v19 offset:38400
v_mfma_f32_16x16x32_bf16 v[144:147], v[180:183], v[204:207], v[144:147]
ds_read_b128 v[232:235], v16 offset:18432
v_mfma_f32_16x16x32_bf16 v[76:79], v[172:175], v[208:211], v[76:79]
buffer_load_dwordx4 v8, s[32:35], s56 offen offset:2048 lds
v_mfma_f32_16x16x32_bf16 v[112:115], v[176:179], v[208:211], v[112:115]
ds_read_b128 v[236:239], v16 offset:20480
v_mfma_f32_16x16x32_bf16 v[148:151], v[180:183], v[208:211], v[148:151]
ds_read_b128 v[240:243], v16 offset:22528
v_mfma_f32_16x16x32_bf16 v[80:83], v[172:175], v[212:215], v[80:83]
ds_read_b128 v[244:247], v16 offset:24576
v_mfma_f32_16x16x32_bf16 v[116:119], v[176:179], v[212:215], v[116:119]
ds_read_b128 v[248:251], v16 offset:26624
v_mfma_f32_16x16x32_bf16 v[152:155], v[180:183], v[212:215], v[152:155]
s_add_u32 m0, s62, 0
s_mov_b32 exec_hi, 0
buffer_load_dwordx4 v1, s[28:31], s60 offen lds
s_mov_b32 exec_hi, -1
v_mfma_f32_16x16x32_bf16 v[84:87], v[172:175], v[216:219], v[84:87]
ds_read_b128 v[252:255], v16 offset:28672
v_mfma_f32_16x16x32_bf16 v[120:123], v[176:179], v[216:219], v[120:123]
ds_read_b128 v[196:199], v16 offset:30720
v_mfma_f32_16x16x32_bf16 v[156:159], v[180:183], v[216:219], v[156:159]
ds_read_b128 v[200:203], v16 offset:32768
v_mfma_f32_16x16x32_bf16 v[88:91], v[172:175], v[220:223], v[88:91]
buffer_load_dwordx4 v2, s[28:31], s60 offen offset:512 lds
v_mfma_f32_16x16x32_bf16 v[124:127], v[176:179], v[220:223], v[124:127]
ds_read_b128 v[204:207], v16 offset:34816
v_mfma_f32_16x16x32_bf16 v[160:163], v[180:183], v[220:223], v[160:163]
ds_read_b128 a[212:215], v55
v_mfma_f32_16x16x32_bf16 v[92:95], v[172:175], v[224:227], v[92:95]
v_mfma_f32_16x16x32_bf16 v[128:131], v[176:179], v[224:227], v[128:131]
buffer_load_dwordx4 v3, s[28:31], s60 offen offset:1536 lds
v_mfma_f32_16x16x32_bf16 v[164:167], v[180:183], v[224:227], v[164:167]
v_mfma_f32_16x16x32_bf16 v[96:99], v[172:175], v[228:231], v[96:99]
v_mfma_f32_16x16x32_bf16 v[132:135], v[176:179], v[228:231], v[132:135]
v_mfma_f32_16x16x32_bf16 v[168:171], v[180:183], v[228:231], v[168:171]
s_waitcnt vmcnt(12) lgkmcnt(0)
s_barrier
v_mfma_f32_16x16x32_bf16 v[64:67], v[184:187], v[232:235], v[64:67]
ds_read_b64_tr_b16 v[172:173], v17
v_accvgpr_read_b32 v36, a160
v_accvgpr_read_b32 v37, a161
v_mfma_f32_16x16x32_bf16 v[100:103], v[188:191], v[232:235], v[100:103]
s_add_u32 m0, s63, 36864
s_mul_i32 s56, s60, 6144
s_add_u32 s56, s56, 393216
buffer_load_dwordx4 v6, s[32:35], s56 offen lds
v_mfma_f32_16x16x32_bf16 v[136:139], v[192:195], v[232:235], v[136:139]
ds_read_b64_tr_b16 v[174:175], v17 offset:1536
v_accvgpr_read_b32 v38, a162
v_mfma_f32_16x16x32_bf16 v[68:71], v[184:187], v[236:239], v[68:71]
ds_read_b64_tr_b16 v[176:177], v18
v_accvgpr_read_b32 v39, a163
v_mul_f32 v36, v36, v45
v_mfma_f32_16x16x32_bf16 v[104:107], v[188:191], v[236:239], v[104:107]
ds_read_b64_tr_b16 v[178:179], v18 offset:1536
v_mul_f32 v37, v37, v45
v_mfma_f32_16x16x32_bf16 v[140:143], v[192:195], v[236:239], v[140:143]
ds_read_b64_tr_b16 v[180:181], v19
v_mul_f32 v38, v38, v45
v_mfma_f32_16x16x32_bf16 v[72:75], v[184:187], v[240:243], v[72:75]
buffer_load_dwordx4 v7, s[32:35], s56 offen offset:1024 lds
v_mul_f32 v39, v39, v45
v_mfma_f32_16x16x32_bf16 v[108:111], v[188:191], v[240:243], v[108:111]
ds_read_b64_tr_b16 v[182:183], v19 offset:1536
v_cvt_pk_bf16_f32 v32, v36, v37
v_mfma_f32_16x16x32_bf16 v[144:147], v[192:195], v[240:243], v[144:147]
ds_read_b128 v[208:211], v15 offset:36864
v_cvt_pk_bf16_f32 v33, v38, v39
v_mfma_f32_16x16x32_bf16 v[76:79], v[184:187], v[244:247], v[76:79]
ds_read_b128 v[212:215], v15 offset:38912
v_accvgpr_read_b32 v36, a164
v_accvgpr_read_b32 v37, a165
v_mfma_f32_16x16x32_bf16 v[112:115], v[188:191], v[244:247], v[112:115]
ds_read_b128 v[216:219], v15 offset:40960
v_accvgpr_read_b32 v38, a166
v_mfma_f32_16x16x32_bf16 v[148:151], v[192:195], v[244:247], v[148:151]
buffer_load_dwordx4 v8, s[32:35], s56 offen offset:2048 lds
v_accvgpr_read_b32 v39, a167
v_mfma_f32_16x16x32_bf16 v[80:83], v[184:187], v[248:251], v[80:83]
ds_read_b128 v[220:223], v15 offset:43008
v_mul_f32 v36, v36, v45
v_mfma_f32_16x16x32_bf16 v[116:119], v[188:191], v[248:251], v[116:119]
ds_read_b128 v[224:227], v15 offset:45056
v_mul_f32 v37, v37, v45
v_mfma_f32_16x16x32_bf16 v[152:155], v[192:195], v[248:251], v[152:155]
ds_read_b128 v[228:231], v15 offset:47104
v_mul_f32 v38, v38, v45
v_mul_f32 v39, v39, v45
v_mfma_f32_16x16x32_bf16 v[84:87], v[184:187], v[252:255], v[84:87]
s_add_u32 m0, s62, 0
ds_read_b128 v[232:235], v15 offset:49152
v_cvt_pk_bf16_f32 v34, v36, v37
v_mfma_f32_16x16x32_bf16 v[120:123], v[188:191], v[252:255], v[120:123]
buffer_load_dwordx4 v4, s[28:31], s60 offen offset:2560 lds
v_cvt_pk_bf16_f32 v35, v38, v39
v_mfma_f32_16x16x32_bf16 v[156:159], v[192:195], v[252:255], v[156:159]
ds_read_b128 v[236:239], v15 offset:51200
v_accvgpr_read_b32 v36, a168
v_mfma_f32_16x16x32_bf16 v[88:91], v[184:187], v[196:199], v[88:91]
ds_read_b128 v[240:243], v15 offset:53248
v_accvgpr_read_b32 v37, a169
v_accvgpr_read_b32 v38, a170
v_mfma_f32_16x16x32_bf16 v[124:127], v[188:191], v[196:199], v[124:127]
ds_read_b128 a[96:99], v23
v_accvgpr_read_b32 v39, a171
v_mfma_f32_16x16x32_bf16 v[160:163], v[192:195], v[196:199], v[160:163]
ds_read_b128 a[100:103], v23 offset:64
v_mul_f32 v36, v36, v45
v_mul_f32 v37, v37, v45
v_mfma_f32_16x16x32_bf16 v[92:95], v[184:187], v[200:203], v[92:95]
buffer_load_dwordx4 v5, s[28:31], s60 offen offset:3584 lds
v_mfma_f32_16x16x32_bf16 v[128:131], v[188:191], v[200:203], v[128:131]
ds_read_b128 a[104:107], v23 offset:128
v_mul_f32 v38, v38, v45
v_mul_f32 v39, v39, v45
v_mfma_f32_16x16x32_bf16 v[164:167], v[192:195], v[200:203], v[164:167]
ds_read_b128 a[108:111], v23 offset:192
v_cvt_pk_bf16_f32 v42, v36, v37
v_mfma_f32_16x16x32_bf16 v[96:99], v[184:187], v[204:207], v[96:99]
ds_read_b128 a[112:115], v23 offset:256
v_cvt_pk_bf16_f32 v43, v38, v39
v_accvgpr_write_b32 a208, v32
v_mfma_f32_16x16x32_bf16 v[132:135], v[188:191], v[204:207], v[132:135]
ds_read_b128 a[116:119], v23 offset:320
v_accvgpr_write_b32 a209, v33
v_mfma_f32_16x16x32_bf16 v[168:171], v[192:195], v[204:207], v[168:171]
v_accvgpr_write_b32 a210, v34
v_accvgpr_write_b32 a211, v35
s_waitcnt lgkmcnt(15)
s_barrier
s_waitcnt lgkmcnt(14)
v_mfma_f32_16x16x32_bf16 v[64:67], v[172:175], v[208:211], v[64:67]
ds_read_b64_tr_b16 v[184:185], v17 offset:12288
ds_read_b64_tr_b16 v[186:187], v17 offset:13824
v_accvgpr_read_b32 v60, a148
v_accvgpr_read_b32 v61, a149
v_mfma_f32_16x16x32_bf16 v[100:103], v[176:179], v[208:211], v[100:103]
s_add_u32 m0, s63, 0
s_mul_i32 s56, s61, 6144
buffer_load_dwordx4 v6, s[32:35], s56 offen lds
v_mfma_f32_16x16x32_bf16 v[136:139], v[180:183], v[208:211], v[136:139]
s_waitcnt lgkmcnt(15)
ds_read_b64_tr_b16 v[188:189], v18 offset:12288
ds_read_b64_tr_b16 v[190:191], v18 offset:13824
v_accvgpr_read_b32 v62, a150
v_accvgpr_read_b32 v63, a151
v_mfma_f32_16x16x32_bf16 v[68:71], v[172:175], v[212:215], v[68:71]
buffer_load_dwordx4 v7, s[32:35], s56 offen offset:1024 lds
v_mul_f32 v60, v60, v44
v_mfma_f32_16x16x32_bf16 v[104:107], v[176:179], v[212:215], v[104:107]
ds_read_b64_tr_b16 v[192:193], v19 offset:12288
ds_read_b64_tr_b16 v[194:195], v19 offset:13824
v_mul_f32 v61, v61, v44
v_mfma_f32_16x16x32_bf16 v[140:143], v[180:183], v[212:215], v[140:143]
s_waitcnt lgkmcnt(15)
buffer_load_dwordx4 v8, s[32:35], s56 offen offset:2048 lds
v_mul_f32 v62, v62, v44
v_mfma_f32_16x16x32_bf16 v[72:75], v[172:175], v[216:219], v[72:75]
ds_read_b128 v[244:247], v16 offset:36864
v_mul_f32 v63, v63, v44
v_cvt_pk_bf16_f32 v56, v60, v61
v_mfma_f32_16x16x32_bf16 v[108:111], v[176:179], v[216:219], v[108:111]
s_add_u32 m0, s62, 18432
s_mov_b32 exec_hi, 0
buffer_load_dwordx4 v1, s[28:31], s61 offen lds
s_mov_b32 exec_hi, -1
v_cvt_pk_bf16_f32 v57, v62, v63
v_mfma_f32_16x16x32_bf16 v[144:147], v[180:183], v[216:219], v[144:147]
ds_read_b128 v[248:251], v16 offset:38912
v_accvgpr_read_b32 v60, a152
v_accvgpr_read_b32 v61, a153
v_mfma_f32_16x16x32_bf16 v[76:79], v[172:175], v[220:223], v[76:79]
buffer_load_dwordx4 v2, s[28:31], s61 offen offset:512 lds
v_accvgpr_read_b32 v62, a154
v_mfma_f32_16x16x32_bf16 v[112:115], v[176:179], v[220:223], v[112:115]
ds_read_b128 v[252:255], v16 offset:40960
v_accvgpr_read_b32 v63, a155
v_mul_f32 v60, v60, v44
v_mfma_f32_16x16x32_bf16 v[148:151], v[180:183], v[220:223], v[148:151]
buffer_load_dwordx4 v3, s[28:31], s61 offen offset:1536 lds
v_mul_f32 v61, v61, v44
v_mfma_f32_16x16x32_bf16 v[80:83], v[172:175], v[224:227], v[80:83]
ds_read_b128 v[196:199], v16 offset:43008
v_mul_f32 v62, v62, v44
v_mul_f32 v63, v63, v44
v_mfma_f32_16x16x32_bf16 v[116:119], v[176:179], v[224:227], v[116:119]
ds_read_b128 v[200:203], v16 offset:45056
v_cvt_pk_bf16_f32 v58, v60, v61
v_cvt_pk_bf16_f32 v59, v62, v63
v_mfma_f32_16x16x32_bf16 v[152:155], v[180:183], v[224:227], v[152:155]
s_waitcnt lgkmcnt(11)
s_add_u32 m0, s64, 0
s_sub_u32 s57, 147456, s16
buffer_load_dwordx4 v9, s[36:39], s57 offen nt lds
v_accvgpr_read_b32 v60, a156
v_mfma_f32_16x16x32_bf16 v[84:87], v[172:175], v[228:231], v[84:87]
ds_read_b128 v[204:207], v16 offset:47104
v_accvgpr_read_b32 v61, a157
v_accvgpr_read_b32 v62, a158
v_accvgpr_read_b32 v63, a159
v_mfma_f32_16x16x32_bf16 v[120:123], v[176:179], v[228:231], v[120:123]
buffer_load_dwordx4 v10, s[36:39], s57 offen offset:1024 nt lds
v_mul_f32 v60, v60, v44
v_mfma_f32_16x16x32_bf16 v[156:159], v[180:183], v[228:231], v[156:159]
ds_read_b128 v[208:211], v16 offset:49152
v_mul_f32 v61, v61, v44
v_mul_f32 v62, v62, v44
v_mul_f32 v63, v63, v44
v_cvt_pk_bf16_f32 v40, v60, v61
v_mfma_f32_16x16x32_bf16 v[88:91], v[172:175], v[232:235], v[88:91]
buffer_load_dwordx4 v11, s[36:39], s57 offen offset:2048 nt lds
v_cvt_pk_bf16_f32 v41, v62, v63
v_mfma_f32_16x16x32_bf16 v[124:127], v[176:179], v[232:235], v[124:127]
ds_read_b128 v[212:215], v16 offset:51200
v_accvgpr_write_b32 a204, v56
v_accvgpr_write_b32 a205, v57
v_accvgpr_write_b32 a206, v58
v_accvgpr_write_b32 a207, v59
v_mfma_f32_16x16x32_bf16 v[160:163], v[180:183], v[232:235], v[160:163]
s_add_u32 m0, s64, 3136
s_sub_u32 s57, 150528, s16
buffer_load_dwordx4 v9, s[36:39], s57 offen nt lds
v_mfma_f32_16x16x32_bf16 v[92:95], v[172:175], v[236:239], v[92:95]
ds_read_b128 v[216:219], v16 offset:53248
ds_write_b64 v0, v[42:43] offset:1024
ds_write_b64 v0, v[40:41]
v_mfma_f32_16x16x32_bf16 v[128:131], v[176:179], v[236:239], v[128:131]
buffer_load_dwordx4 v10, s[36:39], s57 offen offset:1024 nt lds
v_mfma_f32_16x16x32_bf16 v[164:167], v[180:183], v[236:239], v[164:167]
v_mfma_f32_16x16x32_bf16 v[96:99], v[172:175], v[240:243], v[96:99]
buffer_load_dwordx4 v11, s[36:39], s57 offen offset:2048 nt lds
v_mfma_f32_16x16x32_bf16 v[132:135], v[176:179], v[240:243], v[132:135]
v_mfma_f32_16x16x32_bf16 v[168:171], v[180:183], v[240:243], v[168:171]
s_waitcnt vmcnt(12) lgkmcnt(0)
s_barrier
v_mfma_f32_16x16x32_bf16 v[64:67], v[184:187], v[244:247], v[64:67]
ds_read_b64_tr_b16 v[172:173], v17 offset:24576
v_mfma_f32_16x16x32_bf16 v[100:103], v[188:191], v[244:247], v[100:103]
s_add_u32 m0, s63, 12288
s_mul_i32 s56, s61, 6144
s_add_u32 s56, s56, 393216
buffer_load_dwordx4 v6, s[32:35], s56 offen lds
v_mfma_f32_16x16x32_bf16 v[136:139], v[192:195], v[244:247], v[136:139]
ds_read_b64_tr_b16 v[174:175], v17 offset:26112
v_mfma_f32_16x16x32_bf16 v[68:71], v[184:187], v[248:251], v[68:71]
ds_read_b64_tr_b16 v[176:177], v18 offset:24576
v_mfma_f32_16x16x32_bf16 v[104:107], v[188:191], v[248:251], v[104:107]
ds_read_b64_tr_b16 v[178:179], v18 offset:26112
v_mfma_f32_16x16x32_bf16 v[140:143], v[192:195], v[248:251], v[140:143]
ds_read_b64_tr_b16 v[180:181], v19 offset:24576
v_mfma_f32_16x16x32_bf16 v[72:75], v[184:187], v[252:255], v[72:75]
buffer_load_dwordx4 v7, s[32:35], s56 offen offset:1024 lds
v_mfma_f32_16x16x32_bf16 v[108:111], v[188:191], v[252:255], v[108:111]
ds_read_b64_tr_b16 v[182:183], v19 offset:26112
v_mfma_f32_16x16x32_bf16 v[144:147], v[192:195], v[252:255], v[144:147]
ds_read_b128 v[220:223], v15
v_mfma_f32_16x16x32_bf16 v[76:79], v[184:187], v[196:199], v[76:79]
ds_read_b128 v[224:227], v15 offset:2048
v_mfma_f32_16x16x32_bf16 v[112:115], v[188:191], v[196:199], v[112:115]
ds_read_b128 v[228:231], v15 offset:4096
v_mfma_f32_16x16x32_bf16 v[148:151], v[192:195], v[196:199], v[148:151]
buffer_load_dwordx4 v8, s[32:35], s56 offen offset:2048 lds
v_mfma_f32_16x16x32_bf16 v[80:83], v[184:187], v[200:203], v[80:83]
ds_read_b128 v[232:235], v15 offset:6144
v_mfma_f32_16x16x32_bf16 v[116:119], v[188:191], v[200:203], v[116:119]
ds_read_b128 v[236:239], v15 offset:8192
v_mfma_f32_16x16x32_bf16 v[152:155], v[192:195], v[200:203], v[152:155]
ds_read_b128 v[240:243], v15 offset:10240
v_mfma_f32_16x16x32_bf16 v[84:87], v[184:187], v[204:207], v[84:87]
s_add_u32 m0, s62, 18432
ds_read_b128 v[244:247], v15 offset:12288
v_mfma_f32_16x16x32_bf16 v[120:123], v[188:191], v[204:207], v[120:123]
buffer_load_dwordx4 v4, s[28:31], s61 offen offset:2560 lds
v_mfma_f32_16x16x32_bf16 v[156:159], v[192:195], v[204:207], v[156:159]
ds_read_b128 v[248:251], v15 offset:14336
v_mfma_f32_16x16x32_bf16 v[88:91], v[184:187], v[208:211], v[88:91]
ds_read_b128 v[252:255], v15 offset:16384
v_mfma_f32_16x16x32_bf16 v[124:127], v[188:191], v[208:211], v[124:127]
ds_read_b128 a[200:203], v55
v_mfma_f32_16x16x32_bf16 v[160:163], v[192:195], v[208:211], v[160:163]
v_mfma_f32_16x16x32_bf16 v[92:95], v[184:187], v[212:215], v[92:95]
buffer_load_dwordx4 v5, s[28:31], s61 offen offset:3584 lds
v_mfma_f32_16x16x32_bf16 v[128:131], v[188:191], v[212:215], v[128:131]
v_mfma_f32_16x16x32_bf16 v[164:167], v[192:195], v[212:215], v[164:167]
v_mfma_f32_16x16x32_bf16 v[96:99], v[184:187], v[216:219], v[96:99]
v_mfma_f32_16x16x32_bf16 v[132:135], v[188:191], v[216:219], v[132:135]
v_mfma_f32_16x16x32_bf16 v[168:171], v[192:195], v[216:219], v[168:171]
s_waitcnt lgkmcnt(0)
s_barrier
v_mfma_f32_16x16x32_bf16 v[64:67], v[172:175], v[220:223], v[64:67]
ds_read_b64_tr_b16 v[184:185], v17 offset:36864
v_mfma_f32_16x16x32_bf16 v[100:103], v[176:179], v[220:223], v[100:103]
s_add_u32 m0, s63, 24576
s_mul_i32 s56, s69, 6144
buffer_load_dwordx4 v6, s[32:35], s56 offen lds
v_mfma_f32_16x16x32_bf16 v[136:139], v[180:183], v[220:223], v[136:139]
ds_read_b64_tr_b16 v[186:187], v17 offset:38400
v_mfma_f32_16x16x32_bf16 v[68:71], v[172:175], v[224:227], v[68:71]
ds_read_b64_tr_b16 v[188:189], v18 offset:36864
v_mfma_f32_16x16x32_bf16 v[104:107], v[176:179], v[224:227], v[104:107]
ds_read_b64_tr_b16 v[190:191], v18 offset:38400
v_mfma_f32_16x16x32_bf16 v[140:143], v[180:183], v[224:227], v[140:143]
buffer_load_dwordx4 v7, s[32:35], s56 offen offset:1024 lds
v_mfma_f32_16x16x32_bf16 v[72:75], v[172:175], v[228:231], v[72:75]
ds_read_b64_tr_b16 v[192:193], v19 offset:36864
v_mfma_f32_16x16x32_bf16 v[108:111], v[176:179], v[228:231], v[108:111]
ds_read_b64_tr_b16 v[194:195], v19 offset:38400
v_mfma_f32_16x16x32_bf16 v[144:147], v[180:183], v[228:231], v[144:147]
ds_read_b128 v[196:199], v16
v_mfma_f32_16x16x32_bf16 v[76:79], v[172:175], v[232:235], v[76:79]
buffer_load_dwordx4 v8, s[32:35], s56 offen offset:2048 lds
v_mfma_f32_16x16x32_bf16 v[112:115], v[176:179], v[232:235], v[112:115]
ds_read_b128 v[200:203], v16 offset:2048
v_mfma_f32_16x16x32_bf16 v[148:151], v[180:183], v[232:235], v[148:151]
ds_read_b128 v[204:207], v16 offset:4096
v_mfma_f32_16x16x32_bf16 v[80:83], v[172:175], v[236:239], v[80:83]
ds_read_b128 v[208:211], v16 offset:6144
v_mfma_f32_16x16x32_bf16 v[116:119], v[176:179], v[236:239], v[116:119]
ds_read_b128 v[212:215], v16 offset:8192
v_mfma_f32_16x16x32_bf16 v[152:155], v[180:183], v[236:239], v[152:155]
s_add_u32 m0, s62, 36864
s_mov_b32 exec_hi, 0
buffer_load_dwordx4 v1, s[28:31], s69 offen lds
s_mov_b32 exec_hi, -1
v_mfma_f32_16x16x32_bf16 v[84:87], v[172:175], v[240:243], v[84:87]
ds_read_b128 v[216:219], v16 offset:10240
v_mfma_f32_16x16x32_bf16 v[120:123], v[176:179], v[240:243], v[120:123]
ds_read_b128 v[220:223], v16 offset:12288
v_mfma_f32_16x16x32_bf16 v[156:159], v[180:183], v[240:243], v[156:159]
ds_read_b128 v[224:227], v16 offset:14336
v_mfma_f32_16x16x32_bf16 v[88:91], v[172:175], v[244:247], v[88:91]
buffer_load_dwordx4 v2, s[28:31], s69 offen offset:512 lds
v_mfma_f32_16x16x32_bf16 v[124:127], v[176:179], v[244:247], v[124:127]
ds_read_b128 v[228:231], v16 offset:16384
v_mfma_f32_16x16x32_bf16 v[160:163], v[180:183], v[244:247], v[160:163]
v_mfma_f32_16x16x32_bf16 v[92:95], v[172:175], v[248:251], v[92:95]
v_mfma_f32_16x16x32_bf16 v[128:131], v[176:179], v[248:251], v[128:131]
buffer_load_dwordx4 v3, s[28:31], s69 offen offset:1536 lds
v_mfma_f32_16x16x32_bf16 v[164:167], v[180:183], v[248:251], v[164:167]
v_mfma_f32_16x16x32_bf16 v[96:99], v[172:175], v[252:255], v[96:99]
v_mfma_f32_16x16x32_bf16 v[132:135], v[176:179], v[252:255], v[132:135]
v_mfma_f32_16x16x32_bf16 v[168:171], v[180:183], v[252:255], v[168:171]
s_waitcnt vmcnt(6) lgkmcnt(9)
s_barrier
s_waitcnt lgkmcnt(8)
v_mfma_f32_16x16x32_bf16 v[64:67], v[184:187], v[196:199], v[64:67]
ds_read_b64_tr_b16 v[172:173], v17
v_mfma_f32_16x16x32_bf16 v[100:103], v[188:191], v[196:199], v[100:103]
s_add_u32 m0, s63, 36864
s_mul_i32 s56, s69, 6144
s_add_u32 s56, s56, 393216
buffer_load_dwordx4 v6, s[32:35], s56 offen lds
v_mfma_f32_16x16x32_bf16 v[136:139], v[192:195], v[196:199], v[136:139]
s_waitcnt lgkmcnt(8)
ds_read_b64_tr_b16 v[174:175], v17 offset:1536
v_mfma_f32_16x16x32_bf16 v[68:71], v[184:187], v[200:203], v[68:71]
ds_read_b64_tr_b16 v[176:177], v18
v_mfma_f32_16x16x32_bf16 v[104:107], v[188:191], v[200:203], v[104:107]
ds_read_b64_tr_b16 v[178:179], v18 offset:1536
v_mfma_f32_16x16x32_bf16 v[140:143], v[192:195], v[200:203], v[140:143]
s_waitcnt lgkmcnt(10)
ds_read_b64_tr_b16 v[180:181], v19
v_mfma_f32_16x16x32_bf16 v[72:75], v[184:187], v[204:207], v[72:75]
buffer_load_dwordx4 v7, s[32:35], s56 offen offset:1024 lds
v_mfma_f32_16x16x32_bf16 v[108:111], v[188:191], v[204:207], v[108:111]
ds_read_b64_tr_b16 v[182:183], v19 offset:1536
v_mfma_f32_16x16x32_bf16 v[144:147], v[192:195], v[204:207], v[144:147]
s_waitcnt lgkmcnt(11)
ds_read_b128 v[232:235], v15 offset:18432
v_mfma_f32_16x16x32_bf16 v[76:79], v[184:187], v[208:211], v[76:79]
ds_read_b128 v[236:239], v15 offset:20480
v_mfma_f32_16x16x32_bf16 v[112:115], v[188:191], v[208:211], v[112:115]
ds_read_b128 v[240:243], v15 offset:22528
v_mfma_f32_16x16x32_bf16 v[148:151], v[192:195], v[208:211], v[148:151]
s_waitcnt lgkmcnt(13)
buffer_load_dwordx4 v8, s[32:35], s56 offen offset:2048 lds
v_mfma_f32_16x16x32_bf16 v[80:83], v[184:187], v[212:215], v[80:83]
ds_read_b128 v[244:247], v15 offset:24576
v_mfma_f32_16x16x32_bf16 v[116:119], v[188:191], v[212:215], v[116:119]
ds_read_b128 v[248:251], v15 offset:26624
v_mfma_f32_16x16x32_bf16 v[152:155], v[192:195], v[212:215], v[152:155]
s_waitcnt lgkmcnt(14)
ds_read_b128 v[252:255], v15 offset:28672
v_mfma_f32_16x16x32_bf16 v[84:87], v[184:187], v[216:219], v[84:87]
s_add_u32 m0, s62, 36864
ds_read_b128 v[196:199], v15 offset:30720
v_mfma_f32_16x16x32_bf16 v[120:123], v[188:191], v[216:219], v[120:123]
buffer_load_dwordx4 v4, s[28:31], s69 offen offset:2560 lds
v_mfma_f32_16x16x32_bf16 v[156:159], v[192:195], v[216:219], v[156:159]
s_waitcnt lgkmcnt(15)
ds_read_b128 v[200:203], v15 offset:32768
v_mfma_f32_16x16x32_bf16 v[88:91], v[184:187], v[220:223], v[88:91]
ds_read_b128 v[204:207], v15 offset:34816
v_mfma_f32_16x16x32_bf16 v[124:127], v[188:191], v[220:223], v[124:127]
ds_read_b128 a[120:123], v23 offset:24832
v_mfma_f32_16x16x32_bf16 v[160:163], v[192:195], v[220:223], v[160:163]
s_waitcnt lgkmcnt(15)
ds_read_b128 a[124:127], v23 offset:24896
v_mfma_f32_16x16x32_bf16 v[92:95], v[184:187], v[224:227], v[92:95]
buffer_load_dwordx4 v5, s[28:31], s69 offen offset:3584 lds
v_mfma_f32_16x16x32_bf16 v[128:131], v[188:191], v[224:227], v[128:131]
ds_read_b128 a[128:131], v23 offset:24960
v_mfma_f32_16x16x32_bf16 v[164:167], v[192:195], v[224:227], v[164:167]
ds_read_b128 a[132:135], v23 offset:25024
v_mfma_f32_16x16x32_bf16 v[96:99], v[184:187], v[228:231], v[96:99]
ds_read_b128 a[136:139], v23 offset:25088
v_mfma_f32_16x16x32_bf16 v[132:135], v[188:191], v[228:231], v[132:135]
ds_read_b128 a[140:143], v23 offset:25152
v_mfma_f32_16x16x32_bf16 v[168:171], v[192:195], v[228:231], v[168:171]
s_waitcnt lgkmcnt(15)
s_barrier
s_waitcnt lgkmcnt(14)
v_mfma_f32_16x16x32_bf16 v[64:67], v[172:175], v[232:235], v[64:67]
ds_read_b64_tr_b16 v[184:185], v17 offset:12288
v_mfma_f32_16x16x32_bf16 v[100:103], v[176:179], v[232:235], v[100:103]
s_waitcnt lgkmcnt(1)
s_add_u32 m0, s64, 24832
s_sub_u32 s57, 172032, s16
buffer_load_dwordx4 v9, s[36:39], s57 offen nt lds
v_mfma_f32_16x16x32_bf16 v[136:139], v[180:183], v[232:235], v[136:139]
ds_read_b64_tr_b16 v[186:187], v17 offset:13824
v_mfma_f32_16x16x32_bf16 v[68:71], v[172:175], v[236:239], v[68:71]
ds_read_b64_tr_b16 v[188:189], v18 offset:12288
v_mfma_f32_16x16x32_bf16 v[104:107], v[176:179], v[236:239], v[104:107]
ds_read_b64_tr_b16 v[190:191], v18 offset:13824
v_mfma_f32_16x16x32_bf16 v[140:143], v[180:183], v[236:239], v[140:143]
buffer_load_dwordx4 v10, s[36:39], s57 offen offset:1024 nt lds
v_mfma_f32_16x16x32_bf16 v[72:75], v[172:175], v[240:243], v[72:75]
ds_read_b64_tr_b16 v[192:193], v19 offset:12288
v_mfma_f32_16x16x32_bf16 v[108:111], v[176:179], v[240:243], v[108:111]
ds_read_b64_tr_b16 v[194:195], v19 offset:13824
v_mfma_f32_16x16x32_bf16 v[144:147], v[180:183], v[240:243], v[144:147]
ds_read_b128 v[208:211], v16 offset:18432
v_mfma_f32_16x16x32_bf16 v[76:79], v[172:175], v[244:247], v[76:79]
buffer_load_dwordx4 v11, s[36:39], s57 offen offset:2048 nt lds
v_mfma_f32_16x16x32_bf16 v[112:115], v[176:179], v[244:247], v[112:115]
ds_read_b128 v[212:215], v16 offset:20480
v_mfma_f32_16x16x32_bf16 v[148:151], v[180:183], v[244:247], v[148:151]
ds_read_b128 v[216:219], v16 offset:22528
v_mfma_f32_16x16x32_bf16 v[80:83], v[172:175], v[248:251], v[80:83]
ds_read_b128 v[220:223], v16 offset:24576
v_mfma_f32_16x16x32_bf16 v[116:119], v[176:179], v[248:251], v[116:119]
ds_read_b128 v[224:227], v16 offset:26624
v_mfma_f32_16x16x32_bf16 v[152:155], v[180:183], v[248:251], v[152:155]
s_add_u32 m0, s64, 27968
s_sub_u32 s57, 175104, s16
buffer_load_dwordx4 v9, s[36:39], s57 offen nt lds
v_mfma_f32_16x16x32_bf16 v[84:87], v[172:175], v[252:255], v[84:87]
ds_read_b128 v[228:231], v16 offset:28672
v_mfma_f32_16x16x32_bf16 v[120:123], v[176:179], v[252:255], v[120:123]
ds_read_b128 v[232:235], v16 offset:30720
v_mfma_f32_16x16x32_bf16 v[156:159], v[180:183], v[252:255], v[156:159]
ds_read_b128 v[236:239], v16 offset:32768
v_mfma_f32_16x16x32_bf16 v[88:91], v[172:175], v[196:199], v[88:91]
buffer_load_dwordx4 v10, s[36:39], s57 offen offset:1024 nt lds
v_mfma_f32_16x16x32_bf16 v[124:127], v[176:179], v[196:199], v[124:127]
ds_read_b128 v[240:243], v16 offset:34816
v_mfma_f32_16x16x32_bf16 v[160:163], v[180:183], v[196:199], v[160:163]
v_mfma_f32_16x16x32_bf16 v[92:95], v[172:175], v[200:203], v[92:95]
v_mfma_f32_16x16x32_bf16 v[128:131], v[176:179], v[200:203], v[128:131]
buffer_load_dwordx4 v11, s[36:39], s57 offen offset:2048 nt lds
v_mfma_f32_16x16x32_bf16 v[164:167], v[180:183], v[200:203], v[164:167]
v_mfma_f32_16x16x32_bf16 v[96:99], v[172:175], v[204:207], v[96:99]
v_mfma_f32_16x16x32_bf16 v[132:135], v[176:179], v[204:207], v[132:135]
v_mfma_f32_16x16x32_bf16 v[168:171], v[180:183], v[204:207], v[168:171]
s_waitcnt vmcnt(6) lgkmcnt(9)
s_barrier
s_waitcnt lgkmcnt(8)
v_mfma_f32_16x16x32_bf16 v[64:67], v[184:187], v[208:211], v[64:67]
ds_read_b64_tr_b16 v[172:173], v17 offset:24576
v_mfma_f32_16x16x32_bf16 v[100:103], v[188:191], v[208:211], v[100:103]
ds_read_b64_tr_b16 v[174:175], v17 offset:26112
v_mfma_f32_16x16x32_bf16 v[136:139], v[192:195], v[208:211], v[136:139]
s_waitcnt lgkmcnt(9)
ds_read_b64_tr_b16 v[176:177], v18 offset:24576
v_mfma_f32_16x16x32_bf16 v[68:71], v[184:187], v[212:215], v[68:71]
ds_read_b64_tr_b16 v[178:179], v18 offset:26112
v_mfma_f32_16x16x32_bf16 v[104:107], v[188:191], v[212:215], v[104:107]
ds_read_b64_tr_b16 v[180:181], v19 offset:24576
v_mfma_f32_16x16x32_bf16 v[140:143], v[192:195], v[212:215], v[140:143]
s_waitcnt lgkmcnt(11)
ds_read_b64_tr_b16 v[182:183], v19 offset:26112
v_mfma_f32_16x16x32_bf16 v[72:75], v[184:187], v[216:219], v[72:75]
ds_read_b128 v[244:247], v15 offset:36864
v_mfma_f32_16x16x32_bf16 v[108:111], v[188:191], v[216:219], v[108:111]
ds_read_b128 v[248:251], v15 offset:38912
v_mfma_f32_16x16x32_bf16 v[144:147], v[192:195], v[216:219], v[144:147]
s_waitcnt lgkmcnt(13)
ds_read_b128 v[252:255], v15 offset:40960
v_mfma_f32_16x16x32_bf16 v[76:79], v[184:187], v[220:223], v[76:79]
ds_read_b128 v[196:199], v15 offset:43008
v_mfma_f32_16x16x32_bf16 v[112:115], v[188:191], v[220:223], v[112:115]
ds_read_b128 v[200:203], v15 offset:45056
v_mfma_f32_16x16x32_bf16 v[148:151], v[192:195], v[220:223], v[148:151]
s_waitcnt lgkmcnt(15)
ds_read_b128 v[204:207], v15 offset:47104
v_mfma_f32_16x16x32_bf16 v[80:83], v[184:187], v[224:227], v[80:83]
ds_read_b128 v[208:211], v15 offset:49152
v_mfma_f32_16x16x32_bf16 v[116:119], v[188:191], v[224:227], v[116:119]
ds_read_b128 v[212:215], v15 offset:51200
v_mfma_f32_16x16x32_bf16 v[152:155], v[192:195], v[224:227], v[152:155]
s_waitcnt lgkmcnt(15)
ds_read_b128 v[216:219], v15 offset:53248
v_mfma_f32_16x16x32_bf16 v[84:87], v[184:187], v[228:231], v[84:87]
v_mfma_f32_16x16x32_bf16 v[120:123], v[188:191], v[228:231], v[120:123]
v_mfma_f32_16x16x32_bf16 v[156:159], v[192:195], v[228:231], v[156:159]
v_mfma_f32_16x16x32_bf16 v[88:91], v[184:187], v[232:235], v[88:91]
v_mfma_f32_16x16x32_bf16 v[124:127], v[188:191], v[232:235], v[124:127]
v_mfma_f32_16x16x32_bf16 v[160:163], v[192:195], v[232:235], v[160:163]
v_mfma_f32_16x16x32_bf16 v[92:95], v[184:187], v[236:239], v[92:95]
v_mfma_f32_16x16x32_bf16 v[128:131], v[188:191], v[236:239], v[128:131]
v_mfma_f32_16x16x32_bf16 v[164:167], v[192:195], v[236:239], v[164:167]
s_waitcnt lgkmcnt(15)
v_mfma_f32_16x16x32_bf16 v[96:99], v[184:187], v[240:243], v[96:99]
v_mfma_f32_16x16x32_bf16 v[132:135], v[188:191], v[240:243], v[132:135]
v_mfma_f32_16x16x32_bf16 v[168:171], v[192:195], v[240:243], v[168:171]
s_waitcnt lgkmcnt(9)
s_barrier
s_waitcnt lgkmcnt(8)
v_mfma_f32_16x16x32_bf16 v[64:67], v[172:175], v[244:247], v[64:67]
ds_read_b64_tr_b16 v[184:185], v17 offset:36864
v_mfma_f32_16x16x32_bf16 v[100:103], v[176:179], v[244:247], v[100:103]
ds_read_b64_tr_b16 v[186:187], v17 offset:38400
v_mfma_f32_16x16x32_bf16 v[136:139], v[180:183], v[244:247], v[136:139]
s_waitcnt lgkmcnt(9)
ds_read_b64_tr_b16 v[188:189], v18 offset:36864
v_mfma_f32_16x16x32_bf16 v[68:71], v[172:175], v[248:251], v[68:71]
ds_read_b64_tr_b16 v[190:191], v18 offset:38400
v_mfma_f32_16x16x32_bf16 v[104:107], v[176:179], v[248:251], v[104:107]
ds_read_b64_tr_b16 v[192:193], v19 offset:36864
v_mfma_f32_16x16x32_bf16 v[140:143], v[180:183], v[248:251], v[140:143]
s_waitcnt lgkmcnt(11)
ds_read_b64_tr_b16 v[194:195], v19 offset:38400
v_mfma_f32_16x16x32_bf16 v[72:75], v[172:175], v[252:255], v[72:75]
ds_read_b128 v[220:223], v16 offset:36864
v_mfma_f32_16x16x32_bf16 v[108:111], v[176:179], v[252:255], v[108:111]
ds_read_b128 v[224:227], v16 offset:38912
v_mfma_f32_16x16x32_bf16 v[144:147], v[180:183], v[252:255], v[144:147]
s_waitcnt lgkmcnt(13)
ds_read_b128 v[228:231], v16 offset:40960
v_mfma_f32_16x16x32_bf16 v[76:79], v[172:175], v[196:199], v[76:79]
ds_read_b128 v[232:235], v16 offset:43008
v_mfma_f32_16x16x32_bf16 v[112:115], v[176:179], v[196:199], v[112:115]
ds_read_b128 v[236:239], v16 offset:45056
v_mfma_f32_16x16x32_bf16 v[148:151], v[180:183], v[196:199], v[148:151]
s_waitcnt lgkmcnt(4)
ds_read_b128 v[240:243], v16 offset:47104
v_mfma_f32_16x16x32_bf16 v[64:67], v[184:187], v[220:223], v[64:67]
ds_read_b128 v[244:247], v16 offset:49152
v_mfma_f32_16x16x32_bf16 v[100:103], v[188:191], v[220:223], v[100:103]
ds_read_b128 v[248:251], v16 offset:51200
v_mfma_f32_16x16x32_bf16 v[136:139], v[192:195], v[220:223], v[136:139]
ds_read_b128 v[252:255], v16 offset:53248
v_mfma_f32_16x16x32_bf16 v[80:83], v[172:175], v[200:203], v[80:83]
v_mfma_f32_16x16x32_bf16 v[116:119], v[176:179], v[200:203], v[116:119]
v_mfma_f32_16x16x32_bf16 v[152:155], v[180:183], v[200:203], v[152:155]
s_waitcnt lgkmcnt(7)
v_mfma_f32_16x16x32_bf16 v[68:71], v[184:187], v[224:227], v[68:71]
v_mfma_f32_16x16x32_bf16 v[104:107], v[188:191], v[224:227], v[104:107]
v_mfma_f32_16x16x32_bf16 v[140:143], v[192:195], v[224:227], v[140:143]
v_mfma_f32_16x16x32_bf16 v[84:87], v[172:175], v[204:207], v[84:87]
s_waitcnt lgkmcnt(0)
s_barrier
v_mfma_f32_16x16x32_bf16 v[120:123], v[176:179], v[204:207], v[120:123]
s_add_u32 m0, s65, 104960
s_add_u32 s57, s17, 24576
buffer_load_dwordx4 v12, s[40:43], s57 offen nt lds
v_cvt_pk_bf16_f32 v64, v64, v65
v_mfma_f32_16x16x32_bf16 v[156:159], v[180:183], v[204:207], v[156:159]
v_cvt_pk_bf16_f32 v65, v66, v67
v_cvt_pk_bf16_f32 v100, v100, v101
v_cvt_pk_bf16_f32 v101, v102, v103
v_mfma_f32_16x16x32_bf16 v[72:75], v[184:187], v[228:231], v[72:75]
ds_write_b64 v24, v[64:65]
v_cvt_pk_bf16_f32 v136, v136, v137
v_cvt_pk_bf16_f32 v137, v138, v139
v_mfma_f32_16x16x32_bf16 v[108:111], v[188:191], v[228:231], v[108:111]
ds_write_b64 v53, v[100:101]
v_cvt_pk_bf16_f32 v68, v68, v69
v_cvt_pk_bf16_f32 v69, v70, v71
v_mfma_f32_16x16x32_bf16 v[144:147], v[192:195], v[228:231], v[144:147]
ds_write_b64 v54, v[136:137]
v_cvt_pk_bf16_f32 v104, v104, v105
v_mfma_f32_16x16x32_bf16 v[88:91], v[172:175], v[208:211], v[88:91]
ds_write_b64 v24, v[68:69] offset:1024
v_cvt_pk_bf16_f32 v105, v106, v107
v_cvt_pk_bf16_f32 v140, v140, v141
v_mfma_f32_16x16x32_bf16 v[124:127], v[176:179], v[208:211], v[124:127]
buffer_load_dwordx4 v13, s[40:43], s57 offen offset:1024 nt lds
v_cvt_pk_bf16_f32 v141, v142, v143
v_mfma_f32_16x16x32_bf16 v[160:163], v[180:183], v[208:211], v[160:163]
ds_write_b64 v53, v[104:105] offset:1024
v_cvt_pk_bf16_f32 v72, v72, v73
v_mfma_f32_16x16x32_bf16 v[76:79], v[184:187], v[232:235], v[76:79]
ds_write_b64 v54, v[140:141] offset:1024
v_cvt_pk_bf16_f32 v73, v74, v75
v_cvt_pk_bf16_f32 v108, v108, v109
v_mfma_f32_16x16x32_bf16 v[112:115], v[188:191], v[232:235], v[112:115]
ds_write_b64 v24, v[72:73] offset:2048
v_cvt_pk_bf16_f32 v109, v110, v111
v_cvt_pk_bf16_f32 v144, v144, v145
v_mfma_f32_16x16x32_bf16 v[148:151], v[192:195], v[232:235], v[148:151]
ds_write_b64 v53, v[108:109] offset:2048
v_cvt_pk_bf16_f32 v145, v146, v147
v_mfma_f32_16x16x32_bf16 v[92:95], v[172:175], v[212:215], v[92:95]
v_cvt_pk_bf16_f32 v76, v76, v77
v_cvt_pk_bf16_f32 v77, v78, v79
v_mfma_f32_16x16x32_bf16 v[128:131], v[176:179], v[212:215], v[128:131]
buffer_load_dwordx4 v14, s[40:43], s57 offen offset:2048 nt lds
v_cvt_pk_bf16_f32 v112, v112, v113
v_mfma_f32_16x16x32_bf16 v[164:167], v[180:183], v[212:215], v[164:167]
ds_write_b64 v54, v[144:145] offset:2048
v_cvt_pk_bf16_f32 v113, v114, v115
v_mfma_f32_16x16x32_bf16 v[80:83], v[184:187], v[236:239], v[80:83]
ds_write_b64 v24, v[76:77] offset:3072
v_cvt_pk_bf16_f32 v148, v148, v149
v_mfma_f32_16x16x32_bf16 v[116:119], v[188:191], v[236:239], v[116:119]
ds_write_b64 v53, v[112:113] offset:3072
v_cvt_pk_bf16_f32 v149, v150, v151
v_mfma_f32_16x16x32_bf16 v[152:155], v[192:195], v[236:239], v[152:155]
ds_write_b64 v54, v[148:149] offset:3072
v_mfma_f32_16x16x32_bf16 v[96:99], v[172:175], v[216:219], v[96:99]
v_cvt_pk_bf16_f32 v80, v80, v81
v_cvt_pk_bf16_f32 v81, v82, v83
v_mfma_f32_16x16x32_bf16 v[132:135], v[176:179], v[216:219], v[132:135]
s_add_u32 m0, s65, 108032
s_add_u32 s57, s17, 27648
buffer_load_dwordx4 v12, s[40:43], s57 offen nt lds
v_cvt_pk_bf16_f32 v116, v116, v117
v_mfma_f32_16x16x32_bf16 v[168:171], v[180:183], v[216:219], v[168:171]
ds_write_b64 v24, v[80:81] offset:4096
v_cvt_pk_bf16_f32 v117, v118, v119
v_cvt_pk_bf16_f32 v152, v152, v153
v_mfma_f32_16x16x32_bf16 v[84:87], v[184:187], v[240:243], v[84:87]
ds_write_b64 v53, v[116:117] offset:4096
v_cvt_pk_bf16_f32 v153, v154, v155
v_mfma_f32_16x16x32_bf16 v[120:123], v[188:191], v[240:243], v[120:123]
v_mfma_f32_16x16x32_bf16 v[156:159], v[192:195], v[240:243], v[156:159]
ds_write_b64 v54, v[152:153] offset:4096
v_mfma_f32_16x16x32_bf16 v[88:91], v[184:187], v[244:247], v[88:91]
s_nop 1
v_cvt_pk_bf16_f32 v84, v84, v85
v_cvt_pk_bf16_f32 v85, v86, v87
v_mfma_f32_16x16x32_bf16 v[124:127], v[188:191], v[244:247], v[124:127]
buffer_load_dwordx4 v13, s[40:43], s57 offen offset:1024 nt lds
v_cvt_pk_bf16_f32 v120, v120, v121
v_mfma_f32_16x16x32_bf16 v[160:163], v[192:195], v[244:247], v[160:163]
ds_write_b64 v24, v[84:85] offset:5120
v_cvt_pk_bf16_f32 v121, v122, v123
v_mfma_f32_16x16x32_bf16 v[92:95], v[184:187], v[248:251], v[92:95]
v_cvt_pk_bf16_f32 v156, v156, v157
v_cvt_pk_bf16_f32 v157, v158, v159
s_waitcnt lgkmcnt(1)
s_barrier
v_mfma_f32_16x16x32_bf16 v[128:131], v[188:191], v[248:251], v[128:131]
ds_read_b128 a[144:147], v25
v_cvt_pk_bf16_f32 v88, v88, v89
v_cvt_pk_bf16_f32 v89, v90, v91
v_mfma_f32_16x16x32_bf16 v[164:167], v[192:195], v[248:251], v[164:167]
ds_read_b128 a[148:151], v25 offset:1024
v_cvt_pk_bf16_f32 v124, v124, v125
v_mfma_f32_16x16x32_bf16 v[96:99], v[184:187], v[252:255], v[96:99]
ds_read_b128 a[152:155], v25 offset:2048
ds_write_b64 v53, v[120:121] offset:5120
v_cvt_pk_bf16_f32 v125, v126, v127
v_mfma_f32_16x16x32_bf16 v[132:135], v[188:191], v[252:255], v[132:135]
buffer_load_dwordx4 v14, s[40:43], s57 offen offset:2048 nt lds
v_mfma_f32_16x16x32_bf16 v[168:171], v[192:195], v[252:255], v[168:171]
s_waitcnt lgkmcnt(3)
ds_read_b128 a[156:159], v25 offset:3072
v_cvt_pk_bf16_f32 v160, v160, v161
v_cvt_pk_bf16_f32 v161, v162, v163
v_mfma_f32_16x16x32_bf16 v[64:67], a[24:27], a[144:147], 0
ds_read_b128 a[160:163], v25 offset:4096
ds_write_b64 v54, v[156:157] offset:5120
v_cvt_pk_bf16_f32 v92, v92, v93
v_mfma_f32_16x16x32_bf16 v[100:103], a[48:51], a[144:147], 0
ds_read_b128 a[164:167], v25 offset:9216
ds_write_b64 v24, v[88:89] offset:6144
v_cvt_pk_bf16_f32 v93, v94, v95
v_mfma_f32_16x16x32_bf16 v[136:139], a[72:75], a[144:147], 0
ds_read_b128 a[168:171], v25 offset:10240
v_cvt_pk_bf16_f32 v128, v128, v129
v_cvt_pk_bf16_f32 v129, v130, v131
v_mfma_f32_16x16x32_bf16 v[172:175], a[0:3], a[144:147], 0
s_waitcnt lgkmcnt(8)
ds_read_b128 a[172:175], v25 offset:11264
ds_write_b64 v53, v[124:125] offset:6144
v_cvt_pk_bf16_f32 v164, v164, v165
v_mfma_f32_16x16x32_bf16 v[68:71], a[24:27], a[148:151], 0
ds_read_b128 a[176:179], v25 offset:12288
ds_write_b64 v54, v[160:161] offset:6144
v_cvt_pk_bf16_f32 v165, v166, v167
v_mfma_f32_16x16x32_bf16 v[104:107], a[48:51], a[148:151], 0
ds_read_b128 a[180:183], v25 offset:13312
v_cvt_pk_bf16_f32 v96, v96, v97
v_mfma_f32_16x16x32_bf16 v[140:143], a[72:75], a[148:151], 0
ds_write_b64 v24, v[92:93] offset:7168
v_cvt_pk_bf16_f32 v97, v98, v99
v_mfma_f32_16x16x32_bf16 v[176:179], a[0:3], a[148:151], 0
s_waitcnt lgkmcnt(13)
ds_write_b64 v53, v[128:129] offset:7168
v_cvt_pk_bf16_f32 v132, v132, v133
v_mfma_f32_16x16x32_bf16 v[72:75], a[24:27], a[152:155], 0
buffer_store_dwordx4 a[204:207], v30, s[44:47], 0 offen sc1
v_mfma_f32_16x16x32_bf16 v[108:111], a[48:51], a[152:155], 0
ds_write_b64 v54, v[164:165] offset:7168
v_cvt_pk_bf16_f32 v133, v134, v135
v_mfma_f32_16x16x32_bf16 v[144:147], a[72:75], a[152:155], 0
ds_write_b64 v24, v[96:97] offset:8192
v_cvt_pk_bf16_f32 v168, v168, v169
v_mfma_f32_16x16x32_bf16 v[180:183], a[0:3], a[152:155], 0
s_waitcnt lgkmcnt(14)
ds_write_b64 v53, v[132:133] offset:8192
v_cvt_pk_bf16_f32 v169, v170, v171
v_mfma_f32_16x16x32_bf16 v[76:79], a[24:27], a[156:159], 0
v_mfma_f32_16x16x32_bf16 v[112:115], a[48:51], a[156:159], 0
ds_write_b64 v54, v[168:169] offset:8192
v_mfma_f32_16x16x32_bf16 v[148:151], a[72:75], a[156:159], 0
v_mfma_f32_16x16x32_bf16 v[184:187], a[0:3], a[156:159], 0
s_waitcnt lgkmcnt(15)
v_mfma_f32_16x16x32_bf16 v[80:83], a[24:27], a[160:163], 0
v_mfma_f32_16x16x32_bf16 v[116:119], a[48:51], a[160:163], 0
v_mfma_f32_16x16x32_bf16 v[152:155], a[72:75], a[160:163], 0
v_mfma_f32_16x16x32_bf16 v[188:191], a[0:3], a[160:163], 0
buffer_store_dwordx4 a[208:211], v30, s[44:47], 0 offen offset:1024 sc1
s_waitcnt lgkmcnt(0)
s_barrier
v_mfma_f32_16x16x32_bf16 v[64:67], a[28:31], a[164:167], v[64:67]
ds_read_b128 v[248:251], v25 offset:5120
v_mfma_f32_16x16x32_bf16 v[100:103], a[52:55], a[164:167], v[100:103]
ds_read_b128 v[252:255], v25 offset:6144
v_mfma_f32_16x16x32_bf16 v[136:139], a[76:79], a[164:167], v[136:139]
ds_read_b128 v[208:211], v25 offset:7168
v_mfma_f32_16x16x32_bf16 v[172:175], a[4:7], a[164:167], v[172:175]
ds_read_b128 v[212:215], v25 offset:8192
v_mfma_f32_16x16x32_bf16 v[68:71], a[28:31], a[168:171], v[68:71]
ds_read_b128 v[216:219], v25 offset:14336
v_mfma_f32_16x16x32_bf16 v[104:107], a[52:55], a[168:171], v[104:107]
ds_read_b128 v[220:223], v25 offset:15360
v_mfma_f32_16x16x32_bf16 v[140:143], a[76:79], a[168:171], v[140:143]
v_mfma_f32_16x16x32_bf16 v[176:179], a[4:7], a[168:171], v[176:179]
v_mfma_f32_16x16x32_bf16 v[72:75], a[28:31], a[172:175], v[72:75]
ds_read_b128 v[224:227], v25 offset:16384
v_mfma_f32_16x16x32_bf16 v[108:111], a[52:55], a[172:175], v[108:111]
v_mfma_f32_16x16x32_bf16 v[144:147], a[76:79], a[172:175], v[144:147]
buffer_store_dwordx4 a[216:219], v30, s[44:47], 0 offen offset:2048 sc1
v_mfma_f32_16x16x32_bf16 v[180:183], a[4:7], a[172:175], v[180:183]
v_mfma_f32_16x16x32_bf16 v[76:79], a[28:31], a[176:179], v[76:79]
ds_read_b128 v[228:231], v25 offset:17408
v_mfma_f32_16x16x32_bf16 v[112:115], a[52:55], a[176:179], v[112:115]
v_mfma_f32_16x16x32_bf16 v[148:151], a[76:79], a[176:179], v[148:151]
v_mfma_f32_16x16x32_bf16 v[184:187], a[4:7], a[176:179], v[184:187]
v_mfma_f32_16x16x32_bf16 v[80:83], a[28:31], a[180:183], v[80:83]
ds_read_b128 v[232:235], v25 offset:18432
v_mfma_f32_16x16x32_bf16 v[116:119], a[52:55], a[180:183], v[116:119]
v_mfma_f32_16x16x32_bf16 v[152:155], a[76:79], a[180:183], v[152:155]
v_mfma_f32_16x16x32_bf16 v[188:191], a[4:7], a[180:183], v[188:191]
s_waitcnt lgkmcnt(8)
v_mfma_f32_16x16x32_bf16 v[84:87], a[24:27], v[248:251], 0
ds_read_b128 v[236:239], v25 offset:19456
v_mfma_f32_16x16x32_bf16 v[120:123], a[48:51], v[248:251], 0
buffer_store_dwordx4 a[220:223], v30, s[44:47], 0 offen offset:3072 sc1
v_mfma_f32_16x16x32_bf16 v[156:159], a[72:75], v[248:251], 0
v_mfma_f32_16x16x32_bf16 v[192:195], a[0:3], v[248:251], 0
s_waitcnt lgkmcnt(8)
v_mfma_f32_16x16x32_bf16 v[88:91], a[24:27], v[252:255], 0
ds_read_b128 v[240:243], v25 offset:20480
v_mfma_f32_16x16x32_bf16 v[124:127], a[48:51], v[252:255], 0
ds_read_b128 a[144:147], v23
v_mfma_f32_16x16x32_bf16 v[160:163], a[72:75], v[252:255], 0
v_mfma_f32_16x16x32_bf16 v[196:199], a[0:3], v[252:255], 0
s_waitcnt lgkmcnt(9)
ds_read_b128 a[148:151], v23 offset:64
v_mfma_f32_16x16x32_bf16 v[92:95], a[24:27], v[208:211], 0
ds_read_b128 v[244:247], v25 offset:21504
v_mfma_f32_16x16x32_bf16 v[128:131], a[48:51], v[208:211], 0
ds_read_b128 a[152:155], v23 offset:128
v_mfma_f32_16x16x32_bf16 v[164:167], a[72:75], v[208:211], 0
v_mfma_f32_16x16x32_bf16 v[200:203], a[0:3], v[208:211], 0
s_waitcnt lgkmcnt(11)
ds_read_b128 a[156:159], v23 offset:192
v_mfma_f32_16x16x32_bf16 v[96:99], a[24:27], v[212:215], 0
ds_read_b128 v[248:251], v25 offset:22528
v_mfma_f32_16x16x32_bf16 v[132:135], a[48:51], v[212:215], 0
buffer_store_dwordx4 a[228:231], v30, s[44:47], s67 offen sc1
v_mfma_f32_16x16x32_bf16 v[168:171], a[72:75], v[212:215], 0
ds_read_b128 a[160:163], v23 offset:256
v_mfma_f32_16x16x32_bf16 v[204:207], a[0:3], v[212:215], 0
s_waitcnt lgkmcnt(13)
v_mfma_f32_16x16x32_bf16 v[84:87], a[28:31], v[216:219], v[84:87]
ds_read_b128 v[252:255], v25 offset:23552
v_mfma_f32_16x16x32_bf16 v[120:123], a[52:55], v[216:219], v[120:123]
ds_read_b128 a[164:167], v23 offset:320
v_mfma_f32_16x16x32_bf16 v[156:159], a[76:79], v[216:219], v[156:159]
v_mfma_f32_16x16x32_bf16 v[192:195], a[4:7], v[216:219], v[192:195]
s_waitcnt lgkmcnt(14)
v_mfma_f32_16x16x32_bf16 v[88:91], a[28:31], v[220:223], v[88:91]
ds_read_b128 v[208:211], v25 offset:24576
v_mfma_f32_16x16x32_bf16 v[124:127], a[52:55], v[220:223], v[124:127]
v_mfma_f32_16x16x32_bf16 v[160:163], a[76:79], v[220:223], v[160:163]
v_mfma_f32_16x16x32_bf16 v[196:199], a[4:7], v[220:223], v[196:199]
s_waitcnt lgkmcnt(1)
s_barrier
v_mfma_f32_16x16x32_bf16 v[92:95], a[28:31], v[224:227], v[92:95]
ds_read_b128 v[212:215], v25 offset:25600
v_mfma_f32_16x16x32_bf16 v[128:131], a[52:55], v[224:227], v[128:131]
buffer_store_dwordx4 a[232:235], v30, s[44:47], s67 offen offset:1024 sc1
v_mfma_f32_16x16x32_bf16 v[164:167], a[76:79], v[224:227], v[164:167]
s_add_u32 m0, s65, 55296
s_add_u32 s57, s17, 0
buffer_load_dwordx4 v12, s[40:43], s57 offen nt lds
v_mfma_f32_16x16x32_bf16 v[200:203], a[4:7], v[224:227], v[200:203]
v_mfma_f32_16x16x32_bf16 v[96:99], a[28:31], v[228:231], v[96:99]
ds_read_b128 v[216:219], v25 offset:26624
v_mfma_f32_16x16x32_bf16 v[132:135], a[52:55], v[228:231], v[132:135]
v_mfma_f32_16x16x32_bf16 v[168:171], a[76:79], v[228:231], v[168:171]
v_mfma_f32_16x16x32_bf16 v[204:207], a[4:7], v[228:231], v[204:207]
v_mfma_f32_16x16x32_bf16 v[64:67], a[32:35], v[232:235], v[64:67]
ds_read_b128 v[220:223], v25 offset:27648
v_mfma_f32_16x16x32_bf16 v[100:103], a[56:59], v[232:235], v[100:103]
v_mfma_f32_16x16x32_bf16 v[136:139], a[80:83], v[232:235], v[136:139]
v_mfma_f32_16x16x32_bf16 v[172:175], a[8:11], v[232:235], v[172:175]
v_mfma_f32_16x16x32_bf16 v[68:71], a[32:35], v[236:239], v[68:71]
ds_read_b128 v[224:227], v25 offset:28672
v_mfma_f32_16x16x32_bf16 v[104:107], a[56:59], v[236:239], v[104:107]
buffer_store_dwordx4 a[240:243], v30, s[44:47], s67 offen offset:2048 sc1
v_mfma_f32_16x16x32_bf16 v[140:143], a[80:83], v[236:239], v[140:143]
v_mfma_f32_16x16x32_bf16 v[176:179], a[8:11], v[236:239], v[176:179]
v_mfma_f32_16x16x32_bf16 v[72:75], a[32:35], v[240:243], v[72:75]
ds_read_b128 v[228:231], v25 offset:29696
v_mfma_f32_16x16x32_bf16 v[108:111], a[56:59], v[240:243], v[108:111]
v_mfma_f32_16x16x32_bf16 v[144:147], a[80:83], v[240:243], v[144:147]
v_mfma_f32_16x16x32_bf16 v[180:183], a[8:11], v[240:243], v[180:183]
v_mfma_f32_16x16x32_bf16 v[76:79], a[32:35], v[244:247], v[76:79]
ds_read_b128 v[232:235], v25 offset:30720
v_mfma_f32_16x16x32_bf16 v[112:115], a[56:59], v[244:247], v[112:115]
v_mfma_f32_16x16x32_bf16 v[148:151], a[80:83], v[244:247], v[148:151]
v_mfma_f32_16x16x32_bf16 v[184:187], a[8:11], v[244:247], v[184:187]
v_mfma_f32_16x16x32_bf16 v[80:83], a[32:35], v[248:251], v[80:83]
ds_read_b128 v[236:239], v25 offset:31744
v_mfma_f32_16x16x32_bf16 v[116:119], a[56:59], v[248:251], v[116:119]
buffer_store_dwordx4 a[244:247], v30, s[44:47], s67 offen offset:3072 sc1
v_mfma_f32_16x16x32_bf16 v[152:155], a[80:83], v[248:251], v[152:155]
buffer_load_dwordx4 v13, s[40:43], s57 offen offset:1024 nt lds
v_mfma_f32_16x16x32_bf16 v[188:191], a[8:11], v[248:251], v[188:191]
v_mfma_f32_16x16x32_bf16 v[84:87], a[32:35], v[252:255], v[84:87]
ds_read_b128 v[240:243], v25 offset:32768
v_mfma_f32_16x16x32_bf16 v[120:123], a[56:59], v[252:255], v[120:123]
v_mfma_f32_16x16x32_bf16 v[156:159], a[80:83], v[252:255], v[156:159]
v_mfma_f32_16x16x32_bf16 v[192:195], a[8:11], v[252:255], v[192:195]
s_waitcnt lgkmcnt(8)
v_mfma_f32_16x16x32_bf16 v[88:91], a[32:35], v[208:211], v[88:91]
ds_read_b128 v[244:247], v25 offset:33792
v_mfma_f32_16x16x32_bf16 v[124:127], a[56:59], v[208:211], v[124:127]
v_mfma_f32_16x16x32_bf16 v[160:163], a[80:83], v[208:211], v[160:163]
v_mfma_f32_16x16x32_bf16 v[196:199], a[8:11], v[208:211], v[196:199]
s_waitcnt lgkmcnt(8)
v_mfma_f32_16x16x32_bf16 v[92:95], a[32:35], v[212:215], v[92:95]
ds_read_b128 v[248:251], v25 offset:34816
v_mfma_f32_16x16x32_bf16 v[128:131], a[56:59], v[212:215], v[128:131]
buffer_store_dwordx4 a[252:255], v30, s[44:47], s68 offen sc1
v_mfma_f32_16x16x32_bf16 v[164:167], a[80:83], v[212:215], v[164:167]
v_mfma_f32_16x16x32_bf16 v[200:203], a[8:11], v[212:215], v[200:203]
s_waitcnt lgkmcnt(8)
v_mfma_f32_16x16x32_bf16 v[96:99], a[32:35], v[216:219], v[96:99]
ds_read_b128 v[252:255], v25 offset:35840
v_mfma_f32_16x16x32_bf16 v[132:135], a[56:59], v[216:219], v[132:135]
v_mfma_f32_16x16x32_bf16 v[168:171], a[80:83], v[216:219], v[168:171]
v_mfma_f32_16x16x32_bf16 v[204:207], a[8:11], v[216:219], v[204:207]
s_waitcnt lgkmcnt(8)
v_mfma_f32_16x16x32_bf16 v[64:67], a[36:39], v[220:223], v[64:67]
ds_read_b128 v[208:211], v25 offset:36864
v_mfma_f32_16x16x32_bf16 v[100:103], a[60:63], v[220:223], v[100:103]
v_mfma_f32_16x16x32_bf16 v[136:139], a[84:87], v[220:223], v[136:139]
v_mfma_f32_16x16x32_bf16 v[172:175], a[12:15], v[220:223], v[172:175]
s_waitcnt lgkmcnt(8)
v_mfma_f32_16x16x32_bf16 v[68:71], a[36:39], v[224:227], v[68:71]
ds_read_b128 v[212:215], v25 offset:37888
v_mfma_f32_16x16x32_bf16 v[104:107], a[60:63], v[224:227], v[104:107]
buffer_store_dwordx4 a[200:203], v31, s[44:47], 0 offen sc1
v_mfma_f32_16x16x32_bf16 v[140:143], a[84:87], v[224:227], v[140:143]
buffer_load_dwordx4 v14, s[40:43], s57 offen offset:2048 nt lds
v_mfma_f32_16x16x32_bf16 v[176:179], a[12:15], v[224:227], v[176:179]
s_waitcnt lgkmcnt(8)
v_mfma_f32_16x16x32_bf16 v[72:75], a[36:39], v[228:231], v[72:75]
ds_read_b128 v[216:219], v25 offset:38912
v_mfma_f32_16x16x32_bf16 v[108:111], a[60:63], v[228:231], v[108:111]
v_mfma_f32_16x16x32_bf16 v[144:147], a[84:87], v[228:231], v[144:147]
v_mfma_f32_16x16x32_bf16 v[180:183], a[12:15], v[228:231], v[180:183]
s_waitcnt lgkmcnt(8)
v_mfma_f32_16x16x32_bf16 v[76:79], a[36:39], v[232:235], v[76:79]
ds_read_b128 v[220:223], v25 offset:39936
v_mfma_f32_16x16x32_bf16 v[112:115], a[60:63], v[232:235], v[112:115]
v_mfma_f32_16x16x32_bf16 v[148:151], a[84:87], v[232:235], v[148:151]
v_mfma_f32_16x16x32_bf16 v[184:187], a[12:15], v[232:235], v[184:187]
s_waitcnt lgkmcnt(8)
v_mfma_f32_16x16x32_bf16 v[80:83], a[36:39], v[236:239], v[80:83]
ds_read_b128 v[224:227], v25 offset:40960
v_mfma_f32_16x16x32_bf16 v[116:119], a[60:63], v[236:239], v[116:119]
buffer_store_dwordx4 a[212:215], v31, s[44:47], 0 offen offset:2048 sc1
v_mfma_f32_16x16x32_bf16 v[152:155], a[84:87], v[236:239], v[152:155]
v_mfma_f32_16x16x32_bf16 v[188:191], a[12:15], v[236:239], v[188:191]
s_waitcnt lgkmcnt(8)
v_mfma_f32_16x16x32_bf16 v[84:87], a[36:39], v[240:243], v[84:87]
ds_read_b128 v[228:231], v25 offset:41984
v_mfma_f32_16x16x32_bf16 v[120:123], a[60:63], v[240:243], v[120:123]
v_mfma_f32_16x16x32_bf16 v[156:159], a[84:87], v[240:243], v[156:159]
v_mfma_f32_16x16x32_bf16 v[192:195], a[12:15], v[240:243], v[192:195]
s_waitcnt lgkmcnt(8)
v_mfma_f32_16x16x32_bf16 v[88:91], a[36:39], v[244:247], v[88:91]
ds_read_b128 v[232:235], v25 offset:43008
v_mfma_f32_16x16x32_bf16 v[124:127], a[60:63], v[244:247], v[124:127]
v_mfma_f32_16x16x32_bf16 v[160:163], a[84:87], v[244:247], v[160:163]
v_mfma_f32_16x16x32_bf16 v[196:199], a[12:15], v[244:247], v[196:199]
s_waitcnt lgkmcnt(8)
v_mfma_f32_16x16x32_bf16 v[92:95], a[36:39], v[248:251], v[92:95]
ds_read_b128 v[236:239], v25 offset:44032
v_mfma_f32_16x16x32_bf16 v[128:131], a[60:63], v[248:251], v[128:131]
buffer_store_dwordx4 a[224:227], v31, s[44:47], s67 offen sc1
v_mfma_f32_16x16x32_bf16 v[164:167], a[84:87], v[248:251], v[164:167]
s_add_u32 m0, s65, 58368
s_add_u32 s57, s17, 3072
buffer_load_dwordx4 v12, s[40:43], s57 offen nt lds
v_mfma_f32_16x16x32_bf16 v[200:203], a[12:15], v[248:251], v[200:203]
s_waitcnt lgkmcnt(8)
v_mfma_f32_16x16x32_bf16 v[96:99], a[36:39], v[252:255], v[96:99]
ds_read_b128 v[240:243], v25 offset:45056
v_mfma_f32_16x16x32_bf16 v[132:135], a[60:63], v[252:255], v[132:135]
v_mfma_f32_16x16x32_bf16 v[168:171], a[84:87], v[252:255], v[168:171]
v_mfma_f32_16x16x32_bf16 v[204:207], a[12:15], v[252:255], v[204:207]
s_waitcnt lgkmcnt(8)
v_mfma_f32_16x16x32_bf16 v[64:67], a[40:43], v[208:211], v[64:67]
ds_read_b128 v[244:247], v25 offset:46080
v_mfma_f32_16x16x32_bf16 v[100:103], a[64:67], v[208:211], v[100:103]
v_mfma_f32_16x16x32_bf16 v[136:139], a[88:91], v[208:211], v[136:139]
v_mfma_f32_16x16x32_bf16 v[172:175], a[16:19], v[208:211], v[172:175]
s_waitcnt lgkmcnt(8)
v_mfma_f32_16x16x32_bf16 v[68:71], a[40:43], v[212:215], v[68:71]
ds_read_b128 v[248:251], v25 offset:47104
v_mfma_f32_16x16x32_bf16 v[104:107], a[64:67], v[212:215], v[104:107]
buffer_store_dwordx4 a[236:239], v31, s[44:47], s67 offen offset:2048 sc1
v_mfma_f32_16x16x32_bf16 v[140:143], a[88:91], v[212:215], v[140:143]
v_mfma_f32_16x16x32_bf16 v[176:179], a[16:19], v[212:215], v[176:179]
s_waitcnt lgkmcnt(8)
v_mfma_f32_16x16x32_bf16 v[72:75], a[40:43], v[216:219], v[72:75]
ds_read_b128 v[252:255], v25 offset:48128
v_mfma_f32_16x16x32_bf16 v[108:111], a[64:67], v[216:219], v[108:111]
v_mfma_f32_16x16x32_bf16 v[144:147], a[88:91], v[216:219], v[144:147]
v_mfma_f32_16x16x32_bf16 v[180:183], a[16:19], v[216:219], v[180:183]
s_waitcnt lgkmcnt(8)
v_mfma_f32_16x16x32_bf16 v[76:79], a[40:43], v[220:223], v[76:79]
ds_read_b128 v[208:211], v25 offset:49152
v_mfma_f32_16x16x32_bf16 v[112:115], a[64:67], v[220:223], v[112:115]
v_mfma_f32_16x16x32_bf16 v[148:151], a[88:91], v[220:223], v[148:151]
v_mfma_f32_16x16x32_bf16 v[184:187], a[16:19], v[220:223], v[184:187]
s_waitcnt lgkmcnt(8)
v_mfma_f32_16x16x32_bf16 v[80:83], a[40:43], v[224:227], v[80:83]
ds_read_b128 v[212:215], v25 offset:50176
v_mfma_f32_16x16x32_bf16 v[116:119], a[64:67], v[224:227], v[116:119]
buffer_store_dwordx4 a[248:251], v31, s[44:47], s100 offen sc1
v_mfma_f32_16x16x32_bf16 v[152:155], a[88:91], v[224:227], v[152:155]
s_lshl_b32 s51, s48, 2
s_add_u32 s51, s51, s49
s_mul_i32 s52, s51, 55296
s_add_u32 s44, s14, s52
s_addc_u32 s45, s15, 0
s_mov_b32 s46, 55296
buffer_load_dwordx4 v13, s[40:43], s57 offen offset:1024 nt lds
v_mfma_f32_16x16x32_bf16 v[188:191], a[16:19], v[224:227], v[188:191]
s_waitcnt lgkmcnt(8)
v_mfma_f32_16x16x32_bf16 v[84:87], a[40:43], v[228:231], v[84:87]
ds_read_b128 v[216:219], v25 offset:51200
v_mfma_f32_16x16x32_bf16 v[120:123], a[64:67], v[228:231], v[120:123]
v_mfma_f32_16x16x32_bf16 v[156:159], a[88:91], v[228:231], v[156:159]
v_mfma_f32_16x16x32_bf16 v[192:195], a[16:19], v[228:231], v[192:195]
s_waitcnt lgkmcnt(8)
v_mfma_f32_16x16x32_bf16 v[88:91], a[40:43], v[232:235], v[88:91]
ds_read_b128 v[220:223], v25 offset:52224
v_mfma_f32_16x16x32_bf16 v[124:127], a[64:67], v[232:235], v[124:127]
s_waitcnt vmcnt(25)
ds_read_b128 a[168:171], v23 offset:24832
v_mfma_f32_16x16x32_bf16 v[160:163], a[88:91], v[232:235], v[160:163]
v_mfma_f32_16x16x32_bf16 v[196:199], a[16:19], v[232:235], v[196:199]
s_waitcnt lgkmcnt(9)
ds_read_b128 a[172:175], v23 offset:24896
v_mfma_f32_16x16x32_bf16 v[92:95], a[40:43], v[236:239], v[92:95]
ds_read_b128 v[224:227], v25 offset:53248
v_mfma_f32_16x16x32_bf16 v[128:131], a[64:67], v[236:239], v[128:131]
ds_read_b128 a[176:179], v23 offset:24960
v_mfma_f32_16x16x32_bf16 v[164:167], a[88:91], v[236:239], v[164:167]
v_mfma_f32_16x16x32_bf16 v[200:203], a[16:19], v[236:239], v[200:203]
s_waitcnt lgkmcnt(11)
ds_read_b128 a[180:183], v23 offset:25024
v_mfma_f32_16x16x32_bf16 v[96:99], a[40:43], v[240:243], v[96:99]
ds_read_b128 v[228:231], v25 offset:54272
v_mfma_f32_16x16x32_bf16 v[132:135], a[64:67], v[240:243], v[132:135]
ds_read_b128 a[184:187], v23 offset:25088
v_mfma_f32_16x16x32_bf16 v[168:171], a[88:91], v[240:243], v[168:171]
v_mfma_f32_16x16x32_bf16 v[204:207], a[16:19], v[240:243], v[204:207]
s_waitcnt lgkmcnt(13)
ds_read_b128 a[188:191], v23 offset:25152
v_mfma_f32_16x16x32_bf16 v[64:67], a[44:47], v[244:247], v[64:67]
ds_read_b128 a[216:219], v25
v_mfma_f32_16x16x32_bf16 v[100:103], a[68:71], v[244:247], v[100:103]
v_mfma_f32_16x16x32_bf16 v[136:139], a[92:95], v[244:247], v[136:139]
v_mfma_f32_16x16x32_bf16 v[172:175], a[20:23], v[244:247], v[172:175]
s_waitcnt lgkmcnt(14)
v_mfma_f32_16x16x32_bf16 v[68:71], a[44:47], v[248:251], v[68:71]
ds_read_b128 a[220:223], v25 offset:1024
v_mfma_f32_16x16x32_bf16 v[104:107], a[68:71], v[248:251], v[104:107]
v_mfma_f32_16x16x32_bf16 v[140:143], a[92:95], v[248:251], v[140:143]
buffer_load_dwordx4 v14, s[40:43], s57 offen offset:2048 nt lds
v_max_f32 v32, v64, v65
v_mfma_f32_16x16x32_bf16 v[176:179], a[20:23], v[248:251], v[176:179]
s_waitcnt lgkmcnt(14)
v_max3_f32 v32, v32, v66, v67
v_max3_f32 v32, v32, v100, v101
v_mfma_f32_16x16x32_bf16 v[72:75], a[44:47], v[252:255], v[72:75]
ds_read_b128 a[224:227], v25 offset:2048
v_max3_f32 v32, v32, v102, v103
v_mfma_f32_16x16x32_bf16 v[108:111], a[68:71], v[252:255], v[108:111]
v_max3_f32 v32, v32, v136, v137
v_max3_f32 v32, v32, v138, v139
v_mfma_f32_16x16x32_bf16 v[144:147], a[92:95], v[252:255], v[144:147]
v_max3_f32 v32, v32, v172, v173
v_max3_f32 v32, v32, v174, v175
v_mfma_f32_16x16x32_bf16 v[180:183], a[20:23], v[252:255], v[180:183]
s_waitcnt lgkmcnt(14)
v_max_f32 v33, v68, v69
v_max3_f32 v33, v33, v70, v71
v_mfma_f32_16x16x32_bf16 v[76:79], a[44:47], v[208:211], v[76:79]
ds_read_b128 a[228:231], v25 offset:3072
v_max3_f32 v33, v33, v104, v105
v_mfma_f32_16x16x32_bf16 v[112:115], a[68:71], v[208:211], v[112:115]
ds_max_f32 v27, v32
v_max3_f32 v33, v33, v106, v107
v_mfma_f32_16x16x32_bf16 v[148:151], a[92:95], v[208:211], v[148:151]
v_max3_f32 v33, v33, v140, v141
v_max3_f32 v33, v33, v142, v143
v_mfma_f32_16x16x32_bf16 v[184:187], a[20:23], v[208:211], v[184:187]
s_waitcnt lgkmcnt(15)
v_max3_f32 v33, v33, v176, v177
v_max3_f32 v33, v33, v178, v179
v_mfma_f32_16x16x32_bf16 v[80:83], a[44:47], v[212:215], v[80:83]
ds_read_b128 a[232:235], v25 offset:4096
v_max_f32 v34, v72, v73
v_mfma_f32_16x16x32_bf16 v[116:119], a[68:71], v[212:215], v[116:119]
ds_max_f32 v27, v33 offset:4
v_max3_f32 v34, v34, v74, v75
v_mfma_f32_16x16x32_bf16 v[152:155], a[92:95], v[212:215], v[152:155]
v_max3_f32 v34, v34, v108, v109
v_max3_f32 v34, v34, v110, v111
v_mfma_f32_16x16x32_bf16 v[188:191], a[20:23], v[212:215], v[188:191]
s_waitcnt lgkmcnt(15)
v_max3_f32 v34, v34, v144, v145
v_max3_f32 v34, v34, v146, v147
v_mfma_f32_16x16x32_bf16 v[84:87], a[44:47], v[216:219], v[84:87]
ds_read_b128 a[236:239], v25 offset:5120
v_max3_f32 v34, v34, v180, v181
v_mfma_f32_16x16x32_bf16 v[120:123], a[68:71], v[216:219], v[120:123]
v_max3_f32 v34, v34, v182, v183
v_max_f32 v35, v76, v77
v_mfma_f32_16x16x32_bf16 v[156:159], a[92:95], v[216:219], v[156:159]
ds_max_f32 v27, v34 offset:8
v_max3_f32 v35, v35, v78, v79
v_mfma_f32_16x16x32_bf16 v[192:195], a[20:23], v[216:219], v[192:195]
v_max3_f32 v35, v35, v112, v113
v_max3_f32 v35, v35, v114, v115
v_mfma_f32_16x16x32_bf16 v[88:91], a[44:47], v[220:223], v[88:91]
ds_read_b128 a[240:243], v25 offset:6144
v_max3_f32 v35, v35, v148, v149
v_mfma_f32_16x16x32_bf16 v[124:127], a[68:71], v[220:223], v[124:127]
v_max3_f32 v35, v35, v150, v151
v_max3_f32 v35, v35, v184, v185
v_mfma_f32_16x16x32_bf16 v[160:163], a[92:95], v[220:223], v[160:163]
v_max3_f32 v35, v35, v186, v187
v_max_f32 v36, v80, v81
v_mfma_f32_16x16x32_bf16 v[196:199], a[20:23], v[220:223], v[196:199]
s_waitcnt lgkmcnt(15)
ds_max_f32 v27, v35 offset:12
v_max3_f32 v36, v36, v82, v83
v_mfma_f32_16x16x32_bf16 v[92:95], a[44:47], v[224:227], v[92:95]
ds_read_b128 a[244:247], v25 offset:7168
v_max3_f32 v36, v36, v116, v117
v_mfma_f32_16x16x32_bf16 v[128:131], a[68:71], v[224:227], v[128:131]
v_max3_f32 v36, v36, v118, v119
v_max3_f32 v36, v36, v152, v153
v_mfma_f32_16x16x32_bf16 v[164:167], a[92:95], v[224:227], v[164:167]
v_max3_f32 v36, v36, v154, v155
v_max3_f32 v36, v36, v188, v189
v_mfma_f32_16x16x32_bf16 v[200:203], a[20:23], v[224:227], v[200:203]
s_waitcnt lgkmcnt(14)
v_max3_f32 v36, v36, v190, v191
v_max_f32 v37, v84, v85
v_mfma_f32_16x16x32_bf16 v[96:99], a[44:47], v[228:231], v[96:99]
ds_read_b128 a[248:251], v25 offset:8192
v_max3_f32 v37, v37, v86, v87
v_mfma_f32_16x16x32_bf16 v[132:135], a[68:71], v[228:231], v[132:135]
ds_max_f32 v27, v36 offset:16
v_max3_f32 v37, v37, v120, v121
v_mfma_f32_16x16x32_bf16 v[168:171], a[92:95], v[228:231], v[168:171]
v_max3_f32 v37, v37, v122, v123
v_max3_f32 v37, v37, v156, v157
v_mfma_f32_16x16x32_bf16 v[204:207], a[20:23], v[228:231], v[204:207]
s_waitcnt lgkmcnt(13)
v_max3_f32 v37, v37, v158, v159
v_max3_f32 v37, v37, v192, v193
v_mfma_f32_16x16x32_bf16 a[0:3], a[96:99], a[216:219], 0
ds_read_b128 a[252:255], v25 offset:9216
v_max3_f32 v37, v37, v194, v195
v_mfma_f32_16x16x32_bf16 a[36:39], a[120:123], a[216:219], 0
v_max_f32 v38, v88, v89
v_max3_f32 v38, v38, v90, v91
v_mfma_f32_16x16x32_bf16 a[72:75], a[144:147], a[216:219], 0
ds_max_f32 v27, v37 offset:20
v_max3_f32 v38, v38, v124, v125
v_mfma_f32_16x16x32_bf16 v[220:223], a[168:171], a[216:219], 0
s_waitcnt lgkmcnt(14)
v_max3_f32 v38, v38, v126, v127
v_max3_f32 v38, v38, v160, v161
v_mfma_f32_16x16x32_bf16 a[4:7], a[96:99], a[220:223], 0
ds_read_b128 a[192:195], v25 offset:10240
v_max3_f32 v38, v38, v162, v163
v_mfma_f32_16x16x32_bf16 a[40:43], a[120:123], a[220:223], 0
v_max3_f32 v38, v38, v196, v197
v_max3_f32 v38, v38, v198, v199
v_mfma_f32_16x16x32_bf16 a[76:79], a[144:147], a[220:223], 0
v_max_f32 v39, v92, v93
v_max3_f32 v39, v39, v94, v95
v_mfma_f32_16x16x32_bf16 v[224:227], a[168:171], a[220:223], 0
s_waitcnt lgkmcnt(14)
ds_max_f32 v27, v38 offset:24
v_max3_f32 v39, v39, v128, v129
v_mfma_f32_16x16x32_bf16 a[8:11], a[96:99], a[224:227], 0
ds_read_b128 a[196:199], v25 offset:11264
v_max3_f32 v39, v39, v130, v131
v_mfma_f32_16x16x32_bf16 a[44:47], a[120:123], a[224:227], 0
v_max3_f32 v39, v39, v164, v165
v_max3_f32 v39, v39, v166, v167
s_barrier
v_mfma_f32_16x16x32_bf16 a[80:83], a[144:147], a[224:227], 0
s_add_u32 m0, s65, 80128
s_add_u32 s57, s17, 49152
buffer_load_dwordx4 v12, s[40:43], s57 offen nt lds
v_mfma_f32_16x16x32_bf16 v[228:231], a[168:171], a[224:227], 0
s_waitcnt lgkmcnt(15)
v_max3_f32 v39, v39, v200, v201
v_max3_f32 v39, v39, v202, v203
v_mfma_f32_16x16x32_bf16 a[12:15], a[96:99], a[228:231], 0
ds_read_b128 a[200:203], v25 offset:12288
v_max_f32 v40, v96, v97
v_mfma_f32_16x16x32_bf16 a[48:51], a[120:123], a[228:231], 0
ds_max_f32 v27, v39 offset:28
v_max3_f32 v40, v40, v98, v99
v_mfma_f32_16x16x32_bf16 a[84:87], a[144:147], a[228:231], 0
v_max3_f32 v40, v40, v132, v133
v_max3_f32 v40, v40, v134, v135
v_mfma_f32_16x16x32_bf16 v[232:235], a[168:171], a[228:231], 0
s_waitcnt lgkmcnt(15)
v_max3_f32 v40, v40, v168, v169
v_max3_f32 v40, v40, v170, v171
v_mfma_f32_16x16x32_bf16 a[16:19], a[96:99], a[232:235], 0
ds_read_b128 a[204:207], v25 offset:13312
v_max3_f32 v40, v40, v204, v205
v_mfma_f32_16x16x32_bf16 a[52:55], a[120:123], a[232:235], 0
v_max3_f32 v40, v40, v206, v207
v_mfma_f32_16x16x32_bf16 a[88:91], a[144:147], a[232:235], 0
ds_max_f32 v27, v40 offset:32
v_mfma_f32_16x16x32_bf16 v[236:239], a[168:171], a[232:235], 0
s_waitcnt lgkmcnt(15)
v_mfma_f32_16x16x32_bf16 a[20:23], a[96:99], a[236:239], 0
ds_read_b128 a[208:211], v25 offset:14336
v_mfma_f32_16x16x32_bf16 a[56:59], a[120:123], a[236:239], 0
v_mfma_f32_16x16x32_bf16 a[92:95], a[144:147], a[236:239], 0
v_mfma_f32_16x16x32_bf16 v[240:243], a[168:171], a[236:239], 0
s_waitcnt lgkmcnt(14)
v_mfma_f32_16x16x32_bf16 a[24:27], a[96:99], a[240:243], 0
ds_read_b128 a[212:215], v25 offset:15360
v_mfma_f32_16x16x32_bf16 a[60:63], a[120:123], a[240:243], 0
v_mfma_f32_16x16x32_bf16 v[208:211], a[144:147], a[240:243], 0
v_mfma_f32_16x16x32_bf16 v[244:247], a[168:171], a[240:243], 0
s_waitcnt lgkmcnt(13)
v_mfma_f32_16x16x32_bf16 a[28:31], a[96:99], a[244:247], 0
ds_read_b128 a[216:219], v25 offset:16384
v_mfma_f32_16x16x32_bf16 a[64:67], a[120:123], a[244:247], 0
buffer_load_dwordx4 v13, s[40:43], s57 offen offset:1024 nt lds
v_mfma_f32_16x16x32_bf16 v[212:215], a[144:147], a[244:247], 0
v_mfma_f32_16x16x32_bf16 v[248:251], a[168:171], a[244:247], 0
s_waitcnt lgkmcnt(13)
v_mfma_f32_16x16x32_bf16 a[32:35], a[96:99], a[248:251], 0
ds_read_b128 a[220:223], v25 offset:17408
v_mfma_f32_16x16x32_bf16 a[68:71], a[120:123], a[248:251], 0
v_mfma_f32_16x16x32_bf16 v[216:219], a[144:147], a[248:251], 0
v_mfma_f32_16x16x32_bf16 v[252:255], a[168:171], a[248:251], 0
s_waitcnt lgkmcnt(12)
v_mfma_f32_16x16x32_bf16 a[0:3], a[100:103], a[252:255], a[0:3]
ds_read_b128 a[224:227], v25 offset:18432
v_mfma_f32_16x16x32_bf16 a[36:39], a[124:127], a[252:255], a[36:39]
v_mfma_f32_16x16x32_bf16 a[72:75], a[148:151], a[252:255], a[72:75]
v_mfma_f32_16x16x32_bf16 v[220:223], a[172:175], a[252:255], v[220:223]
s_waitcnt lgkmcnt(11)
v_mfma_f32_16x16x32_bf16 a[4:7], a[100:103], a[192:195], a[4:7]
ds_read_b128 a[228:231], v25 offset:19456
v_mfma_f32_16x16x32_bf16 a[40:43], a[124:127], a[192:195], a[40:43]
s_waitcnt lgkmcnt(2)
s_barrier
v_mfma_f32_16x16x32_bf16 a[76:79], a[148:151], a[192:195], a[76:79]
ds_read_b128 v[32:35], v27
v_mfma_f32_16x16x32_bf16 v[224:227], a[172:175], a[192:195], v[224:227]
ds_read_b128 v[36:39], v27 offset:16
v_mfma_f32_16x16x32_bf16 a[8:11], a[100:103], a[196:199], a[8:11]
ds_read_b128 a[232:235], v25 offset:20480
v_mfma_f32_16x16x32_bf16 a[44:47], a[124:127], a[196:199], a[44:47]
ds_read_b32 v40, v27 offset:32
v_mfma_f32_16x16x32_bf16 a[80:83], a[148:151], a[196:199], a[80:83]
v_mfma_f32_16x16x32_bf16 v[228:231], a[172:175], a[196:199], v[228:231]
buffer_load_dwordx4 v14, s[40:43], s57 offen offset:2048 nt lds
v_mfma_f32_16x16x32_bf16 a[12:15], a[100:103], a[200:203], a[12:15]
ds_read_b128 a[236:239], v25 offset:21504
v_mfma_f32_16x16x32_bf16 a[48:51], a[124:127], a[200:203], a[48:51]
v_mfma_f32_16x16x32_bf16 a[84:87], a[148:151], a[200:203], a[84:87]
v_mfma_f32_16x16x32_bf16 v[232:235], a[172:175], a[200:203], v[232:235]
v_mfma_f32_16x16x32_bf16 a[16:19], a[100:103], a[204:207], a[16:19]
s_waitcnt lgkmcnt(4)
ds_read_b128 a[240:243], v25 offset:22528
v_mul_f32 v32, s66, v32
v_mul_f32 v33, s66, v33
v_mul_f32 v34, s66, v34
v_mfma_f32_16x16x32_bf16 a[52:55], a[124:127], a[204:207], a[52:55]
s_waitcnt lgkmcnt(4)
v_mul_f32 v35, s66, v35
v_mul_f32 v36, s66, v36
v_mul_f32 v37, s66, v37
v_mul_f32 v38, s66, v38
v_mfma_f32_16x16x32_bf16 a[88:91], a[148:151], a[204:207], a[88:91]
s_waitcnt lgkmcnt(2)
v_mul_f32 v39, s66, v39
v_mul_f32 v40, s66, v40
v_fma_f32 v64, v64, s66, -v32
v_fma_f32 v65, v65, s66, -v32
v_mfma_f32_16x16x32_bf16 v[236:239], a[172:175], a[204:207], v[236:239]
v_fma_f32 v66, v66, s66, -v32
v_fma_f32 v67, v67, s66, -v32
v_exp_f32 v64, v64
v_mfma_f32_16x16x32_bf16 a[20:23], a[100:103], a[208:211], a[20:23]
ds_read_b128 a[244:247], v25 offset:23552
v_exp_f32 v65, v65
v_mfma_f32_16x16x32_bf16 a[56:59], a[124:127], a[208:211], a[56:59]
v_exp_f32 v66, v66
v_exp_f32 v67, v67
v_mfma_f32_16x16x32_bf16 a[92:95], a[148:151], a[208:211], a[92:95]
v_add_f32 v44, v64, v65
v_add_f32 v44, v44, v66
v_add_f32 v44, v44, v67
v_mfma_f32_16x16x32_bf16 v[240:243], a[172:175], a[208:211], v[240:243]
v_cvt_pk_bf16_f32 v64, v64, v65
v_cvt_pk_bf16_f32 v65, v66, v67
v_fma_f32 v68, v68, s66, -v33
v_fma_f32 v69, v69, s66, -v33
v_mfma_f32_16x16x32_bf16 a[24:27], a[100:103], a[212:215], a[24:27]
ds_read_b128 a[248:251], v25 offset:24576
v_fma_f32 v70, v70, s66, -v33
v_fma_f32 v71, v71, s66, -v33
v_exp_f32 v68, v68
v_mfma_f32_16x16x32_bf16 a[60:63], a[124:127], a[212:215], a[60:63]
ds_write_b64 v26, v[64:65]
v_exp_f32 v69, v69
v_mfma_f32_16x16x32_bf16 v[208:211], a[148:151], a[212:215], v[208:211]
v_exp_f32 v70, v70
v_exp_f32 v71, v71
v_mfma_f32_16x16x32_bf16 v[244:247], a[172:175], a[212:215], v[244:247]
v_add_f32 v45, v68, v69
v_add_f32 v45, v45, v70
v_add_f32 v45, v45, v71
v_mfma_f32_16x16x32_bf16 a[28:31], a[100:103], a[216:219], a[28:31]
ds_read_b128 a[252:255], v25 offset:25600
v_cvt_pk_bf16_f32 v68, v68, v69
v_cvt_pk_bf16_f32 v69, v70, v71
v_fma_f32 v72, v72, s66, -v34
v_mfma_f32_16x16x32_bf16 a[64:67], a[124:127], a[216:219], a[64:67]
s_add_u32 m0, s65, 83200
s_add_u32 s57, s17, 52224
buffer_load_dwordx4 v12, s[40:43], s57 offen nt lds
v_fma_f32 v73, v73, s66, -v34
v_mfma_f32_16x16x32_bf16 v[212:215], a[148:151], a[216:219], v[212:215]
ds_write_b64 v26, v[68:69] offset:1024
v_fma_f32 v74, v74, s66, -v34
v_fma_f32 v75, v75, s66, -v34
v_exp_f32 v72, v72
v_mfma_f32_16x16x32_bf16 v[248:251], a[172:175], a[216:219], v[248:251]
v_exp_f32 v73, v73
v_exp_f32 v74, v74
v_mfma_f32_16x16x32_bf16 a[32:35], a[100:103], a[220:223], a[32:35]
ds_read_b128 a[192:195], v25 offset:26624
v_exp_f32 v75, v75
v_mfma_f32_16x16x32_bf16 a[68:71], a[124:127], a[220:223], a[68:71]
v_add_f32 v46, v72, v73
v_add_f32 v46, v46, v74
v_add_f32 v46, v46, v75
v_mfma_f32_16x16x32_bf16 v[216:219], a[148:151], a[220:223], v[216:219]
v_cvt_pk_bf16_f32 v72, v72, v73
v_cvt_pk_bf16_f32 v73, v74, v75
v_fma_f32 v76, v76, s66, -v35
v_fma_f32 v77, v77, s66, -v35
v_mfma_f32_16x16x32_bf16 v[252:255], a[172:175], a[220:223], v[252:255]
ds_write_b64 v26, v[72:73] offset:2048
v_fma_f32 v78, v78, s66, -v35
v_fma_f32 v79, v79, s66, -v35
v_mfma_f32_16x16x32_bf16 a[0:3], a[104:107], a[224:227], a[0:3]
ds_read_b128 a[196:199], v25 offset:27648
v_exp_f32 v76, v76
v_exp_f32 v77, v77
v_mfma_f32_16x16x32_bf16 a[36:39], a[128:131], a[224:227], a[36:39]
v_exp_f32 v78, v78
v_exp_f32 v79, v79
v_mfma_f32_16x16x32_bf16 a[72:75], a[152:155], a[224:227], a[72:75]
v_add_f32 v47, v76, v77
v_add_f32 v47, v47, v78
v_mfma_f32_16x16x32_bf16 v[220:223], a[176:179], a[224:227], v[220:223]
v_add_f32 v47, v47, v79
v_cvt_pk_bf16_f32 v76, v76, v77
v_cvt_pk_bf16_f32 v77, v78, v79
v_fma_f32 v80, v80, s66, -v36
v_mfma_f32_16x16x32_bf16 a[4:7], a[104:107], a[228:231], a[4:7]
ds_read_b128 a[200:203], v25 offset:28672
v_fma_f32 v81, v81, s66, -v36
v_fma_f32 v82, v82, s66, -v36
v_fma_f32 v83, v83, s66, -v36
v_mfma_f32_16x16x32_bf16 a[40:43], a[128:131], a[228:231], a[40:43]
ds_write_b64 v26, v[76:77] offset:3072
v_exp_f32 v80, v80
v_mfma_f32_16x16x32_bf16 a[76:79], a[152:155], a[228:231], a[76:79]
v_exp_f32 v81, v81
v_exp_f32 v82, v82
v_mfma_f32_16x16x32_bf16 v[224:227], a[176:179], a[228:231], v[224:227]
v_exp_f32 v83, v83
v_add_f32 v48, v80, v81
v_add_f32 v48, v48, v82
v_mfma_f32_16x16x32_bf16 a[8:11], a[104:107], a[232:235], a[8:11]
ds_read_b128 a[204:207], v25 offset:29696
v_add_f32 v48, v48, v83
v_cvt_pk_bf16_f32 v80, v80, v81
v_mfma_f32_16x16x32_bf16 a[44:47], a[128:131], a[232:235], a[44:47]
v_cvt_pk_bf16_f32 v81, v82, v83
v_fma_f32 v84, v84, s66, -v37
v_fma_f32 v85, v85, s66, -v37
v_fma_f32 v86, v86, s66, -v37
v_mfma_f32_16x16x32_bf16 a[80:83], a[152:155], a[232:235], a[80:83]
ds_write_b64 v26, v[80:81] offset:4096
v_fma_f32 v87, v87, s66, -v37
v_exp_f32 v84, v84
v_mfma_f32_16x16x32_bf16 v[228:231], a[176:179], a[232:235], v[228:231]
s_waitcnt lgkmcnt(13)
buffer_load_dwordx4 v13, s[40:43], s57 offen offset:1024 nt lds
v_exp_f32 v85, v85
v_mfma_f32_16x16x32_bf16 a[12:15], a[104:107], a[236:239], a[12:15]
ds_read_b128 a[208:211], v25 offset:30720
v_exp_f32 v86, v86
v_mfma_f32_16x16x32_bf16 a[48:51], a[128:131], a[236:239], a[48:51]
v_exp_f32 v87, v87
v_add_f32 v49, v84, v85
v_add_f32 v49, v49, v86
v_mfma_f32_16x16x32_bf16 a[84:87], a[152:155], a[236:239], a[84:87]
v_add_f32 v49, v49, v87
v_cvt_pk_bf16_f32 v84, v84, v85
v_cvt_pk_bf16_f32 v85, v86, v87
v_fma_f32 v88, v88, s66, -v38
v_mfma_f32_16x16x32_bf16 v[232:235], a[176:179], a[236:239], v[232:235]
s_waitcnt lgkmcnt(13)
ds_write_b64 v26, v[84:85] offset:5120
v_fma_f32 v89, v89, s66, -v38
v_fma_f32 v90, v90, s66, -v38
v_mfma_f32_16x16x32_bf16 a[16:19], a[104:107], a[240:243], a[16:19]
ds_read_b128 a[212:215], v25 offset:31744
v_fma_f32 v91, v91, s66, -v38
v_exp_f32 v88, v88
v_mfma_f32_16x16x32_bf16 a[52:55], a[128:131], a[240:243], a[52:55]
v_exp_f32 v89, v89
v_exp_f32 v90, v90
v_mfma_f32_16x16x32_bf16 a[88:91], a[152:155], a[240:243], a[88:91]
v_exp_f32 v91, v91
v_add_f32 v50, v88, v89
v_mfma_f32_16x16x32_bf16 v[236:239], a[176:179], a[240:243], v[236:239]
s_waitcnt lgkmcnt(14)
v_add_f32 v50, v50, v90
v_add_f32 v50, v50, v91
v_cvt_pk_bf16_f32 v88, v88, v89
v_cvt_pk_bf16_f32 v89, v90, v91
v_mfma_f32_16x16x32_bf16 a[20:23], a[104:107], a[244:247], a[20:23]
ds_read_b128 a[216:219], v25 offset:32768
v_fma_f32 v92, v92, s66, -v39
v_fma_f32 v93, v93, s66, -v39
v_fma_f32 v94, v94, s66, -v39
v_mfma_f32_16x16x32_bf16 a[56:59], a[128:131], a[244:247], a[56:59]
ds_write_b64 v26, v[88:89] offset:6144
v_fma_f32 v95, v95, s66, -v39
v_exp_f32 v92, v92
v_mfma_f32_16x16x32_bf16 a[92:95], a[152:155], a[244:247], a[92:95]
v_exp_f32 v93, v93
v_exp_f32 v94, v94
v_mfma_f32_16x16x32_bf16 v[240:243], a[176:179], a[244:247], v[240:243]
s_waitcnt lgkmcnt(15)
v_exp_f32 v95, v95
v_add_f32 v51, v92, v93
v_mfma_f32_16x16x32_bf16 a[24:27], a[104:107], a[248:251], a[24:27]
ds_read_b128 a[220:223], v25 offset:33792
v_add_f32 v51, v51, v94
v_add_f32 v51, v51, v95
v_mfma_f32_16x16x32_bf16 a[60:63], a[128:131], a[248:251], a[60:63]
v_cvt_pk_bf16_f32 v92, v92, v93
v_cvt_pk_bf16_f32 v93, v94, v95
v_fma_f32 v96, v96, s66, -v40
v_fma_f32 v97, v97, s66, -v40
v_mfma_f32_16x16x32_bf16 v[208:211], a[152:155], a[248:251], v[208:211]
ds_write_b64 v26, v[92:93] offset:7168
v_fma_f32 v98, v98, s66, -v40
v_fma_f32 v99, v99, s66, -v40
v_mfma_f32_16x16x32_bf16 v[244:247], a[176:179], a[248:251], v[244:247]
s_waitcnt lgkmcnt(15)
v_exp_f32 v96, v96
v_exp_f32 v97, v97
v_mfma_f32_16x16x32_bf16 a[28:31], a[104:107], a[252:255], a[28:31]
ds_read_b128 a[224:227], v25 offset:34816
v_exp_f32 v98, v98
v_exp_f32 v99, v99
v_mfma_f32_16x16x32_bf16 a[64:67], a[128:131], a[252:255], a[64:67]
buffer_load_dwordx4 v14, s[40:43], s57 offen offset:2048 nt lds
v_mfma_f32_16x16x32_bf16 v[212:215], a[152:155], a[252:255], v[212:215]
v_add_f32 v52, v96, v97
v_add_f32 v52, v52, v98
v_add_f32 v52, v52, v99
v_cvt_pk_bf16_f32 v96, v96, v97
v_mfma_f32_16x16x32_bf16 v[248:251], a[176:179], a[252:255], v[248:251]
s_waitcnt lgkmcnt(14)
v_cvt_pk_bf16_f32 v97, v98, v99
v_fma_f32 v100, v100, s66, -v32
v_fma_f32 v101, v101, s66, -v32
v_fma_f32 v102, v102, s66, -v32
v_mfma_f32_16x16x32_bf16 a[32:35], a[104:107], a[192:195], a[32:35]
ds_read_b128 a[228:231], v25 offset:35840
v_fma_f32 v103, v103, s66, -v32
v_exp_f32 v100, v100
v_mfma_f32_16x16x32_bf16 a[68:71], a[128:131], a[192:195], a[68:71]
ds_write_b64 v26, v[96:97] offset:8192
v_exp_f32 v101, v101
v_mfma_f32_16x16x32_bf16 v[216:219], a[152:155], a[192:195], v[216:219]
v_exp_f32 v102, v102
v_exp_f32 v103, v103
v_mfma_f32_16x16x32_bf16 v[252:255], a[176:179], a[192:195], v[252:255]
s_waitcnt lgkmcnt(14)
v_add_f32 v44, v44, v100
v_add_f32 v44, v44, v101
v_add_f32 v44, v44, v102
v_mfma_f32_16x16x32_bf16 a[0:3], a[108:111], a[196:199], a[0:3]
ds_read_b128 a[232:235], v25 offset:36864
v_add_f32 v44, v44, v103
v_cvt_pk_bf16_f32 v100, v100, v101
v_cvt_pk_bf16_f32 v101, v102, v103
v_mfma_f32_16x16x32_bf16 a[36:39], a[132:135], a[196:199], a[36:39]
v_fma_f32 v104, v104, s66, -v33
v_fma_f32 v105, v105, s66, -v33
v_fma_f32 v106, v106, s66, -v33
v_fma_f32 v107, v107, s66, -v33
v_mfma_f32_16x16x32_bf16 a[72:75], a[156:159], a[196:199], a[72:75]
v_exp_f32 v104, v104
v_exp_f32 v105, v105
v_mfma_f32_16x16x32_bf16 v[220:223], a[180:183], a[196:199], v[220:223]
s_waitcnt lgkmcnt(14)
v_exp_f32 v106, v106
v_exp_f32 v107, v107
v_mfma_f32_16x16x32_bf16 a[4:7], a[108:111], a[200:203], a[4:7]
ds_read_b128 a[236:239], v25 offset:37888
v_add_f32 v45, v45, v104
v_add_f32 v45, v45, v105
v_mfma_f32_16x16x32_bf16 a[40:43], a[132:135], a[200:203], a[40:43]
v_add_f32 v45, v45, v106
v_add_f32 v45, v45, v107
v_cvt_pk_bf16_f32 v104, v104, v105
v_mfma_f32_16x16x32_bf16 a[76:79], a[156:159], a[200:203], a[76:79]
v_cvt_pk_bf16_f32 v105, v106, v107
v_fma_f32 v108, v108, s66, -v34
v_fma_f32 v109, v109, s66, -v34
v_fma_f32 v110, v110, s66, -v34
v_mfma_f32_16x16x32_bf16 v[224:227], a[180:183], a[200:203], v[224:227]
s_waitcnt lgkmcnt(13)
v_fma_f32 v111, v111, s66, -v34
v_exp_f32 v108, v108
v_exp_f32 v109, v109
v_mfma_f32_16x16x32_bf16 a[8:11], a[108:111], a[204:207], a[8:11]
ds_read_b128 a[240:243], v25 offset:38912
v_exp_f32 v110, v110
v_mfma_f32_16x16x32_bf16 a[44:47], a[132:135], a[204:207], a[44:47]
v_exp_f32 v111, v111
v_add_f32 v46, v46, v108
v_mfma_f32_16x16x32_bf16 a[80:83], a[156:159], a[204:207], a[80:83]
v_add_f32 v46, v46, v109
v_add_f32 v46, v46, v110
v_add_f32 v46, v46, v111
v_mfma_f32_16x16x32_bf16 v[228:231], a[180:183], a[204:207], v[228:231]
s_waitcnt lgkmcnt(12)
v_cvt_pk_bf16_f32 v108, v108, v109
v_cvt_pk_bf16_f32 v109, v110, v111
v_fma_f32 v112, v112, s66, -v35
v_fma_f32 v113, v113, s66, -v35
v_mfma_f32_16x16x32_bf16 a[12:15], a[108:111], a[208:211], a[12:15]
ds_read_b128 a[244:247], v25 offset:39936
v_fma_f32 v114, v114, s66, -v35
v_fma_f32 v115, v115, s66, -v35
v_exp_f32 v112, v112
v_mfma_f32_16x16x32_bf16 a[48:51], a[132:135], a[208:211], a[48:51]
v_exp_f32 v113, v113
v_mfma_f32_16x16x32_bf16 a[84:87], a[156:159], a[208:211], a[84:87]
v_exp_f32 v114, v114
v_exp_f32 v115, v115
v_mfma_f32_16x16x32_bf16 v[232:235], a[180:183], a[208:211], v[232:235]
s_waitcnt lgkmcnt(11)
v_add_f32 v47, v47, v112
v_add_f32 v47, v47, v113
v_add_f32 v47, v47, v114
v_add_f32 v47, v47, v115
v_mfma_f32_16x16x32_bf16 a[16:19], a[108:111], a[212:215], a[16:19]
ds_read_b128 a[248:251], v25 offset:40960
v_cvt_pk_bf16_f32 v112, v112, v113
v_cvt_pk_bf16_f32 v113, v114, v115
v_mfma_f32_16x16x32_bf16 a[52:55], a[132:135], a[212:215], a[52:55]
s_add_u32 m0, s65, 129536
s_add_u32 s57, s17, 73728
buffer_load_dwordx4 v12, s[40:43], s57 offen nt lds
v_fma_f32 v116, v116, s66, -v36
v_fma_f32 v117, v117, s66, -v36
v_mfma_f32_16x16x32_bf16 a[88:91], a[156:159], a[212:215], a[88:91]
v_fma_f32 v118, v118, s66, -v36
v_fma_f32 v119, v119, s66, -v36
v_exp_f32 v116, v116
v_mfma_f32_16x16x32_bf16 v[236:239], a[180:183], a[212:215], v[236:239]
s_waitcnt lgkmcnt(11)
v_exp_f32 v117, v117
v_exp_f32 v118, v118
v_mfma_f32_16x16x32_bf16 a[20:23], a[108:111], a[216:219], a[20:23]
ds_read_b128 a[252:255], v25 offset:41984
v_exp_f32 v119, v119
v_mfma_f32_16x16x32_bf16 a[56:59], a[132:135], a[216:219], a[56:59]
v_add_f32 v48, v48, v116
v_add_f32 v48, v48, v117
v_add_f32 v48, v48, v118
v_mfma_f32_16x16x32_bf16 a[92:95], a[156:159], a[216:219], a[92:95]
v_add_f32 v48, v48, v119
v_cvt_pk_bf16_f32 v116, v116, v117
v_cvt_pk_bf16_f32 v117, v118, v119
v_fma_f32 v120, v120, s66, -v37
v_mfma_f32_16x16x32_bf16 v[240:243], a[180:183], a[216:219], v[240:243]
s_waitcnt lgkmcnt(10)
v_fma_f32 v121, v121, s66, -v37
v_fma_f32 v122, v122, s66, -v37
v_fma_f32 v123, v123, s66, -v37
v_exp_f32 v120, v120
v_mfma_f32_16x16x32_bf16 a[24:27], a[108:111], a[220:223], a[24:27]
ds_read_b128 a[192:195], v25 offset:43008
v_exp_f32 v121, v121
v_mfma_f32_16x16x32_bf16 a[60:63], a[132:135], a[220:223], a[60:63]
v_exp_f32 v122, v122
v_exp_f32 v123, v123
v_mfma_f32_16x16x32_bf16 v[208:211], a[156:159], a[220:223], v[208:211]
v_add_f32 v49, v49, v120
v_add_f32 v49, v49, v121
v_add_f32 v49, v49, v122
v_mfma_f32_16x16x32_bf16 v[244:247], a[180:183], a[220:223], v[244:247]
s_waitcnt lgkmcnt(9)
v_add_f32 v49, v49, v123
v_cvt_pk_bf16_f32 v120, v120, v121
v_cvt_pk_bf16_f32 v121, v122, v123
v_mfma_f32_16x16x32_bf16 a[28:31], a[108:111], a[224:227], a[28:31]
ds_read_b128 a[196:199], v25 offset:44032
v_fma_f32 v124, v124, s66, -v38
v_fma_f32 v125, v125, s66, -v38
v_fma_f32 v126, v126, s66, -v38
v_mfma_f32_16x16x32_bf16 a[64:67], a[132:135], a[224:227], a[64:67]
v_fma_f32 v127, v127, s66, -v38
v_exp_f32 v124, v124
v_mfma_f32_16x16x32_bf16 v[212:215], a[156:159], a[224:227], v[212:215]
v_exp_f32 v125, v125
v_exp_f32 v126, v126
v_mfma_f32_16x16x32_bf16 v[248:251], a[180:183], a[224:227], v[248:251]
s_waitcnt lgkmcnt(9)
v_exp_f32 v127, v127
v_add_f32 v50, v50, v124
v_add_f32 v50, v50, v125
v_mfma_f32_16x16x32_bf16 a[32:35], a[108:111], a[228:231], a[32:35]
ds_read_b128 a[200:203], v25 offset:45056
v_add_f32 v50, v50, v126
v_add_f32 v50, v50, v127
v_mfma_f32_16x16x32_bf16 a[68:71], a[132:135], a[228:231], a[68:71]
v_cvt_pk_bf16_f32 v124, v124, v125
v_cvt_pk_bf16_f32 v125, v126, v127
v_fma_f32 v128, v128, s66, -v39
v_fma_f32 v129, v129, s66, -v39
v_mfma_f32_16x16x32_bf16 v[216:219], a[156:159], a[228:231], v[216:219]
v_fma_f32 v130, v130, s66, -v39
v_fma_f32 v131, v131, s66, -v39
v_exp_f32 v128, v128
v_mfma_f32_16x16x32_bf16 v[252:255], a[180:183], a[228:231], v[252:255]
s_waitcnt lgkmcnt(8)
buffer_load_dwordx4 v13, s[40:43], s57 offen offset:1024 nt lds
v_exp_f32 v129, v129
v_mfma_f32_16x16x32_bf16 a[0:3], a[112:115], a[232:235], a[0:3]
ds_read_b128 a[204:207], v25 offset:46080
v_exp_f32 v130, v130
v_mfma_f32_16x16x32_bf16 a[36:39], a[136:139], a[232:235], a[36:39]
v_exp_f32 v131, v131
v_add_f32 v51, v51, v128
v_mfma_f32_16x16x32_bf16 a[72:75], a[160:163], a[232:235], a[72:75]
v_add_f32 v51, v51, v129
v_add_f32 v51, v51, v130
v_add_f32 v51, v51, v131
v_cvt_pk_bf16_f32 v128, v128, v129
v_mfma_f32_16x16x32_bf16 v[220:223], a[184:187], a[232:235], v[220:223]
s_waitcnt lgkmcnt(8)
v_cvt_pk_bf16_f32 v129, v130, v131
v_fma_f32 v132, v132, s66, -v40
v_fma_f32 v133, v133, s66, -v40
v_fma_f32 v134, v134, s66, -v40
v_mfma_f32_16x16x32_bf16 a[4:7], a[112:115], a[236:239], a[4:7]
ds_read_b128 a[208:211], v25 offset:47104
v_fma_f32 v135, v135, s66, -v40
v_exp_f32 v132, v132
v_mfma_f32_16x16x32_bf16 a[40:43], a[136:139], a[236:239], a[40:43]
v_exp_f32 v133, v133
v_exp_f32 v134, v134
v_mfma_f32_16x16x32_bf16 a[76:79], a[160:163], a[236:239], a[76:79]
v_exp_f32 v135, v135
v_mfma_f32_16x16x32_bf16 v[224:227], a[184:187], a[236:239], v[224:227]
s_waitcnt lgkmcnt(8)
v_add_f32 v52, v52, v132
v_add_f32 v52, v52, v133
v_add_f32 v52, v52, v134
v_add_f32 v52, v52, v135
v_mfma_f32_16x16x32_bf16 a[8:11], a[112:115], a[240:243], a[8:11]
ds_read_b128 a[212:215], v25 offset:48128
v_cvt_pk_bf16_f32 v132, v132, v133
v_cvt_pk_bf16_f32 v133, v134, v135
v_mfma_f32_16x16x32_bf16 a[44:47], a[136:139], a[240:243], a[44:47]
v_mfma_f32_16x16x32_bf16 a[80:83], a[160:163], a[240:243], a[80:83]
v_mfma_f32_16x16x32_bf16 v[228:231], a[184:187], a[240:243], v[228:231]
s_waitcnt lgkmcnt(8)
v_mfma_f32_16x16x32_bf16 a[12:15], a[112:115], a[244:247], a[12:15]
ds_read_b128 a[216:219], v25 offset:49152
v_mfma_f32_16x16x32_bf16 a[48:51], a[136:139], a[244:247], a[48:51]
v_mfma_f32_16x16x32_bf16 a[84:87], a[160:163], a[244:247], a[84:87]
v_mfma_f32_16x16x32_bf16 v[232:235], a[184:187], a[244:247], v[232:235]
s_waitcnt lgkmcnt(8)
v_mfma_f32_16x16x32_bf16 a[16:19], a[112:115], a[248:251], a[16:19]
ds_read_b128 a[220:223], v25 offset:50176
v_mfma_f32_16x16x32_bf16 a[52:55], a[136:139], a[248:251], a[52:55]
buffer_load_dwordx4 v14, s[40:43], s57 offen offset:2048 nt lds
v_mfma_f32_16x16x32_bf16 a[88:91], a[160:163], a[248:251], a[88:91]
v_mfma_f32_16x16x32_bf16 v[236:239], a[184:187], a[248:251], v[236:239]
s_waitcnt lgkmcnt(8)
v_mfma_f32_16x16x32_bf16 a[20:23], a[112:115], a[252:255], a[20:23]
ds_read_b128 a[224:227], v25 offset:51200
v_mfma_f32_16x16x32_bf16 a[56:59], a[136:139], a[252:255], a[56:59]
v_mfma_f32_16x16x32_bf16 a[92:95], a[160:163], a[252:255], a[92:95]
v_mfma_f32_16x16x32_bf16 v[240:243], a[184:187], a[252:255], v[240:243]
s_waitcnt lgkmcnt(8)
v_mfma_f32_16x16x32_bf16 a[24:27], a[112:115], a[192:195], a[24:27]
ds_read_b128 a[228:231], v25 offset:52224
v_mfma_f32_16x16x32_bf16 a[60:63], a[136:139], a[192:195], a[60:63]
v_mfma_f32_16x16x32_bf16 v[208:211], a[160:163], a[192:195], v[208:211]
v_mfma_f32_16x16x32_bf16 v[244:247], a[184:187], a[192:195], v[244:247]
s_waitcnt lgkmcnt(8)
v_mfma_f32_16x16x32_bf16 a[28:31], a[112:115], a[196:199], a[28:31]
ds_read_b128 a[232:235], v25 offset:53248
v_mfma_f32_16x16x32_bf16 a[64:67], a[136:139], a[196:199], a[64:67]
v_mfma_f32_16x16x32_bf16 v[212:215], a[160:163], a[196:199], v[212:215]
v_mfma_f32_16x16x32_bf16 v[248:251], a[184:187], a[196:199], v[248:251]
s_waitcnt lgkmcnt(8)
v_mfma_f32_16x16x32_bf16 a[32:35], a[112:115], a[200:203], a[32:35]
ds_read_b128 a[236:239], v25 offset:54272
v_mfma_f32_16x16x32_bf16 a[68:71], a[136:139], a[200:203], a[68:71]
v_mfma_f32_16x16x32_bf16 v[216:219], a[160:163], a[200:203], v[216:219]
v_mfma_f32_16x16x32_bf16 v[252:255], a[184:187], a[200:203], v[252:255]
s_waitcnt lgkmcnt(8)
s_add_u32 m0, s65, 132608
s_add_u32 s57, s17, 76800
buffer_load_dwordx4 v12, s[40:43], s57 offen nt lds
v_mfma_f32_16x16x32_bf16 a[0:3], a[116:119], a[204:207], a[0:3]
v_mfma_f32_16x16x32_bf16 a[36:39], a[140:143], a[204:207], a[36:39]
v_mfma_f32_16x16x32_bf16 a[72:75], a[164:167], a[204:207], a[72:75]
v_mfma_f32_16x16x32_bf16 v[220:223], a[188:191], a[204:207], v[220:223]
s_waitcnt lgkmcnt(7)
v_mfma_f32_16x16x32_bf16 a[4:7], a[116:119], a[208:211], a[4:7]
v_mfma_f32_16x16x32_bf16 a[40:43], a[140:143], a[208:211], a[40:43]
v_mfma_f32_16x16x32_bf16 a[76:79], a[164:167], a[208:211], a[76:79]
v_mfma_f32_16x16x32_bf16 v[224:227], a[188:191], a[208:211], v[224:227]
s_waitcnt vmcnt(10) lgkmcnt(0)
s_barrier
v_mfma_f32_16x16x32_bf16 a[8:11], a[116:119], a[212:215], a[8:11]
ds_read_b64_tr_b16 v[64:65], v20
v_fma_f32 v136, v136, s66, -v32
v_fma_f32 v137, v137, s66, -v32
v_fma_f32 v138, v138, s66, -v32
v_mfma_f32_16x16x32_bf16 a[44:47], a[140:143], a[212:215], a[44:47]
ds_read_b64_tr_b16 v[66:67], v20 offset:6144
ds_write_b64 v26, v[100:101] offset:18432
v_fma_f32 v139, v139, s66, -v32
v_exp_f32 v136, v136
v_mfma_f32_16x16x32_bf16 a[80:83], a[164:167], a[212:215], a[80:83]
ds_read_b64_tr_b16 v[68:69], v21
ds_write_b64 v26, v[104:105] offset:19456
v_exp_f32 v137, v137
v_exp_f32 v138, v138
v_mfma_f32_16x16x32_bf16 v[228:231], a[188:191], a[212:215], v[228:231]
ds_read_b64_tr_b16 v[70:71], v21 offset:6144
ds_write_b64 v26, v[108:109] offset:20480
v_exp_f32 v139, v139
v_mfma_f32_16x16x32_bf16 a[12:15], a[116:119], a[216:219], a[12:15]
ds_read_b64_tr_b16 v[72:73], v22
ds_write_b64 v26, v[112:113] offset:21504
v_add_f32 v44, v44, v136
v_add_f32 v44, v44, v137
v_add_f32 v44, v44, v138
v_mfma_f32_16x16x32_bf16 a[48:51], a[140:143], a[216:219], a[48:51]
ds_read_b64_tr_b16 v[74:75], v22 offset:6144
ds_write_b64 v26, v[116:117] offset:22528
v_add_f32 v44, v44, v139
v_cvt_pk_bf16_f32 v136, v136, v137
v_cvt_pk_bf16_f32 v137, v138, v139
v_mfma_f32_16x16x32_bf16 a[84:87], a[164:167], a[216:219], a[84:87]
ds_read_b128 a[96:99], v25
ds_write_b64 v26, v[120:121] offset:23552
v_fma_f32 v140, v140, s66, -v33
v_fma_f32 v141, v141, s66, -v33
v_mfma_f32_16x16x32_bf16 v[232:235], a[188:191], a[216:219], v[232:235]
ds_read_b128 a[100:103], v25 offset:1024
ds_write_b64 v26, v[124:125] offset:24576
v_fma_f32 v142, v142, s66, -v33
v_fma_f32 v143, v143, s66, -v33
v_exp_f32 v140, v140
v_mfma_f32_16x16x32_bf16 a[16:19], a[116:119], a[220:223], a[16:19]
ds_read_b128 a[104:107], v25 offset:2048
ds_write_b64 v26, v[128:129] offset:25600
v_exp_f32 v141, v141
v_mfma_f32_16x16x32_bf16 a[52:55], a[140:143], a[220:223], a[52:55]
buffer_load_dwordx4 v13, s[40:43], s57 offen offset:1024 nt lds
v_exp_f32 v142, v142
v_mfma_f32_16x16x32_bf16 a[88:91], a[164:167], a[220:223], a[88:91]
ds_read_b128 a[108:111], v25 offset:3072
v_exp_f32 v143, v143
v_add_f32 v45, v45, v140
v_mfma_f32_16x16x32_bf16 v[236:239], a[188:191], a[220:223], v[236:239]
ds_read_b128 a[112:115], v25 offset:4096
v_add_f32 v45, v45, v141
v_add_f32 v45, v45, v142
v_add_f32 v45, v45, v143
v_mfma_f32_16x16x32_bf16 a[20:23], a[116:119], a[224:227], a[20:23]
ds_read_b128 a[120:123], v25 offset:5120
v_cvt_pk_bf16_f32 v140, v140, v141
v_cvt_pk_bf16_f32 v141, v142, v143
v_fma_f32 v144, v144, s66, -v34
v_mfma_f32_16x16x32_bf16 a[56:59], a[140:143], a[224:227], a[56:59]
ds_read_b128 a[124:127], v25 offset:6144
ds_write_b64 v26, v[132:133] offset:26624
v_fma_f32 v145, v145, s66, -v34
v_fma_f32 v146, v146, s66, -v34
v_mfma_f32_16x16x32_bf16 a[92:95], a[164:167], a[224:227], a[92:95]
ds_read_b128 a[128:131], v25 offset:7168
v_fma_f32 v147, v147, s66, -v34
v_exp_f32 v144, v144
v_mfma_f32_16x16x32_bf16 v[240:243], a[188:191], a[224:227], v[240:243]
ds_read_b128 a[132:135], v25 offset:8192
v_exp_f32 v145, v145
v_exp_f32 v146, v146
v_mfma_f32_16x16x32_bf16 a[24:27], a[116:119], a[228:231], a[24:27]
ds_write_b64 v26, v[136:137] offset:36864
v_exp_f32 v147, v147
v_mfma_f32_16x16x32_bf16 a[60:63], a[140:143], a[228:231], a[60:63]
ds_write_b64 v26, v[140:141] offset:37888
v_add_f32 v46, v46, v144
v_add_f32 v46, v46, v145
v_add_f32 v46, v46, v146
v_mfma_f32_16x16x32_bf16 v[208:211], a[164:167], a[228:231], v[208:211]
v_add_f32 v46, v46, v147
v_cvt_pk_bf16_f32 v144, v144, v145
v_cvt_pk_bf16_f32 v145, v146, v147
v_fma_f32 v148, v148, s66, -v35
v_mfma_f32_16x16x32_bf16 v[244:247], a[188:191], a[228:231], v[244:247]
ds_write_b64 v26, v[144:145] offset:38912
v_fma_f32 v149, v149, s66, -v35
v_fma_f32 v150, v150, s66, -v35
v_mfma_f32_16x16x32_bf16 a[28:31], a[116:119], a[232:235], a[28:31]
v_fma_f32 v151, v151, s66, -v35
v_exp_f32 v148, v148
v_exp_f32 v149, v149
v_mfma_f32_16x16x32_bf16 a[64:67], a[140:143], a[232:235], a[64:67]
v_exp_f32 v150, v150
v_exp_f32 v151, v151
v_mfma_f32_16x16x32_bf16 v[212:215], a[164:167], a[232:235], v[212:215]
v_add_f32 v47, v47, v148
v_add_f32 v47, v47, v149
v_add_f32 v47, v47, v150
v_mfma_f32_16x16x32_bf16 v[248:251], a[188:191], a[232:235], v[248:251]
v_add_f32 v47, v47, v151
v_cvt_pk_bf16_f32 v148, v148, v149
v_cvt_pk_bf16_f32 v149, v150, v151
v_fma_f32 v152, v152, s66, -v36
v_mfma_f32_16x16x32_bf16 a[32:35], a[116:119], a[236:239], a[32:35]
ds_write_b64 v26, v[148:149] offset:39936
v_fma_f32 v153, v153, s66, -v36
v_fma_f32 v154, v154, s66, -v36
v_fma_f32 v155, v155, s66, -v36
v_mfma_f32_16x16x32_bf16 a[68:71], a[140:143], a[236:239], a[68:71]
v_exp_f32 v152, v152
v_exp_f32 v153, v153
v_mfma_f32_16x16x32_bf16 v[216:219], a[164:167], a[236:239], v[216:219]
v_exp_f32 v154, v154
v_exp_f32 v155, v155
v_mfma_f32_16x16x32_bf16 v[252:255], a[188:191], a[236:239], v[252:255]
s_waitcnt lgkmcnt(15)
buffer_load_dwordx4 v14, s[40:43], s57 offen offset:2048 nt lds
v_add_f32 v48, v48, v152
v_mfma_f32_16x16x32_bf16 a[148:151], v[64:67], a[96:99], 0
ds_read_b64_tr_b16 v[76:77], v20 offset:12288
v_add_f32 v48, v48, v153
v_add_f32 v48, v48, v154
v_add_f32 v48, v48, v155
v_mfma_f32_16x16x32_bf16 a[152:155], v[68:71], a[96:99], 0
ds_read_b64_tr_b16 v[78:79], v20 offset:18432
v_cvt_pk_bf16_f32 v152, v152, v153
v_cvt_pk_bf16_f32 v153, v154, v155
v_fma_f32 v156, v156, s66, -v37
v_mfma_f32_16x16x32_bf16 a[156:159], v[72:75], a[96:99], 0
s_waitcnt lgkmcnt(15)
ds_read_b64_tr_b16 v[80:81], v21 offset:12288
v_fma_f32 v157, v157, s66, -v37
v_fma_f32 v158, v158, s66, -v37
v_fma_f32 v159, v159, s66, -v37
v_mfma_f32_16x16x32_bf16 a[160:163], v[64:67], a[100:103], 0
ds_read_b64_tr_b16 v[82:83], v21 offset:18432
v_exp_f32 v156, v156
v_exp_f32 v157, v157
v_mfma_f32_16x16x32_bf16 a[164:167], v[68:71], a[100:103], 0
ds_read_b64_tr_b16 v[84:85], v22 offset:12288
v_exp_f32 v158, v158
v_mfma_f32_16x16x32_bf16 a[168:171], v[72:75], a[100:103], 0
s_waitcnt lgkmcnt(15)
ds_read_b64_tr_b16 v[86:87], v22 offset:18432
v_exp_f32 v159, v159
v_mfma_f32_16x16x32_bf16 a[172:175], v[64:67], a[104:107], 0
ds_read_b128 a[136:139], v25 offset:9216
v_add_f32 v49, v49, v156
v_add_f32 v49, v49, v157
v_add_f32 v49, v49, v158
v_mfma_f32_16x16x32_bf16 a[176:179], v[68:71], a[104:107], 0
ds_read_b128 a[144:147], v25 offset:10240
v_add_f32 v49, v49, v159
v_cvt_pk_bf16_f32 v156, v156, v157
v_cvt_pk_bf16_f32 v157, v158, v159
v_mfma_f32_16x16x32_bf16 a[180:183], v[72:75], a[104:107], 0
ds_read_b128 a[116:119], v25 offset:11264
v_fma_f32 v160, v160, s66, -v38
v_fma_f32 v161, v161, s66, -v38
v_fma_f32 v162, v162, s66, -v38
v_mfma_f32_16x16x32_bf16 a[184:187], v[64:67], a[108:111], 0
ds_read_b128 a[140:143], v25 offset:12288
v_fma_f32 v163, v163, s66, -v38
v_exp_f32 v160, v160
v_mfma_f32_16x16x32_bf16 a[188:191], v[68:71], a[108:111], 0
ds_read_b128 a[96:99], v25 offset:13312
v_exp_f32 v161, v161
v_mfma_f32_16x16x32_bf16 a[192:195], v[72:75], a[108:111], 0
s_waitcnt lgkmcnt(15)
ds_read_b128 a[100:103], v25 offset:14336
v_exp_f32 v162, v162
v_exp_f32 v163, v163
v_mfma_f32_16x16x32_bf16 a[196:199], v[64:67], a[112:115], 0
ds_read_b128 a[104:107], v25 offset:15360
v_add_f32 v50, v50, v160
v_add_f32 v50, v50, v161
v_mfma_f32_16x16x32_bf16 a[200:203], v[68:71], a[112:115], 0
ds_read_b128 a[108:111], v25 offset:16384
v_add_f32 v50, v50, v162
v_add_f32 v50, v50, v163
v_cvt_pk_bf16_f32 v160, v160, v161
v_mfma_f32_16x16x32_bf16 a[204:207], v[72:75], a[112:115], 0
ds_read_b128 a[112:115], v25 offset:17408
v_cvt_pk_bf16_f32 v161, v162, v163
v_fma_f32 v164, v164, s66, -v39
v_fma_f32 v165, v165, s66, -v39
v_mfma_f32_16x16x32_bf16 a[208:211], v[64:67], a[120:123], 0
ds_write_b64 v26, v[152:153] offset:40960
v_fma_f32 v166, v166, s66, -v39
v_fma_f32 v167, v167, s66, -v39
v_exp_f32 v164, v164
v_mfma_f32_16x16x32_bf16 a[212:215], v[68:71], a[120:123], 0
ds_write_b64 v26, v[156:157] offset:41984
v_exp_f32 v165, v165
v_mfma_f32_16x16x32_bf16 a[216:219], v[72:75], a[120:123], 0
ds_write_b64 v26, v[160:161] offset:43008
v_exp_f32 v166, v166
v_mfma_f32_16x16x32_bf16 a[220:223], v[64:67], a[124:127], 0
v_exp_f32 v167, v167
v_add_f32 v51, v51, v164
v_add_f32 v51, v51, v165
v_mfma_f32_16x16x32_bf16 a[224:227], v[68:71], a[124:127], 0
v_add_f32 v51, v51, v166
v_add_f32 v51, v51, v167
v_cvt_pk_bf16_f32 v164, v164, v165
v_cvt_pk_bf16_f32 v165, v166, v167
v_mfma_f32_16x16x32_bf16 a[228:231], v[72:75], a[124:127], 0
v_fma_f32 v168, v168, s66, -v40
v_fma_f32 v169, v169, s66, -v40
v_fma_f32 v170, v170, s66, -v40
v_fma_f32 v171, v171, s66, -v40
v_mfma_f32_16x16x32_bf16 a[232:235], v[64:67], a[128:131], 0
ds_write_b64 v26, v[164:165] offset:44032
v_exp_f32 v168, v168
v_exp_f32 v169, v169
v_mfma_f32_16x16x32_bf16 a[236:239], v[68:71], a[128:131], 0
v_exp_f32 v170, v170
v_mfma_f32_16x16x32_bf16 a[240:243], v[72:75], a[128:131], 0
v_exp_f32 v171, v171
v_add_f32 v52, v52, v168
v_add_f32 v52, v52, v169
v_mfma_f32_16x16x32_bf16 a[244:247], v[64:67], a[132:135], 0
v_add_f32 v52, v52, v170
v_add_f32 v52, v52, v171
v_cvt_pk_bf16_f32 v168, v168, v169
v_cvt_pk_bf16_f32 v169, v170, v171
v_mfma_f32_16x16x32_bf16 a[248:251], v[68:71], a[132:135], 0
v_mov_b32 v56, 0xff800000
v_mov_b32 v57, 0xff800000
v_mov_b32 v58, 0xff800000
v_mov_b32 v59, 0xff800000
v_mfma_f32_16x16x32_bf16 a[252:255], v[72:75], a[132:135], 0
ds_write_b64 v26, v[168:169] offset:45056
v_add_u32 v60, s19, v27
s_waitcnt lgkmcnt(5)
s_barrier
v_add_u32 v20, 0xc200, v20
v_add_u32 v21, 0xc200, v21
v_add_u32 v22, 0xc200, v22
v_mfma_f32_16x16x32_bf16 a[148:151], v[76:79], a[136:139], a[148:151]
ds_read_b64_tr_b16 v[64:65], v20
ds_write_b128 v60, v[56:59]
v_fma_f32 v172, v172, s66, -v32
v_fma_f32 v173, v173, s66, -v32
v_fma_f32 v174, v174, s66, -v32
v_mfma_f32_16x16x32_bf16 a[152:155], v[80:83], a[136:139], a[152:155]
s_add_u32 m0, s65, 55296
s_sub_u32 s57, 98304, s17
buffer_load_dwordx4 v12, s[40:43], s57 offen nt lds
v_fma_f32 v175, v175, s66, -v32
v_exp_f32 v172, v172
v_mfma_f32_16x16x32_bf16 a[156:159], v[84:87], a[136:139], a[156:159]
ds_read_b64_tr_b16 v[66:67], v20 offset:6144
v_exp_f32 v173, v173
v_mfma_f32_16x16x32_bf16 a[160:163], v[76:79], a[144:147], a[160:163]
ds_read_b64_tr_b16 v[68:69], v21
v_exp_f32 v174, v174
v_exp_f32 v175, v175
v_mfma_f32_16x16x32_bf16 a[164:167], v[80:83], a[144:147], a[164:167]
ds_read_b64_tr_b16 v[70:71], v21 offset:6144
v_add_f32 v44, v44, v172
v_add_f32 v44, v44, v173
v_mfma_f32_16x16x32_bf16 a[168:171], v[84:87], a[144:147], a[168:171]
ds_read_b64_tr_b16 v[72:73], v22
v_add_f32 v44, v44, v174
v_add_f32 v44, v44, v175
v_mfma_f32_16x16x32_bf16 a[172:175], v[76:79], a[116:119], a[172:175]
ds_write_b128 v60, v[56:59] offset:16
v_cvt_pk_bf16_f32 v172, v172, v173
v_cvt_pk_bf16_f32 v173, v174, v175
v_fma_f32 v176, v176, s66, -v33
v_mfma_f32_16x16x32_bf16 a[176:179], v[80:83], a[116:119], a[176:179]
ds_read_b64_tr_b16 v[74:75], v22 offset:6144
v_fma_f32 v177, v177, s66, -v33
v_fma_f32 v178, v178, s66, -v33
v_fma_f32 v179, v179, s66, -v33
v_mfma_f32_16x16x32_bf16 a[180:183], v[84:87], a[116:119], a[180:183]
ds_read_b128 a[120:123], v25 offset:18432
v_exp_f32 v176, v176
v_exp_f32 v177, v177
v_mfma_f32_16x16x32_bf16 a[184:187], v[76:79], a[140:143], a[184:187]
buffer_load_dwordx4 v13, s[40:43], s57 offen offset:1024 nt lds
v_exp_f32 v178, v178
v_mfma_f32_16x16x32_bf16 a[188:191], v[80:83], a[140:143], a[188:191]
ds_read_b128 a[124:127], v25 offset:19456
v_exp_f32 v179, v179
v_mfma_f32_16x16x32_bf16 a[192:195], v[84:87], a[140:143], a[192:195]
ds_read_b128 a[128:131], v25 offset:20480
v_add_f32 v45, v45, v176
v_add_f32 v45, v45, v177
v_mfma_f32_16x16x32_bf16 a[196:199], v[76:79], a[96:99], a[196:199]
ds_read_b128 a[132:135], v25 offset:21504
v_add_f32 v45, v45, v178
v_add_f32 v45, v45, v179
v_cvt_pk_bf16_f32 v176, v176, v177
v_mfma_f32_16x16x32_bf16 a[200:203], v[80:83], a[96:99], a[200:203]
ds_write_b128 v60, v[56:59] offset:32
v_cvt_pk_bf16_f32 v177, v178, v179
v_fma_f32 v180, v180, s66, -v34
v_fma_f32 v181, v181, s66, -v34
v_mfma_f32_16x16x32_bf16 a[204:207], v[84:87], a[96:99], a[204:207]
ds_read_b128 a[136:139], v25 offset:22528
v_fma_f32 v182, v182, s66, -v34
v_fma_f32 v183, v183, s66, -v34
v_exp_f32 v180, v180
v_mfma_f32_16x16x32_bf16 a[208:211], v[76:79], a[100:103], a[208:211]
ds_read_b128 a[144:147], v25 offset:23552
v_exp_f32 v181, v181
v_mfma_f32_16x16x32_bf16 a[212:215], v[80:83], a[100:103], a[212:215]
ds_read_b128 a[116:119], v25 offset:24576
v_exp_f32 v182, v182
v_mfma_f32_16x16x32_bf16 a[216:219], v[84:87], a[100:103], a[216:219]
ds_read_b128 a[140:143], v25 offset:25600
v_exp_f32 v183, v183
v_add_f32 v46, v46, v180
v_mfma_f32_16x16x32_bf16 a[220:223], v[76:79], a[104:107], a[220:223]
buffer_load_dwordx4 v14, s[40:43], s57 offen offset:2048 nt lds
v_add_f32 v46, v46, v181
v_add_f32 v46, v46, v182
v_mfma_f32_16x16x32_bf16 a[224:227], v[80:83], a[104:107], a[224:227]
ds_read_b128 a[96:99], v25 offset:26624
v_add_f32 v46, v46, v183
v_cvt_pk_bf16_f32 v180, v180, v181
v_cvt_pk_bf16_f32 v181, v182, v183
v_mfma_f32_16x16x32_bf16 a[228:231], v[84:87], a[104:107], a[228:231]
ds_write_b64 v26, v[172:173]
v_fma_f32 v184, v184, s66, -v35
v_fma_f32 v185, v185, s66, -v35
v_fma_f32 v186, v186, s66, -v35
v_mfma_f32_16x16x32_bf16 a[232:235], v[76:79], a[108:111], a[232:235]
ds_write_b64 v26, v[176:177] offset:1024
v_fma_f32 v187, v187, s66, -v35
v_exp_f32 v184, v184
v_mfma_f32_16x16x32_bf16 a[236:239], v[80:83], a[108:111], a[236:239]
ds_write_b64 v26, v[180:181] offset:2048
v_exp_f32 v185, v185
v_mfma_f32_16x16x32_bf16 a[240:243], v[84:87], a[108:111], a[240:243]
v_exp_f32 v186, v186
v_exp_f32 v187, v187
v_mfma_f32_16x16x32_bf16 a[244:247], v[76:79], a[112:115], a[244:247]
v_add_f32 v47, v47, v184
v_add_f32 v47, v47, v185
v_add_f32 v47, v47, v186
v_add_f32 v47, v47, v187
v_mfma_f32_16x16x32_bf16 a[248:251], v[80:83], a[112:115], a[248:251]
v_cvt_pk_bf16_f32 v184, v184, v185
v_cvt_pk_bf16_f32 v185, v186, v187
v_fma_f32 v188, v188, s66, -v36
v_fma_f32 v189, v189, s66, -v36
v_mfma_f32_16x16x32_bf16 a[252:255], v[84:87], a[112:115], a[252:255]
s_waitcnt lgkmcnt(12)
ds_write_b64 v26, v[184:185] offset:3072
v_fma_f32 v190, v190, s66, -v36
v_fma_f32 v191, v191, s66, -v36
v_exp_f32 v188, v188
v_mfma_f32_16x16x32_bf16 a[148:151], v[64:67], a[120:123], a[148:151]
s_add_u32 m0, s65, 58368
s_sub_u32 s57, 101376, s17
buffer_load_dwordx4 v12, s[40:43], s57 offen nt lds
v_mfma_f32_16x16x32_bf16 a[152:155], v[68:71], a[120:123], a[152:155]
ds_read_b64_tr_b16 v[76:77], v20 offset:12288
v_exp_f32 v189, v189
v_exp_f32 v190, v190
v_mfma_f32_16x16x32_bf16 a[156:159], v[72:75], a[120:123], a[156:159]
s_waitcnt lgkmcnt(13)
ds_read_b64_tr_b16 v[78:79], v20 offset:18432
v_exp_f32 v191, v191
v_mfma_f32_16x16x32_bf16 a[160:163], v[64:67], a[124:127], a[160:163]
ds_read_b64_tr_b16 v[80:81], v21 offset:12288
v_add_f32 v48, v48, v188
v_add_f32 v48, v48, v189
v_add_f32 v48, v48, v190
v_mfma_f32_16x16x32_bf16 a[164:167], v[68:71], a[124:127], a[164:167]
ds_read_b64_tr_b16 v[82:83], v21 offset:18432
v_add_f32 v48, v48, v191
v_cvt_pk_bf16_f32 v188, v188, v189
v_cvt_pk_bf16_f32 v189, v190, v191
v_mfma_f32_16x16x32_bf16 a[168:171], v[72:75], a[124:127], a[168:171]
s_waitcnt lgkmcnt(15)
ds_read_b64_tr_b16 v[84:85], v22 offset:12288
v_fma_f32 v192, v192, s66, -v37
v_fma_f32 v193, v193, s66, -v37
v_mfma_f32_16x16x32_bf16 a[172:175], v[64:67], a[128:131], a[172:175]
ds_read_b64_tr_b16 v[86:87], v22 offset:18432
v_fma_f32 v194, v194, s66, -v37
v_fma_f32 v195, v195, s66, -v37
v_exp_f32 v192, v192
v_mfma_f32_16x16x32_bf16 a[176:179], v[68:71], a[128:131], a[176:179]
ds_read_b128 a[100:103], v25 offset:27648
v_exp_f32 v193, v193
v_mfma_f32_16x16x32_bf16 a[180:183], v[72:75], a[128:131], a[180:183]
s_waitcnt lgkmcnt(15)
ds_read_b128 a[104:107], v25 offset:28672
v_exp_f32 v194, v194
v_exp_f32 v195, v195
v_mfma_f32_16x16x32_bf16 a[184:187], v[64:67], a[132:135], a[184:187]
buffer_load_dwordx4 v13, s[40:43], s57 offen offset:1024 nt lds
v_add_f32 v49, v49, v192
v_mfma_f32_16x16x32_bf16 a[188:191], v[68:71], a[132:135], a[188:191]
ds_read_b128 a[108:111], v25 offset:29696
v_add_f32 v49, v49, v193
v_add_f32 v49, v49, v194
v_add_f32 v49, v49, v195
v_mfma_f32_16x16x32_bf16 a[192:195], v[72:75], a[132:135], a[192:195]
ds_read_b128 a[112:115], v25 offset:30720
v_cvt_pk_bf16_f32 v192, v192, v193
v_cvt_pk_bf16_f32 v193, v194, v195
v_mfma_f32_16x16x32_bf16 a[196:199], v[64:67], a[136:139], a[196:199]
ds_read_b128 a[120:123], v25 offset:31744
v_fma_f32 v196, v196, s66, -v38
v_fma_f32 v197, v197, s66, -v38
v_fma_f32 v198, v198, s66, -v38
v_mfma_f32_16x16x32_bf16 a[200:203], v[68:71], a[136:139], a[200:203]
ds_read_b128 a[124:127], v25 offset:32768
v_fma_f32 v199, v199, s66, -v38
v_exp_f32 v196, v196
v_mfma_f32_16x16x32_bf16 a[204:207], v[72:75], a[136:139], a[204:207]
s_waitcnt lgkmcnt(15)
ds_read_b128 a[128:131], v25 offset:33792
v_exp_f32 v197, v197
v_exp_f32 v198, v198
v_mfma_f32_16x16x32_bf16 a[208:211], v[64:67], a[144:147], a[208:211]
ds_read_b128 a[132:135], v25 offset:34816
v_exp_f32 v199, v199
v_mfma_f32_16x16x32_bf16 a[212:215], v[68:71], a[144:147], a[212:215]
ds_read_b128 a[136:139], v25 offset:35840
v_add_f32 v50, v50, v196
v_add_f32 v50, v50, v197
v_mfma_f32_16x16x32_bf16 a[216:219], v[72:75], a[144:147], a[216:219]
ds_write_b64 v26, v[188:189] offset:4096
v_add_f32 v50, v50, v198
v_add_f32 v50, v50, v199
v_cvt_pk_bf16_f32 v196, v196, v197
v_mfma_f32_16x16x32_bf16 a[220:223], v[64:67], a[116:119], a[220:223]
buffer_load_dwordx4 v14, s[40:43], s57 offen offset:2048 nt lds
v_cvt_pk_bf16_f32 v197, v198, v199
v_fma_f32 v200, v200, s66, -v39
v_mfma_f32_16x16x32_bf16 a[224:227], v[68:71], a[116:119], a[224:227]
ds_write_b64 v26, v[192:193] offset:5120
v_fma_f32 v201, v201, s66, -v39
v_fma_f32 v202, v202, s66, -v39
v_fma_f32 v203, v203, s66, -v39
v_mfma_f32_16x16x32_bf16 a[228:231], v[72:75], a[116:119], a[228:231]
ds_write_b64 v26, v[196:197] offset:6144
v_exp_f32 v200, v200
v_exp_f32 v201, v201
v_mfma_f32_16x16x32_bf16 a[232:235], v[64:67], a[140:143], a[232:235]
v_exp_f32 v202, v202
v_exp_f32 v203, v203
v_mfma_f32_16x16x32_bf16 a[236:239], v[68:71], a[140:143], a[236:239]
v_add_f32 v51, v51, v200
v_add_f32 v51, v51, v201
v_mfma_f32_16x16x32_bf16 a[240:243], v[72:75], a[140:143], a[240:243]
v_add_f32 v51, v51, v202
v_add_f32 v51, v51, v203
v_cvt_pk_bf16_f32 v200, v200, v201
v_cvt_pk_bf16_f32 v201, v202, v203
v_mfma_f32_16x16x32_bf16 a[244:247], v[64:67], a[96:99], a[244:247]
v_fma_f32 v204, v204, s66, -v40
v_fma_f32 v205, v205, s66, -v40
v_fma_f32 v206, v206, s66, -v40
v_fma_f32 v207, v207, s66, -v40
v_mfma_f32_16x16x32_bf16 a[248:251], v[68:71], a[96:99], a[248:251]
ds_write_b64 v26, v[200:201] offset:7168
v_exp_f32 v204, v204
v_exp_f32 v205, v205
v_mfma_f32_16x16x32_bf16 a[252:255], v[72:75], a[96:99], a[252:255]
v_exp_f32 v206, v206
v_exp_f32 v207, v207
s_waitcnt vmcnt(12) lgkmcnt(4)
s_barrier
v_add_u32 v20, 0xffff3e00, v20
v_add_u32 v21, 0xffff3e00, v21
v_add_u32 v22, 0xffff3e00, v22
v_mfma_f32_16x16x32_bf16 a[148:151], v[76:79], a[100:103], a[148:151]
ds_read_b64_tr_b16 v[64:65], v20 offset:24832
v_add_f32 v52, v52, v204
v_mfma_f32_16x16x32_bf16 a[152:155], v[80:83], a[100:103], a[152:155]
s_add_u32 m0, s65, 104960
s_sub_u32 s57, 122880, s17
buffer_load_dwordx4 v12, s[40:43], s57 offen nt lds
v_add_f32 v52, v52, v205
v_add_f32 v52, v52, v206
v_mfma_f32_16x16x32_bf16 a[156:159], v[84:87], a[100:103], a[156:159]
ds_read_b64_tr_b16 v[66:67], v20 offset:30976
v_add_f32 v52, v52, v207
v_cvt_pk_bf16_f32 v204, v204, v205
v_cvt_pk_bf16_f32 v205, v206, v207
v_mfma_f32_16x16x32_bf16 a[160:163], v[76:79], a[104:107], a[160:163]
ds_read_b64_tr_b16 v[68:69], v21 offset:24832
v_accvgpr_read_b32 v100, a0
v_accvgpr_read_b32 v101, a1
v_accvgpr_read_b32 v102, a2
v_mfma_f32_16x16x32_bf16 a[164:167], v[80:83], a[104:107], a[164:167]
ds_read_b64_tr_b16 v[70:71], v21 offset:30976
v_accvgpr_read_b32 v103, a3
v_fma_f32 v100, v100, s66, -v32
v_fma_f32 v101, v101, s66, -v32
v_mfma_f32_16x16x32_bf16 a[168:171], v[84:87], a[104:107], a[168:171]
ds_read_b64_tr_b16 v[72:73], v22 offset:24832
v_fma_f32 v102, v102, s66, -v32
v_fma_f32 v103, v103, s66, -v32
v_exp_f32 v100, v100
v_mfma_f32_16x16x32_bf16 a[172:175], v[76:79], a[108:111], a[172:175]
ds_write_b64 v26, v[204:205] offset:8192
v_exp_f32 v101, v101
v_mfma_f32_16x16x32_bf16 a[176:179], v[80:83], a[108:111], a[176:179]
ds_read_b64_tr_b16 v[74:75], v22 offset:30976
v_exp_f32 v102, v102
v_mfma_f32_16x16x32_bf16 a[180:183], v[84:87], a[108:111], a[180:183]
ds_read_b128 a[144:147], v25 offset:36864
v_exp_f32 v103, v103
v_add_f32 v44, v44, v100
v_mfma_f32_16x16x32_bf16 a[184:187], v[76:79], a[112:115], a[184:187]
buffer_load_dwordx4 v13, s[40:43], s57 offen offset:1024 nt lds
v_add_f32 v44, v44, v101
v_add_f32 v44, v44, v102
v_mfma_f32_16x16x32_bf16 a[188:191], v[80:83], a[112:115], a[188:191]
ds_read_b128 a[116:119], v25 offset:37888
v_add_f32 v44, v44, v103
v_cvt_pk_bf16_f32 v100, v100, v101
v_cvt_pk_bf16_f32 v101, v102, v103
v_mfma_f32_16x16x32_bf16 a[192:195], v[84:87], a[112:115], a[192:195]
ds_read_b128 a[140:143], v25 offset:38912
v_accvgpr_read_b32 v104, a4
v_accvgpr_read_b32 v105, a5
v_mfma_f32_16x16x32_bf16 a[196:199], v[76:79], a[120:123], a[196:199]
ds_read_b128 a[96:99], v25 offset:39936
v_accvgpr_read_b32 v106, a6
v_accvgpr_read_b32 v107, a7
v_fma_f32 v104, v104, s66, -v33
v_mfma_f32_16x16x32_bf16 a[200:203], v[80:83], a[120:123], a[200:203]
ds_write_b64 v26, v[100:101] offset:18432
v_fma_f32 v105, v105, s66, -v33
v_fma_f32 v106, v106, s66, -v33
v_fma_f32 v107, v107, s66, -v33
v_mfma_f32_16x16x32_bf16 a[204:207], v[84:87], a[120:123], a[204:207]
ds_read_b128 a[100:103], v25 offset:40960
v_exp_f32 v104, v104
v_exp_f32 v105, v105
v_mfma_f32_16x16x32_bf16 a[208:211], v[76:79], a[124:127], a[208:211]
ds_read_b128 a[104:107], v25 offset:41984
v_exp_f32 v106, v106
v_mfma_f32_16x16x32_bf16 a[212:215], v[80:83], a[124:127], a[212:215]
ds_read_b128 a[108:111], v25 offset:43008
v_exp_f32 v107, v107
v_add_f32 v45, v45, v104
v_mfma_f32_16x16x32_bf16 a[216:219], v[84:87], a[124:127], a[216:219]
ds_read_b128 a[112:115], v25 offset:44032
v_add_f32 v45, v45, v105
v_add_f32 v45, v45, v106
v_mfma_f32_16x16x32_bf16 a[220:223], v[76:79], a[128:131], a[220:223]
buffer_load_dwordx4 v14, s[40:43], s57 offen offset:2048 nt lds
v_add_f32 v45, v45, v107
v_cvt_pk_bf16_f32 v104, v104, v105
v_mfma_f32_16x16x32_bf16 a[224:227], v[80:83], a[128:131], a[224:227]
ds_read_b128 a[120:123], v25 offset:45056
v_cvt_pk_bf16_f32 v105, v106, v107
v_accvgpr_read_b32 v108, a8
v_accvgpr_read_b32 v109, a9
v_mfma_f32_16x16x32_bf16 a[228:231], v[84:87], a[128:131], a[228:231]
ds_write_b64 v26, v[104:105] offset:19456
v_accvgpr_read_b32 v110, a10
v_accvgpr_read_b32 v111, a11
v_fma_f32 v108, v108, s66, -v34
v_mfma_f32_16x16x32_bf16 a[232:235], v[76:79], a[132:135], a[232:235]
v_fma_f32 v109, v109, s66, -v34
v_fma_f32 v110, v110, s66, -v34
v_fma_f32 v111, v111, s66, -v34
v_exp_f32 v108, v108
v_mfma_f32_16x16x32_bf16 a[236:239], v[80:83], a[132:135], a[236:239]
v_exp_f32 v109, v109
v_mfma_f32_16x16x32_bf16 a[240:243], v[84:87], a[132:135], a[240:243]
v_exp_f32 v110, v110
v_exp_f32 v111, v111
v_mfma_f32_16x16x32_bf16 a[244:247], v[76:79], a[136:139], a[244:247]
v_add_f32 v46, v46, v108
v_add_f32 v46, v46, v109
v_add_f32 v46, v46, v110
v_add_f32 v46, v46, v111
v_mfma_f32_16x16x32_bf16 a[248:251], v[80:83], a[136:139], a[248:251]
v_cvt_pk_bf16_f32 v108, v108, v109
v_cvt_pk_bf16_f32 v109, v110, v111
v_accvgpr_read_b32 v112, a12
v_accvgpr_read_b32 v113, a13
v_mfma_f32_16x16x32_bf16 a[252:255], v[84:87], a[136:139], a[252:255]
s_waitcnt lgkmcnt(10)
ds_write_b64 v26, v[108:109] offset:20480
v_accvgpr_read_b32 v114, a14
v_accvgpr_read_b32 v115, a15
v_fma_f32 v112, v112, s66, -v35
v_mfma_f32_16x16x32_bf16 a[148:151], v[64:67], a[144:147], a[148:151]
s_add_u32 m0, s65, 108032
s_sub_u32 s57, 125952, s17
buffer_load_dwordx4 v12, s[40:43], s57 offen nt lds
v_fma_f32 v113, v113, s66, -v35
v_mfma_f32_16x16x32_bf16 a[152:155], v[68:71], a[144:147], a[152:155]
ds_read_b64_tr_b16 v[76:77], v20 offset:37120
v_fma_f32 v114, v114, s66, -v35
v_fma_f32 v115, v115, s66, -v35
v_exp_f32 v112, v112
v_mfma_f32_16x16x32_bf16 a[156:159], v[72:75], a[144:147], a[156:159]
s_waitcnt lgkmcnt(11)
ds_read_b64_tr_b16 v[78:79], v20 offset:43264
v_exp_f32 v113, v113
v_mfma_f32_16x16x32_bf16 a[160:163], v[64:67], a[116:119], a[160:163]
ds_read_b64_tr_b16 v[80:81], v21 offset:37120
v_exp_f32 v114, v114
v_exp_f32 v115, v115
v_mfma_f32_16x16x32_bf16 a[164:167], v[68:71], a[116:119], a[164:167]
ds_read_b64_tr_b16 v[82:83], v21 offset:43264
v_add_f32 v47, v47, v112
v_add_f32 v47, v47, v113
v_mfma_f32_16x16x32_bf16 a[168:171], v[72:75], a[116:119], a[168:171]
s_waitcnt lgkmcnt(13)
ds_read_b64_tr_b16 v[84:85], v22 offset:37120
v_add_f32 v47, v47, v114
v_add_f32 v47, v47, v115
v_cvt_pk_bf16_f32 v112, v112, v113
v_mfma_f32_16x16x32_bf16 a[172:175], v[64:67], a[140:143], a[172:175]
ds_read_b64_tr_b16 v[86:87], v22 offset:43264
v_cvt_pk_bf16_f32 v113, v114, v115
v_accvgpr_read_b32 v116, a16
v_mfma_f32_16x16x32_bf16 a[176:179], v[68:71], a[140:143], a[176:179]
ds_read_b128 a[124:127], v25 offset:46080
v_accvgpr_read_b32 v117, a17
v_accvgpr_read_b32 v118, a18
v_accvgpr_read_b32 v119, a19
v_mfma_f32_16x16x32_bf16 a[180:183], v[72:75], a[140:143], a[180:183]
s_waitcnt lgkmcnt(15)
ds_read_b128 a[128:131], v25 offset:47104
v_fma_f32 v116, v116, s66, -v36
v_fma_f32 v117, v117, s66, -v36
v_fma_f32 v118, v118, s66, -v36
v_mfma_f32_16x16x32_bf16 a[184:187], v[64:67], a[96:99], a[184:187]
buffer_load_dwordx4 v13, s[40:43], s57 offen offset:1024 nt lds
v_fma_f32 v119, v119, s66, -v36
v_exp_f32 v116, v116
v_mfma_f32_16x16x32_bf16 a[188:191], v[68:71], a[96:99], a[188:191]
ds_read_b128 a[132:135], v25 offset:48128
v_exp_f32 v117, v117
v_mfma_f32_16x16x32_bf16 a[192:195], v[72:75], a[96:99], a[192:195]
s_waitcnt lgkmcnt(15)
ds_read_b128 a[136:139], v25 offset:49152
v_exp_f32 v118, v118
v_mfma_f32_16x16x32_bf16 a[196:199], v[64:67], a[100:103], a[196:199]
ds_read_b128 a[144:147], v25 offset:50176
v_exp_f32 v119, v119
v_add_f32 v48, v48, v116
v_mfma_f32_16x16x32_bf16 a[200:203], v[68:71], a[100:103], a[200:203]
ds_read_b128 a[116:119], v25 offset:51200
v_add_f32 v48, v48, v117
v_add_f32 v48, v48, v118
v_add_f32 v48, v48, v119
v_mfma_f32_16x16x32_bf16 a[204:207], v[72:75], a[100:103], a[204:207]
s_waitcnt lgkmcnt(15)
ds_read_b128 a[140:143], v25 offset:52224
v_cvt_pk_bf16_f32 v116, v116, v117
v_cvt_pk_bf16_f32 v117, v118, v119
v_accvgpr_read_b32 v120, a20
v_mfma_f32_16x16x32_bf16 a[208:211], v[64:67], a[104:107], a[208:211]
ds_read_b128 a[96:99], v25 offset:53248
v_accvgpr_read_b32 v121, a21
v_accvgpr_read_b32 v122, a22
v_accvgpr_read_b32 v123, a23
v_mfma_f32_16x16x32_bf16 a[212:215], v[68:71], a[104:107], a[212:215]
ds_read_b128 a[100:103], v25 offset:54272
v_fma_f32 v120, v120, s66, -v37
v_fma_f32 v121, v121, s66, -v37
v_fma_f32 v122, v122, s66, -v37
v_mfma_f32_16x16x32_bf16 a[216:219], v[72:75], a[104:107], a[216:219]
ds_write_b64 v26, v[112:113] offset:21504
v_fma_f32 v123, v123, s66, -v37
v_exp_f32 v120, v120
v_mfma_f32_16x16x32_bf16 a[220:223], v[64:67], a[108:111], a[220:223]
buffer_load_dwordx4 v14, s[40:43], s57 offen offset:2048 nt lds
v_exp_f32 v121, v121
v_mfma_f32_16x16x32_bf16 a[224:227], v[68:71], a[108:111], a[224:227]
ds_write_b64 v26, v[116:117] offset:22528
v_exp_f32 v122, v122
v_mfma_f32_16x16x32_bf16 a[228:231], v[72:75], a[108:111], a[228:231]
v_exp_f32 v123, v123
v_add_f32 v49, v49, v120
v_add_f32 v49, v49, v121
v_mfma_f32_16x16x32_bf16 a[232:235], v[64:67], a[112:115], a[232:235]
v_add_f32 v49, v49, v122
v_add_f32 v49, v49, v123
v_cvt_pk_bf16_f32 v120, v120, v121
v_cvt_pk_bf16_f32 v121, v122, v123
v_mfma_f32_16x16x32_bf16 a[236:239], v[68:71], a[112:115], a[236:239]
v_accvgpr_read_b32 v124, a24
v_accvgpr_read_b32 v125, a25
v_accvgpr_read_b32 v126, a26
v_mfma_f32_16x16x32_bf16 a[240:243], v[72:75], a[112:115], a[240:243]
s_waitcnt lgkmcnt(15)
ds_write_b64 v26, v[120:121] offset:23552
v_accvgpr_read_b32 v127, a27
v_fma_f32 v124, v124, s66, -v38
v_fma_f32 v125, v125, s66, -v38
v_mfma_f32_16x16x32_bf16 a[244:247], v[64:67], a[120:123], a[244:247]
v_fma_f32 v126, v126, s66, -v38
v_fma_f32 v127, v127, s66, -v38
v_exp_f32 v124, v124
v_mfma_f32_16x16x32_bf16 a[248:251], v[68:71], a[120:123], a[248:251]
v_exp_f32 v125, v125
v_exp_f32 v126, v126
v_mfma_f32_16x16x32_bf16 a[252:255], v[72:75], a[120:123], a[252:255]
v_exp_f32 v127, v127
v_add_f32 v50, v50, v124
v_add_f32 v50, v50, v125
s_waitcnt vmcnt(12) lgkmcnt(3)
s_barrier
v_mov_b32 v41, s11
s_mov_b64 exec, 1
buffer_atomic_add v41, v25, s[72:75], s21 offen sc1
s_mov_b64 exec, -1
v_add_u32 v20, 0xc200, v20
v_add_u32 v21, 0xc200, v21
v_add_u32 v22, 0xc200, v22
v_mfma_f32_16x16x32_bf16 a[148:151], v[76:79], a[124:127], a[148:151]
ds_read_b64_tr_b16 v[64:65], v20 offset:24576
v_add_f32 v50, v50, v126
v_add_f32 v50, v50, v127
v_cvt_pk_bf16_f32 v124, v124, v125
v_mfma_f32_16x16x32_bf16 a[152:155], v[80:83], a[124:127], a[152:155]
s_add_u32 m0, s65, 80128
s_sub_u32 s57, 147456, s17
buffer_load_dwordx4 v12, s[40:43], s57 offen nt lds
v_cvt_pk_bf16_f32 v125, v126, v127
v_mfma_f32_16x16x32_bf16 a[156:159], v[84:87], a[124:127], a[156:159]
ds_read_b64_tr_b16 v[66:67], v20 offset:30720
v_accvgpr_read_b32 v128, a28
v_accvgpr_read_b32 v129, a29
v_accvgpr_read_b32 v130, a30
v_mfma_f32_16x16x32_bf16 a[160:163], v[76:79], a[128:131], a[160:163]
ds_read_b64_tr_b16 v[68:69], v21 offset:24576
v_accvgpr_read_b32 v131, a31
v_fma_f32 v128, v128, s66, -v39
v_fma_f32 v129, v129, s66, -v39
v_mfma_f32_16x16x32_bf16 a[164:167], v[80:83], a[128:131], a[164:167]
ds_read_b64_tr_b16 v[70:71], v21 offset:30720
v_fma_f32 v130, v130, s66, -v39
v_fma_f32 v131, v131, s66, -v39
v_exp_f32 v128, v128
v_mfma_f32_16x16x32_bf16 a[168:171], v[84:87], a[128:131], a[168:171]
ds_read_b64_tr_b16 v[72:73], v22 offset:24576
v_exp_f32 v129, v129
v_mfma_f32_16x16x32_bf16 a[172:175], v[76:79], a[132:135], a[172:175]
ds_write_b64 v26, v[124:125] offset:24576
v_exp_f32 v130, v130
v_mfma_f32_16x16x32_bf16 a[176:179], v[80:83], a[132:135], a[176:179]
ds_read_b64_tr_b16 v[74:75], v22 offset:30720
v_exp_f32 v131, v131
v_add_f32 v51, v51, v128
v_mfma_f32_16x16x32_bf16 a[180:183], v[84:87], a[132:135], a[180:183]
ds_read_b128 a[104:107], v25
v_add_f32 v51, v51, v129
v_add_f32 v51, v51, v130
v_add_f32 v51, v51, v131
v_mfma_f32_16x16x32_bf16 a[184:187], v[76:79], a[136:139], a[184:187]
buffer_load_dwordx4 v13, s[40:43], s57 offen offset:1024 nt lds
v_cvt_pk_bf16_f32 v128, v128, v129
v_cvt_pk_bf16_f32 v129, v130, v131
v_mfma_f32_16x16x32_bf16 a[188:191], v[80:83], a[136:139], a[188:191]
ds_read_b128 a[108:111], v25 offset:1024
v_accvgpr_read_b32 v132, a32
v_accvgpr_read_b32 v133, a33
v_accvgpr_read_b32 v134, a34
v_mfma_f32_16x16x32_bf16 a[192:195], v[84:87], a[136:139], a[192:195]
ds_read_b128 a[112:115], v25 offset:2048
v_accvgpr_read_b32 v135, a35
v_fma_f32 v132, v132, s66, -v40
v_mfma_f32_16x16x32_bf16 a[196:199], v[76:79], a[144:147], a[196:199]
ds_read_b128 a[120:123], v25 offset:3072
v_fma_f32 v133, v133, s66, -v40
v_fma_f32 v134, v134, s66, -v40
v_fma_f32 v135, v135, s66, -v40
v_mfma_f32_16x16x32_bf16 a[200:203], v[80:83], a[144:147], a[200:203]
ds_write_b64 v26, v[128:129] offset:25600
v_exp_f32 v132, v132
v_exp_f32 v133, v133
v_mfma_f32_16x16x32_bf16 a[204:207], v[84:87], a[144:147], a[204:207]
ds_read_b128 a[124:127], v25 offset:4096
v_exp_f32 v134, v134
v_mfma_f32_16x16x32_bf16 a[208:211], v[76:79], a[116:119], a[208:211]
ds_read_b128 a[128:131], v25 offset:5120
v_exp_f32 v135, v135
v_add_f32 v52, v52, v132
v_mfma_f32_16x16x32_bf16 a[212:215], v[80:83], a[116:119], a[212:215]
ds_read_b128 a[132:135], v25 offset:6144
v_add_f32 v52, v52, v133
v_add_f32 v52, v52, v134
v_mfma_f32_16x16x32_bf16 a[216:219], v[84:87], a[116:119], a[216:219]
ds_read_b128 a[136:139], v25 offset:7168
v_add_f32 v52, v52, v135
v_cvt_pk_bf16_f32 v132, v132, v133
v_cvt_pk_bf16_f32 v133, v134, v135
v_mfma_f32_16x16x32_bf16 a[220:223], v[76:79], a[140:143], a[220:223]
buffer_load_dwordx4 v14, s[40:43], s57 offen offset:2048 nt lds
v_accvgpr_read_b32 v100, a36
v_accvgpr_read_b32 v101, a37
v_mfma_f32_16x16x32_bf16 a[224:227], v[80:83], a[140:143], a[224:227]
ds_read_b128 a[144:147], v25 offset:8192
v_accvgpr_read_b32 v102, a38
v_accvgpr_read_b32 v103, a39
v_fma_f32 v100, v100, s66, -v32
v_mfma_f32_16x16x32_bf16 a[228:231], v[84:87], a[140:143], a[228:231]
ds_write_b64 v26, v[132:133] offset:26624
v_fma_f32 v101, v101, s66, -v32
v_fma_f32 v102, v102, s66, -v32
v_fma_f32 v103, v103, s66, -v32
v_mfma_f32_16x16x32_bf16 a[232:235], v[76:79], a[96:99], a[232:235]
v_exp_f32 v100, v100
v_exp_f32 v101, v101
v_mfma_f32_16x16x32_bf16 a[236:239], v[80:83], a[96:99], a[236:239]
v_exp_f32 v102, v102
v_exp_f32 v103, v103
v_mfma_f32_16x16x32_bf16 a[240:243], v[84:87], a[96:99], a[240:243]
v_add_f32 v44, v44, v100
v_add_f32 v44, v44, v101
v_add_f32 v44, v44, v102
v_mfma_f32_16x16x32_bf16 a[244:247], v[76:79], a[100:103], a[244:247]
v_add_f32 v44, v44, v103
v_cvt_pk_bf16_f32 v100, v100, v101
v_cvt_pk_bf16_f32 v101, v102, v103
v_accvgpr_read_b32 v104, a40
v_mfma_f32_16x16x32_bf16 a[248:251], v[80:83], a[100:103], a[248:251]
ds_write_b64 v26, v[100:101] offset:36864
v_accvgpr_read_b32 v105, a41
v_accvgpr_read_b32 v106, a42
v_accvgpr_read_b32 v107, a43
v_mfma_f32_16x16x32_bf16 a[252:255], v[84:87], a[100:103], a[252:255]
s_waitcnt lgkmcnt(11)
v_fma_f32 v104, v104, s66, -v33
v_fma_f32 v105, v105, s66, -v33
v_fma_f32 v106, v106, s66, -v33
v_fma_f32 v107, v107, s66, -v33
v_mfma_f32_16x16x32_bf16 a[148:151], v[64:67], a[104:107], a[148:151]
s_add_u32 m0, s65, 83200
s_sub_u32 s57, 150528, s17
buffer_load_dwordx4 v12, s[40:43], s57 offen nt lds
v_exp_f32 v104, v104
v_mfma_f32_16x16x32_bf16 a[152:155], v[68:71], a[104:107], a[152:155]
ds_read_b64_tr_b16 v[76:77], v20 offset:36864
v_exp_f32 v105, v105
v_mfma_f32_16x16x32_bf16 a[156:159], v[72:75], a[104:107], a[156:159]
s_waitcnt lgkmcnt(11)
ds_read_b64_tr_b16 v[78:79], v20 offset:43008
v_exp_f32 v106, v106
v_exp_f32 v107, v107
v_mfma_f32_16x16x32_bf16 a[160:163], v[64:67], a[108:111], a[160:163]
ds_read_b64_tr_b16 v[80:81], v21 offset:36864
v_add_f32 v45, v45, v104
v_add_f32 v45, v45, v105
v_mfma_f32_16x16x32_bf16 a[164:167], v[68:71], a[108:111], a[164:167]
ds_read_b64_tr_b16 v[82:83], v21 offset:43008
v_add_f32 v45, v45, v106
v_add_f32 v45, v45, v107
v_cvt_pk_bf16_f32 v104, v104, v105
v_mfma_f32_16x16x32_bf16 a[168:171], v[72:75], a[108:111], a[168:171]
s_waitcnt lgkmcnt(13)
ds_read_b64_tr_b16 v[84:85], v22 offset:36864
v_cvt_pk_bf16_f32 v105, v106, v107
v_accvgpr_read_b32 v108, a44
v_mfma_f32_16x16x32_bf16 a[172:175], v[64:67], a[112:115], a[172:175]
ds_read_b64_tr_b16 v[86:87], v22 offset:43008
v_accvgpr_read_b32 v109, a45
v_accvgpr_read_b32 v110, a46
v_accvgpr_read_b32 v111, a47
v_mfma_f32_16x16x32_bf16 a[176:179], v[68:71], a[112:115], a[176:179]
ds_read_b128 a[116:119], v25 offset:9216
v_fma_f32 v108, v108, s66, -v34
v_fma_f32 v109, v109, s66, -v34
v_fma_f32 v110, v110, s66, -v34
v_mfma_f32_16x16x32_bf16 a[180:183], v[72:75], a[112:115], a[180:183]
s_waitcnt lgkmcnt(15)
ds_read_b128 a[140:143], v25 offset:10240
v_fma_f32 v111, v111, s66, -v34
v_exp_f32 v108, v108
v_mfma_f32_16x16x32_bf16 a[184:187], v[64:67], a[120:123], a[184:187]
buffer_load_dwordx4 v13, s[40:43], s57 offen offset:1024 nt lds
v_exp_f32 v109, v109
v_mfma_f32_16x16x32_bf16 a[188:191], v[68:71], a[120:123], a[188:191]
ds_read_b128 a[96:99], v25 offset:11264
v_exp_f32 v110, v110
v_mfma_f32_16x16x32_bf16 a[192:195], v[72:75], a[120:123], a[192:195]
s_waitcnt lgkmcnt(15)
ds_read_b128 a[100:103], v25 offset:12288
v_exp_f32 v111, v111
v_add_f32 v46, v46, v108
v_mfma_f32_16x16x32_bf16 a[196:199], v[64:67], a[124:127], a[196:199]
ds_read_b128 a[104:107], v25 offset:13312
v_add_f32 v46, v46, v109
v_add_f32 v46, v46, v110
v_add_f32 v46, v46, v111
v_mfma_f32_16x16x32_bf16 a[200:203], v[68:71], a[124:127], a[200:203]
ds_read_b128 a[108:111], v25 offset:14336
v_cvt_pk_bf16_f32 v108, v108, v109
v_cvt_pk_bf16_f32 v109, v110, v111
v_accvgpr_read_b32 v112, a48
v_mfma_f32_16x16x32_bf16 a[204:207], v[72:75], a[124:127], a[204:207]
s_waitcnt lgkmcnt(15)
ds_read_b128 a[112:115], v25 offset:15360
v_accvgpr_read_b32 v113, a49
v_accvgpr_read_b32 v114, a50
v_accvgpr_read_b32 v115, a51
v_mfma_f32_16x16x32_bf16 a[208:211], v[64:67], a[128:131], a[208:211]
ds_read_b128 a[120:123], v25 offset:16384
v_fma_f32 v112, v112, s66, -v35
v_fma_f32 v113, v113, s66, -v35
v_fma_f32 v114, v114, s66, -v35
v_mfma_f32_16x16x32_bf16 a[212:215], v[68:71], a[128:131], a[212:215]
ds_read_b128 a[124:127], v25 offset:17408
v_fma_f32 v115, v115, s66, -v35
v_exp_f32 v112, v112
v_mfma_f32_16x16x32_bf16 a[216:219], v[72:75], a[128:131], a[216:219]
ds_write_b64 v26, v[104:105] offset:37888
v_exp_f32 v113, v113
v_mfma_f32_16x16x32_bf16 a[220:223], v[64:67], a[132:135], a[220:223]
buffer_load_dwordx4 v14, s[40:43], s57 offen offset:2048 nt lds
v_exp_f32 v114, v114
v_mfma_f32_16x16x32_bf16 a[224:227], v[68:71], a[132:135], a[224:227]
ds_write_b64 v26, v[108:109] offset:38912
v_exp_f32 v115, v115
v_add_f32 v47, v47, v112
v_mfma_f32_16x16x32_bf16 a[228:231], v[72:75], a[132:135], a[228:231]
v_add_f32 v47, v47, v113
v_add_f32 v47, v47, v114
v_add_f32 v47, v47, v115
v_cvt_pk_bf16_f32 v112, v112, v113
v_mfma_f32_16x16x32_bf16 a[232:235], v[64:67], a[136:139], a[232:235]
v_cvt_pk_bf16_f32 v113, v114, v115
v_accvgpr_read_b32 v116, a52
v_accvgpr_read_b32 v117, a53
v_mfma_f32_16x16x32_bf16 a[236:239], v[68:71], a[136:139], a[236:239]
ds_write_b64 v26, v[112:113] offset:39936
v_accvgpr_read_b32 v118, a54
v_accvgpr_read_b32 v119, a55
v_fma_f32 v116, v116, s66, -v36
v_mfma_f32_16x16x32_bf16 a[240:243], v[72:75], a[136:139], a[240:243]
s_waitcnt lgkmcnt(15)
v_fma_f32 v117, v117, s66, -v36
v_fma_f32 v118, v118, s66, -v36
v_fma_f32 v119, v119, s66, -v36
v_exp_f32 v116, v116
v_mfma_f32_16x16x32_bf16 a[244:247], v[64:67], a[144:147], a[244:247]
v_exp_f32 v117, v117
v_exp_f32 v118, v118
v_mfma_f32_16x16x32_bf16 a[248:251], v[68:71], a[144:147], a[248:251]
v_exp_f32 v119, v119
v_add_f32 v48, v48, v116
v_mfma_f32_16x16x32_bf16 a[252:255], v[72:75], a[144:147], a[252:255]
v_add_f32 v48, v48, v117
v_add_f32 v48, v48, v118
v_add_f32 v48, v48, v119
s_waitcnt vmcnt(13) lgkmcnt(3)
s_barrier
s_add_u32 s54, s48, 1
s_cmp_eq_u32 s18, 1
s_cselect_b32 s54, s48, s54
s_cselect_b32 s16, 98304, 0
s_cmp_eq_u32 s18, 2
s_cselect_b32 s54, 4, s54
s_mul_i32 s52, s54, 1536
s_add_u32 s32, s4, s52
s_addc_u32 s33, s5, 0
s_sub_u32 s53, s20, s52
s_lshl_b32 s51, s54, 2
s_add_u32 s51, s51, s49
s_mul_i32 s52, s51, 196608
s_add_u32 s36, s6, s52
s_addc_u32 s37, s7, 0
s_cmp_lt_u32 s54, 4
s_cselect_b32 s30, 184320, 0
s_cselect_b32 s34, s53, 0
s_cselect_b32 s38, 196608, 0
s_bfe_u32 s51, s2, 0x10001
s_mul_i32 s51, s51, 80
s_lshr_b32 s52, s2, 3
s_add_u32 s51, s51, s52
s_mul_i32 s51, s51, 49152
s_add_u32 s51, s58, s51
s_addc_u32 s52, s59, 0
s_cmp_lt_u32 s54, 4
s_cselect_b32 s36, s36, s51
s_cselect_b32 s37, s37, s52
s_cselect_b32 s38, s38, 49152
v_add_u32 v20, 0xffff3e00, v20
v_add_u32 v21, 0xffff3e00, v21
v_add_u32 v22, 0xffff3e00, v22
v_mfma_f32_16x16x32_bf16 a[148:151], v[76:79], a[116:119], a[148:151]
ds_read_b64_tr_b16 v[64:65], v20
v_cvt_pk_bf16_f32 v116, v116, v117
v_cvt_pk_bf16_f32 v117, v118, v119
v_accvgpr_read_b32 v120, a56
v_mfma_f32_16x16x32_bf16 a[152:155], v[80:83], a[116:119], a[152:155]
s_add_u32 s70, s50, s54
s_add_u32 m0, s65, 129536
s_sub_u32 s57, 172032, s17
buffer_load_dwordx4 v12, s[40:43], s57 offen nt lds
v_accvgpr_read_b32 v121, a57
v_accvgpr_read_b32 v122, a58
v_mfma_f32_16x16x32_bf16 a[156:159], v[84:87], a[116:119], a[156:159]
s_and_b32 s70, s70, 7
ds_read_b64_tr_b16 v[66:67], v20 offset:6144
v_accvgpr_read_b32 v123, a59
v_fma_f32 v120, v120, s66, -v37
v_fma_f32 v121, v121, s66, -v37
v_mfma_f32_16x16x32_bf16 a[160:163], v[76:79], a[140:143], a[160:163]
s_mul_i32 s70, s70, 5
ds_read_b64_tr_b16 v[68:69], v21
v_fma_f32 v122, v122, s66, -v37
v_fma_f32 v123, v123, s66, -v37
v_exp_f32 v120, v120
v_mfma_f32_16x16x32_bf16 a[164:167], v[80:83], a[140:143], a[164:167]
s_add_u32 s70, s70, 2
ds_read_b64_tr_b16 v[70:71], v21 offset:6144
v_exp_f32 v121, v121
v_mfma_f32_16x16x32_bf16 a[168:171], v[84:87], a[140:143], a[168:171]
s_lshr_b32 s70, s70, 2
ds_read_b64_tr_b16 v[72:73], v22
v_exp_f32 v122, v122
v_mfma_f32_16x16x32_bf16 a[172:175], v[76:79], a[96:99], a[172:175]
s_and_b32 s71, s49, 3
ds_write_b64 v26, v[116:117] offset:40960
v_exp_f32 v123, v123
v_add_f32 v49, v49, v120
v_mfma_f32_16x16x32_bf16 a[176:179], v[80:83], a[96:99], a[176:179]
s_mul_i32 s71, s71, 5
ds_read_b64_tr_b16 v[74:75], v22 offset:6144
v_add_f32 v49, v49, v121
v_add_f32 v49, v49, v122
v_add_f32 v49, v49, v123
v_mfma_f32_16x16x32_bf16 a[180:183], v[84:87], a[96:99], a[180:183]
s_lshr_b32 s71, s71, 1
ds_read_b128 a[128:131], v25 offset:18432
v_cvt_pk_bf16_f32 v120, v120, v121
v_cvt_pk_bf16_f32 v121, v122, v123
v_accvgpr_read_b32 v124, a60
v_mfma_f32_16x16x32_bf16 a[184:187], v[76:79], a[100:103], a[184:187]
s_add_u32 s70, s70, s71
buffer_load_dwordx4 v13, s[40:43], s57 offen offset:1024 nt lds
v_accvgpr_read_b32 v125, a61
v_mfma_f32_16x16x32_bf16 a[188:191], v[80:83], a[100:103], a[188:191]
s_lshl_b32 s70, s70, 7
ds_read_b128 a[132:135], v25 offset:19456
v_accvgpr_read_b32 v126, a62
v_accvgpr_read_b32 v127, a63
v_fma_f32 v124, v124, s66, -v38
v_mfma_f32_16x16x32_bf16 a[192:195], v[84:87], a[100:103], a[192:195]
s_sub_u32 s71, s70, 1280
ds_read_b128 a[136:139], v25 offset:20480
v_fma_f32 v125, v125, s66, -v38
v_fma_f32 v126, v126, s66, -v38
v_fma_f32 v127, v127, s66, -v38
v_mfma_f32_16x16x32_bf16 a[196:199], v[76:79], a[104:107], a[196:199]
s_min_u32 s70, s70, s71
ds_read_b128 a[144:147], v25 offset:21504
v_exp_f32 v124, v124
v_exp_f32 v125, v125
v_mfma_f32_16x16x32_bf16 a[200:203], v[80:83], a[104:107], a[200:203]
s_add_u32 s12, s70, 0
ds_write_b64 v26, v[120:121] offset:41984
v_exp_f32 v126, v126
v_mfma_f32_16x16x32_bf16 a[204:207], v[84:87], a[104:107], a[204:207]
s_sub_u32 s71, s12, 1280
ds_read_b128 a[116:119], v25 offset:22528
v_exp_f32 v127, v127
v_mfma_f32_16x16x32_bf16 a[208:211], v[76:79], a[108:111], a[208:211]
s_min_u32 s12, s12, s71
ds_read_b128 a[140:143], v25 offset:23552
v_add_f32 v50, v50, v124
v_add_f32 v50, v50, v125
v_add_f32 v50, v50, v126
v_mfma_f32_16x16x32_bf16 a[212:215], v[80:83], a[108:111], a[212:215]
s_add_u32 s13, s70, 128
ds_read_b128 a[96:99], v25 offset:24576
v_add_f32 v50, v50, v127
v_cvt_pk_bf16_f32 v124, v124, v125
v_cvt_pk_bf16_f32 v125, v126, v127
v_mfma_f32_16x16x32_bf16 a[216:219], v[84:87], a[108:111], a[216:219]
s_sub_u32 s71, s13, 1280
ds_read_b128 a[100:103], v25 offset:25600
v_accvgpr_read_b32 v128, a64
v_accvgpr_read_b32 v129, a65
v_accvgpr_read_b32 v130, a66
v_mfma_f32_16x16x32_bf16 a[220:223], v[76:79], a[112:115], a[220:223]
s_min_u32 s13, s13, s71
buffer_load_dwordx4 v14, s[40:43], s57 offen offset:2048 nt lds
v_accvgpr_read_b32 v131, a67
v_fma_f32 v128, v128, s66, -v39
v_mfma_f32_16x16x32_bf16 a[224:227], v[80:83], a[112:115], a[224:227]
s_add_u32 s22, s70, 256
ds_read_b128 a[104:107], v25 offset:26624
v_fma_f32 v129, v129, s66, -v39
v_fma_f32 v130, v130, s66, -v39
v_mfma_f32_16x16x32_bf16 a[228:231], v[84:87], a[112:115], a[228:231]
s_sub_u32 s71, s22, 1280
ds_write_b64 v26, v[124:125] offset:43008
v_fma_f32 v131, v131, s66, -v39
v_exp_f32 v128, v128
v_mfma_f32_16x16x32_bf16 a[232:235], v[76:79], a[120:123], a[232:235]
s_min_u32 s22, s22, s71
v_exp_f32 v129, v129
v_exp_f32 v130, v130
v_mfma_f32_16x16x32_bf16 a[236:239], v[80:83], a[120:123], a[236:239]
s_add_u32 s23, s70, 384
v_exp_f32 v131, v131
v_add_f32 v51, v51, v128
v_add_f32 v51, v51, v129
v_mfma_f32_16x16x32_bf16 a[240:243], v[84:87], a[120:123], a[240:243]
s_sub_u32 s71, s23, 1280
v_add_f32 v51, v51, v130
v_add_f32 v51, v51, v131
v_cvt_pk_bf16_f32 v128, v128, v129
v_cvt_pk_bf16_f32 v129, v130, v131
v_mfma_f32_16x16x32_bf16 a[244:247], v[76:79], a[124:127], a[244:247]
s_min_u32 s23, s23, s71
v_accvgpr_read_b32 v132, a68
v_accvgpr_read_b32 v133, a69
v_accvgpr_read_b32 v134, a70
v_accvgpr_read_b32 v135, a71
v_mfma_f32_16x16x32_bf16 a[248:251], v[80:83], a[124:127], a[248:251]
s_add_u32 s24, s70, 512
ds_write_b64 v26, v[128:129] offset:44032
v_fma_f32 v132, v132, s66, -v40
v_fma_f32 v133, v133, s66, -v40
v_mfma_f32_16x16x32_bf16 a[252:255], v[84:87], a[124:127], a[252:255]
s_waitcnt lgkmcnt(11)
s_sub_u32 s71, s24, 1280
v_fma_f32 v134, v134, s66, -v40
v_fma_f32 v135, v135, s66, -v40
v_exp_f32 v132, v132
v_mfma_f32_16x16x32_bf16 a[148:151], v[64:67], a[128:131], a[148:151]
s_min_u32 s24, s24, s71
s_add_u32 m0, s65, 132608
s_sub_u32 s57, 175104, s17
buffer_load_dwordx4 v12, s[40:43], s57 offen nt lds
v_exp_f32 v133, v133
v_mfma_f32_16x16x32_bf16 a[152:155], v[68:71], a[128:131], a[152:155]
s_add_u32 s25, s70, 640
ds_read_b64_tr_b16 v[76:77], v20 offset:12288
v_exp_f32 v134, v134
v_exp_f32 v135, v135
v_mfma_f32_16x16x32_bf16 a[156:159], v[72:75], a[128:131], a[156:159]
s_waitcnt lgkmcnt(11)
s_sub_u32 s71, s25, 1280
ds_read_b64_tr_b16 v[78:79], v20 offset:18432
v_add_f32 v52, v52, v132
v_mfma_f32_16x16x32_bf16 a[160:163], v[64:67], a[132:135], a[160:163]
s_min_u32 s25, s25, s71
ds_read_b64_tr_b16 v[80:81], v21 offset:12288
v_add_f32 v52, v52, v133
v_add_f32 v52, v52, v134
v_add_f32 v52, v52, v135
v_mfma_f32_16x16x32_bf16 a[164:167], v[68:71], a[132:135], a[164:167]
s_add_u32 s55, s70, 768
ds_read_b64_tr_b16 v[82:83], v21 offset:18432
v_cvt_pk_bf16_f32 v132, v132, v133
v_cvt_pk_bf16_f32 v133, v134, v135
v_accvgpr_read_b32 v100, a72
v_mfma_f32_16x16x32_bf16 a[168:171], v[72:75], a[132:135], a[168:171]
s_waitcnt lgkmcnt(13)
s_sub_u32 s71, s55, 1280
ds_read_b64_tr_b16 v[84:85], v22 offset:12288
v_accvgpr_read_b32 v101, a73
v_accvgpr_read_b32 v102, a74
v_accvgpr_read_b32 v103, a75
v_mfma_f32_16x16x32_bf16 a[172:175], v[64:67], a[136:139], a[172:175]
s_min_u32 s55, s55, s71
ds_read_b64_tr_b16 v[86:87], v22 offset:18432
v_fma_f32 v100, v100, s66, -v32
v_fma_f32 v101, v101, s66, -v32
v_fma_f32 v102, v102, s66, -v32
v_mfma_f32_16x16x32_bf16 a[176:179], v[68:71], a[136:139], a[176:179]
s_add_u32 s60, s70, 896
ds_read_b128 a[108:111], v25 offset:27648
v_fma_f32 v103, v103, s66, -v32
v_exp_f32 v100, v100
v_mfma_f32_16x16x32_bf16 a[180:183], v[72:75], a[136:139], a[180:183]
s_waitcnt lgkmcnt(15)
s_sub_u32 s71, s60, 1280
ds_read_b128 a[112:115], v25 offset:28672
v_exp_f32 v101, v101
v_mfma_f32_16x16x32_bf16 a[184:187], v[64:67], a[144:147], a[184:187]
s_min_u32 s60, s60, s71
buffer_load_dwordx4 v13, s[40:43], s57 offen offset:1024 nt lds
v_exp_f32 v102, v102
v_mfma_f32_16x16x32_bf16 a[188:191], v[68:71], a[144:147], a[188:191]
s_add_u32 s61, s70, 1024
ds_read_b128 a[120:123], v25 offset:29696
v_exp_f32 v103, v103
v_add_f32 v44, v44, v100
v_mfma_f32_16x16x32_bf16 a[192:195], v[72:75], a[144:147], a[192:195]
s_waitcnt lgkmcnt(15)
s_sub_u32 s71, s61, 1280
ds_read_b128 a[124:127], v25 offset:30720
v_add_f32 v44, v44, v101
v_add_f32 v44, v44, v102
v_add_f32 v44, v44, v103
v_mfma_f32_16x16x32_bf16 a[196:199], v[64:67], a[116:119], a[196:199]
s_min_u32 s61, s61, s71
ds_read_b128 a[128:131], v25 offset:31744
v_cvt_pk_bf16_f32 v100, v100, v101
v_cvt_pk_bf16_f32 v101, v102, v103
v_mfma_f32_16x16x32_bf16 a[200:203], v[68:71], a[116:119], a[200:203]
s_add_u32 s69, s70, 1152
ds_read_b128 a[132:135], v25 offset:32768
v_accvgpr_read_b32 v104, a76
v_accvgpr_read_b32 v105, a77
v_accvgpr_read_b32 v106, a78
v_mfma_f32_16x16x32_bf16 a[204:207], v[72:75], a[116:119], a[204:207]
s_waitcnt lgkmcnt(15)
s_sub_u32 s71, s69, 1280
ds_read_b128 a[136:139], v25 offset:33792
v_accvgpr_read_b32 v107, a79
v_fma_f32 v104, v104, s66, -v33
v_fma_f32 v105, v105, s66, -v33
v_mfma_f32_16x16x32_bf16 a[208:211], v[64:67], a[140:143], a[208:211]
s_min_u32 s69, s69, s71
ds_read_b128 a[144:147], v25 offset:34816
v_fma_f32 v106, v106, s66, -v33
v_fma_f32 v107, v107, s66, -v33
v_exp_f32 v104, v104
v_mfma_f32_16x16x32_bf16 a[212:215], v[68:71], a[140:143], a[212:215]
ds_read_b128 a[116:119], v25 offset:35840
v_exp_f32 v105, v105
v_mfma_f32_16x16x32_bf16 a[216:219], v[72:75], a[140:143], a[216:219]
ds_write_b64 v26, v[132:133] offset:45056
v_exp_f32 v106, v106
v_exp_f32 v107, v107
v_mfma_f32_16x16x32_bf16 a[220:223], v[64:67], a[96:99], a[220:223]
buffer_load_dwordx4 v14, s[40:43], s57 offen offset:2048 nt lds
v_mfma_f32_16x16x32_bf16 a[224:227], v[68:71], a[96:99], a[224:227]
ds_write_b64 v26, v[100:101]
v_add_f32 v45, v45, v104
v_add_f32 v45, v45, v105
v_add_f32 v45, v45, v106
v_mfma_f32_16x16x32_bf16 a[228:231], v[72:75], a[96:99], a[228:231]
v_add_f32 v45, v45, v107
v_cvt_pk_bf16_f32 v104, v104, v105
v_cvt_pk_bf16_f32 v105, v106, v107
v_accvgpr_read_b32 v108, a80
v_mfma_f32_16x16x32_bf16 a[232:235], v[64:67], a[100:103], a[232:235]
ds_write_b64 v26, v[104:105] offset:1024
v_accvgpr_read_b32 v109, a81
v_accvgpr_read_b32 v110, a82
v_accvgpr_read_b32 v111, a83
v_mfma_f32_16x16x32_bf16 a[236:239], v[68:71], a[100:103], a[236:239]
v_fma_f32 v108, v108, s66, -v34
v_fma_f32 v109, v109, s66, -v34
v_fma_f32 v110, v110, s66, -v34
v_fma_f32 v111, v111, s66, -v34
v_mfma_f32_16x16x32_bf16 a[240:243], v[72:75], a[100:103], a[240:243]
s_waitcnt lgkmcnt(15)
v_exp_f32 v108, v108
v_exp_f32 v109, v109
v_mfma_f32_16x16x32_bf16 a[244:247], v[64:67], a[104:107], a[244:247]
v_exp_f32 v110, v110
v_exp_f32 v111, v111
v_mfma_f32_16x16x32_bf16 a[248:251], v[68:71], a[104:107], a[248:251]
v_add_f32 v46, v46, v108
v_add_f32 v46, v46, v109
v_add_f32 v46, v46, v110
v_mfma_f32_16x16x32_bf16 a[252:255], v[72:75], a[104:107], a[252:255]
v_add_f32 v46, v46, v111
v_cvt_pk_bf16_f32 v108, v108, v109
v_cvt_pk_bf16_f32 v109, v110, v111
v_accvgpr_read_b32 v112, a84
s_waitcnt vmcnt(13) lgkmcnt(2)
s_barrier
v_add_u32 v20, 0xc200, v20
v_add_u32 v21, 0xc200, v21
v_add_u32 v22, 0xc200, v22
v_mfma_f32_16x16x32_bf16 a[148:151], v[76:79], a[108:111], a[148:151]
ds_read_b64_tr_b16 v[64:65], v20
v_accvgpr_read_b32 v113, a85
v_accvgpr_read_b32 v114, a86
v_accvgpr_read_b32 v115, a87
v_mfma_f32_16x16x32_bf16 a[152:155], v[80:83], a[108:111], a[152:155]
s_add_u32 m0, s64, 0
s_add_u32 s57, s16, 0
buffer_load_dwordx4 v9, s[36:39], s57 offen nt lds
v_fma_f32 v112, v112, s66, -v35
v_mfma_f32_16x16x32_bf16 a[156:159], v[84:87], a[108:111], a[156:159]
ds_read_b64_tr_b16 v[66:67], v20 offset:6144
v_fma_f32 v113, v113, s66, -v35
v_fma_f32 v114, v114, s66, -v35
v_fma_f32 v115, v115, s66, -v35
v_mfma_f32_16x16x32_bf16 a[160:163], v[76:79], a[112:115], a[160:163]
ds_read_b64_tr_b16 v[68:69], v21
v_exp_f32 v112, v112
v_exp_f32 v113, v113
v_mfma_f32_16x16x32_bf16 a[164:167], v[80:83], a[112:115], a[164:167]
ds_read_b64_tr_b16 v[70:71], v21 offset:6144
v_exp_f32 v114, v114
v_mfma_f32_16x16x32_bf16 a[168:171], v[84:87], a[112:115], a[168:171]
ds_read_b64_tr_b16 v[72:73], v22
v_exp_f32 v115, v115
v_mfma_f32_16x16x32_bf16 a[172:175], v[76:79], a[120:123], a[172:175]
ds_write_b64 v26, v[108:109] offset:2048
v_add_f32 v47, v47, v112
v_add_f32 v47, v47, v113
v_add_f32 v47, v47, v114
v_mfma_f32_16x16x32_bf16 a[176:179], v[80:83], a[120:123], a[176:179]
ds_read_b64_tr_b16 v[74:75], v22 offset:6144
v_add_f32 v47, v47, v115
v_cvt_pk_bf16_f32 v112, v112, v113
v_cvt_pk_bf16_f32 v113, v114, v115
v_mfma_f32_16x16x32_bf16 a[180:183], v[84:87], a[120:123], a[180:183]
ds_read_b128 a[140:143], v25 offset:36864
v_accvgpr_read_b32 v116, a88
v_accvgpr_read_b32 v117, a89
v_accvgpr_read_b32 v118, a90
v_mfma_f32_16x16x32_bf16 a[184:187], v[76:79], a[124:127], a[184:187]
buffer_load_dwordx4 v10, s[36:39], s57 offen offset:1024 nt lds
v_accvgpr_read_b32 v119, a91
v_fma_f32 v116, v116, s66, -v36
v_mfma_f32_16x16x32_bf16 a[188:191], v[80:83], a[124:127], a[188:191]
ds_read_b128 a[96:99], v25 offset:37888
v_fma_f32 v117, v117, s66, -v36
v_fma_f32 v118, v118, s66, -v36
v_mfma_f32_16x16x32_bf16 a[192:195], v[84:87], a[124:127], a[192:195]
ds_read_b128 a[100:103], v25 offset:38912
v_fma_f32 v119, v119, s66, -v36
v_exp_f32 v116, v116
v_mfma_f32_16x16x32_bf16 a[196:199], v[76:79], a[128:131], a[196:199]
ds_read_b128 a[104:107], v25 offset:39936
v_exp_f32 v117, v117
v_exp_f32 v118, v118
v_mfma_f32_16x16x32_bf16 a[200:203], v[80:83], a[128:131], a[200:203]
ds_write_b64 v26, v[112:113] offset:3072
v_exp_f32 v119, v119
v_mfma_f32_16x16x32_bf16 a[204:207], v[84:87], a[128:131], a[204:207]
ds_read_b128 a[108:111], v25 offset:40960
v_add_f32 v48, v48, v116
v_add_f32 v48, v48, v117
v_add_f32 v48, v48, v118
v_mfma_f32_16x16x32_bf16 a[208:211], v[76:79], a[132:135], a[208:211]
ds_read_b128 a[112:115], v25 offset:41984
v_add_f32 v48, v48, v119
v_cvt_pk_bf16_f32 v116, v116, v117
v_mfma_f32_16x16x32_bf16 a[212:215], v[80:83], a[132:135], a[212:215]
ds_read_b128 a[120:123], v25 offset:43008
v_cvt_pk_bf16_f32 v117, v118, v119
v_accvgpr_read_b32 v120, a92
v_accvgpr_read_b32 v121, a93
v_mfma_f32_16x16x32_bf16 a[216:219], v[84:87], a[132:135], a[216:219]
ds_read_b128 a[124:127], v25 offset:44032
v_accvgpr_read_b32 v122, a94
v_accvgpr_read_b32 v123, a95
v_fma_f32 v120, v120, s66, -v37
v_mfma_f32_16x16x32_bf16 a[220:223], v[76:79], a[136:139], a[220:223]
buffer_load_dwordx4 v11, s[36:39], s57 offen offset:2048 nt lds
v_fma_f32 v121, v121, s66, -v37
v_fma_f32 v122, v122, s66, -v37
v_mfma_f32_16x16x32_bf16 a[224:227], v[80:83], a[136:139], a[224:227]
ds_read_b128 a[128:131], v25 offset:45056
v_fma_f32 v123, v123, s66, -v37
v_exp_f32 v120, v120
v_mfma_f32_16x16x32_bf16 a[228:231], v[84:87], a[136:139], a[228:231]
ds_write_b64 v26, v[116:117] offset:4096
v_exp_f32 v121, v121
v_mfma_f32_16x16x32_bf16 a[232:235], v[76:79], a[144:147], a[232:235]
v_exp_f32 v122, v122
v_exp_f32 v123, v123
v_mfma_f32_16x16x32_bf16 a[236:239], v[80:83], a[144:147], a[236:239]
v_add_f32 v49, v49, v120
v_add_f32 v49, v49, v121
v_add_f32 v49, v49, v122
v_add_f32 v49, v49, v123
v_mfma_f32_16x16x32_bf16 a[240:243], v[84:87], a[144:147], a[240:243]
v_cvt_pk_bf16_f32 v120, v120, v121
v_cvt_pk_bf16_f32 v121, v122, v123
v_fma_f32 v208, v208, s66, -v38
v_fma_f32 v209, v209, s66, -v38
v_mfma_f32_16x16x32_bf16 a[244:247], v[76:79], a[116:119], a[244:247]
ds_write_b64 v26, v[120:121] offset:5120
v_fma_f32 v210, v210, s66, -v38
v_fma_f32 v211, v211, s66, -v38
v_exp_f32 v208, v208
v_mfma_f32_16x16x32_bf16 a[248:251], v[80:83], a[116:119], a[248:251]
v_exp_f32 v209, v209
v_mfma_f32_16x16x32_bf16 a[252:255], v[84:87], a[116:119], a[252:255]
s_waitcnt lgkmcnt(11)
v_exp_f32 v210, v210
v_exp_f32 v211, v211
v_mfma_f32_16x16x32_bf16 a[148:151], v[64:67], a[140:143], a[148:151]
s_add_u32 m0, s64, 3136
s_add_u32 s57, s16, 3072
buffer_load_dwordx4 v9, s[36:39], s57 offen nt lds
v_add_f32 v50, v50, v208
v_add_f32 v50, v50, v209
v_mfma_f32_16x16x32_bf16 a[152:155], v[68:71], a[140:143], a[152:155]
ds_read_b64_tr_b16 v[76:77], v20 offset:12288
v_add_f32 v50, v50, v210
v_add_f32 v50, v50, v211
v_cvt_pk_bf16_f32 v208, v208, v209
v_mfma_f32_16x16x32_bf16 a[156:159], v[72:75], a[140:143], a[156:159]
s_waitcnt lgkmcnt(11)
ds_read_b64_tr_b16 v[78:79], v20 offset:18432
v_cvt_pk_bf16_f32 v209, v210, v211
v_fma_f32 v212, v212, s66, -v39
v_mfma_f32_16x16x32_bf16 a[160:163], v[64:67], a[96:99], a[160:163]
ds_read_b64_tr_b16 v[80:81], v21 offset:12288
v_fma_f32 v213, v213, s66, -v39
v_fma_f32 v214, v214, s66, -v39
v_fma_f32 v215, v215, s66, -v39
v_mfma_f32_16x16x32_bf16 a[164:167], v[68:71], a[96:99], a[164:167]
ds_read_b64_tr_b16 v[82:83], v21 offset:18432
v_exp_f32 v212, v212
v_exp_f32 v213, v213
v_mfma_f32_16x16x32_bf16 a[168:171], v[72:75], a[96:99], a[168:171]
s_waitcnt lgkmcnt(13)
ds_read_b64_tr_b16 v[84:85], v22 offset:12288
v_exp_f32 v214, v214
v_mfma_f32_16x16x32_bf16 a[172:175], v[64:67], a[100:103], a[172:175]
ds_read_b64_tr_b16 v[86:87], v22 offset:18432
v_exp_f32 v215, v215
v_mfma_f32_16x16x32_bf16 a[176:179], v[68:71], a[100:103], a[176:179]
ds_read_b128 a[132:135], v25 offset:46080
v_add_f32 v51, v51, v212
v_add_f32 v51, v51, v213
v_add_f32 v51, v51, v214
v_mfma_f32_16x16x32_bf16 a[180:183], v[72:75], a[100:103], a[180:183]
s_waitcnt lgkmcnt(15)
ds_read_b128 a[136:139], v25 offset:47104
v_add_f32 v51, v51, v215
v_cvt_pk_bf16_f32 v212, v212, v213
v_cvt_pk_bf16_f32 v213, v214, v215
v_mfma_f32_16x16x32_bf16 a[184:187], v[64:67], a[104:107], a[184:187]
buffer_load_dwordx4 v10, s[36:39], s57 offen offset:1024 nt lds
v_fma_f32 v216, v216, s66, -v40
v_fma_f32 v217, v217, s66, -v40
v_mfma_f32_16x16x32_bf16 a[188:191], v[68:71], a[104:107], a[188:191]
ds_read_b128 a[144:147], v25 offset:48128
v_fma_f32 v218, v218, s66, -v40
v_fma_f32 v219, v219, s66, -v40
v_exp_f32 v216, v216
v_mfma_f32_16x16x32_bf16 a[192:195], v[72:75], a[104:107], a[192:195]
s_waitcnt lgkmcnt(15)
ds_read_b128 a[116:119], v25 offset:49152
v_exp_f32 v217, v217
v_mfma_f32_16x16x32_bf16 a[196:199], v[64:67], a[108:111], a[196:199]
ds_read_b128 a[140:143], v25 offset:50176
v_exp_f32 v218, v218
v_mfma_f32_16x16x32_bf16 a[200:203], v[68:71], a[108:111], a[200:203]
ds_read_b128 a[96:99], v25 offset:51200
v_exp_f32 v219, v219
v_add_f32 v52, v52, v216
v_mfma_f32_16x16x32_bf16 a[204:207], v[72:75], a[108:111], a[204:207]
s_waitcnt lgkmcnt(15)
ds_read_b128 a[100:103], v25 offset:52224
v_add_f32 v52, v52, v217
v_add_f32 v52, v52, v218
v_add_f32 v52, v52, v219
v_mfma_f32_16x16x32_bf16 a[208:211], v[64:67], a[112:115], a[208:211]
ds_read_b128 a[104:107], v25 offset:53248
v_cvt_pk_bf16_f32 v216, v216, v217
v_cvt_pk_bf16_f32 v217, v218, v219
v_fma_f32 v220, v220, s66, -v32
v_mfma_f32_16x16x32_bf16 a[212:215], v[68:71], a[112:115], a[212:215]
ds_read_b128 a[108:111], v25 offset:54272
ds_write_b64 v26, v[208:209] offset:6144
v_fma_f32 v221, v221, s66, -v32
v_fma_f32 v222, v222, s66, -v32
v_mfma_f32_16x16x32_bf16 a[216:219], v[72:75], a[112:115], a[216:219]
ds_write_b64 v26, v[212:213] offset:7168
v_fma_f32 v223, v223, s66, -v32
v_exp_f32 v220, v220
v_mfma_f32_16x16x32_bf16 a[220:223], v[64:67], a[120:123], a[220:223]
buffer_load_dwordx4 v11, s[36:39], s57 offen offset:2048 nt lds
v_exp_f32 v221, v221
v_mfma_f32_16x16x32_bf16 a[224:227], v[68:71], a[120:123], a[224:227]
ds_write_b64 v26, v[216:217] offset:8192
v_exp_f32 v222, v222
v_exp_f32 v223, v223
v_mfma_f32_16x16x32_bf16 a[228:231], v[72:75], a[120:123], a[228:231]
v_add_f32 v44, v44, v220
v_add_f32 v44, v44, v221
v_add_f32 v44, v44, v222
v_mfma_f32_16x16x32_bf16 a[232:235], v[64:67], a[124:127], a[232:235]
v_add_f32 v44, v44, v223
v_cvt_pk_bf16_f32 v220, v220, v221
v_cvt_pk_bf16_f32 v221, v222, v223
v_mfma_f32_16x16x32_bf16 a[236:239], v[68:71], a[124:127], a[236:239]
v_fma_f32 v224, v224, s66, -v33
v_fma_f32 v225, v225, s66, -v33
v_fma_f32 v226, v226, s66, -v33
v_fma_f32 v227, v227, s66, -v33
v_mfma_f32_16x16x32_bf16 a[240:243], v[72:75], a[124:127], a[240:243]
s_waitcnt lgkmcnt(15)
ds_write_b64 v26, v[220:221] offset:18432
v_exp_f32 v224, v224
v_exp_f32 v225, v225
v_mfma_f32_16x16x32_bf16 a[244:247], v[64:67], a[128:131], a[244:247]
v_exp_f32 v226, v226
v_exp_f32 v227, v227
v_mfma_f32_16x16x32_bf16 a[248:251], v[68:71], a[128:131], a[248:251]
v_add_f32 v45, v45, v224
v_add_f32 v45, v45, v225
v_mfma_f32_16x16x32_bf16 a[252:255], v[72:75], a[128:131], a[252:255]
v_add_f32 v45, v45, v226
v_add_f32 v45, v45, v227
v_cvt_pk_bf16_f32 v224, v224, v225
v_cvt_pk_bf16_f32 v225, v226, v227
s_waitcnt vmcnt(12) lgkmcnt(1)
s_barrier
v_add_u32 v20, 0xffff3e00, v20
v_add_u32 v21, 0xffff3e00, v21
v_add_u32 v22, 0xffff3e00, v22
v_mfma_f32_16x16x32_bf16 a[148:151], v[76:79], a[132:135], a[148:151]
ds_read_b64_tr_b16 v[64:65], v20 offset:24832
v_fma_f32 v228, v228, s66, -v34
v_fma_f32 v229, v229, s66, -v34
v_fma_f32 v230, v230, s66, -v34
v_mfma_f32_16x16x32_bf16 a[152:155], v[80:83], a[132:135], a[152:155]
s_add_u32 m0, s63, 0
s_mul_i32 s56, s12, 6144
buffer_load_dwordx4 v6, s[32:35], s56 offen lds
v_fma_f32 v231, v231, s66, -v34
v_exp_f32 v228, v228
v_mfma_f32_16x16x32_bf16 a[156:159], v[84:87], a[132:135], a[156:159]
ds_read_b64_tr_b16 v[66:67], v20 offset:30976
v_exp_f32 v229, v229
v_mfma_f32_16x16x32_bf16 a[160:163], v[76:79], a[136:139], a[160:163]
ds_read_b64_tr_b16 v[68:69], v21 offset:24832
v_exp_f32 v230, v230
v_mfma_f32_16x16x32_bf16 a[164:167], v[80:83], a[136:139], a[164:167]
ds_read_b64_tr_b16 v[70:71], v21 offset:30976
v_exp_f32 v231, v231
v_add_f32 v46, v46, v228
v_mfma_f32_16x16x32_bf16 a[168:171], v[84:87], a[136:139], a[168:171]
buffer_load_dwordx4 v7, s[32:35], s56 offen offset:1024 lds
v_add_f32 v46, v46, v229
v_mfma_f32_16x16x32_bf16 a[172:175], v[76:79], a[144:147], a[172:175]
ds_read_b64_tr_b16 v[72:73], v22 offset:24832
v_add_f32 v46, v46, v230
v_add_f32 v46, v46, v231
v_cvt_pk_bf16_f32 v228, v228, v229
v_mfma_f32_16x16x32_bf16 a[176:179], v[80:83], a[144:147], a[176:179]
ds_read_b64_tr_b16 v[74:75], v22 offset:30976
v_cvt_pk_bf16_f32 v229, v230, v231
v_fma_f32 v232, v232, s66, -v35
v_fma_f32 v233, v233, s66, -v35
v_mfma_f32_16x16x32_bf16 a[180:183], v[84:87], a[144:147], a[180:183]
ds_read_b128 a[112:115], v25
v_fma_f32 v234, v234, s66, -v35
v_fma_f32 v235, v235, s66, -v35
v_exp_f32 v232, v232
v_mfma_f32_16x16x32_bf16 a[184:187], v[76:79], a[116:119], a[184:187]
ds_read_b128 a[120:123], v25 offset:1024
v_exp_f32 v233, v233
v_mfma_f32_16x16x32_bf16 a[188:191], v[80:83], a[116:119], a[188:191]
buffer_load_dwordx4 v8, s[32:35], s56 offen offset:2048 lds
v_exp_f32 v234, v234
v_mfma_f32_16x16x32_bf16 a[192:195], v[84:87], a[116:119], a[192:195]
ds_read_b128 a[124:127], v25 offset:2048
v_exp_f32 v235, v235
v_mfma_f32_16x16x32_bf16 a[196:199], v[76:79], a[140:143], a[196:199]
ds_read_b128 a[128:131], v25 offset:3072
v_add_f32 v47, v47, v232
v_add_f32 v47, v47, v233
v_add_f32 v47, v47, v234
v_mfma_f32_16x16x32_bf16 a[200:203], v[80:83], a[140:143], a[200:203]
ds_read_b128 a[132:135], v25 offset:4096
v_add_f32 v47, v47, v235
v_cvt_pk_bf16_f32 v232, v232, v233
v_mfma_f32_16x16x32_bf16 a[204:207], v[84:87], a[140:143], a[204:207]
ds_read_b128 a[136:139], v25 offset:5120
v_cvt_pk_bf16_f32 v233, v234, v235
v_fma_f32 v236, v236, s66, -v36
v_fma_f32 v237, v237, s66, -v36
v_mfma_f32_16x16x32_bf16 a[208:211], v[76:79], a[96:99], a[208:211]
s_add_u32 m0, s62, 36864
s_mov_b32 exec_hi, 0
buffer_load_dwordx4 v1, s[28:31], s12 offen lds
s_mov_b32 exec_hi, -1
v_fma_f32 v238, v238, s66, -v36
v_fma_f32 v239, v239, s66, -v36
v_mfma_f32_16x16x32_bf16 a[212:215], v[80:83], a[96:99], a[212:215]
ds_read_b128 a[144:147], v25 offset:6144
ds_write_b64 v26, v[224:225] offset:19456
v_exp_f32 v236, v236
v_exp_f32 v237, v237
v_mfma_f32_16x16x32_bf16 a[216:219], v[84:87], a[96:99], a[216:219]
ds_read_b128 a[116:119], v25 offset:7168
v_exp_f32 v238, v238
v_mfma_f32_16x16x32_bf16 a[220:223], v[76:79], a[100:103], a[220:223]
ds_read_b128 a[140:143], v25 offset:8192
v_exp_f32 v239, v239
v_add_f32 v48, v48, v236
v_mfma_f32_16x16x32_bf16 a[224:227], v[80:83], a[100:103], a[224:227]
ds_write_b64 v26, v[228:229] offset:20480
v_add_f32 v48, v48, v237
v_add_f32 v48, v48, v238
v_mfma_f32_16x16x32_bf16 a[228:231], v[84:87], a[100:103], a[228:231]
buffer_load_dwordx4 v2, s[28:31], s12 offen offset:512 lds
v_add_f32 v48, v48, v239
v_cvt_pk_bf16_f32 v236, v236, v237
v_mfma_f32_16x16x32_bf16 a[232:235], v[76:79], a[104:107], a[232:235]
ds_write_b64 v26, v[232:233] offset:21504
v_cvt_pk_bf16_f32 v237, v238, v239
v_fma_f32 v240, v240, s66, -v37
v_fma_f32 v241, v241, s66, -v37
v_mfma_f32_16x16x32_bf16 a[236:239], v[80:83], a[104:107], a[236:239]
ds_write_b64 v26, v[236:237] offset:22528
v_fma_f32 v242, v242, s66, -v37
v_fma_f32 v243, v243, s66, -v37
v_exp_f32 v240, v240
v_mfma_f32_16x16x32_bf16 a[240:243], v[84:87], a[104:107], a[240:243]
v_exp_f32 v241, v241
v_exp_f32 v242, v242
v_mfma_f32_16x16x32_bf16 a[244:247], v[76:79], a[108:111], a[244:247]
v_exp_f32 v243, v243
v_add_f32 v49, v49, v240
v_mfma_f32_16x16x32_bf16 a[248:251], v[80:83], a[108:111], a[248:251]
buffer_load_dwordx4 v3, s[28:31], s12 offen offset:1536 lds
v_add_f32 v49, v49, v241
v_add_f32 v49, v49, v242
v_mfma_f32_16x16x32_bf16 a[252:255], v[84:87], a[108:111], a[252:255]
s_waitcnt lgkmcnt(12)
v_add_f32 v49, v49, v243
v_cvt_pk_bf16_f32 v240, v240, v241
v_cvt_pk_bf16_f32 v241, v242, v243
v_mfma_f32_16x16x32_bf16 a[148:151], v[64:67], a[112:115], a[148:151]
ds_read_b64_tr_b16 v[76:77], v20 offset:37120
v_fma_f32 v244, v244, s66, -v38
v_fma_f32 v245, v245, s66, -v38
v_fma_f32 v246, v246, s66, -v38
v_mfma_f32_16x16x32_bf16 a[152:155], v[68:71], a[112:115], a[152:155]
ds_read_b64_tr_b16 v[78:79], v20 offset:43264
v_fma_f32 v247, v247, s66, -v38
v_exp_f32 v244, v244
v_mfma_f32_16x16x32_bf16 a[156:159], v[72:75], a[112:115], a[156:159]
s_waitcnt lgkmcnt(13)
buffer_load_dwordx4 v4, s[28:31], s12 offen offset:2560 lds
v_exp_f32 v245, v245
v_mfma_f32_16x16x32_bf16 a[160:163], v[64:67], a[120:123], a[160:163]
ds_read_b64_tr_b16 v[80:81], v21 offset:37120
v_exp_f32 v246, v246
v_exp_f32 v247, v247
v_mfma_f32_16x16x32_bf16 a[164:167], v[68:71], a[120:123], a[164:167]
ds_read_b64_tr_b16 v[82:83], v21 offset:43264
v_add_f32 v50, v50, v244
v_add_f32 v50, v50, v245
v_mfma_f32_16x16x32_bf16 a[168:171], v[72:75], a[120:123], a[168:171]
s_waitcnt lgkmcnt(14)
ds_read_b64_tr_b16 v[84:85], v22 offset:37120
v_add_f32 v50, v50, v246
v_add_f32 v50, v50, v247
v_mfma_f32_16x16x32_bf16 a[172:175], v[64:67], a[124:127], a[172:175]
ds_read_b64_tr_b16 v[86:87], v22 offset:43264
v_cvt_pk_bf16_f32 v244, v244, v245
v_cvt_pk_bf16_f32 v245, v246, v247
v_fma_f32 v248, v248, s66, -v39
v_mfma_f32_16x16x32_bf16 a[176:179], v[68:71], a[124:127], a[176:179]
buffer_load_dwordx4 v5, s[28:31], s12 offen offset:3584 lds
v_fma_f32 v249, v249, s66, -v39
v_fma_f32 v250, v250, s66, -v39
v_mfma_f32_16x16x32_bf16 a[180:183], v[72:75], a[124:127], a[180:183]
s_waitcnt lgkmcnt(15)
ds_read_b128 a[96:99], v25 offset:9216
v_fma_f32 v251, v251, s66, -v39
v_exp_f32 v248, v248
v_mfma_f32_16x16x32_bf16 a[184:187], v[64:67], a[128:131], a[184:187]
ds_read_b128 a[100:103], v25 offset:10240
v_exp_f32 v249, v249
v_exp_f32 v250, v250
v_mfma_f32_16x16x32_bf16 a[188:191], v[68:71], a[128:131], a[188:191]
ds_read_b128 a[104:107], v25 offset:11264
v_exp_f32 v251, v251
v_mfma_f32_16x16x32_bf16 a[192:195], v[72:75], a[128:131], a[192:195]
s_waitcnt lgkmcnt(15)
ds_read_b128 a[108:111], v25 offset:12288
v_add_f32 v51, v51, v248
v_add_f32 v51, v51, v249
v_add_f32 v51, v51, v250
v_mfma_f32_16x16x32_bf16 a[196:199], v[64:67], a[132:135], a[196:199]
s_add_u32 m0, s63, 12288
s_mul_i32 s56, s12, 6144
s_add_u32 s56, s56, 393216
buffer_load_dwordx4 v6, s[32:35], s56 offen lds
v_add_f32 v51, v51, v251
v_cvt_pk_bf16_f32 v248, v248, v249
v_mfma_f32_16x16x32_bf16 a[200:203], v[68:71], a[132:135], a[200:203]
ds_read_b128 a[112:115], v25 offset:13312
v_cvt_pk_bf16_f32 v249, v250, v251
v_fma_f32 v252, v252, s66, -v40
v_fma_f32 v253, v253, s66, -v40
v_fma_f32 v254, v254, s66, -v40
v_mfma_f32_16x16x32_bf16 a[204:207], v[72:75], a[132:135], a[204:207]
ds_read_b128 a[120:123], v25 offset:14336
ds_write_b64 v26, v[240:241] offset:23552
v_fma_f32 v255, v255, s66, -v40
v_exp_f32 v252, v252
v_mfma_f32_16x16x32_bf16 a[208:211], v[64:67], a[136:139], a[208:211]
ds_read_b128 a[124:127], v25 offset:15360
v_exp_f32 v253, v253
v_exp_f32 v254, v254
v_mfma_f32_16x16x32_bf16 a[212:215], v[68:71], a[136:139], a[212:215]
ds_read_b128 a[128:131], v25 offset:16384
v_exp_f32 v255, v255
v_mfma_f32_16x16x32_bf16 a[216:219], v[72:75], a[136:139], a[216:219]
buffer_load_dwordx4 v7, s[32:35], s56 offen offset:1024 lds
v_add_f32 v52, v52, v252
v_add_f32 v52, v52, v253
v_mfma_f32_16x16x32_bf16 a[220:223], v[64:67], a[144:147], a[220:223]
ds_read_b128 a[132:135], v25 offset:17408
v_add_f32 v52, v52, v254
v_add_f32 v52, v52, v255
v_cvt_pk_bf16_f32 v252, v252, v253
v_cvt_pk_bf16_f32 v253, v254, v255
v_mfma_f32_16x16x32_bf16 a[224:227], v[68:71], a[144:147], a[224:227]
ds_write_b64 v26, v[244:245] offset:24576
v_permlane32_swap_b32 v44, v46
v_mfma_f32_16x16x32_bf16 a[228:231], v[72:75], a[144:147], a[228:231]
s_waitcnt lgkmcnt(15)
ds_write_b64 v26, v[248:249] offset:25600
v_permlane32_swap_b32 v45, v47
ds_write_b64 v26, v[252:253] offset:26624
v_mfma_f32_16x16x32_bf16 a[232:235], v[64:67], a[116:119], a[232:235]
v_add_f32 v44, v44, v46
v_add_f32 v45, v45, v47
v_mfma_f32_16x16x32_bf16 a[236:239], v[68:71], a[116:119], a[236:239]
buffer_load_dwordx4 v8, s[32:35], s56 offen offset:2048 lds
v_mfma_f32_16x16x32_bf16 a[240:243], v[72:75], a[116:119], a[240:243]
v_permlane16_swap_b32 v44, v45
v_add_f32 v44, v44, v45
v_mfma_f32_16x16x32_bf16 a[244:247], v[64:67], a[140:143], a[244:247]
v_permlane32_swap_b32 v48, v50
v_permlane32_swap_b32 v49, v51
v_mfma_f32_16x16x32_bf16 a[248:251], v[68:71], a[140:143], a[248:251]
ds_write_b32 v28, v44
v_add_f32 v48, v48, v50
v_mfma_f32_16x16x32_bf16 a[252:255], v[72:75], a[140:143], a[252:255]
v_add_f32 v49, v49, v51
s_nop 1
v_permlane16_swap_b32 v48, v49
s_waitcnt vmcnt(17) lgkmcnt(0)
s_barrier
s_getpc_b64 s[52:53]
L1_pc:
s_bfe_u32 s51, s2, 0x30003
s_lshl_b32 s51, s51, 2
s_add_u32 s51, s51, s3
s_lshl_b32 s51, s51, 11
s_min_u32 s51, s51, L2_end-L2_start-2048
s_add_u32 s51, s51, L2_start-L1_pc
v_lshl_add_u32 v136, v25, 3, s51
v_mov_b32 v137, s53
v_add_co_u32 v136, vcc, s52, v136
s_nop 1
v_addc_co_u32 v137, vcc, 0, v137, vcc
s_mov_b64 exec, 0xffff
global_load_dword v138, v[136:137], off
s_mov_b64 exec, -1
v_add_u32 v20, 0xc200, v20
v_add_u32 v21, 0xc200, v21
v_add_u32 v22, 0xc200, v22
v_mfma_f32_16x16x32_bf16 a[148:151], v[76:79], a[96:99], a[148:151]
ds_read_b64_tr_b16 v[64:65], v20 offset:24576
v_add_f32 v48, v48, v49
v_mfma_f32_16x16x32_bf16 a[152:155], v[80:83], a[96:99], a[152:155]
s_add_u32 m0, s62, 0
s_mov_b32 exec_hi, 0
buffer_load_dwordx4 v1, s[28:31], s13 offen lds
s_mov_b32 exec_hi, -1
v_mfma_f32_16x16x32_bf16 a[156:159], v[84:87], a[96:99], a[156:159]
ds_read_b64_tr_b16 v[66:67], v20 offset:30720
v_permlane32_swap_b32 v52, v56
v_mfma_f32_16x16x32_bf16 a[160:163], v[76:79], a[100:103], a[160:163]
ds_read_b64_tr_b16 v[68:69], v21 offset:24576
v_permlane32_swap_b32 v57, v58
v_mfma_f32_16x16x32_bf16 a[164:167], v[80:83], a[100:103], a[164:167]
ds_read_b64_tr_b16 v[70:71], v21 offset:30720
v_add_f32 v52, v52, v56
v_mfma_f32_16x16x32_bf16 a[168:171], v[84:87], a[100:103], a[168:171]
buffer_load_dwordx4 v2, s[28:31], s13 offen offset:512 lds
v_mfma_f32_16x16x32_bf16 a[172:175], v[76:79], a[104:107], a[172:175]
ds_read_b64_tr_b16 v[72:73], v22 offset:24576
v_add_f32 v57, v57, v58
v_mfma_f32_16x16x32_bf16 a[176:179], v[80:83], a[104:107], a[176:179]
ds_read_b64_tr_b16 v[74:75], v22 offset:30720
v_permlane16_swap_b32 v52, v57
v_mfma_f32_16x16x32_bf16 a[180:183], v[84:87], a[104:107], a[180:183]
ds_read_b128 a[136:139], v25 offset:18432
v_add_f32 v52, v52, v57
v_mfma_f32_16x16x32_bf16 a[184:187], v[76:79], a[108:111], a[184:187]
ds_read_b128 a[144:147], v25 offset:19456
v_mfma_f32_16x16x32_bf16 a[188:191], v[80:83], a[108:111], a[188:191]
buffer_load_dwordx4 v3, s[28:31], s13 offen offset:1536 lds
v_mfma_f32_16x16x32_bf16 a[192:195], v[84:87], a[108:111], a[192:195]
ds_read_b128 a[116:119], v25 offset:20480
v_mfma_f32_16x16x32_bf16 a[196:199], v[76:79], a[112:115], a[196:199]
ds_read_b128 a[140:143], v25 offset:21504
v_mfma_f32_16x16x32_bf16 a[200:203], v[80:83], a[112:115], a[200:203]
ds_read_b128 a[96:99], v25 offset:22528
v_mfma_f32_16x16x32_bf16 a[204:207], v[84:87], a[112:115], a[204:207]
ds_read_b128 a[100:103], v25 offset:23552
v_mfma_f32_16x16x32_bf16 a[208:211], v[76:79], a[120:123], a[208:211]
buffer_load_dwordx4 v4, s[28:31], s13 offen offset:2560 lds
v_mfma_f32_16x16x32_bf16 a[212:215], v[80:83], a[120:123], a[212:215]
ds_read_b128 a[104:107], v25 offset:24576
v_mfma_f32_16x16x32_bf16 a[216:219], v[84:87], a[120:123], a[216:219]
ds_read_b128 a[108:111], v25 offset:25600
v_mfma_f32_16x16x32_bf16 a[220:223], v[76:79], a[124:127], a[220:223]
ds_read_b128 a[112:115], v25 offset:26624
v_mfma_f32_16x16x32_bf16 a[224:227], v[80:83], a[124:127], a[224:227]
s_waitcnt vmcnt(16)
ds_read_b128 a[24:27], v23
ds_read_b128 a[28:31], v23 offset:64
v_mfma_f32_16x16x32_bf16 a[228:231], v[84:87], a[124:127], a[228:231]
buffer_load_dwordx4 v5, s[28:31], s13 offen offset:3584 lds
v_mfma_f32_16x16x32_bf16 a[232:235], v[76:79], a[128:131], a[232:235]
ds_read_b128 a[32:35], v23 offset:128
ds_read_b128 a[36:39], v23 offset:192
v_mfma_f32_16x16x32_bf16 a[236:239], v[80:83], a[128:131], a[236:239]
ds_read_b128 a[40:43], v23 offset:256
ds_read_b128 a[44:47], v23 offset:320
v_mfma_f32_16x16x32_bf16 a[240:243], v[84:87], a[128:131], a[240:243]
ds_write_b32 v28, v48 offset:1024
v_mfma_f32_16x16x32_bf16 a[244:247], v[76:79], a[132:135], a[244:247]
ds_write_b32 v28, v52 offset:2048
v_mfma_f32_16x16x32_bf16 a[248:251], v[80:83], a[132:135], a[248:251]
s_add_u32 m0, s64, 24832
s_add_u32 s57, s16, 24576
buffer_load_dwordx4 v9, s[36:39], s57 offen nt lds
v_mfma_f32_16x16x32_bf16 a[252:255], v[84:87], a[132:135], a[252:255]
s_waitcnt lgkmcnt(15)
v_mfma_f32_16x16x32_bf16 a[148:151], v[64:67], a[136:139], a[148:151]
ds_read_b64_tr_b16 v[76:77], v20 offset:36864
v_mfma_f32_16x16x32_bf16 a[152:155], v[68:71], a[136:139], a[152:155]
ds_read_b64_tr_b16 v[78:79], v20 offset:43008
v_mfma_f32_16x16x32_bf16 a[156:159], v[72:75], a[136:139], a[156:159]
buffer_load_dwordx4 v10, s[36:39], s57 offen offset:1024 nt lds
v_mfma_f32_16x16x32_bf16 a[160:163], v[64:67], a[144:147], a[160:163]
ds_read_b64_tr_b16 v[80:81], v21 offset:36864
v_mfma_f32_16x16x32_bf16 a[164:167], v[68:71], a[144:147], a[164:167]
ds_read_b64_tr_b16 v[82:83], v21 offset:43008
v_mfma_f32_16x16x32_bf16 a[168:171], v[72:75], a[144:147], a[168:171]
s_waitcnt lgkmcnt(15)
ds_read_b64_tr_b16 v[84:85], v22 offset:36864
v_mfma_f32_16x16x32_bf16 a[172:175], v[64:67], a[116:119], a[172:175]
ds_read_b64_tr_b16 v[86:87], v22 offset:43008
v_mfma_f32_16x16x32_bf16 a[176:179], v[68:71], a[116:119], a[176:179]
buffer_load_dwordx4 v11, s[36:39], s57 offen offset:2048 nt lds
v_mfma_f32_16x16x32_bf16 a[180:183], v[72:75], a[116:119], a[180:183]
ds_read_b128 a[120:123], v25 offset:27648
v_mfma_f32_16x16x32_bf16 a[184:187], v[64:67], a[140:143], a[184:187]
ds_read_b128 a[124:127], v25 offset:28672
v_mfma_f32_16x16x32_bf16 a[188:191], v[68:71], a[140:143], a[188:191]
ds_read_b128 a[128:131], v25 offset:29696
v_mfma_f32_16x16x32_bf16 a[192:195], v[72:75], a[140:143], a[192:195]
ds_read_b128 a[132:135], v25 offset:30720
v_mfma_f32_16x16x32_bf16 a[196:199], v[64:67], a[96:99], a[196:199]
s_add_u32 m0, s64, 27968
s_add_u32 s57, s16, 27648
buffer_load_dwordx4 v9, s[36:39], s57 offen nt lds
v_mfma_f32_16x16x32_bf16 a[200:203], v[68:71], a[96:99], a[200:203]
ds_read_b128 a[136:139], v25 offset:31744
v_mfma_f32_16x16x32_bf16 a[204:207], v[72:75], a[96:99], a[204:207]
ds_read_b128 a[144:147], v25 offset:32768
v_mfma_f32_16x16x32_bf16 a[208:211], v[64:67], a[100:103], a[208:211]
ds_read_b128 a[116:119], v25 offset:33792
v_mfma_f32_16x16x32_bf16 a[212:215], v[68:71], a[100:103], a[212:215]
ds_read_b128 a[140:143], v25 offset:34816
v_mfma_f32_16x16x32_bf16 a[216:219], v[72:75], a[100:103], a[216:219]
s_waitcnt lgkmcnt(15)
buffer_load_dwordx4 v10, s[36:39], s57 offen offset:1024 nt lds
v_mfma_f32_16x16x32_bf16 a[220:223], v[64:67], a[104:107], a[220:223]
ds_read_b128 a[96:99], v25 offset:35840
v_mfma_f32_16x16x32_bf16 a[224:227], v[68:71], a[104:107], a[224:227]
v_mfma_f32_16x16x32_bf16 a[228:231], v[72:75], a[104:107], a[228:231]
v_mfma_f32_16x16x32_bf16 a[232:235], v[64:67], a[108:111], a[232:235]
v_mfma_f32_16x16x32_bf16 a[236:239], v[68:71], a[108:111], a[236:239]
buffer_load_dwordx4 v11, s[36:39], s57 offen offset:2048 nt lds
v_mfma_f32_16x16x32_bf16 a[240:243], v[72:75], a[108:111], a[240:243]
v_mfma_f32_16x16x32_bf16 a[244:247], v[64:67], a[112:115], a[244:247]
v_mfma_f32_16x16x32_bf16 a[248:251], v[68:71], a[112:115], a[248:251]
v_mfma_f32_16x16x32_bf16 a[252:255], v[72:75], a[112:115], a[252:255]
s_waitcnt vmcnt(15) lgkmcnt(9)
s_barrier
v_lshlrev_b32 v141, 2, v25
v_xor_b32 v141, s10, v141
s_cmp_eq_u32 s48, 3
s_cselect_b32 s51, 0, 0x40000000
s_mov_b64 exec, 3
buffer_load_dword v142, v141, s[72:75], s51 offen sc1
s_mov_b64 exec, -1
v_add_u32 v20, 0xffff3e00, v20
v_add_u32 v21, 0xffff3e00, v21
v_add_u32 v22, 0xffff3e00, v22
s_waitcnt lgkmcnt(8)
v_mfma_f32_16x16x32_bf16 a[148:151], v[76:79], a[120:123], a[148:151]
ds_read_b64_tr_b16 v[172:173], v17
v_mfma_f32_16x16x32_bf16 a[152:155], v[80:83], a[120:123], a[152:155]
s_add_u32 m0, s63, 24576
s_mul_i32 s56, s13, 6144
buffer_load_dwordx4 v6, s[32:35], s56 offen lds
v_mfma_f32_16x16x32_bf16 a[156:159], v[84:87], a[120:123], a[156:159]
s_waitcnt lgkmcnt(8)
ds_read_b64_tr_b16 v[174:175], v17 offset:1536
ds_read_b128 v[100:103], v29
s_waitcnt lgkmcnt(0)
v_add_f32 v100, v100, v101
v_add_f32 v102, v102, v103
v_mfma_f32_16x16x32_bf16 a[160:163], v[76:79], a[124:127], a[160:163]
ds_read_b64_tr_b16 v[176:177], v18
ds_read_b128 v[104:107], v29 offset:256
v_add_f32 v100, v100, v102
v_rcp_f32 v44, v100
v_mfma_f32_16x16x32_bf16 a[164:167], v[80:83], a[124:127], a[164:167]
s_waitcnt lgkmcnt(0)
ds_read_b64_tr_b16 v[178:179], v18 offset:1536
ds_read_b128 v[108:111], v29 offset:512
v_add_f32 v104, v104, v105
v_mfma_f32_16x16x32_bf16 a[168:171], v[84:87], a[124:127], a[168:171]
buffer_load_dwordx4 v7, s[32:35], s56 offen offset:1024 lds
v_add_f32 v106, v106, v107
v_mfma_f32_16x16x32_bf16 a[172:175], v[76:79], a[128:131], a[172:175]
ds_read_b64_tr_b16 v[180:181], v19
ds_read_b128 v[112:115], v29 offset:768
v_add_f32 v104, v104, v106
v_rcp_f32 v45, v104
v_mfma_f32_16x16x32_bf16 a[176:179], v[80:83], a[128:131], a[176:179]
s_waitcnt lgkmcnt(2)
ds_read_b64_tr_b16 v[182:183], v19 offset:1536
ds_read_b128 v[116:119], v29 offset:1024
v_add_f32 v108, v108, v109
v_mfma_f32_16x16x32_bf16 a[180:183], v[84:87], a[128:131], a[180:183]
ds_read_b128 v[196:199], v15 offset:36864
ds_read_b128 v[120:123], v29 offset:1280
v_add_f32 v110, v110, v111
v_add_f32 v108, v108, v110
v_rcp_f32 v46, v108
v_mfma_f32_16x16x32_bf16 a[184:187], v[76:79], a[132:135], a[184:187]
buffer_load_dwordx4 v8, s[32:35], s56 offen offset:2048 lds
v_mfma_f32_16x16x32_bf16 a[188:191], v[80:83], a[132:135], a[188:191]
s_waitcnt lgkmcnt(4)
ds_read_b128 v[200:203], v15 offset:38912
ds_read_b128 v[124:127], v29 offset:1536
v_add_f32 v112, v112, v113
v_add_f32 v114, v114, v115
v_mfma_f32_16x16x32_bf16 a[192:195], v[84:87], a[132:135], a[192:195]
ds_read_b128 v[204:207], v15 offset:40960
v_add_f32 v112, v112, v114
v_rcp_f32 v47, v112
v_mfma_f32_16x16x32_bf16 a[196:199], v[76:79], a[136:139], a[196:199]
s_waitcnt lgkmcnt(5)
ds_read_b128 v[208:211], v15 offset:43008
v_add_f32 v116, v116, v117
v_mfma_f32_16x16x32_bf16 a[200:203], v[80:83], a[136:139], a[200:203]
ds_read_b128 v[212:215], v15 offset:45056
v_add_f32 v118, v118, v119
v_add_f32 v116, v116, v118
v_mfma_f32_16x16x32_bf16 a[204:207], v[84:87], a[136:139], a[204:207]
s_add_u32 m0, s63, 36864
s_mul_i32 s56, s13, 6144
s_add_u32 s56, s56, 393216
buffer_load_dwordx4 v6, s[32:35], s56 offen lds
v_rcp_f32 v48, v116
v_mfma_f32_16x16x32_bf16 a[208:211], v[76:79], a[144:147], a[208:211]
s_waitcnt lgkmcnt(5)
ds_read_b128 v[216:219], v15 offset:47104
v_add_f32 v120, v120, v121
v_add_f32 v122, v122, v123
v_mfma_f32_16x16x32_bf16 a[212:215], v[80:83], a[144:147], a[212:215]
ds_read_b128 v[220:223], v15 offset:49152
v_add_f32 v120, v120, v122
v_rcp_f32 v49, v120
v_mfma_f32_16x16x32_bf16 a[216:219], v[84:87], a[144:147], a[216:219]
s_waitcnt lgkmcnt(5)
ds_read_b128 v[224:227], v15 offset:51200
v_add_f32 v124, v124, v125
v_mfma_f32_16x16x32_bf16 a[220:223], v[76:79], a[116:119], a[220:223]
buffer_load_dwordx4 v7, s[32:35], s56 offen offset:1024 lds
v_add_f32 v126, v126, v127
v_add_f32 v124, v124, v126
v_mfma_f32_16x16x32_bf16 a[224:227], v[80:83], a[116:119], a[224:227]
ds_read_b128 v[228:231], v15 offset:53248
v_rcp_f32 v50, v124
v_mfma_f32_16x16x32_bf16 a[228:231], v[84:87], a[116:119], a[228:231]
ds_read_b128 v[128:131], v29 offset:1792
s_waitcnt lgkmcnt(0)
v_add_f32 v128, v128, v129
v_add_f32 v130, v130, v131
v_add_f32 v128, v128, v130
v_mfma_f32_16x16x32_bf16 a[232:235], v[76:79], a[140:143], a[232:235]
ds_read_b128 v[132:135], v29 offset:2048
v_rcp_f32 v51, v128
s_waitcnt lgkmcnt(0)
v_add_f32 v132, v132, v133
v_mfma_f32_16x16x32_bf16 a[236:239], v[80:83], a[140:143], a[236:239]
buffer_load_dwordx4 v8, s[32:35], s56 offen offset:2048 lds
v_add_f32 v134, v134, v135
v_add_f32 v132, v132, v134
v_mfma_f32_16x16x32_bf16 a[240:243], v[84:87], a[140:143], a[240:243]
v_rcp_f32 v52, v132
v_max3_f32 v100, v100, v104, v108
v_max3_f32 v100, v100, v112, v116
v_mfma_f32_16x16x32_bf16 a[244:247], v[76:79], a[96:99], a[244:247]
v_max3_f32 v100, v100, v120, v124
v_max3_f32 v100, v100, v128, v132
v_cmp_ngt_f32 vcc, 0x49800000, v100
v_mfma_f32_16x16x32_bf16 a[248:251], v[80:83], a[96:99], a[248:251]
v_mfma_f32_16x16x32_bf16 a[252:255], v[84:87], a[96:99], a[252:255]
s_nop 7
s_mov_b32 s21, s10
s_lshl_b32 s51, s48, 3
s_lshl_b32 s11, 1, s51
s_cmp_eq_u32 s18, 1
s_cbranch_scc1 L1_m1
s_cmp_eq_u32 s18, 2
s_cbranch_scc1 L1_exit
s_lshl_b32 s51, 1, s48
s_cmp_lg_u64 vcc, 0
s_cselect_b32 s51, s51, 0
s_cselect_b32 s21, 0x40000000, s21
s_or_b32 s101, s101, s51
s_add_u32 s48, s48, 1
s_cmp_lt_u32 s48, 4
s_cbranch_scc1 L1_loop
s_branch L1_exit
L1_m1:
s_mov_b32 s18, 2
s_mov_b32 s19, 0
s_mov_b32 s21, 0x40000000
s_branch L1_loop
L1_exit:
s_waitcnt vmcnt(0)
s_barrier
v_mov_b32 v41, s11
s_cmp_ge_u32 s2, 240
s_cselect_b32 s51, 1, s101
s_or_b32 s51, s51, s18
s_cmp_eq_u32 s51, 0
s_cbranch_scc1 L2_start
v_subrev_u32 v64, 26880, v0
v_subrev_u32 v65, 26880, v55
v_accvgpr_read_b32 v68, a156
v_accvgpr_read_b32 v69, a157
v_accvgpr_read_b32 v70, a158
v_accvgpr_read_b32 v71, a159
v_mul_f32 v68, v68, v44
v_mul_f32 v69, v69, v44
v_mul_f32 v70, v70, v44
v_mul_f32 v71, v71, v44
v_cvt_pk_bf16_f32 v68, v68, v69
v_cvt_pk_bf16_f32 v69, v70, v71
ds_write_b64 v64, v[68:69]
v_accvgpr_read_b32 v72, a168
v_accvgpr_read_b32 v73, a169
v_accvgpr_read_b32 v74, a170
v_accvgpr_read_b32 v75, a171
v_mul_f32 v72, v72, v45
v_mul_f32 v73, v73, v45
v_mul_f32 v74, v74, v45
v_mul_f32 v75, v75, v45
v_cvt_pk_bf16_f32 v72, v72, v73
v_cvt_pk_bf16_f32 v73, v74, v75
ds_write_b64 v64, v[72:73] offset:1024
v_accvgpr_read_b32 v68, a180
v_accvgpr_read_b32 v69, a181
v_accvgpr_read_b32 v70, a182
v_accvgpr_read_b32 v71, a183
v_mul_f32 v68, v68, v46
v_mul_f32 v69, v69, v46
v_mul_f32 v70, v70, v46
v_mul_f32 v71, v71, v46
v_cvt_pk_bf16_f32 v68, v68, v69
v_cvt_pk_bf16_f32 v69, v70, v71
ds_write_b64 v64, v[68:69] offset:4096
v_accvgpr_read_b32 v72, a192
v_accvgpr_read_b32 v73, a193
v_accvgpr_read_b32 v74, a194
v_accvgpr_read_b32 v75, a195
v_mul_f32 v72, v72, v47
v_mul_f32 v73, v73, v47
v_mul_f32 v74, v74, v47
v_mul_f32 v75, v75, v47
v_cvt_pk_bf16_f32 v72, v72, v73
v_cvt_pk_bf16_f32 v73, v74, v75
ds_write_b64 v64, v[72:73] offset:5120
v_accvgpr_read_b32 v68, a204
v_accvgpr_read_b32 v69, a205
v_accvgpr_read_b32 v70, a206
v_accvgpr_read_b32 v71, a207
v_mul_f32 v68, v68, v48
v_mul_f32 v69, v69, v48
v_mul_f32 v70, v70, v48
v_mul_f32 v71, v71, v48
v_cvt_pk_bf16_f32 v68, v68, v69
v_cvt_pk_bf16_f32 v69, v70, v71
ds_write_b64 v64, v[68:69] offset:8192
v_accvgpr_read_b32 v72, a216
v_accvgpr_read_b32 v73, a217
v_accvgpr_read_b32 v74, a218
v_accvgpr_read_b32 v75, a219
v_mul_f32 v72, v72, v49
v_mul_f32 v73, v73, v49
v_mul_f32 v74, v74, v49
v_mul_f32 v75, v75, v49
v_cvt_pk_bf16_f32 v72, v72, v73
v_cvt_pk_bf16_f32 v73, v74, v75
ds_write_b64 v64, v[72:73] offset:9216
v_accvgpr_read_b32 v68, a228
v_accvgpr_read_b32 v69, a229
v_accvgpr_read_b32 v70, a230
v_accvgpr_read_b32 v71, a231
v_mul_f32 v68, v68, v50
v_mul_f32 v69, v69, v50
v_mul_f32 v70, v70, v50
v_mul_f32 v71, v71, v50
v_cvt_pk_bf16_f32 v68, v68, v69
v_cvt_pk_bf16_f32 v69, v70, v71
ds_write_b64 v64, v[68:69] offset:12288
v_accvgpr_read_b32 v72, a240
v_accvgpr_read_b32 v73, a241
v_accvgpr_read_b32 v74, a242
v_accvgpr_read_b32 v75, a243
v_mul_f32 v72, v72, v51
v_mul_f32 v73, v73, v51
v_mul_f32 v74, v74, v51
v_mul_f32 v75, v75, v51
v_cvt_pk_bf16_f32 v72, v72, v73
v_cvt_pk_bf16_f32 v73, v74, v75
ds_write_b64 v64, v[72:73] offset:13312
v_accvgpr_read_b32 v68, a252
v_accvgpr_read_b32 v69, a253
v_accvgpr_read_b32 v70, a254
v_accvgpr_read_b32 v71, a255
v_mul_f32 v68, v68, v52
v_mul_f32 v69, v69, v52
v_mul_f32 v70, v70, v52
v_mul_f32 v71, v71, v52
v_cvt_pk_bf16_f32 v68, v68, v69
v_cvt_pk_bf16_f32 v69, v70, v71
ds_write_b64 v64, v[68:69] offset:16384
ds_write_b64 v64, v[68:69] offset:17408
s_waitcnt lgkmcnt(0)
s_barrier
ds_read_b128 v[80:83], v65
ds_read_b128 v[84:87], v65 offset:4096
ds_read_b128 v[88:91], v65 offset:8192
ds_read_b128 v[92:95], v65 offset:12288
ds_read_b128 v[96:99], v65 offset:16384
v_accvgpr_read_b32 v68, a148
v_accvgpr_read_b32 v69, a149
v_accvgpr_read_b32 v70, a150
v_accvgpr_read_b32 v71, a151
v_mul_f32 v68, v68, v44
v_mul_f32 v69, v69, v44
v_mul_f32 v70, v70, v44
v_mul_f32 v71, v71, v44
v_cvt_pk_bf16_f32 v100, v68, v69
v_cvt_pk_bf16_f32 v101, v70, v71
v_accvgpr_read_b32 v72, a152
v_accvgpr_read_b32 v73, a153
v_accvgpr_read_b32 v74, a154
v_accvgpr_read_b32 v75, a155
v_mul_f32 v72, v72, v44
v_mul_f32 v73, v73, v44
v_mul_f32 v74, v74, v44
v_mul_f32 v75, v75, v44
v_cvt_pk_bf16_f32 v102, v72, v73
v_cvt_pk_bf16_f32 v103, v74, v75
buffer_store_dwordx4 v[100:103], v30, s[44:47], 0 offen sc1
s_waitcnt lgkmcnt(4)
buffer_store_dwordx4 v[80:83], v31, s[44:47], 0 offen sc1
v_accvgpr_read_b32 v68, a160
v_accvgpr_read_b32 v69, a161
v_accvgpr_read_b32 v70, a162
v_accvgpr_read_b32 v71, a163
v_mul_f32 v68, v68, v45
v_mul_f32 v69, v69, v45
v_mul_f32 v70, v70, v45
v_mul_f32 v71, v71, v45
v_cvt_pk_bf16_f32 v104, v68, v69
v_cvt_pk_bf16_f32 v105, v70, v71
v_accvgpr_read_b32 v72, a164
v_accvgpr_read_b32 v73, a165
v_accvgpr_read_b32 v74, a166
v_accvgpr_read_b32 v75, a167
v_mul_f32 v72, v72, v45
v_mul_f32 v73, v73, v45
v_mul_f32 v74, v74, v45
v_mul_f32 v75, v75, v45
v_cvt_pk_bf16_f32 v106, v72, v73
v_cvt_pk_bf16_f32 v107, v74, v75
buffer_store_dwordx4 v[104:107], v30, s[44:47], 0 offen offset:1024 sc1
s_waitcnt lgkmcnt(3)
buffer_store_dwordx4 v[84:87], v31, s[44:47], 0 offen offset:2048 sc1
v_accvgpr_read_b32 v68, a172
v_accvgpr_read_b32 v69, a173
v_accvgpr_read_b32 v70, a174
v_accvgpr_read_b32 v71, a175
v_mul_f32 v68, v68, v46
v_mul_f32 v69, v69, v46
v_mul_f32 v70, v70, v46
v_mul_f32 v71, v71, v46
v_cvt_pk_bf16_f32 v108, v68, v69
v_cvt_pk_bf16_f32 v109, v70, v71
v_accvgpr_read_b32 v72, a176
v_accvgpr_read_b32 v73, a177
v_accvgpr_read_b32 v74, a178
v_accvgpr_read_b32 v75, a179
v_mul_f32 v72, v72, v46
v_mul_f32 v73, v73, v46
v_mul_f32 v74, v74, v46
v_mul_f32 v75, v75, v46
v_cvt_pk_bf16_f32 v110, v72, v73
v_cvt_pk_bf16_f32 v111, v74, v75
buffer_store_dwordx4 v[108:111], v30, s[44:47], 0 offen offset:2048 sc1
s_waitcnt lgkmcnt(2)
buffer_store_dwordx4 v[88:91], v31, s[44:47], s67 offen sc1
v_accvgpr_read_b32 v68, a184
v_accvgpr_read_b32 v69, a185
v_accvgpr_read_b32 v70, a186
v_accvgpr_read_b32 v71, a187
v_mul_f32 v68, v68, v47
v_mul_f32 v69, v69, v47
v_mul_f32 v70, v70, v47
v_mul_f32 v71, v71, v47
v_cvt_pk_bf16_f32 v112, v68, v69
v_cvt_pk_bf16_f32 v113, v70, v71
v_accvgpr_read_b32 v72, a188
v_accvgpr_read_b32 v73, a189
v_accvgpr_read_b32 v74, a190
v_accvgpr_read_b32 v75, a191
v_mul_f32 v72, v72, v47
v_mul_f32 v73, v73, v47
v_mul_f32 v74, v74, v47
v_mul_f32 v75, v75, v47
v_cvt_pk_bf16_f32 v114, v72, v73
v_cvt_pk_bf16_f32 v115, v74, v75
buffer_store_dwordx4 v[112:115], v30, s[44:47], 0 offen offset:3072 sc1
s_waitcnt lgkmcnt(1)
buffer_store_dwordx4 v[92:95], v31, s[44:47], s67 offen offset:2048 sc1
v_accvgpr_read_b32 v68, a196
v_accvgpr_read_b32 v69, a197
v_accvgpr_read_b32 v70, a198
v_accvgpr_read_b32 v71, a199
v_mul_f32 v68, v68, v48
v_mul_f32 v69, v69, v48
v_mul_f32 v70, v70, v48
v_mul_f32 v71, v71, v48
v_cvt_pk_bf16_f32 v116, v68, v69
v_cvt_pk_bf16_f32 v117, v70, v71
v_accvgpr_read_b32 v72, a200
v_accvgpr_read_b32 v73, a201
v_accvgpr_read_b32 v74, a202
v_accvgpr_read_b32 v75, a203
v_mul_f32 v72, v72, v48
v_mul_f32 v73, v73, v48
v_mul_f32 v74, v74, v48
v_mul_f32 v75, v75, v48
v_cvt_pk_bf16_f32 v118, v72, v73
v_cvt_pk_bf16_f32 v119, v74, v75
buffer_store_dwordx4 v[116:119], v30, s[44:47], s67 offen sc1
s_waitcnt lgkmcnt(0)
buffer_store_dwordx4 v[96:99], v31, s[44:47], s100 offen sc1
v_accvgpr_read_b32 v68, a208
v_accvgpr_read_b32 v69, a209
v_accvgpr_read_b32 v70, a210
v_accvgpr_read_b32 v71, a211
v_mul_f32 v68, v68, v49
v_mul_f32 v69, v69, v49
v_mul_f32 v70, v70, v49
v_mul_f32 v71, v71, v49
v_cvt_pk_bf16_f32 v120, v68, v69
v_cvt_pk_bf16_f32 v121, v70, v71
v_accvgpr_read_b32 v72, a212
v_accvgpr_read_b32 v73, a213
v_accvgpr_read_b32 v74, a214
v_accvgpr_read_b32 v75, a215
v_mul_f32 v72, v72, v49
v_mul_f32 v73, v73, v49
v_mul_f32 v74, v74, v49
v_mul_f32 v75, v75, v49
v_cvt_pk_bf16_f32 v122, v72, v73
v_cvt_pk_bf16_f32 v123, v74, v75
buffer_store_dwordx4 v[120:123], v30, s[44:47], s67 offen offset:1024 sc1
v_accvgpr_read_b32 v68, a220
v_accvgpr_read_b32 v69, a221
v_accvgpr_read_b32 v70, a222
v_accvgpr_read_b32 v71, a223
v_mul_f32 v68, v68, v50
v_mul_f32 v69, v69, v50
v_mul_f32 v70, v70, v50
v_mul_f32 v71, v71, v50
v_cvt_pk_bf16_f32 v124, v68, v69
v_cvt_pk_bf16_f32 v125, v70, v71
v_accvgpr_read_b32 v72, a224
v_accvgpr_read_b32 v73, a225
v_accvgpr_read_b32 v74, a226
v_accvgpr_read_b32 v75, a227
v_mul_f32 v72, v72, v50
v_mul_f32 v73, v73, v50
v_mul_f32 v74, v74, v50
v_mul_f32 v75, v75, v50
v_cvt_pk_bf16_f32 v126, v72, v73
v_cvt_pk_bf16_f32 v127, v74, v75
buffer_store_dwordx4 v[124:127], v30, s[44:47], s67 offen offset:2048 sc1
v_accvgpr_read_b32 v68, a232
v_accvgpr_read_b32 v69, a233
v_accvgpr_read_b32 v70, a234
v_accvgpr_read_b32 v71, a235
v_mul_f32 v68, v68, v51
v_mul_f32 v69, v69, v51
v_mul_f32 v70, v70, v51
v_mul_f32 v71, v71, v51
v_cvt_pk_bf16_f32 v128, v68, v69
v_cvt_pk_bf16_f32 v129, v70, v71
v_accvgpr_read_b32 v72, a236
v_accvgpr_read_b32 v73, a237
v_accvgpr_read_b32 v74, a238
v_accvgpr_read_b32 v75, a239
v_mul_f32 v72, v72, v51
v_mul_f32 v73, v73, v51
v_mul_f32 v74, v74, v51
v_mul_f32 v75, v75, v51
v_cvt_pk_bf16_f32 v130, v72, v73
v_cvt_pk_bf16_f32 v131, v74, v75
buffer_store_dwordx4 v[128:131], v30, s[44:47], s67 offen offset:3072 sc1
v_accvgpr_read_b32 v68, a244
v_accvgpr_read_b32 v69, a245
v_accvgpr_read_b32 v70, a246
v_accvgpr_read_b32 v71, a247
v_mul_f32 v68, v68, v52
v_mul_f32 v69, v69, v52
v_mul_f32 v70, v70, v52
v_mul_f32 v71, v71, v52
v_cvt_pk_bf16_f32 v132, v68, v69
v_cvt_pk_bf16_f32 v133, v70, v71
v_accvgpr_read_b32 v72, a248
v_accvgpr_read_b32 v73, a249
v_accvgpr_read_b32 v74, a250
v_accvgpr_read_b32 v75, a251
v_mul_f32 v72, v72, v52
v_mul_f32 v73, v73, v52
v_mul_f32 v74, v74, v52
v_mul_f32 v75, v75, v52
v_cvt_pk_bf16_f32 v134, v72, v73
v_cvt_pk_bf16_f32 v135, v74, v75
buffer_store_dwordx4 v[132:135], v30, s[44:47], s68 offen sc1
s_waitcnt vmcnt(0)
s_barrier
v_mov_b32 v41, s11
s_mov_b64 exec, 1
buffer_atomic_add v41, v25, s[72:75], s21 offen sc1
s_mov_b64 exec, -1
s_mov_b32 s21, 0x40000000
s_cmp_lg_u32 s101, 0
s_cbranch_scc1 L1_fix
s_cmp_ge_u32 s2, 240
s_cbranch_scc1 L2_end
s_waitcnt vmcnt(0) lgkmcnt(0)
s_barrier
s_branch L2_start
L1_fix:
s_ff1_i32_b32 s48, s101
s_bitset0_b32 s101, s48
s_mov_b32 s18, 1
s_mov_b32 s19, 3840
s_mov_b32 s16, 0
s_mov_b32 s46, 0
s_waitcnt vmcnt(0) lgkmcnt(0)
s_barrier
s_branch L1_restart
L2_start:
s_load_dwordx2 s[8:9], s[0:1], 80
s_lshr_b32 s77, s2, 3
v_mov_b32 v16, 0
s_mov_b32 s50, 4000
v_lshrrev_b32 v148, 4, v25
s_mov_b32 s10, s26
s_mov_b32 s11, s27
s_mov_b32 s4, s58
s_mov_b32 s5, s59
v_and_b32 v149, 15, v148
v_lshrrev_b32 v150, 4, v148
v_lshrrev_b32 v151, 2, v149
v_and_b32 v152, 3, v148
v_lshlrev_b32 v14, 4, v148
s_bfe_u32 s65, s2, 0x10002
s_bfe_u32 s66, s2, 0x10001
s_and_b32 s51, s2, 1
s_and_b32 s52, s2, 7
s_lshl_b32 s78, s52, 5
s_add_u32 s78, s78, s77
s_xor_b32 s76, s78, 64
s_mul_i32 s53, s77, 52
s_lshr_b32 s53, s53, 8
s_mul_i32 s63, s51, 6
s_add_u32 s63, s63, s53
s_mul_i32 s54, s53, 5
s_sub_u32 s64, s77, s54
s_add_u32 s55, s53, s64
s_sub_u32 s54, s55, 6
s_cmp_ge_u32 s55, 6
s_cselect_b32 s55, s54, s55
s_mul_i32 s56, s55, 2
s_lshl_b32 s62, s3, 11
s_mul_i32 s51, s63, 12
s_mul_i32 s52, s3, 3
s_add_u32 s51, s51, s52
s_add_u32 s51, s51, 0
s_mul_i32 s52, s51, 57
s_lshr_b32 s52, s52, 9
s_mul_i32 s53, s52, 9
s_sub_u32 s53, s51, s53
s_mul_i32 s52, s52, 1769472
s_lshl_b32 s54, s53, 10
s_add_u32 s54, s54, s52
v_add_u32 v1, s54, v14
s_mul_i32 s51, s63, 12
s_mul_i32 s52, s3, 3
s_add_u32 s51, s51, s52
s_add_u32 s51, s51, 1
s_mul_i32 s52, s51, 57
s_lshr_b32 s52, s52, 9
s_mul_i32 s53, s52, 9
s_sub_u32 s53, s51, s53
s_mul_i32 s52, s52, 1769472
s_lshl_b32 s54, s53, 10
s_add_u32 s54, s54, s52
v_add_u32 v2, s54, v14
s_mul_i32 s51, s63, 12
s_mul_i32 s52, s3, 3
s_add_u32 s51, s51, s52
s_add_u32 s51, s51, 2
s_mul_i32 s52, s51, 57
s_lshr_b32 s52, s52, 9
s_mul_i32 s53, s52, 9
s_sub_u32 s53, s51, s53
s_mul_i32 s52, s52, 1769472
s_lshl_b32 s54, s53, 10
s_add_u32 s54, s54, s52
v_add_u32 v3, s54, v14
s_lshl_b32 s51, s64, 8
s_mul_i32 s52, s3, 10240
s_add_u32 s51, s51, s52
v_add_u32 v153, 0, v150
v_lshlrev_b32 v154, 1, v153
v_xor_b32 v154, v154, v149
v_mul_u32_u24 v153, 1280, v153
v_lshl_add_u32 v153, v154, 4, v153
v_add_u32 v153, s51, v153
v_subrev_u32 v4, 0, v153
v_add_u32 v153, 4, v150
v_lshlrev_b32 v154, 1, v153
v_xor_b32 v154, v154, v149
v_mul_u32_u24 v153, 1280, v153
v_lshl_add_u32 v153, v154, 4, v153
v_add_u32 v153, s51, v153
v_subrev_u32 v5, 1024, v153
s_mov_b32 s28, s4
s_mov_b32 s29, s5
s_mul_i32 s51, s66, 3932160
s_add_u32 s28, s28, s51
s_addc_u32 s29, s29, 0
s_mov_b32 s30, 3932160
s_mov_b32 s31, 0x20000
s_mul_i32 s51, s65, 28311552
s_mul_i32 s52, s66, 884736
s_add_u32 s51, s51, s52
s_add_u32 s32, s10, s51
s_addc_u32 s33, s11, 0
s_sub_u32 s34, 28311552, s52
s_mov_b32 s35, 0x20000
v_mov_b32 v36, v141
v_mov_b32 v38, v142
s_cmp_lg_u32 s3, 0
s_cbranch_scc1 L2_dja
s_mov_b32 s52, 0xffffff
s_mov_b32 s50, 4000
v_mov_b32 v37, 0xff
v_writelane_b32 v37, s52, 0
s_mov_b64 exec, 3
L2_dpa:
v_xor_b32 v38, 0x20202020, v38
v_and_b32 v38, v37, v38
v_cmp_ne_u32 vcc, 0, v38
s_nop 3
s_cmp_eq_u64 vcc, 0
s_cbranch_scc1 L2_dga
s_sleep 16
buffer_load_dword v38, v36, s[72:75], 0 offen sc1
s_waitcnt vmcnt(0)
s_sub_u32 s50, s50, 1
s_cbranch_scc0 L2_dpa
L2_dga:
s_mov_b64 exec, -1
L2_dja:
s_barrier
s_add_u32 s51, s56, 0
s_sub_u32 s52, s51, 12
s_min_u32 s51, s51, s52
s_mul_i32 s12, s51, 9216
s_mul_i32 s60, s51, 40960
s_add_u32 m0, s62, 0
s_nop 0
buffer_load_dwordx4 v4, s[28:31], s60 offen lds
buffer_load_dwordx4 v5, s[28:31], s60 offen offset:1024 lds
buffer_load_dwordx4 a[0:3], v1, s[32:35], s12 offen sc1
buffer_load_dwordx4 a[4:7], v2, s[32:35], s12 offen sc1
buffer_load_dwordx4 a[8:11], v3, s[32:35], s12 offen sc1
s_add_u32 s51, s56, 1
s_sub_u32 s52, s51, 12
s_min_u32 s51, s51, s52
s_mul_i32 s13, s51, 9216
s_mul_i32 s61, s51, 40960
s_add_u32 m0, s62, 8192
s_nop 0
buffer_load_dwordx4 v4, s[28:31], s61 offen lds
buffer_load_dwordx4 v5, s[28:31], s61 offen offset:1024 lds
buffer_load_dwordx4 a[12:15], v1, s[32:35], s13 offen sc1
buffer_load_dwordx4 a[16:19], v2, s[32:35], s13 offen sc1
buffer_load_dwordx4 a[20:23], v3, s[32:35], s13 offen sc1
s_add_u32 s51, s56, 2
s_sub_u32 s52, s51, 12
s_min_u32 s51, s51, s52
s_mul_i32 s14, s51, 9216
s_mul_i32 s69, s51, 40960
s_add_u32 m0, s62, 16384
s_nop 0
buffer_load_dwordx4 v4, s[28:31], s69 offen lds
buffer_load_dwordx4 v5, s[28:31], s69 offen offset:1024 lds
buffer_load_dwordx4 a[24:27], v1, s[32:35], s14 offen sc1
buffer_load_dwordx4 a[28:31], v2, s[32:35], s14 offen sc1
buffer_load_dwordx4 a[32:35], v3, s[32:35], s14 offen sc1
s_add_u32 s51, s56, 3
s_sub_u32 s52, s51, 12
s_min_u32 s51, s51, s52
s_mul_i32 s15, s51, 9216
s_mul_i32 s70, s51, 40960
s_add_u32 s51, s56, 4
s_sub_u32 s52, s51, 12
s_min_u32 s51, s51, s52
s_mul_i32 s16, s51, 9216
s_mul_i32 s71, s51, 40960
s_add_u32 s51, s56, 5
s_sub_u32 s52, s51, 12
s_min_u32 s51, s51, s52
s_mul_i32 s17, s51, 9216
s_mul_i32 s79, s51, 40960
s_add_u32 s51, s56, 6
s_sub_u32 s52, s51, 12
s_min_u32 s51, s51, s52
s_mul_i32 s18, s51, 9216
s_mul_i32 s80, s51, 40960
s_add_u32 s51, s56, 7
s_sub_u32 s52, s51, 12
s_min_u32 s51, s51, s52
s_mul_i32 s19, s51, 9216
s_mul_i32 s81, s51, 40960
s_add_u32 s51, s56, 8
s_sub_u32 s52, s51, 12
s_min_u32 s51, s51, s52
s_mul_i32 s20, s51, 9216
s_mul_i32 s82, s51, 40960
s_add_u32 s51, s56, 9
s_sub_u32 s52, s51, 12
s_min_u32 s51, s51, s52
s_mul_i32 s22, s51, 9216
s_mul_i32 s83, s51, 40960
s_add_u32 s51, s56, 10
s_sub_u32 s52, s51, 12
s_min_u32 s51, s51, s52
s_mul_i32 s23, s51, 9216
s_mul_i32 s25, s51, 40960
s_add_u32 s51, s56, 11
s_sub_u32 s52, s51, 12
s_min_u32 s51, s51, s52
s_mul_i32 s24, s51, 9216
s_mul_i32 s49, s51, 40960
s_waitcnt lgkmcnt(0)
v_subrev_u32 v64, 26880, v0
v_subrev_u32 v65, 26880, v55
v_accvgpr_read_b32 v68, a156
v_accvgpr_read_b32 v69, a157
v_accvgpr_read_b32 v70, a158
v_accvgpr_read_b32 v71, a159
v_mul_f32 v68, v68, v44
v_mul_f32 v69, v69, v44
v_mul_f32 v70, v70, v44
v_mul_f32 v71, v71, v44
v_cvt_pk_bf16_f32 v68, v68, v69
v_cvt_pk_bf16_f32 v69, v70, v71
ds_write_b64 v64, v[68:69]
v_accvgpr_read_b32 v72, a168
v_accvgpr_read_b32 v73, a169
v_accvgpr_read_b32 v74, a170
v_accvgpr_read_b32 v75, a171
v_mul_f32 v72, v72, v45
v_mul_f32 v73, v73, v45
v_mul_f32 v74, v74, v45
v_mul_f32 v75, v75, v45
v_cvt_pk_bf16_f32 v72, v72, v73
v_cvt_pk_bf16_f32 v73, v74, v75
ds_write_b64 v64, v[72:73] offset:1024
v_accvgpr_read_b32 v68, a180
v_accvgpr_read_b32 v69, a181
v_accvgpr_read_b32 v70, a182
v_accvgpr_read_b32 v71, a183
v_mul_f32 v68, v68, v46
v_mul_f32 v69, v69, v46
v_mul_f32 v70, v70, v46
v_mul_f32 v71, v71, v46
v_cvt_pk_bf16_f32 v68, v68, v69
v_cvt_pk_bf16_f32 v69, v70, v71
ds_write_b64 v64, v[68:69] offset:4096
v_accvgpr_read_b32 v72, a192
v_accvgpr_read_b32 v73, a193
v_accvgpr_read_b32 v74, a194
v_accvgpr_read_b32 v75, a195
v_mul_f32 v72, v72, v47
v_mul_f32 v73, v73, v47
v_mul_f32 v74, v74, v47
v_mul_f32 v75, v75, v47
v_cvt_pk_bf16_f32 v72, v72, v73
v_cvt_pk_bf16_f32 v73, v74, v75
ds_write_b64 v64, v[72:73] offset:5120
v_accvgpr_read_b32 v68, a204
v_accvgpr_read_b32 v69, a205
v_accvgpr_read_b32 v70, a206
v_accvgpr_read_b32 v71, a207
v_mul_f32 v68, v68, v48
v_mul_f32 v69, v69, v48
v_mul_f32 v70, v70, v48
v_mul_f32 v71, v71, v48
v_cvt_pk_bf16_f32 v68, v68, v69
v_cvt_pk_bf16_f32 v69, v70, v71
ds_write_b64 v64, v[68:69] offset:8192
v_accvgpr_read_b32 v72, a216
v_accvgpr_read_b32 v73, a217
v_accvgpr_read_b32 v74, a218
v_accvgpr_read_b32 v75, a219
v_mul_f32 v72, v72, v49
v_mul_f32 v73, v73, v49
v_mul_f32 v74, v74, v49
v_mul_f32 v75, v75, v49
v_cvt_pk_bf16_f32 v72, v72, v73
v_cvt_pk_bf16_f32 v73, v74, v75
ds_write_b64 v64, v[72:73] offset:9216
v_accvgpr_read_b32 v68, a228
v_accvgpr_read_b32 v69, a229
v_accvgpr_read_b32 v70, a230
v_accvgpr_read_b32 v71, a231
v_mul_f32 v68, v68, v50
v_mul_f32 v69, v69, v50
v_mul_f32 v70, v70, v50
v_mul_f32 v71, v71, v50
v_cvt_pk_bf16_f32 v68, v68, v69
v_cvt_pk_bf16_f32 v69, v70, v71
ds_write_b64 v64, v[68:69] offset:12288
v_accvgpr_read_b32 v72, a240
v_accvgpr_read_b32 v73, a241
v_accvgpr_read_b32 v74, a242
v_accvgpr_read_b32 v75, a243
v_mul_f32 v72, v72, v51
v_mul_f32 v73, v73, v51
v_mul_f32 v74, v74, v51
v_mul_f32 v75, v75, v51
v_cvt_pk_bf16_f32 v72, v72, v73
v_cvt_pk_bf16_f32 v73, v74, v75
ds_write_b64 v64, v[72:73] offset:13312
v_accvgpr_read_b32 v68, a252
v_accvgpr_read_b32 v69, a253
v_accvgpr_read_b32 v70, a254
v_accvgpr_read_b32 v71, a255
v_mul_f32 v68, v68, v52
v_mul_f32 v69, v69, v52
v_mul_f32 v70, v70, v52
v_mul_f32 v71, v71, v52
v_cvt_pk_bf16_f32 v68, v68, v69
v_cvt_pk_bf16_f32 v69, v70, v71
ds_write_b64 v64, v[68:69] offset:16384
ds_write_b64 v64, v[68:69] offset:17408
s_waitcnt lgkmcnt(0)
s_barrier
ds_read_b128 v[80:83], v65
ds_read_b128 v[84:87], v65 offset:4096
ds_read_b128 v[88:91], v65 offset:8192
ds_read_b128 v[92:95], v65 offset:12288
ds_read_b128 v[96:99], v65 offset:16384
v_accvgpr_read_b32 v68, a148
v_accvgpr_read_b32 v69, a149
v_accvgpr_read_b32 v70, a150
v_accvgpr_read_b32 v71, a151
v_mul_f32 v68, v68, v44
v_mul_f32 v69, v69, v44
v_mul_f32 v70, v70, v44
v_mul_f32 v71, v71, v44
v_cvt_pk_bf16_f32 v100, v68, v69
v_cvt_pk_bf16_f32 v101, v70, v71
v_accvgpr_read_b32 v72, a152
v_accvgpr_read_b32 v73, a153
v_accvgpr_read_b32 v74, a154
v_accvgpr_read_b32 v75, a155
v_mul_f32 v72, v72, v44
v_mul_f32 v73, v73, v44
v_mul_f32 v74, v74, v44
v_mul_f32 v75, v75, v44
v_cvt_pk_bf16_f32 v102, v72, v73
v_cvt_pk_bf16_f32 v103, v74, v75
buffer_store_dwordx4 v[100:103], v30, s[44:47], 0 offen sc1
s_waitcnt lgkmcnt(4)
buffer_store_dwordx4 v[80:83], v31, s[44:47], 0 offen sc1
v_accvgpr_read_b32 v68, a160
v_accvgpr_read_b32 v69, a161
v_accvgpr_read_b32 v70, a162
v_accvgpr_read_b32 v71, a163
v_mul_f32 v68, v68, v45
v_mul_f32 v69, v69, v45
v_mul_f32 v70, v70, v45
v_mul_f32 v71, v71, v45
v_cvt_pk_bf16_f32 v104, v68, v69
v_cvt_pk_bf16_f32 v105, v70, v71
v_accvgpr_read_b32 v72, a164
v_accvgpr_read_b32 v73, a165
v_accvgpr_read_b32 v74, a166
v_accvgpr_read_b32 v75, a167
v_mul_f32 v72, v72, v45
v_mul_f32 v73, v73, v45
v_mul_f32 v74, v74, v45
v_mul_f32 v75, v75, v45
v_cvt_pk_bf16_f32 v106, v72, v73
v_cvt_pk_bf16_f32 v107, v74, v75
buffer_store_dwordx4 v[104:107], v30, s[44:47], 0 offen offset:1024 sc1
s_waitcnt lgkmcnt(3)
buffer_store_dwordx4 v[84:87], v31, s[44:47], 0 offen offset:2048 sc1
v_accvgpr_read_b32 v68, a172
v_accvgpr_read_b32 v69, a173
v_accvgpr_read_b32 v70, a174
v_accvgpr_read_b32 v71, a175
v_mul_f32 v68, v68, v46
v_mul_f32 v69, v69, v46
v_mul_f32 v70, v70, v46
v_mul_f32 v71, v71, v46
v_cvt_pk_bf16_f32 v108, v68, v69
v_cvt_pk_bf16_f32 v109, v70, v71
v_accvgpr_read_b32 v72, a176
v_accvgpr_read_b32 v73, a177
v_accvgpr_read_b32 v74, a178
v_accvgpr_read_b32 v75, a179
v_mul_f32 v72, v72, v46
v_mul_f32 v73, v73, v46
v_mul_f32 v74, v74, v46
v_mul_f32 v75, v75, v46
v_cvt_pk_bf16_f32 v110, v72, v73
v_cvt_pk_bf16_f32 v111, v74, v75
buffer_store_dwordx4 v[108:111], v30, s[44:47], 0 offen offset:2048 sc1
s_waitcnt lgkmcnt(2)
buffer_store_dwordx4 v[88:91], v31, s[44:47], s67 offen sc1
v_accvgpr_read_b32 v68, a184
v_accvgpr_read_b32 v69, a185
v_accvgpr_read_b32 v70, a186
v_accvgpr_read_b32 v71, a187
v_mul_f32 v68, v68, v47
v_mul_f32 v69, v69, v47
v_mul_f32 v70, v70, v47
v_mul_f32 v71, v71, v47
v_cvt_pk_bf16_f32 v112, v68, v69
v_cvt_pk_bf16_f32 v113, v70, v71
v_accvgpr_read_b32 v72, a188
v_accvgpr_read_b32 v73, a189
v_accvgpr_read_b32 v74, a190
v_accvgpr_read_b32 v75, a191
v_mul_f32 v72, v72, v47
v_mul_f32 v73, v73, v47
v_mul_f32 v74, v74, v47
v_mul_f32 v75, v75, v47
v_cvt_pk_bf16_f32 v114, v72, v73
v_cvt_pk_bf16_f32 v115, v74, v75
buffer_store_dwordx4 v[112:115], v30, s[44:47], 0 offen offset:3072 sc1
s_waitcnt lgkmcnt(1)
buffer_store_dwordx4 v[92:95], v31, s[44:47], s67 offen offset:2048 sc1
v_accvgpr_read_b32 v68, a196
v_accvgpr_read_b32 v69, a197
v_accvgpr_read_b32 v70, a198
v_accvgpr_read_b32 v71, a199
v_mul_f32 v68, v68, v48
v_mul_f32 v69, v69, v48
v_mul_f32 v70, v70, v48
v_mul_f32 v71, v71, v48
v_cvt_pk_bf16_f32 v116, v68, v69
v_cvt_pk_bf16_f32 v117, v70, v71
v_accvgpr_read_b32 v72, a200
v_accvgpr_read_b32 v73, a201
v_accvgpr_read_b32 v74, a202
v_accvgpr_read_b32 v75, a203
v_mul_f32 v72, v72, v48
v_mul_f32 v73, v73, v48
v_mul_f32 v74, v74, v48
v_mul_f32 v75, v75, v48
v_cvt_pk_bf16_f32 v118, v72, v73
v_cvt_pk_bf16_f32 v119, v74, v75
buffer_store_dwordx4 v[116:119], v30, s[44:47], s67 offen sc1
s_waitcnt lgkmcnt(0)
buffer_store_dwordx4 v[96:99], v31, s[44:47], s100 offen sc1
v_accvgpr_read_b32 v68, a208
v_accvgpr_read_b32 v69, a209
v_accvgpr_read_b32 v70, a210
v_accvgpr_read_b32 v71, a211
v_mul_f32 v68, v68, v49
v_mul_f32 v69, v69, v49
v_mul_f32 v70, v70, v49
v_mul_f32 v71, v71, v49
v_cvt_pk_bf16_f32 v120, v68, v69
v_cvt_pk_bf16_f32 v121, v70, v71
v_accvgpr_read_b32 v72, a212
v_accvgpr_read_b32 v73, a213
v_accvgpr_read_b32 v74, a214
v_accvgpr_read_b32 v75, a215
v_mul_f32 v72, v72, v49
v_mul_f32 v73, v73, v49
v_mul_f32 v74, v74, v49
v_mul_f32 v75, v75, v49
v_cvt_pk_bf16_f32 v122, v72, v73
v_cvt_pk_bf16_f32 v123, v74, v75
buffer_store_dwordx4 v[120:123], v30, s[44:47], s67 offen offset:1024 sc1
v_accvgpr_read_b32 v68, a220
v_accvgpr_read_b32 v69, a221
v_accvgpr_read_b32 v70, a222
v_accvgpr_read_b32 v71, a223
v_mul_f32 v68, v68, v50
v_mul_f32 v69, v69, v50
v_mul_f32 v70, v70, v50
v_mul_f32 v71, v71, v50
v_cvt_pk_bf16_f32 v124, v68, v69
v_cvt_pk_bf16_f32 v125, v70, v71
v_accvgpr_read_b32 v72, a224
v_accvgpr_read_b32 v73, a225
v_accvgpr_read_b32 v74, a226
v_accvgpr_read_b32 v75, a227
v_mul_f32 v72, v72, v50
v_mul_f32 v73, v73, v50
v_mul_f32 v74, v74, v50
v_mul_f32 v75, v75, v50
v_cvt_pk_bf16_f32 v126, v72, v73
v_cvt_pk_bf16_f32 v127, v74, v75
buffer_store_dwordx4 v[124:127], v30, s[44:47], s67 offen offset:2048 sc1
v_accvgpr_read_b32 v68, a232
v_accvgpr_read_b32 v69, a233
v_accvgpr_read_b32 v70, a234
v_accvgpr_read_b32 v71, a235
v_mul_f32 v68, v68, v51
v_mul_f32 v69, v69, v51
v_mul_f32 v70, v70, v51
v_mul_f32 v71, v71, v51
v_cvt_pk_bf16_f32 v128, v68, v69
v_cvt_pk_bf16_f32 v129, v70, v71
v_accvgpr_read_b32 v72, a236
v_accvgpr_read_b32 v73, a237
v_accvgpr_read_b32 v74, a238
v_accvgpr_read_b32 v75, a239
v_mul_f32 v72, v72, v51
v_mul_f32 v73, v73, v51
v_mul_f32 v74, v74, v51
v_mul_f32 v75, v75, v51
v_cvt_pk_bf16_f32 v130, v72, v73
v_cvt_pk_bf16_f32 v131, v74, v75
buffer_store_dwordx4 v[128:131], v30, s[44:47], s67 offen offset:3072 sc1
v_accvgpr_read_b32 v68, a244
v_accvgpr_read_b32 v69, a245
v_accvgpr_read_b32 v70, a246
v_accvgpr_read_b32 v71, a247
v_mul_f32 v68, v68, v52
v_mul_f32 v69, v69, v52
v_mul_f32 v70, v70, v52
v_mul_f32 v71, v71, v52
v_cvt_pk_bf16_f32 v132, v68, v69
v_cvt_pk_bf16_f32 v133, v70, v71
v_accvgpr_read_b32 v72, a248
v_accvgpr_read_b32 v73, a249
v_accvgpr_read_b32 v74, a250
v_accvgpr_read_b32 v75, a251
v_mul_f32 v72, v72, v52
v_mul_f32 v73, v73, v52
v_mul_f32 v74, v74, v52
v_mul_f32 v75, v75, v52
v_cvt_pk_bf16_f32 v134, v72, v73
v_cvt_pk_bf16_f32 v135, v74, v75
buffer_store_dwordx4 v[132:135], v30, s[44:47], s68 offen sc1
v_lshl_add_u32 v153, v150, 2, v151
v_and_b32 v154, 7, v153
v_lshlrev_b32 v153, 8, v153
v_lshl_add_u32 v153, v152, 3, v153
s_lshl_b32 s51, s66, 2
s_add_u32 s51, s51, 0
s_and_b32 s51, s51, 7
v_xor_b32 v155, s51, v154
v_lshl_add_u32 v6, v155, 5, v153
v_add_u32 v17, 65536, v6
v_add_u32 v28, 131072, v6
s_lshl_b32 s51, s66, 2
s_add_u32 s51, s51, 1
s_and_b32 s51, s51, 7
v_xor_b32 v155, s51, v154
v_lshl_add_u32 v7, v155, 5, v153
v_add_u32 v18, 65536, v7
v_add_u32 v29, 131072, v7
s_lshl_b32 s51, s66, 2
s_add_u32 s51, s51, 2
s_and_b32 s51, s51, 7
v_xor_b32 v155, s51, v154
v_lshl_add_u32 v8, v155, 5, v153
v_add_u32 v19, 65536, v8
v_add_u32 v30, 131072, v8
s_lshl_b32 s51, s66, 2
s_add_u32 s51, s51, 3
s_and_b32 s51, s51, 7
v_xor_b32 v155, s51, v154
v_lshl_add_u32 v9, v155, 5, v153
v_add_u32 v20, 65536, v9
v_add_u32 v31, 131072, v9
s_lshl_b32 s51, s66, 2
s_add_u32 s51, s51, 4
s_and_b32 s51, s51, 7
v_xor_b32 v155, s51, v154
v_lshl_add_u32 v10, v155, 5, v153
v_add_u32 v21, 65536, v10
v_add_u32 v32, 131072, v10
s_lshl_b32 s51, s66, 2
s_add_u32 s51, s51, 5
s_and_b32 s51, s51, 7
v_xor_b32 v155, s51, v154
v_lshl_add_u32 v11, v155, 5, v153
v_add_u32 v22, 65536, v11
v_add_u32 v33, 131072, v11
s_lshl_b32 s51, s66, 2
s_add_u32 s51, s51, 6
s_and_b32 s51, s51, 7
v_xor_b32 v155, s51, v154
v_lshl_add_u32 v12, v155, 5, v153
v_add_u32 v23, 65536, v12
v_add_u32 v34, 131072, v12
s_lshl_b32 s51, s66, 2
s_add_u32 s51, s51, 7
s_and_b32 s51, s51, 7
v_xor_b32 v155, s51, v154
v_lshl_add_u32 v13, v155, 5, v153
v_add_u32 v24, 65536, v13
v_add_u32 v35, 131072, v13
s_waitcnt lgkmcnt(0)
s_mov_b32 s36, s8
s_mov_b32 s37, s9
s_mov_b32 s38, 5898240
s_mov_b32 s39, 0x20000
s_add_u32 s40, s10, 67108864
s_addc_u32 s41, s11, 0
s_mov_b32 s42, 33619968
s_mov_b32 s43, 0x20000
s_mul_i32 s51, s63, 491520
s_mul_i32 s52, s3, 122880
s_add_u32 s51, s51, s52
s_mul_i32 s52, s65, 1280
s_add_u32 s51, s51, s52
s_lshl_b32 s52, s64, 8
s_add_u32 s51, s51, s52
s_lshl_b32 s52, s66, 7
s_add_u32 s51, s51, s52
v_mul_u32_u24 v153, 2560, v149
v_and_b32 v154, 1, v150
v_lshl_add_u32 v153, v154, 5, v153
v_lshrrev_b32 v154, 1, v150
v_lshl_add_u32 v153, v154, 4, v153
v_add_u32 v15, s51, v153
s_waitcnt vmcnt(27)
s_barrier
ds_read_b64_tr_b16 v[112:113], v10
ds_read_b64_tr_b16 v[114:115], v10 offset:4096
ds_read_b64_tr_b16 v[116:117], v11
ds_read_b64_tr_b16 v[118:119], v11 offset:4096
ds_read_b64_tr_b16 v[120:121], v12
ds_read_b64_tr_b16 v[122:123], v12 offset:4096
ds_read_b64_tr_b16 v[124:125], v13
ds_read_b64_tr_b16 v[126:127], v13 offset:4096
s_waitcnt vmcnt(17)
s_barrier
s_waitcnt lgkmcnt(6)
v_mfma_f32_16x16x32_bf16 v[208:211], v[112:115], a[0:3], 0
s_add_u32 m0, s62, 24576
s_nop 0
buffer_load_dwordx4 v4, s[28:31], s70 offen lds
v_mfma_f32_16x16x32_bf16 v[212:215], v[112:115], a[4:7], 0
buffer_load_dwordx4 v5, s[28:31], s70 offen offset:1024 lds
v_mfma_f32_16x16x32_bf16 v[216:219], v[112:115], a[8:11], 0
s_waitcnt lgkmcnt(4)
buffer_load_dwordx4 a[36:39], v1, s[32:35], s15 offen sc1
v_mfma_f32_16x16x32_bf16 v[220:223], v[116:119], a[0:3], 0
buffer_load_dwordx4 a[40:43], v2, s[32:35], s15 offen sc1
v_mfma_f32_16x16x32_bf16 v[224:227], v[116:119], a[4:7], 0
buffer_load_dwordx4 a[44:47], v3, s[32:35], s15 offen sc1
v_mfma_f32_16x16x32_bf16 v[228:231], v[116:119], a[8:11], 0
s_waitcnt lgkmcnt(2)
s_add_u32 m0, s62, 32768
ds_read_b64_tr_b16 v[144:145], v10 offset:8192
ds_read_b64_tr_b16 v[146:147], v10 offset:12288
ds_read_b64_tr_b16 v[148:149], v11 offset:8192
ds_read_b64_tr_b16 v[150:151], v11 offset:12288
v_mfma_f32_16x16x32_bf16 v[232:235], v[120:123], a[0:3], 0
buffer_load_dwordx4 v4, s[28:31], s71 offen lds
v_mfma_f32_16x16x32_bf16 v[236:239], v[120:123], a[4:7], 0
buffer_load_dwordx4 v5, s[28:31], s71 offen offset:1024 lds
v_mfma_f32_16x16x32_bf16 v[240:243], v[120:123], a[8:11], 0
s_waitcnt lgkmcnt(4)
buffer_load_dwordx4 a[48:51], v1, s[32:35], s16 offen sc1
v_mfma_f32_16x16x32_bf16 v[244:247], v[124:127], a[0:3], 0
buffer_load_dwordx4 a[52:55], v2, s[32:35], s16 offen sc1
v_mfma_f32_16x16x32_bf16 v[248:251], v[124:127], a[4:7], 0
buffer_load_dwordx4 a[56:59], v3, s[32:35], s16 offen sc1
v_mfma_f32_16x16x32_bf16 v[252:255], v[124:127], a[8:11], 0
s_waitcnt lgkmcnt(2)
s_add_u32 m0, s62, 40960
ds_read_b64_tr_b16 v[152:153], v12 offset:8192
ds_read_b64_tr_b16 v[154:155], v12 offset:12288
ds_read_b64_tr_b16 v[156:157], v13 offset:8192
ds_read_b64_tr_b16 v[158:159], v13 offset:12288
v_mfma_f32_16x16x32_bf16 v[208:211], v[144:147], a[12:15], v[208:211]
buffer_load_dwordx4 v4, s[28:31], s79 offen lds
v_mfma_f32_16x16x32_bf16 v[212:215], v[144:147], a[16:19], v[212:215]
ds_read_b64_tr_b16 v[112:113], v10 offset:16384
ds_read_b64_tr_b16 v[114:115], v10 offset:20480
v_mfma_f32_16x16x32_bf16 v[216:219], v[144:147], a[20:23], v[216:219]
s_waitcnt lgkmcnt(6)
buffer_load_dwordx4 v5, s[28:31], s79 offen offset:1024 lds
v_mfma_f32_16x16x32_bf16 v[220:223], v[148:151], a[12:15], v[220:223]
ds_read_b64_tr_b16 v[116:117], v11 offset:16384
ds_read_b64_tr_b16 v[118:119], v11 offset:20480
v_mfma_f32_16x16x32_bf16 v[224:227], v[148:151], a[16:19], v[224:227]
buffer_load_dwordx4 a[60:63], v1, s[32:35], s17 offen sc1
v_mfma_f32_16x16x32_bf16 v[228:231], v[148:151], a[20:23], v[228:231]
s_waitcnt lgkmcnt(6)
ds_read_b64_tr_b16 v[120:121], v12 offset:16384
ds_read_b64_tr_b16 v[122:123], v12 offset:20480
v_mfma_f32_16x16x32_bf16 v[232:235], v[152:155], a[12:15], v[232:235]
ds_read_b64_tr_b16 v[124:125], v13 offset:16384
ds_read_b64_tr_b16 v[126:127], v13 offset:20480
v_mfma_f32_16x16x32_bf16 v[236:239], v[152:155], a[16:19], v[236:239]
buffer_load_dwordx4 a[64:67], v2, s[32:35], s17 offen sc1
v_mfma_f32_16x16x32_bf16 v[240:243], v[152:155], a[20:23], v[240:243]
s_waitcnt lgkmcnt(8)
v_mfma_f32_16x16x32_bf16 v[244:247], v[156:159], a[12:15], v[244:247]
buffer_load_dwordx4 a[68:71], v3, s[32:35], s17 offen sc1
v_mfma_f32_16x16x32_bf16 v[248:251], v[156:159], a[16:19], v[248:251]
v_mfma_f32_16x16x32_bf16 v[252:255], v[156:159], a[20:23], v[252:255]
s_waitcnt vmcnt(8)
s_barrier
s_waitcnt lgkmcnt(6)
v_mfma_f32_16x16x32_bf16 v[208:211], v[112:115], a[24:27], v[208:211]
s_add_u32 m0, s62, 49152
s_nop 0
buffer_load_dwordx4 v4, s[28:31], s80 offen lds
v_mfma_f32_16x16x32_bf16 v[212:215], v[112:115], a[28:31], v[212:215]
buffer_load_dwordx4 v5, s[28:31], s80 offen offset:1024 lds
v_mfma_f32_16x16x32_bf16 v[216:219], v[112:115], a[32:35], v[216:219]
s_waitcnt lgkmcnt(4)
buffer_load_dwordx4 a[72:75], v1, s[32:35], s18 offen sc1
v_mfma_f32_16x16x32_bf16 v[220:223], v[116:119], a[24:27], v[220:223]
buffer_load_dwordx4 a[76:79], v2, s[32:35], s18 offen sc1
v_mfma_f32_16x16x32_bf16 v[224:227], v[116:119], a[28:31], v[224:227]
buffer_load_dwordx4 a[80:83], v3, s[32:35], s18 offen sc1
v_mfma_f32_16x16x32_bf16 v[228:231], v[116:119], a[32:35], v[228:231]
s_waitcnt lgkmcnt(2)
s_add_u32 m0, s62, 57344
ds_read_b64_tr_b16 v[144:145], v10 offset:24576
ds_read_b64_tr_b16 v[146:147], v10 offset:28672
ds_read_b64_tr_b16 v[148:149], v11 offset:24576
ds_read_b64_tr_b16 v[150:151], v11 offset:28672
v_mfma_f32_16x16x32_bf16 v[232:235], v[120:123], a[24:27], v[232:235]
buffer_load_dwordx4 v4, s[28:31], s81 offen lds
v_mfma_f32_16x16x32_bf16 v[236:239], v[120:123], a[28:31], v[236:239]
buffer_load_dwordx4 v5, s[28:31], s81 offen offset:1024 lds
v_mfma_f32_16x16x32_bf16 v[240:243], v[120:123], a[32:35], v[240:243]
s_waitcnt lgkmcnt(4)
buffer_load_dwordx4 a[84:87], v1, s[32:35], s19 offen sc1
v_mfma_f32_16x16x32_bf16 v[244:247], v[124:127], a[24:27], v[244:247]
buffer_load_dwordx4 a[88:91], v2, s[32:35], s19 offen sc1
v_mfma_f32_16x16x32_bf16 v[248:251], v[124:127], a[28:31], v[248:251]
buffer_load_dwordx4 a[92:95], v3, s[32:35], s19 offen sc1
v_mfma_f32_16x16x32_bf16 v[252:255], v[124:127], a[32:35], v[252:255]
s_waitcnt lgkmcnt(2)
s_add_u32 m0, s62, 65536
ds_read_b64_tr_b16 v[152:153], v12 offset:24576
ds_read_b64_tr_b16 v[154:155], v12 offset:28672
ds_read_b64_tr_b16 v[156:157], v13 offset:24576
ds_read_b64_tr_b16 v[158:159], v13 offset:28672
v_mfma_f32_16x16x32_bf16 v[208:211], v[144:147], a[36:39], v[208:211]
buffer_load_dwordx4 v4, s[28:31], s82 offen lds
v_mfma_f32_16x16x32_bf16 v[212:215], v[144:147], a[40:43], v[212:215]
ds_read_b64_tr_b16 v[112:113], v10 offset:32768
ds_read_b64_tr_b16 v[114:115], v10 offset:36864
v_mfma_f32_16x16x32_bf16 v[216:219], v[144:147], a[44:47], v[216:219]
s_waitcnt lgkmcnt(6)
buffer_load_dwordx4 v5, s[28:31], s82 offen offset:1024 lds
v_mfma_f32_16x16x32_bf16 v[220:223], v[148:151], a[36:39], v[220:223]
ds_read_b64_tr_b16 v[116:117], v11 offset:32768
ds_read_b64_tr_b16 v[118:119], v11 offset:36864
v_mfma_f32_16x16x32_bf16 v[224:227], v[148:151], a[40:43], v[224:227]
buffer_load_dwordx4 a[96:99], v1, s[32:35], s20 offen sc1
v_mfma_f32_16x16x32_bf16 v[228:231], v[148:151], a[44:47], v[228:231]
s_waitcnt lgkmcnt(6)
ds_read_b64_tr_b16 v[120:121], v12 offset:32768
ds_read_b64_tr_b16 v[122:123], v12 offset:36864
v_mfma_f32_16x16x32_bf16 v[232:235], v[152:155], a[36:39], v[232:235]
ds_read_b64_tr_b16 v[124:125], v13 offset:32768
ds_read_b64_tr_b16 v[126:127], v13 offset:36864
v_mfma_f32_16x16x32_bf16 v[236:239], v[152:155], a[40:43], v[236:239]
buffer_load_dwordx4 a[100:103], v2, s[32:35], s20 offen sc1
v_mfma_f32_16x16x32_bf16 v[240:243], v[152:155], a[44:47], v[240:243]
s_waitcnt lgkmcnt(8)
v_mfma_f32_16x16x32_bf16 v[244:247], v[156:159], a[36:39], v[244:247]
buffer_load_dwordx4 a[104:107], v3, s[32:35], s20 offen sc1
v_mfma_f32_16x16x32_bf16 v[248:251], v[156:159], a[40:43], v[248:251]
v_mfma_f32_16x16x32_bf16 v[252:255], v[156:159], a[44:47], v[252:255]
s_waitcnt vmcnt(13)
s_barrier
s_waitcnt lgkmcnt(6)
v_mfma_f32_16x16x32_bf16 v[208:211], v[112:115], a[48:51], v[208:211]
s_add_u32 m0, s62, 73728
s_nop 0
buffer_load_dwordx4 v4, s[28:31], s83 offen lds
v_mfma_f32_16x16x32_bf16 v[212:215], v[112:115], a[52:55], v[212:215]
buffer_load_dwordx4 v5, s[28:31], s83 offen offset:1024 lds
v_mfma_f32_16x16x32_bf16 v[216:219], v[112:115], a[56:59], v[216:219]
s_waitcnt lgkmcnt(4)
buffer_load_dwordx4 a[108:111], v1, s[32:35], s22 offen sc1
v_mfma_f32_16x16x32_bf16 v[220:223], v[116:119], a[48:51], v[220:223]
buffer_load_dwordx4 a[112:115], v2, s[32:35], s22 offen sc1
v_mfma_f32_16x16x32_bf16 v[224:227], v[116:119], a[52:55], v[224:227]
buffer_load_dwordx4 a[116:119], v3, s[32:35], s22 offen sc1
v_mfma_f32_16x16x32_bf16 v[228:231], v[116:119], a[56:59], v[228:231]
s_waitcnt lgkmcnt(2)
s_add_u32 m0, s62, 81920
ds_read_b64_tr_b16 v[144:145], v10 offset:40960
ds_read_b64_tr_b16 v[146:147], v10 offset:45056
ds_read_b64_tr_b16 v[148:149], v11 offset:40960
ds_read_b64_tr_b16 v[150:151], v11 offset:45056
v_mfma_f32_16x16x32_bf16 v[232:235], v[120:123], a[48:51], v[232:235]
buffer_load_dwordx4 v4, s[28:31], s25 offen lds
v_mfma_f32_16x16x32_bf16 v[236:239], v[120:123], a[52:55], v[236:239]
buffer_load_dwordx4 v5, s[28:31], s25 offen offset:1024 lds
v_mfma_f32_16x16x32_bf16 v[240:243], v[120:123], a[56:59], v[240:243]
s_waitcnt lgkmcnt(4)
buffer_load_dwordx4 a[120:123], v1, s[32:35], s23 offen sc1
v_mfma_f32_16x16x32_bf16 v[244:247], v[124:127], a[48:51], v[244:247]
buffer_load_dwordx4 a[124:127], v2, s[32:35], s23 offen sc1
v_mfma_f32_16x16x32_bf16 v[248:251], v[124:127], a[52:55], v[248:251]
buffer_load_dwordx4 a[128:131], v3, s[32:35], s23 offen sc1
v_mfma_f32_16x16x32_bf16 v[252:255], v[124:127], a[56:59], v[252:255]
s_waitcnt lgkmcnt(2)
s_add_u32 m0, s62, 90112
ds_read_b64_tr_b16 v[152:153], v12 offset:40960
ds_read_b64_tr_b16 v[154:155], v12 offset:45056
ds_read_b64_tr_b16 v[156:157], v13 offset:40960
ds_read_b64_tr_b16 v[158:159], v13 offset:45056
v_mfma_f32_16x16x32_bf16 v[208:211], v[144:147], a[60:63], v[208:211]
buffer_load_dwordx4 v4, s[28:31], s49 offen lds
v_mfma_f32_16x16x32_bf16 v[212:215], v[144:147], a[64:67], v[212:215]
ds_read_b64_tr_b16 v[112:113], v10 offset:49152
ds_read_b64_tr_b16 v[114:115], v10 offset:53248
v_mfma_f32_16x16x32_bf16 v[216:219], v[144:147], a[68:71], v[216:219]
s_waitcnt lgkmcnt(6)
buffer_load_dwordx4 v5, s[28:31], s49 offen offset:1024 lds
v_mfma_f32_16x16x32_bf16 v[220:223], v[148:151], a[60:63], v[220:223]
ds_read_b64_tr_b16 v[116:117], v11 offset:49152
ds_read_b64_tr_b16 v[118:119], v11 offset:53248
v_mfma_f32_16x16x32_bf16 v[224:227], v[148:151], a[64:67], v[224:227]
buffer_load_dwordx4 a[132:135], v1, s[32:35], s24 offen sc1
v_mfma_f32_16x16x32_bf16 v[228:231], v[148:151], a[68:71], v[228:231]
s_waitcnt lgkmcnt(6)
ds_read_b64_tr_b16 v[120:121], v12 offset:49152
ds_read_b64_tr_b16 v[122:123], v12 offset:53248
v_mfma_f32_16x16x32_bf16 v[232:235], v[152:155], a[60:63], v[232:235]
ds_read_b64_tr_b16 v[124:125], v13 offset:49152
ds_read_b64_tr_b16 v[126:127], v13 offset:53248
v_mfma_f32_16x16x32_bf16 v[236:239], v[152:155], a[64:67], v[236:239]
buffer_load_dwordx4 a[136:139], v2, s[32:35], s24 offen sc1
v_mfma_f32_16x16x32_bf16 v[240:243], v[152:155], a[68:71], v[240:243]
s_waitcnt lgkmcnt(8)
v_mfma_f32_16x16x32_bf16 v[244:247], v[156:159], a[60:63], v[244:247]
buffer_load_dwordx4 a[140:143], v3, s[32:35], s24 offen sc1
v_mfma_f32_16x16x32_bf16 v[248:251], v[156:159], a[64:67], v[248:251]
v_mfma_f32_16x16x32_bf16 v[252:255], v[156:159], a[68:71], v[252:255]
s_waitcnt vmcnt(18)
s_barrier
s_waitcnt lgkmcnt(6)
v_mfma_f32_16x16x32_bf16 v[208:211], v[112:115], a[72:75], v[208:211]
s_add_u32 s28, s28, 491520
s_addc_u32 s29, s29, 0
s_sub_u32 s30, s30, 491520
s_add_u32 s32, s32, 110592
s_addc_u32 s33, s33, 0
s_sub_u32 s34, s34, 110592
s_add_u32 m0, s62, 98304
s_nop 0
buffer_load_dwordx4 v4, s[28:31], s60 offen lds
v_mfma_f32_16x16x32_bf16 v[212:215], v[112:115], a[76:79], v[212:215]
ds_read_b64_tr_b16 v[144:145], v10 offset:57344
ds_read_b64_tr_b16 v[146:147], v10 offset:61440
v_mfma_f32_16x16x32_bf16 v[216:219], v[112:115], a[80:83], v[216:219]
s_waitcnt lgkmcnt(6)
buffer_load_dwordx4 v5, s[28:31], s60 offen offset:1024 lds
v_mfma_f32_16x16x32_bf16 v[220:223], v[116:119], a[72:75], v[220:223]
ds_read_b64_tr_b16 v[148:149], v11 offset:57344
ds_read_b64_tr_b16 v[150:151], v11 offset:61440
v_mfma_f32_16x16x32_bf16 v[224:227], v[116:119], a[76:79], v[224:227]
buffer_load_dwordx4 a[144:147], v1, s[32:35], s12 offen sc1
v_mfma_f32_16x16x32_bf16 v[228:231], v[116:119], a[80:83], v[228:231]
s_waitcnt lgkmcnt(6)
ds_read_b64_tr_b16 v[152:153], v12 offset:57344
ds_read_b64_tr_b16 v[154:155], v12 offset:61440
v_mfma_f32_16x16x32_bf16 v[232:235], v[120:123], a[72:75], v[232:235]
ds_read_b64_tr_b16 v[156:157], v13 offset:57344
ds_read_b64_tr_b16 v[158:159], v13 offset:61440
v_mfma_f32_16x16x32_bf16 v[236:239], v[120:123], a[76:79], v[236:239]
buffer_load_dwordx4 a[148:151], v2, s[32:35], s12 offen sc1
v_mfma_f32_16x16x32_bf16 v[240:243], v[120:123], a[80:83], v[240:243]
s_waitcnt lgkmcnt(8)
v_mfma_f32_16x16x32_bf16 v[244:247], v[124:127], a[72:75], v[244:247]
buffer_load_dwordx4 a[152:155], v3, s[32:35], s12 offen sc1
v_mfma_f32_16x16x32_bf16 v[248:251], v[124:127], a[76:79], v[248:251]
v_mfma_f32_16x16x32_bf16 v[252:255], v[124:127], a[80:83], v[252:255]
s_waitcnt lgkmcnt(6)
s_add_u32 m0, s62, 106496
v_mfma_f32_16x16x32_bf16 v[208:211], v[144:147], a[84:87], v[208:211]
buffer_load_dwordx4 v4, s[28:31], s61 offen lds
v_mfma_f32_16x16x32_bf16 v[212:215], v[144:147], a[88:91], v[212:215]
ds_read_b64_tr_b16 v[112:113], v21
ds_read_b64_tr_b16 v[114:115], v21 offset:4096
v_mfma_f32_16x16x32_bf16 v[216:219], v[144:147], a[92:95], v[216:219]
s_waitcnt lgkmcnt(6)
buffer_load_dwordx4 v5, s[28:31], s61 offen offset:1024 lds
v_mfma_f32_16x16x32_bf16 v[220:223], v[148:151], a[84:87], v[220:223]
ds_read_b64_tr_b16 v[116:117], v22
ds_read_b64_tr_b16 v[118:119], v22 offset:4096
v_mfma_f32_16x16x32_bf16 v[224:227], v[148:151], a[88:91], v[224:227]
buffer_load_dwordx4 a[156:159], v1, s[32:35], s13 offen sc1
v_mfma_f32_16x16x32_bf16 v[228:231], v[148:151], a[92:95], v[228:231]
s_waitcnt lgkmcnt(6)
ds_read_b64_tr_b16 v[120:121], v23
ds_read_b64_tr_b16 v[122:123], v23 offset:4096
v_mfma_f32_16x16x32_bf16 v[232:235], v[152:155], a[84:87], v[232:235]
ds_read_b64_tr_b16 v[124:125], v24
ds_read_b64_tr_b16 v[126:127], v24 offset:4096
v_mfma_f32_16x16x32_bf16 v[236:239], v[152:155], a[88:91], v[236:239]
buffer_load_dwordx4 a[160:163], v2, s[32:35], s13 offen sc1
v_mfma_f32_16x16x32_bf16 v[240:243], v[152:155], a[92:95], v[240:243]
s_waitcnt lgkmcnt(8)
v_mfma_f32_16x16x32_bf16 v[244:247], v[156:159], a[84:87], v[244:247]
buffer_load_dwordx4 a[164:167], v3, s[32:35], s13 offen sc1
v_mfma_f32_16x16x32_bf16 v[248:251], v[156:159], a[88:91], v[248:251]
v_mfma_f32_16x16x32_bf16 v[252:255], v[156:159], a[92:95], v[252:255]
s_waitcnt vmcnt(18)
s_barrier
s_mov_b64 exec, 1
buffer_atomic_add v41, v16, s[72:75], s21 offen sc1
s_mov_b64 exec, -1
s_waitcnt lgkmcnt(6)
v_mfma_f32_16x16x32_bf16 v[208:211], v[112:115], a[96:99], v[208:211]
s_add_u32 m0, s62, 114688
s_nop 0
buffer_load_dwordx4 v4, s[28:31], s69 offen lds
v_mfma_f32_16x16x32_bf16 v[212:215], v[112:115], a[100:103], v[212:215]
ds_read_b64_tr_b16 v[144:145], v21 offset:8192
ds_read_b64_tr_b16 v[146:147], v21 offset:12288
v_mfma_f32_16x16x32_bf16 v[216:219], v[112:115], a[104:107], v[216:219]
s_waitcnt lgkmcnt(6)
buffer_load_dwordx4 v5, s[28:31], s69 offen offset:1024 lds
v_mfma_f32_16x16x32_bf16 v[220:223], v[116:119], a[96:99], v[220:223]
ds_read_b64_tr_b16 v[148:149], v22 offset:8192
ds_read_b64_tr_b16 v[150:151], v22 offset:12288
v_mfma_f32_16x16x32_bf16 v[224:227], v[116:119], a[100:103], v[224:227]
buffer_load_dwordx4 a[168:171], v1, s[32:35], s14 offen sc1
v_mfma_f32_16x16x32_bf16 v[228:231], v[116:119], a[104:107], v[228:231]
s_waitcnt lgkmcnt(6)
ds_read_b64_tr_b16 v[152:153], v23 offset:8192
ds_read_b64_tr_b16 v[154:155], v23 offset:12288
v_mfma_f32_16x16x32_bf16 v[232:235], v[120:123], a[96:99], v[232:235]
ds_read_b64_tr_b16 v[156:157], v24 offset:8192
ds_read_b64_tr_b16 v[158:159], v24 offset:12288
v_mfma_f32_16x16x32_bf16 v[236:239], v[120:123], a[100:103], v[236:239]
buffer_load_dwordx4 a[172:175], v2, s[32:35], s14 offen sc1
v_mfma_f32_16x16x32_bf16 v[240:243], v[120:123], a[104:107], v[240:243]
s_waitcnt lgkmcnt(8)
v_mfma_f32_16x16x32_bf16 v[244:247], v[124:127], a[96:99], v[244:247]
buffer_load_dwordx4 a[176:179], v3, s[32:35], s14 offen sc1
v_mfma_f32_16x16x32_bf16 v[248:251], v[124:127], a[100:103], v[248:251]
v_mfma_f32_16x16x32_bf16 v[252:255], v[124:127], a[104:107], v[252:255]
s_waitcnt lgkmcnt(6)
s_add_u32 m0, s62, 122880
v_mfma_f32_16x16x32_bf16 v[208:211], v[144:147], a[108:111], v[208:211]
buffer_load_dwordx4 v4, s[28:31], s70 offen lds
v_mfma_f32_16x16x32_bf16 v[212:215], v[144:147], a[112:115], v[212:215]
ds_read_b64_tr_b16 v[112:113], v21 offset:16384
ds_read_b64_tr_b16 v[114:115], v21 offset:20480
ds_read_b64_tr_b16 v[116:117], v22 offset:16384
ds_read_b64_tr_b16 v[118:119], v22 offset:20480
v_mfma_f32_16x16x32_bf16 v[216:219], v[144:147], a[116:119], v[216:219]
s_waitcnt lgkmcnt(8)
buffer_load_dwordx4 v5, s[28:31], s70 offen offset:1024 lds
v_mfma_f32_16x16x32_bf16 v[220:223], v[148:151], a[108:111], v[220:223]
ds_read_b64_tr_b16 v[120:121], v23 offset:16384
ds_read_b64_tr_b16 v[122:123], v23 offset:20480
ds_read_b64_tr_b16 v[124:125], v24 offset:16384
ds_read_b64_tr_b16 v[126:127], v24 offset:20480
v_mfma_f32_16x16x32_bf16 v[224:227], v[148:151], a[112:115], v[224:227]
buffer_load_dwordx4 a[180:183], v1, s[32:35], s15 offen sc1
v_mfma_f32_16x16x32_bf16 v[228:231], v[148:151], a[116:119], v[228:231]
s_waitcnt lgkmcnt(10)
ds_read_b64_tr_b16 v[96:97], v6
ds_read_b64_tr_b16 v[98:99], v6 offset:4096
ds_read_b64_tr_b16 v[100:101], v7
ds_read_b64_tr_b16 v[102:103], v7 offset:4096
v_mfma_f32_16x16x32_bf16 v[232:235], v[152:155], a[108:111], v[232:235]
ds_read_b64_tr_b16 v[104:105], v8
ds_read_b64_tr_b16 v[106:107], v8 offset:4096
ds_read_b64_tr_b16 v[108:109], v9
ds_read_b64_tr_b16 v[110:111], v9 offset:4096
v_mfma_f32_16x16x32_bf16 v[236:239], v[152:155], a[112:115], v[236:239]
buffer_load_dwordx4 a[184:187], v2, s[32:35], s15 offen sc1
v_mfma_f32_16x16x32_bf16 v[240:243], v[152:155], a[116:119], v[240:243]
s_waitcnt lgkmcnt(15)
v_mfma_f32_16x16x32_bf16 v[244:247], v[156:159], a[108:111], v[244:247]
buffer_load_dwordx4 a[188:191], v3, s[32:35], s15 offen sc1
v_mfma_f32_16x16x32_bf16 v[248:251], v[156:159], a[112:115], v[248:251]
v_mfma_f32_16x16x32_bf16 v[252:255], v[156:159], a[116:119], v[252:255]
s_waitcnt vmcnt(19)
s_barrier
s_waitcnt lgkmcnt(14)
v_mfma_f32_16x16x32_bf16 v[208:211], v[112:115], a[120:123], v[208:211]
s_add_u32 m0, s62, 131072
ds_read_b64_tr_b16 v[144:145], v21 offset:24576
v_mfma_f32_16x16x32_bf16 v[212:215], v[112:115], a[124:127], v[212:215]
buffer_load_dwordx4 v4, s[28:31], s71 offen lds
v_mfma_f32_16x16x32_bf16 v[216:219], v[112:115], a[128:131], v[216:219]
s_waitcnt lgkmcnt(13)
ds_read_b64_tr_b16 v[146:147], v21 offset:28672
v_mfma_f32_16x16x32_bf16 v[220:223], v[116:119], a[120:123], v[220:223]
ds_read_b64_tr_b16 v[148:149], v22 offset:24576
v_mfma_f32_16x16x32_bf16 v[224:227], v[116:119], a[124:127], v[224:227]
ds_read_b64_tr_b16 v[150:151], v22 offset:28672
v_mfma_f32_16x16x32_bf16 v[228:231], v[116:119], a[128:131], v[228:231]
s_waitcnt lgkmcnt(14)
buffer_load_dwordx4 v5, s[28:31], s71 offen offset:1024 lds
v_mfma_f32_16x16x32_bf16 v[232:235], v[120:123], a[120:123], v[232:235]
ds_read_b64_tr_b16 v[152:153], v23 offset:24576
v_mfma_f32_16x16x32_bf16 v[236:239], v[120:123], a[124:127], v[236:239]
ds_read_b64_tr_b16 v[154:155], v23 offset:28672
v_mfma_f32_16x16x32_bf16 v[240:243], v[120:123], a[128:131], v[240:243]
s_waitcnt lgkmcnt(14)
ds_read_b64_tr_b16 v[156:157], v24 offset:24576
v_mfma_f32_16x16x32_bf16 v[244:247], v[124:127], a[120:123], v[244:247]
ds_read_b64_tr_b16 v[158:159], v24 offset:28672
v_mfma_f32_16x16x32_bf16 v[248:251], v[124:127], a[124:127], v[248:251]
buffer_load_dwordx4 a[192:195], v1, s[32:35], s16 offen sc1
v_mfma_f32_16x16x32_bf16 v[252:255], v[124:127], a[128:131], v[252:255]
s_waitcnt lgkmcnt(14)
ds_read_b64_tr_b16 v[128:129], v6 offset:8192
v_mfma_f32_16x16x32_bf16 v[160:163], v[96:99], a[0:3], 0
ds_read_b64_tr_b16 v[130:131], v6 offset:12288
v_mfma_f32_16x16x32_bf16 v[164:167], v[96:99], a[4:7], 0
ds_read_b64_tr_b16 v[132:133], v7 offset:8192
v_mfma_f32_16x16x32_bf16 v[168:171], v[96:99], a[8:11], 0
s_waitcnt lgkmcnt(15)
ds_read_b64_tr_b16 v[134:135], v7 offset:12288
v_mfma_f32_16x16x32_bf16 v[172:175], v[100:103], a[0:3], 0
buffer_load_dwordx4 a[196:199], v2, s[32:35], s16 offen sc1
v_mfma_f32_16x16x32_bf16 v[176:179], v[100:103], a[4:7], 0
ds_read_b64_tr_b16 v[136:137], v8 offset:8192
v_mfma_f32_16x16x32_bf16 v[180:183], v[100:103], a[8:11], 0
s_waitcnt lgkmcnt(15)
ds_read_b64_tr_b16 v[138:139], v8 offset:12288
v_mfma_f32_16x16x32_bf16 v[184:187], v[104:107], a[0:3], 0
ds_read_b64_tr_b16 v[140:141], v9 offset:8192
v_mfma_f32_16x16x32_bf16 v[188:191], v[104:107], a[4:7], 0
ds_read_b64_tr_b16 v[142:143], v9 offset:12288
v_mfma_f32_16x16x32_bf16 v[192:195], v[104:107], a[8:11], 0
s_waitcnt lgkmcnt(15)
buffer_load_dwordx4 a[200:203], v3, s[32:35], s16 offen sc1
v_mfma_f32_16x16x32_bf16 v[196:199], v[108:111], a[0:3], 0
v_mfma_f32_16x16x32_bf16 v[200:203], v[108:111], a[4:7], 0
v_mfma_f32_16x16x32_bf16 v[204:207], v[108:111], a[8:11], 0
s_waitcnt lgkmcnt(14)
v_mfma_f32_16x16x32_bf16 v[208:211], v[144:147], a[132:135], v[208:211]
s_add_u32 m0, s62, 139264
ds_read_b64_tr_b16 v[112:113], v21 offset:32768
v_mfma_f32_16x16x32_bf16 v[212:215], v[144:147], a[136:139], v[212:215]
buffer_load_dwordx4 v4, s[28:31], s79 offen lds
v_mfma_f32_16x16x32_bf16 v[216:219], v[144:147], a[140:143], v[216:219]
s_waitcnt lgkmcnt(13)
ds_read_b64_tr_b16 v[114:115], v21 offset:36864
v_mfma_f32_16x16x32_bf16 v[220:223], v[148:151], a[132:135], v[220:223]
ds_read_b64_tr_b16 v[116:117], v22 offset:32768
v_mfma_f32_16x16x32_bf16 v[224:227], v[148:151], a[136:139], v[224:227]
ds_read_b64_tr_b16 v[118:119], v22 offset:36864
v_mfma_f32_16x16x32_bf16 v[228:231], v[148:151], a[140:143], v[228:231]
s_waitcnt lgkmcnt(14)
buffer_load_dwordx4 v5, s[28:31], s79 offen offset:1024 lds
v_mfma_f32_16x16x32_bf16 v[232:235], v[152:155], a[132:135], v[232:235]
ds_read_b64_tr_b16 v[120:121], v23 offset:32768
v_mfma_f32_16x16x32_bf16 v[236:239], v[152:155], a[136:139], v[236:239]
ds_read_b64_tr_b16 v[122:123], v23 offset:36864
v_mfma_f32_16x16x32_bf16 v[240:243], v[152:155], a[140:143], v[240:243]
s_waitcnt lgkmcnt(14)
ds_read_b64_tr_b16 v[124:125], v24 offset:32768
v_mfma_f32_16x16x32_bf16 v[244:247], v[156:159], a[132:135], v[244:247]
ds_read_b64_tr_b16 v[126:127], v24 offset:36864
v_mfma_f32_16x16x32_bf16 v[248:251], v[156:159], a[136:139], v[248:251]
buffer_load_dwordx4 a[204:207], v1, s[32:35], s17 offen sc1
v_mfma_f32_16x16x32_bf16 v[252:255], v[156:159], a[140:143], v[252:255]
s_waitcnt lgkmcnt(14)
ds_read_b64_tr_b16 v[96:97], v6 offset:16384
v_mfma_f32_16x16x32_bf16 v[160:163], v[128:131], a[12:15], v[160:163]
ds_read_b64_tr_b16 v[98:99], v6 offset:20480
v_mfma_f32_16x16x32_bf16 v[164:167], v[128:131], a[16:19], v[164:167]
ds_read_b64_tr_b16 v[100:101], v7 offset:16384
v_mfma_f32_16x16x32_bf16 v[168:171], v[128:131], a[20:23], v[168:171]
s_waitcnt lgkmcnt(15)
ds_read_b64_tr_b16 v[102:103], v7 offset:20480
v_mfma_f32_16x16x32_bf16 v[172:175], v[132:135], a[12:15], v[172:175]
buffer_load_dwordx4 a[208:211], v2, s[32:35], s17 offen sc1
v_mfma_f32_16x16x32_bf16 v[176:179], v[132:135], a[16:19], v[176:179]
ds_read_b64_tr_b16 v[104:105], v8 offset:16384
v_mfma_f32_16x16x32_bf16 v[180:183], v[132:135], a[20:23], v[180:183]
s_waitcnt lgkmcnt(15)
ds_read_b64_tr_b16 v[106:107], v8 offset:20480
v_mfma_f32_16x16x32_bf16 v[184:187], v[136:139], a[12:15], v[184:187]
ds_read_b64_tr_b16 v[108:109], v9 offset:16384
v_mfma_f32_16x16x32_bf16 v[188:191], v[136:139], a[16:19], v[188:191]
ds_read_b64_tr_b16 v[110:111], v9 offset:20480
v_mfma_f32_16x16x32_bf16 v[192:195], v[136:139], a[20:23], v[192:195]
s_waitcnt lgkmcnt(15)
buffer_load_dwordx4 a[212:215], v3, s[32:35], s17 offen sc1
v_mfma_f32_16x16x32_bf16 v[196:199], v[140:143], a[12:15], v[196:199]
v_mfma_f32_16x16x32_bf16 v[200:203], v[140:143], a[16:19], v[200:203]
v_mfma_f32_16x16x32_bf16 v[204:207], v[140:143], a[20:23], v[204:207]
s_waitcnt vmcnt(18)
s_barrier
s_waitcnt lgkmcnt(14)
v_mfma_f32_16x16x32_bf16 v[208:211], v[112:115], a[144:147], v[208:211]
s_add_u32 m0, s62, 147456
ds_read_b64_tr_b16 v[144:145], v21 offset:40960
v_mfma_f32_16x16x32_bf16 v[212:215], v[112:115], a[148:151], v[212:215]
buffer_load_dwordx4 v4, s[28:31], s80 offen lds
v_mfma_f32_16x16x32_bf16 v[216:219], v[112:115], a[152:155], v[216:219]
s_waitcnt lgkmcnt(13)
ds_read_b64_tr_b16 v[146:147], v21 offset:45056
v_mfma_f32_16x16x32_bf16 v[220:223], v[116:119], a[144:147], v[220:223]
ds_read_b64_tr_b16 v[148:149], v22 offset:40960
v_mfma_f32_16x16x32_bf16 v[224:227], v[116:119], a[148:151], v[224:227]
ds_read_b64_tr_b16 v[150:151], v22 offset:45056
v_mfma_f32_16x16x32_bf16 v[228:231], v[116:119], a[152:155], v[228:231]
s_waitcnt lgkmcnt(14)
buffer_load_dwordx4 v5, s[28:31], s80 offen offset:1024 lds
v_mfma_f32_16x16x32_bf16 v[232:235], v[120:123], a[144:147], v[232:235]
ds_read_b64_tr_b16 v[152:153], v23 offset:40960
v_mfma_f32_16x16x32_bf16 v[236:239], v[120:123], a[148:151], v[236:239]
ds_read_b64_tr_b16 v[154:155], v23 offset:45056
v_mfma_f32_16x16x32_bf16 v[240:243], v[120:123], a[152:155], v[240:243]
s_waitcnt lgkmcnt(14)
ds_read_b64_tr_b16 v[156:157], v24 offset:40960
v_mfma_f32_16x16x32_bf16 v[244:247], v[124:127], a[144:147], v[244:247]
ds_read_b64_tr_b16 v[158:159], v24 offset:45056
v_mfma_f32_16x16x32_bf16 v[248:251], v[124:127], a[148:151], v[248:251]
buffer_load_dwordx4 a[216:219], v1, s[32:35], s18 offen sc1
v_mfma_f32_16x16x32_bf16 v[252:255], v[124:127], a[152:155], v[252:255]
s_waitcnt lgkmcnt(14)
ds_read_b64_tr_b16 v[128:129], v6 offset:24576
v_mfma_f32_16x16x32_bf16 v[160:163], v[96:99], a[24:27], v[160:163]
ds_read_b64_tr_b16 v[130:131], v6 offset:28672
v_mfma_f32_16x16x32_bf16 v[164:167], v[96:99], a[28:31], v[164:167]
ds_read_b64_tr_b16 v[132:133], v7 offset:24576
v_mfma_f32_16x16x32_bf16 v[168:171], v[96:99], a[32:35], v[168:171]
s_waitcnt lgkmcnt(15)
ds_read_b64_tr_b16 v[134:135], v7 offset:28672
v_mfma_f32_16x16x32_bf16 v[172:175], v[100:103], a[24:27], v[172:175]
buffer_load_dwordx4 a[220:223], v2, s[32:35], s18 offen sc1
v_mfma_f32_16x16x32_bf16 v[176:179], v[100:103], a[28:31], v[176:179]
ds_read_b64_tr_b16 v[136:137], v8 offset:24576
v_mfma_f32_16x16x32_bf16 v[180:183], v[100:103], a[32:35], v[180:183]
s_waitcnt lgkmcnt(15)
ds_read_b64_tr_b16 v[138:139], v8 offset:28672
v_mfma_f32_16x16x32_bf16 v[184:187], v[104:107], a[24:27], v[184:187]
ds_read_b64_tr_b16 v[140:141], v9 offset:24576
v_mfma_f32_16x16x32_bf16 v[188:191], v[104:107], a[28:31], v[188:191]
ds_read_b64_tr_b16 v[142:143], v9 offset:28672
v_mfma_f32_16x16x32_bf16 v[192:195], v[104:107], a[32:35], v[192:195]
s_waitcnt lgkmcnt(15)
buffer_load_dwordx4 a[224:227], v3, s[32:35], s18 offen sc1
v_mfma_f32_16x16x32_bf16 v[196:199], v[108:111], a[24:27], v[196:199]
v_mfma_f32_16x16x32_bf16 v[200:203], v[108:111], a[28:31], v[200:203]
v_mfma_f32_16x16x32_bf16 v[204:207], v[108:111], a[32:35], v[204:207]
s_waitcnt lgkmcnt(14)
v_mfma_f32_16x16x32_bf16 v[208:211], v[144:147], a[156:159], v[208:211]
s_add_u32 m0, s62, 155648
ds_read_b64_tr_b16 v[112:113], v21 offset:49152
v_mfma_f32_16x16x32_bf16 v[212:215], v[144:147], a[160:163], v[212:215]
buffer_load_dwordx4 v4, s[28:31], s81 offen lds
v_mfma_f32_16x16x32_bf16 v[216:219], v[144:147], a[164:167], v[216:219]
s_waitcnt lgkmcnt(13)
ds_read_b64_tr_b16 v[114:115], v21 offset:53248
v_mfma_f32_16x16x32_bf16 v[220:223], v[148:151], a[156:159], v[220:223]
ds_read_b64_tr_b16 v[116:117], v22 offset:49152
v_mfma_f32_16x16x32_bf16 v[224:227], v[148:151], a[160:163], v[224:227]
ds_read_b64_tr_b16 v[118:119], v22 offset:53248
v_mfma_f32_16x16x32_bf16 v[228:231], v[148:151], a[164:167], v[228:231]
s_waitcnt lgkmcnt(14)
buffer_load_dwordx4 v5, s[28:31], s81 offen offset:1024 lds
v_mfma_f32_16x16x32_bf16 v[232:235], v[152:155], a[156:159], v[232:235]
ds_read_b64_tr_b16 v[120:121], v23 offset:49152
v_mfma_f32_16x16x32_bf16 v[236:239], v[152:155], a[160:163], v[236:239]
ds_read_b64_tr_b16 v[122:123], v23 offset:53248
v_mfma_f32_16x16x32_bf16 v[240:243], v[152:155], a[164:167], v[240:243]
s_waitcnt lgkmcnt(14)
ds_read_b64_tr_b16 v[124:125], v24 offset:49152
v_mfma_f32_16x16x32_bf16 v[244:247], v[156:159], a[156:159], v[244:247]
ds_read_b64_tr_b16 v[126:127], v24 offset:53248
v_mfma_f32_16x16x32_bf16 v[248:251], v[156:159], a[160:163], v[248:251]
buffer_load_dwordx4 a[228:231], v1, s[32:35], s19 offen sc1
v_mfma_f32_16x16x32_bf16 v[252:255], v[156:159], a[164:167], v[252:255]
s_waitcnt lgkmcnt(14)
ds_read_b64_tr_b16 v[96:97], v6 offset:32768
v_mfma_f32_16x16x32_bf16 v[160:163], v[128:131], a[36:39], v[160:163]
ds_read_b64_tr_b16 v[98:99], v6 offset:36864
v_mfma_f32_16x16x32_bf16 v[164:167], v[128:131], a[40:43], v[164:167]
ds_read_b64_tr_b16 v[100:101], v7 offset:32768
v_mfma_f32_16x16x32_bf16 v[168:171], v[128:131], a[44:47], v[168:171]
s_waitcnt lgkmcnt(15)
ds_read_b64_tr_b16 v[102:103], v7 offset:36864
v_mfma_f32_16x16x32_bf16 v[172:175], v[132:135], a[36:39], v[172:175]
buffer_load_dwordx4 a[232:235], v2, s[32:35], s19 offen sc1
v_mfma_f32_16x16x32_bf16 v[176:179], v[132:135], a[40:43], v[176:179]
ds_read_b64_tr_b16 v[104:105], v8 offset:32768
v_mfma_f32_16x16x32_bf16 v[180:183], v[132:135], a[44:47], v[180:183]
s_waitcnt lgkmcnt(15)
ds_read_b64_tr_b16 v[106:107], v8 offset:36864
v_mfma_f32_16x16x32_bf16 v[184:187], v[136:139], a[36:39], v[184:187]
ds_read_b64_tr_b16 v[108:109], v9 offset:32768
v_mfma_f32_16x16x32_bf16 v[188:191], v[136:139], a[40:43], v[188:191]
ds_read_b64_tr_b16 v[110:111], v9 offset:36864
v_mfma_f32_16x16x32_bf16 v[192:195], v[136:139], a[44:47], v[192:195]
s_waitcnt lgkmcnt(15)
buffer_load_dwordx4 a[236:239], v3, s[32:35], s19 offen sc1
v_mfma_f32_16x16x32_bf16 v[196:199], v[140:143], a[36:39], v[196:199]
v_mfma_f32_16x16x32_bf16 v[200:203], v[140:143], a[40:43], v[200:203]
v_mfma_f32_16x16x32_bf16 v[204:207], v[140:143], a[44:47], v[204:207]
s_waitcnt vmcnt(18)
s_barrier
s_waitcnt lgkmcnt(14)
v_mfma_f32_16x16x32_bf16 v[208:211], v[112:115], a[168:171], v[208:211]
s_add_u32 m0, s62, 0
ds_read_b64_tr_b16 v[144:145], v21 offset:57344
v_mfma_f32_16x16x32_bf16 v[212:215], v[112:115], a[172:175], v[212:215]
buffer_load_dwordx4 v4, s[28:31], s82 offen lds
v_mfma_f32_16x16x32_bf16 v[216:219], v[112:115], a[176:179], v[216:219]
s_waitcnt lgkmcnt(13)
ds_read_b64_tr_b16 v[146:147], v21 offset:61440
v_mfma_f32_16x16x32_bf16 v[220:223], v[116:119], a[168:171], v[220:223]
ds_read_b64_tr_b16 v[148:149], v22 offset:57344
v_mfma_f32_16x16x32_bf16 v[224:227], v[116:119], a[172:175], v[224:227]
ds_read_b64_tr_b16 v[150:151], v22 offset:61440
v_mfma_f32_16x16x32_bf16 v[228:231], v[116:119], a[176:179], v[228:231]
s_waitcnt lgkmcnt(14)
buffer_load_dwordx4 v5, s[28:31], s82 offen offset:1024 lds
v_mfma_f32_16x16x32_bf16 v[232:235], v[120:123], a[168:171], v[232:235]
ds_read_b64_tr_b16 v[152:153], v23 offset:57344
v_mfma_f32_16x16x32_bf16 v[236:239], v[120:123], a[172:175], v[236:239]
ds_read_b64_tr_b16 v[154:155], v23 offset:61440
v_mfma_f32_16x16x32_bf16 v[240:243], v[120:123], a[176:179], v[240:243]
s_waitcnt lgkmcnt(14)
ds_read_b64_tr_b16 v[156:157], v24 offset:57344
v_mfma_f32_16x16x32_bf16 v[244:247], v[124:127], a[168:171], v[244:247]
ds_read_b64_tr_b16 v[158:159], v24 offset:61440
v_mfma_f32_16x16x32_bf16 v[248:251], v[124:127], a[172:175], v[248:251]
buffer_load_dwordx4 a[0:3], v1, s[32:35], s20 offen sc1
v_mfma_f32_16x16x32_bf16 v[252:255], v[124:127], a[176:179], v[252:255]
s_waitcnt lgkmcnt(14)
ds_read_b64_tr_b16 v[128:129], v6 offset:40960
v_mfma_f32_16x16x32_bf16 v[160:163], v[96:99], a[48:51], v[160:163]
ds_read_b64_tr_b16 v[130:131], v6 offset:45056
v_mfma_f32_16x16x32_bf16 v[164:167], v[96:99], a[52:55], v[164:167]
ds_read_b64_tr_b16 v[132:133], v7 offset:40960
v_mfma_f32_16x16x32_bf16 v[168:171], v[96:99], a[56:59], v[168:171]
s_waitcnt lgkmcnt(15)
ds_read_b64_tr_b16 v[134:135], v7 offset:45056
v_mfma_f32_16x16x32_bf16 v[172:175], v[100:103], a[48:51], v[172:175]
buffer_load_dwordx4 a[4:7], v2, s[32:35], s20 offen sc1
v_mfma_f32_16x16x32_bf16 v[176:179], v[100:103], a[52:55], v[176:179]
ds_read_b64_tr_b16 v[136:137], v8 offset:40960
v_mfma_f32_16x16x32_bf16 v[180:183], v[100:103], a[56:59], v[180:183]
s_waitcnt lgkmcnt(15)
ds_read_b64_tr_b16 v[138:139], v8 offset:45056
v_mfma_f32_16x16x32_bf16 v[184:187], v[104:107], a[48:51], v[184:187]
ds_read_b64_tr_b16 v[140:141], v9 offset:40960
v_mfma_f32_16x16x32_bf16 v[188:191], v[104:107], a[52:55], v[188:191]
ds_read_b64_tr_b16 v[142:143], v9 offset:45056
v_mfma_f32_16x16x32_bf16 v[192:195], v[104:107], a[56:59], v[192:195]
s_waitcnt lgkmcnt(15)
buffer_load_dwordx4 a[8:11], v3, s[32:35], s20 offen sc1
v_mfma_f32_16x16x32_bf16 v[196:199], v[108:111], a[48:51], v[196:199]
v_mfma_f32_16x16x32_bf16 v[200:203], v[108:111], a[52:55], v[200:203]
v_mfma_f32_16x16x32_bf16 v[204:207], v[108:111], a[56:59], v[204:207]
s_waitcnt lgkmcnt(14)
v_mfma_f32_16x16x32_bf16 v[208:211], v[144:147], a[180:183], v[208:211]
s_add_u32 m0, s62, 8192
ds_read_b64_tr_b16 v[112:113], v32
v_mfma_f32_16x16x32_bf16 v[212:215], v[144:147], a[184:187], v[212:215]
buffer_load_dwordx4 v4, s[28:31], s83 offen lds
v_mfma_f32_16x16x32_bf16 v[216:219], v[144:147], a[188:191], v[216:219]
s_waitcnt lgkmcnt(13)
ds_read_b64_tr_b16 v[114:115], v32 offset:4096
v_mfma_f32_16x16x32_bf16 v[220:223], v[148:151], a[180:183], v[220:223]
ds_read_b64_tr_b16 v[116:117], v33
v_mfma_f32_16x16x32_bf16 v[224:227], v[148:151], a[184:187], v[224:227]
ds_read_b64_tr_b16 v[118:119], v33 offset:4096
v_mfma_f32_16x16x32_bf16 v[228:231], v[148:151], a[188:191], v[228:231]
s_waitcnt lgkmcnt(14)
buffer_load_dwordx4 v5, s[28:31], s83 offen offset:1024 lds
v_mfma_f32_16x16x32_bf16 v[232:235], v[152:155], a[180:183], v[232:235]
ds_read_b64_tr_b16 v[120:121], v34
v_mfma_f32_16x16x32_bf16 v[236:239], v[152:155], a[184:187], v[236:239]
ds_read_b64_tr_b16 v[122:123], v34 offset:4096
v_mfma_f32_16x16x32_bf16 v[240:243], v[152:155], a[188:191], v[240:243]
s_waitcnt lgkmcnt(14)
ds_read_b64_tr_b16 v[124:125], v35
v_mfma_f32_16x16x32_bf16 v[244:247], v[156:159], a[180:183], v[244:247]
ds_read_b64_tr_b16 v[126:127], v35 offset:4096
v_mfma_f32_16x16x32_bf16 v[248:251], v[156:159], a[184:187], v[248:251]
buffer_load_dwordx4 a[12:15], v1, s[32:35], s22 offen sc1
v_mfma_f32_16x16x32_bf16 v[252:255], v[156:159], a[188:191], v[252:255]
s_waitcnt lgkmcnt(14)
ds_read_b64_tr_b16 v[96:97], v6 offset:49152
v_mfma_f32_16x16x32_bf16 v[160:163], v[128:131], a[60:63], v[160:163]
ds_read_b64_tr_b16 v[98:99], v6 offset:53248
v_mfma_f32_16x16x32_bf16 v[164:167], v[128:131], a[64:67], v[164:167]
ds_read_b64_tr_b16 v[100:101], v7 offset:49152
v_mfma_f32_16x16x32_bf16 v[168:171], v[128:131], a[68:71], v[168:171]
s_waitcnt lgkmcnt(15)
ds_read_b64_tr_b16 v[102:103], v7 offset:53248
v_mfma_f32_16x16x32_bf16 v[172:175], v[132:135], a[60:63], v[172:175]
buffer_load_dwordx4 a[16:19], v2, s[32:35], s22 offen sc1
v_mfma_f32_16x16x32_bf16 v[176:179], v[132:135], a[64:67], v[176:179]
ds_read_b64_tr_b16 v[104:105], v8 offset:49152
v_mfma_f32_16x16x32_bf16 v[180:183], v[132:135], a[68:71], v[180:183]
s_waitcnt lgkmcnt(15)
ds_read_b64_tr_b16 v[106:107], v8 offset:53248
v_mfma_f32_16x16x32_bf16 v[184:187], v[136:139], a[60:63], v[184:187]
ds_read_b64_tr_b16 v[108:109], v9 offset:49152
v_mfma_f32_16x16x32_bf16 v[188:191], v[136:139], a[64:67], v[188:191]
ds_read_b64_tr_b16 v[110:111], v9 offset:53248
v_mfma_f32_16x16x32_bf16 v[192:195], v[136:139], a[68:71], v[192:195]
s_waitcnt lgkmcnt(15)
buffer_load_dwordx4 a[20:23], v3, s[32:35], s22 offen sc1
v_mfma_f32_16x16x32_bf16 v[196:199], v[140:143], a[60:63], v[196:199]
v_mfma_f32_16x16x32_bf16 v[200:203], v[140:143], a[64:67], v[200:203]
v_mfma_f32_16x16x32_bf16 v[204:207], v[140:143], a[68:71], v[204:207]
s_waitcnt vmcnt(18)
s_barrier
s_waitcnt lgkmcnt(14)
v_mfma_f32_16x16x32_bf16 v[208:211], v[112:115], a[192:195], v[208:211]
s_add_u32 m0, s62, 16384
ds_read_b64_tr_b16 v[144:145], v32 offset:8192
v_mfma_f32_16x16x32_bf16 v[212:215], v[112:115], a[196:199], v[212:215]
buffer_load_dwordx4 v4, s[28:31], s25 offen lds
v_mfma_f32_16x16x32_bf16 v[216:219], v[112:115], a[200:203], v[216:219]
s_waitcnt lgkmcnt(13)
ds_read_b64_tr_b16 v[146:147], v32 offset:12288
v_mfma_f32_16x16x32_bf16 v[220:223], v[116:119], a[192:195], v[220:223]
ds_read_b64_tr_b16 v[148:149], v33 offset:8192
v_mfma_f32_16x16x32_bf16 v[224:227], v[116:119], a[196:199], v[224:227]
ds_read_b64_tr_b16 v[150:151], v33 offset:12288
v_mfma_f32_16x16x32_bf16 v[228:231], v[116:119], a[200:203], v[228:231]
s_waitcnt lgkmcnt(14)
buffer_load_dwordx4 v5, s[28:31], s25 offen offset:1024 lds
v_mfma_f32_16x16x32_bf16 v[232:235], v[120:123], a[192:195], v[232:235]
ds_read_b64_tr_b16 v[152:153], v34 offset:8192
v_mfma_f32_16x16x32_bf16 v[236:239], v[120:123], a[196:199], v[236:239]
ds_read_b64_tr_b16 v[154:155], v34 offset:12288
v_mfma_f32_16x16x32_bf16 v[240:243], v[120:123], a[200:203], v[240:243]
s_waitcnt lgkmcnt(14)
ds_read_b64_tr_b16 v[156:157], v35 offset:8192
v_mfma_f32_16x16x32_bf16 v[244:247], v[124:127], a[192:195], v[244:247]
ds_read_b64_tr_b16 v[158:159], v35 offset:12288
v_mfma_f32_16x16x32_bf16 v[248:251], v[124:127], a[196:199], v[248:251]
buffer_load_dwordx4 a[24:27], v1, s[32:35], s23 offen sc1
v_mfma_f32_16x16x32_bf16 v[252:255], v[124:127], a[200:203], v[252:255]
s_waitcnt lgkmcnt(14)
ds_read_b64_tr_b16 v[128:129], v6 offset:57344
v_mfma_f32_16x16x32_bf16 v[160:163], v[96:99], a[72:75], v[160:163]
ds_read_b64_tr_b16 v[130:131], v6 offset:61440
v_mfma_f32_16x16x32_bf16 v[164:167], v[96:99], a[76:79], v[164:167]
ds_read_b64_tr_b16 v[132:133], v7 offset:57344
v_mfma_f32_16x16x32_bf16 v[168:171], v[96:99], a[80:83], v[168:171]
s_waitcnt lgkmcnt(15)
ds_read_b64_tr_b16 v[134:135], v7 offset:61440
v_mfma_f32_16x16x32_bf16 v[172:175], v[100:103], a[72:75], v[172:175]
buffer_load_dwordx4 a[28:31], v2, s[32:35], s23 offen sc1
v_mfma_f32_16x16x32_bf16 v[176:179], v[100:103], a[76:79], v[176:179]
ds_read_b64_tr_b16 v[136:137], v8 offset:57344
v_mfma_f32_16x16x32_bf16 v[180:183], v[100:103], a[80:83], v[180:183]
s_waitcnt lgkmcnt(15)
ds_read_b64_tr_b16 v[138:139], v8 offset:61440
v_mfma_f32_16x16x32_bf16 v[184:187], v[104:107], a[72:75], v[184:187]
ds_read_b64_tr_b16 v[140:141], v9 offset:57344
v_mfma_f32_16x16x32_bf16 v[188:191], v[104:107], a[76:79], v[188:191]
ds_read_b64_tr_b16 v[142:143], v9 offset:61440
v_mfma_f32_16x16x32_bf16 v[192:195], v[104:107], a[80:83], v[192:195]
s_waitcnt lgkmcnt(15)
buffer_load_dwordx4 a[32:35], v3, s[32:35], s23 offen sc1
v_mfma_f32_16x16x32_bf16 v[196:199], v[108:111], a[72:75], v[196:199]
v_mfma_f32_16x16x32_bf16 v[200:203], v[108:111], a[76:79], v[200:203]
v_mfma_f32_16x16x32_bf16 v[204:207], v[108:111], a[80:83], v[204:207]
s_waitcnt lgkmcnt(14)
v_mfma_f32_16x16x32_bf16 v[208:211], v[144:147], a[204:207], v[208:211]
s_add_u32 m0, s62, 24576
ds_read_b64_tr_b16 v[112:113], v32 offset:16384
v_mfma_f32_16x16x32_bf16 v[212:215], v[144:147], a[208:211], v[212:215]
buffer_load_dwordx4 v4, s[28:31], s49 offen lds
v_mfma_f32_16x16x32_bf16 v[216:219], v[144:147], a[212:215], v[216:219]
s_waitcnt lgkmcnt(13)
ds_read_b64_tr_b16 v[114:115], v32 offset:20480
v_mfma_f32_16x16x32_bf16 v[220:223], v[148:151], a[204:207], v[220:223]
ds_read_b64_tr_b16 v[116:117], v33 offset:16384
v_mfma_f32_16x16x32_bf16 v[224:227], v[148:151], a[208:211], v[224:227]
ds_read_b64_tr_b16 v[118:119], v33 offset:20480
v_mfma_f32_16x16x32_bf16 v[228:231], v[148:151], a[212:215], v[228:231]
s_waitcnt lgkmcnt(14)
buffer_load_dwordx4 v5, s[28:31], s49 offen offset:1024 lds
v_mfma_f32_16x16x32_bf16 v[232:235], v[152:155], a[204:207], v[232:235]
ds_read_b64_tr_b16 v[120:121], v34 offset:16384
v_mfma_f32_16x16x32_bf16 v[236:239], v[152:155], a[208:211], v[236:239]
ds_read_b64_tr_b16 v[122:123], v34 offset:20480
v_mfma_f32_16x16x32_bf16 v[240:243], v[152:155], a[212:215], v[240:243]
s_waitcnt lgkmcnt(14)
ds_read_b64_tr_b16 v[124:125], v35 offset:16384
v_mfma_f32_16x16x32_bf16 v[244:247], v[156:159], a[204:207], v[244:247]
ds_read_b64_tr_b16 v[126:127], v35 offset:20480
v_mfma_f32_16x16x32_bf16 v[248:251], v[156:159], a[208:211], v[248:251]
buffer_load_dwordx4 a[36:39], v1, s[32:35], s24 offen sc1
v_mfma_f32_16x16x32_bf16 v[252:255], v[156:159], a[212:215], v[252:255]
s_waitcnt lgkmcnt(14)
ds_read_b64_tr_b16 v[96:97], v17
v_mfma_f32_16x16x32_bf16 v[160:163], v[128:131], a[84:87], v[160:163]
ds_read_b64_tr_b16 v[98:99], v17 offset:4096
v_mfma_f32_16x16x32_bf16 v[164:167], v[128:131], a[88:91], v[164:167]
ds_read_b64_tr_b16 v[100:101], v18
v_mfma_f32_16x16x32_bf16 v[168:171], v[128:131], a[92:95], v[168:171]
s_waitcnt lgkmcnt(15)
ds_read_b64_tr_b16 v[102:103], v18 offset:4096
v_mfma_f32_16x16x32_bf16 v[172:175], v[132:135], a[84:87], v[172:175]
buffer_load_dwordx4 a[40:43], v2, s[32:35], s24 offen sc1
v_mfma_f32_16x16x32_bf16 v[176:179], v[132:135], a[88:91], v[176:179]
ds_read_b64_tr_b16 v[104:105], v19
v_mfma_f32_16x16x32_bf16 v[180:183], v[132:135], a[92:95], v[180:183]
s_waitcnt lgkmcnt(15)
ds_read_b64_tr_b16 v[106:107], v19 offset:4096
v_mfma_f32_16x16x32_bf16 v[184:187], v[136:139], a[84:87], v[184:187]
ds_read_b64_tr_b16 v[108:109], v20
v_mfma_f32_16x16x32_bf16 v[188:191], v[136:139], a[88:91], v[188:191]
ds_read_b64_tr_b16 v[110:111], v20 offset:4096
v_mfma_f32_16x16x32_bf16 v[192:195], v[136:139], a[92:95], v[192:195]
s_waitcnt lgkmcnt(15)
buffer_load_dwordx4 a[44:47], v3, s[32:35], s24 offen sc1
v_mfma_f32_16x16x32_bf16 v[196:199], v[140:143], a[84:87], v[196:199]
v_mfma_f32_16x16x32_bf16 v[200:203], v[140:143], a[88:91], v[200:203]
v_mfma_f32_16x16x32_bf16 v[204:207], v[140:143], a[92:95], v[204:207]
s_waitcnt vmcnt(18)
s_barrier
s_waitcnt lgkmcnt(14)
v_mfma_f32_16x16x32_bf16 v[208:211], v[112:115], a[216:219], v[208:211]
ds_read_b64_tr_b16 v[144:145], v32 offset:24576
v_mfma_f32_16x16x32_bf16 v[212:215], v[112:115], a[220:223], v[212:215]
s_add_u32 s28, s28, 491520
s_addc_u32 s29, s29, 0
s_sub_u32 s30, s30, 491520
s_add_u32 s32, s32, 110592
s_addc_u32 s33, s33, 0
s_sub_u32 s34, s34, 110592
s_add_u32 m0, s62, 32768
s_nop 0
buffer_load_dwordx4 v4, s[28:31], s60 offen lds
v_mfma_f32_16x16x32_bf16 v[216:219], v[112:115], a[224:227], v[216:219]
s_waitcnt lgkmcnt(13)
ds_read_b64_tr_b16 v[146:147], v32 offset:28672
v_mfma_f32_16x16x32_bf16 v[220:223], v[116:119], a[216:219], v[220:223]
ds_read_b64_tr_b16 v[148:149], v33 offset:24576
v_mfma_f32_16x16x32_bf16 v[224:227], v[116:119], a[220:223], v[224:227]
ds_read_b64_tr_b16 v[150:151], v33 offset:28672
v_mfma_f32_16x16x32_bf16 v[228:231], v[116:119], a[224:227], v[228:231]
s_waitcnt lgkmcnt(14)
buffer_load_dwordx4 v5, s[28:31], s60 offen offset:1024 lds
v_mfma_f32_16x16x32_bf16 v[232:235], v[120:123], a[216:219], v[232:235]
ds_read_b64_tr_b16 v[152:153], v34 offset:24576
v_mfma_f32_16x16x32_bf16 v[236:239], v[120:123], a[220:223], v[236:239]
ds_read_b64_tr_b16 v[154:155], v34 offset:28672
v_mfma_f32_16x16x32_bf16 v[240:243], v[120:123], a[224:227], v[240:243]
s_waitcnt lgkmcnt(14)
ds_read_b64_tr_b16 v[156:157], v35 offset:24576
v_mfma_f32_16x16x32_bf16 v[244:247], v[124:127], a[216:219], v[244:247]
ds_read_b64_tr_b16 v[158:159], v35 offset:28672
v_mfma_f32_16x16x32_bf16 v[248:251], v[124:127], a[220:223], v[248:251]
buffer_load_dwordx4 a[48:51], v1, s[32:35], s12 offen sc1
v_mfma_f32_16x16x32_bf16 v[252:255], v[124:127], a[224:227], v[252:255]
s_waitcnt lgkmcnt(14)
ds_read_b64_tr_b16 v[128:129], v17 offset:8192
v_mfma_f32_16x16x32_bf16 v[160:163], v[96:99], a[96:99], v[160:163]
ds_read_b64_tr_b16 v[130:131], v17 offset:12288
v_mfma_f32_16x16x32_bf16 v[164:167], v[96:99], a[100:103], v[164:167]
ds_read_b64_tr_b16 v[132:133], v18 offset:8192
v_mfma_f32_16x16x32_bf16 v[168:171], v[96:99], a[104:107], v[168:171]
s_waitcnt lgkmcnt(15)
ds_read_b64_tr_b16 v[134:135], v18 offset:12288
v_mfma_f32_16x16x32_bf16 v[172:175], v[100:103], a[96:99], v[172:175]
buffer_load_dwordx4 a[52:55], v2, s[32:35], s12 offen sc1
v_mfma_f32_16x16x32_bf16 v[176:179], v[100:103], a[100:103], v[176:179]
ds_read_b64_tr_b16 v[136:137], v19 offset:8192
v_mfma_f32_16x16x32_bf16 v[180:183], v[100:103], a[104:107], v[180:183]
s_waitcnt lgkmcnt(15)
ds_read_b64_tr_b16 v[138:139], v19 offset:12288
v_mfma_f32_16x16x32_bf16 v[184:187], v[104:107], a[96:99], v[184:187]
ds_read_b64_tr_b16 v[140:141], v20 offset:8192
v_mfma_f32_16x16x32_bf16 v[188:191], v[104:107], a[100:103], v[188:191]
ds_read_b64_tr_b16 v[142:143], v20 offset:12288
v_mfma_f32_16x16x32_bf16 v[192:195], v[104:107], a[104:107], v[192:195]
s_waitcnt lgkmcnt(15)
buffer_load_dwordx4 a[56:59], v3, s[32:35], s12 offen sc1
v_mfma_f32_16x16x32_bf16 v[196:199], v[108:111], a[96:99], v[196:199]
v_mfma_f32_16x16x32_bf16 v[200:203], v[108:111], a[100:103], v[200:203]
v_mfma_f32_16x16x32_bf16 v[204:207], v[108:111], a[104:107], v[204:207]
s_waitcnt lgkmcnt(14)
v_mfma_f32_16x16x32_bf16 v[208:211], v[144:147], a[228:231], v[208:211]
s_add_u32 m0, s62, 40960
ds_read_b64_tr_b16 v[112:113], v10
v_mfma_f32_16x16x32_bf16 v[212:215], v[144:147], a[232:235], v[212:215]
buffer_load_dwordx4 v4, s[28:31], s61 offen lds
v_mfma_f32_16x16x32_bf16 v[216:219], v[144:147], a[236:239], v[216:219]
s_waitcnt lgkmcnt(13)
ds_read_b64_tr_b16 v[114:115], v10 offset:4096
v_mfma_f32_16x16x32_bf16 v[220:223], v[148:151], a[228:231], v[220:223]
ds_read_b64_tr_b16 v[116:117], v11
v_mfma_f32_16x16x32_bf16 v[224:227], v[148:151], a[232:235], v[224:227]
ds_read_b64_tr_b16 v[118:119], v11 offset:4096
v_mfma_f32_16x16x32_bf16 v[228:231], v[148:151], a[236:239], v[228:231]
s_waitcnt lgkmcnt(14)
buffer_load_dwordx4 v5, s[28:31], s61 offen offset:1024 lds
v_mfma_f32_16x16x32_bf16 v[232:235], v[152:155], a[228:231], v[232:235]
ds_read_b64_tr_b16 v[120:121], v12
v_mfma_f32_16x16x32_bf16 v[236:239], v[152:155], a[232:235], v[236:239]
ds_read_b64_tr_b16 v[122:123], v12 offset:4096
v_mfma_f32_16x16x32_bf16 v[240:243], v[152:155], a[236:239], v[240:243]
s_waitcnt lgkmcnt(14)
ds_read_b64_tr_b16 v[124:125], v13
v_mfma_f32_16x16x32_bf16 v[244:247], v[156:159], a[228:231], v[244:247]
ds_read_b64_tr_b16 v[126:127], v13 offset:4096
v_mfma_f32_16x16x32_bf16 v[248:251], v[156:159], a[232:235], v[248:251]
buffer_load_dwordx4 a[60:63], v1, s[32:35], s13 offen sc1
v_mfma_f32_16x16x32_bf16 v[252:255], v[156:159], a[236:239], v[252:255]
s_waitcnt lgkmcnt(14)
ds_read_b64_tr_b16 v[96:97], v17 offset:16384
v_mfma_f32_16x16x32_bf16 v[160:163], v[128:131], a[108:111], v[160:163]
ds_read_b64_tr_b16 v[98:99], v17 offset:20480
v_mfma_f32_16x16x32_bf16 v[164:167], v[128:131], a[112:115], v[164:167]
ds_read_b64_tr_b16 v[100:101], v18 offset:16384
v_mfma_f32_16x16x32_bf16 v[168:171], v[128:131], a[116:119], v[168:171]
s_waitcnt lgkmcnt(15)
ds_read_b64_tr_b16 v[102:103], v18 offset:20480
v_mfma_f32_16x16x32_bf16 v[172:175], v[132:135], a[108:111], v[172:175]
buffer_load_dwordx4 a[64:67], v2, s[32:35], s13 offen sc1
v_mfma_f32_16x16x32_bf16 v[176:179], v[132:135], a[112:115], v[176:179]
ds_read_b64_tr_b16 v[104:105], v19 offset:16384
v_mfma_f32_16x16x32_bf16 v[180:183], v[132:135], a[116:119], v[180:183]
s_waitcnt lgkmcnt(15)
ds_read_b64_tr_b16 v[106:107], v19 offset:20480
v_mfma_f32_16x16x32_bf16 v[184:187], v[136:139], a[108:111], v[184:187]
ds_read_b64_tr_b16 v[108:109], v20 offset:16384
v_mfma_f32_16x16x32_bf16 v[188:191], v[136:139], a[112:115], v[188:191]
ds_read_b64_tr_b16 v[110:111], v20 offset:20480
v_mfma_f32_16x16x32_bf16 v[192:195], v[136:139], a[116:119], v[192:195]
s_waitcnt lgkmcnt(15)
buffer_load_dwordx4 a[68:71], v3, s[32:35], s13 offen sc1
v_mfma_f32_16x16x32_bf16 v[196:199], v[140:143], a[108:111], v[196:199]
v_mfma_f32_16x16x32_bf16 v[200:203], v[140:143], a[112:115], v[200:203]
v_mfma_f32_16x16x32_bf16 v[204:207], v[140:143], a[116:119], v[204:207]
s_waitcnt vmcnt(18)
s_barrier
s_waitcnt lgkmcnt(14)
v_mfma_f32_16x16x32_bf16 v[208:211], v[112:115], a[0:3], v[208:211]
s_add_u32 m0, s62, 49152
ds_read_b64_tr_b16 v[144:145], v10 offset:8192
v_mfma_f32_16x16x32_bf16 v[212:215], v[112:115], a[4:7], v[212:215]
buffer_load_dwordx4 v4, s[28:31], s69 offen lds
v_mfma_f32_16x16x32_bf16 v[216:219], v[112:115], a[8:11], v[216:219]
s_waitcnt lgkmcnt(13)
ds_read_b64_tr_b16 v[146:147], v10 offset:12288
v_mfma_f32_16x16x32_bf16 v[220:223], v[116:119], a[0:3], v[220:223]
ds_read_b64_tr_b16 v[148:149], v11 offset:8192
v_mfma_f32_16x16x32_bf16 v[224:227], v[116:119], a[4:7], v[224:227]
ds_read_b64_tr_b16 v[150:151], v11 offset:12288
v_mfma_f32_16x16x32_bf16 v[228:231], v[116:119], a[8:11], v[228:231]
s_waitcnt lgkmcnt(14)
buffer_load_dwordx4 v5, s[28:31], s69 offen offset:1024 lds
v_mfma_f32_16x16x32_bf16 v[232:235], v[120:123], a[0:3], v[232:235]
ds_read_b64_tr_b16 v[152:153], v12 offset:8192
v_mfma_f32_16x16x32_bf16 v[236:239], v[120:123], a[4:7], v[236:239]
ds_read_b64_tr_b16 v[154:155], v12 offset:12288
v_mfma_f32_16x16x32_bf16 v[240:243], v[120:123], a[8:11], v[240:243]
s_waitcnt lgkmcnt(14)
ds_read_b64_tr_b16 v[156:157], v13 offset:8192
v_mfma_f32_16x16x32_bf16 v[244:247], v[124:127], a[0:3], v[244:247]
ds_read_b64_tr_b16 v[158:159], v13 offset:12288
v_mfma_f32_16x16x32_bf16 v[248:251], v[124:127], a[4:7], v[248:251]
buffer_load_dwordx4 a[72:75], v1, s[32:35], s14 offen sc1
v_mfma_f32_16x16x32_bf16 v[252:255], v[124:127], a[8:11], v[252:255]
s_waitcnt lgkmcnt(14)
ds_read_b64_tr_b16 v[128:129], v17 offset:24576
v_mfma_f32_16x16x32_bf16 v[160:163], v[96:99], a[120:123], v[160:163]
ds_read_b64_tr_b16 v[130:131], v17 offset:28672
v_mfma_f32_16x16x32_bf16 v[164:167], v[96:99], a[124:127], v[164:167]
ds_read_b64_tr_b16 v[132:133], v18 offset:24576
v_mfma_f32_16x16x32_bf16 v[168:171], v[96:99], a[128:131], v[168:171]
s_waitcnt lgkmcnt(15)
ds_read_b64_tr_b16 v[134:135], v18 offset:28672
v_mfma_f32_16x16x32_bf16 v[172:175], v[100:103], a[120:123], v[172:175]
buffer_load_dwordx4 a[76:79], v2, s[32:35], s14 offen sc1
v_mfma_f32_16x16x32_bf16 v[176:179], v[100:103], a[124:127], v[176:179]
ds_read_b64_tr_b16 v[136:137], v19 offset:24576
v_mfma_f32_16x16x32_bf16 v[180:183], v[100:103], a[128:131], v[180:183]
s_waitcnt lgkmcnt(15)
ds_read_b64_tr_b16 v[138:139], v19 offset:28672
v_mfma_f32_16x16x32_bf16 v[184:187], v[104:107], a[120:123], v[184:187]
ds_read_b64_tr_b16 v[140:141], v20 offset:24576
v_mfma_f32_16x16x32_bf16 v[188:191], v[104:107], a[124:127], v[188:191]
ds_read_b64_tr_b16 v[142:143], v20 offset:28672
v_mfma_f32_16x16x32_bf16 v[192:195], v[104:107], a[128:131], v[192:195]
s_waitcnt lgkmcnt(15)
buffer_load_dwordx4 a[80:83], v3, s[32:35], s14 offen sc1
v_mfma_f32_16x16x32_bf16 v[196:199], v[108:111], a[120:123], v[196:199]
v_mfma_f32_16x16x32_bf16 v[200:203], v[108:111], a[124:127], v[200:203]
v_mfma_f32_16x16x32_bf16 v[204:207], v[108:111], a[128:131], v[204:207]
s_waitcnt lgkmcnt(14)
v_mfma_f32_16x16x32_bf16 v[208:211], v[144:147], a[12:15], v[208:211]
s_add_u32 m0, s62, 57344
ds_read_b64_tr_b16 v[112:113], v10 offset:16384
v_mfma_f32_16x16x32_bf16 v[212:215], v[144:147], a[16:19], v[212:215]
buffer_load_dwordx4 v4, s[28:31], s70 offen lds
v_mfma_f32_16x16x32_bf16 v[216:219], v[144:147], a[20:23], v[216:219]
s_waitcnt lgkmcnt(13)
ds_read_b64_tr_b16 v[114:115], v10 offset:20480
v_mfma_f32_16x16x32_bf16 v[220:223], v[148:151], a[12:15], v[220:223]
ds_read_b64_tr_b16 v[116:117], v11 offset:16384
v_mfma_f32_16x16x32_bf16 v[224:227], v[148:151], a[16:19], v[224:227]
ds_read_b64_tr_b16 v[118:119], v11 offset:20480
v_mfma_f32_16x16x32_bf16 v[228:231], v[148:151], a[20:23], v[228:231]
s_waitcnt lgkmcnt(14)
buffer_load_dwordx4 v5, s[28:31], s70 offen offset:1024 lds
v_mfma_f32_16x16x32_bf16 v[232:235], v[152:155], a[12:15], v[232:235]
ds_read_b64_tr_b16 v[120:121], v12 offset:16384
v_mfma_f32_16x16x32_bf16 v[236:239], v[152:155], a[16:19], v[236:239]
ds_read_b64_tr_b16 v[122:123], v12 offset:20480
v_mfma_f32_16x16x32_bf16 v[240:243], v[152:155], a[20:23], v[240:243]
s_waitcnt lgkmcnt(14)
ds_read_b64_tr_b16 v[124:125], v13 offset:16384
v_mfma_f32_16x16x32_bf16 v[244:247], v[156:159], a[12:15], v[244:247]
ds_read_b64_tr_b16 v[126:127], v13 offset:20480
v_mfma_f32_16x16x32_bf16 v[248:251], v[156:159], a[16:19], v[248:251]
buffer_load_dwordx4 a[84:87], v1, s[32:35], s15 offen sc1
v_mfma_f32_16x16x32_bf16 v[252:255], v[156:159], a[20:23], v[252:255]
s_waitcnt lgkmcnt(14)
ds_read_b64_tr_b16 v[96:97], v17 offset:32768
v_mfma_f32_16x16x32_bf16 v[160:163], v[128:131], a[132:135], v[160:163]
ds_read_b64_tr_b16 v[98:99], v17 offset:36864
v_mfma_f32_16x16x32_bf16 v[164:167], v[128:131], a[136:139], v[164:167]
ds_read_b64_tr_b16 v[100:101], v18 offset:32768
v_mfma_f32_16x16x32_bf16 v[168:171], v[128:131], a[140:143], v[168:171]
s_waitcnt lgkmcnt(15)
ds_read_b64_tr_b16 v[102:103], v18 offset:36864
v_mfma_f32_16x16x32_bf16 v[172:175], v[132:135], a[132:135], v[172:175]
buffer_load_dwordx4 a[88:91], v2, s[32:35], s15 offen sc1
v_mfma_f32_16x16x32_bf16 v[176:179], v[132:135], a[136:139], v[176:179]
ds_read_b64_tr_b16 v[104:105], v19 offset:32768
v_mfma_f32_16x16x32_bf16 v[180:183], v[132:135], a[140:143], v[180:183]
s_waitcnt lgkmcnt(15)
ds_read_b64_tr_b16 v[106:107], v19 offset:36864
v_mfma_f32_16x16x32_bf16 v[184:187], v[136:139], a[132:135], v[184:187]
ds_read_b64_tr_b16 v[108:109], v20 offset:32768
v_mfma_f32_16x16x32_bf16 v[188:191], v[136:139], a[136:139], v[188:191]
ds_read_b64_tr_b16 v[110:111], v20 offset:36864
v_mfma_f32_16x16x32_bf16 v[192:195], v[136:139], a[140:143], v[192:195]
s_waitcnt lgkmcnt(15)
buffer_load_dwordx4 a[92:95], v3, s[32:35], s15 offen sc1
v_mfma_f32_16x16x32_bf16 v[196:199], v[140:143], a[132:135], v[196:199]
v_mfma_f32_16x16x32_bf16 v[200:203], v[140:143], a[136:139], v[200:203]
v_mfma_f32_16x16x32_bf16 v[204:207], v[140:143], a[140:143], v[204:207]
s_waitcnt vmcnt(18)
s_barrier
s_waitcnt lgkmcnt(14)
v_mfma_f32_16x16x32_bf16 v[208:211], v[112:115], a[24:27], v[208:211]
s_add_u32 m0, s62, 65536
ds_read_b64_tr_b16 v[144:145], v10 offset:24576
v_mfma_f32_16x16x32_bf16 v[212:215], v[112:115], a[28:31], v[212:215]
buffer_load_dwordx4 v4, s[28:31], s71 offen lds
v_mfma_f32_16x16x32_bf16 v[216:219], v[112:115], a[32:35], v[216:219]
s_waitcnt lgkmcnt(13)
ds_read_b64_tr_b16 v[146:147], v10 offset:28672
v_mfma_f32_16x16x32_bf16 v[220:223], v[116:119], a[24:27], v[220:223]
ds_read_b64_tr_b16 v[148:149], v11 offset:24576
v_mfma_f32_16x16x32_bf16 v[224:227], v[116:119], a[28:31], v[224:227]
ds_read_b64_tr_b16 v[150:151], v11 offset:28672
v_mfma_f32_16x16x32_bf16 v[228:231], v[116:119], a[32:35], v[228:231]
s_waitcnt lgkmcnt(14)
buffer_load_dwordx4 v5, s[28:31], s71 offen offset:1024 lds
v_mfma_f32_16x16x32_bf16 v[232:235], v[120:123], a[24:27], v[232:235]
ds_read_b64_tr_b16 v[152:153], v12 offset:24576
v_mfma_f32_16x16x32_bf16 v[236:239], v[120:123], a[28:31], v[236:239]
ds_read_b64_tr_b16 v[154:155], v12 offset:28672
v_mfma_f32_16x16x32_bf16 v[240:243], v[120:123], a[32:35], v[240:243]
s_waitcnt lgkmcnt(14)
ds_read_b64_tr_b16 v[156:157], v13 offset:24576
v_mfma_f32_16x16x32_bf16 v[244:247], v[124:127], a[24:27], v[244:247]
ds_read_b64_tr_b16 v[158:159], v13 offset:28672
v_mfma_f32_16x16x32_bf16 v[248:251], v[124:127], a[28:31], v[248:251]
buffer_load_dwordx4 a[96:99], v1, s[32:35], s16 offen sc1
v_mfma_f32_16x16x32_bf16 v[252:255], v[124:127], a[32:35], v[252:255]
s_waitcnt lgkmcnt(14)
ds_read_b64_tr_b16 v[128:129], v17 offset:40960
v_mfma_f32_16x16x32_bf16 v[160:163], v[96:99], a[144:147], v[160:163]
ds_read_b64_tr_b16 v[130:131], v17 offset:45056
v_mfma_f32_16x16x32_bf16 v[164:167], v[96:99], a[148:151], v[164:167]
ds_read_b64_tr_b16 v[132:133], v18 offset:40960
v_mfma_f32_16x16x32_bf16 v[168:171], v[96:99], a[152:155], v[168:171]
s_waitcnt lgkmcnt(15)
ds_read_b64_tr_b16 v[134:135], v18 offset:45056
v_mfma_f32_16x16x32_bf16 v[172:175], v[100:103], a[144:147], v[172:175]
buffer_load_dwordx4 a[100:103], v2, s[32:35], s16 offen sc1
v_mfma_f32_16x16x32_bf16 v[176:179], v[100:103], a[148:151], v[176:179]
ds_read_b64_tr_b16 v[136:137], v19 offset:40960
v_mfma_f32_16x16x32_bf16 v[180:183], v[100:103], a[152:155], v[180:183]
s_waitcnt lgkmcnt(15)
ds_read_b64_tr_b16 v[138:139], v19 offset:45056
v_mfma_f32_16x16x32_bf16 v[184:187], v[104:107], a[144:147], v[184:187]
ds_read_b64_tr_b16 v[140:141], v20 offset:40960
v_mfma_f32_16x16x32_bf16 v[188:191], v[104:107], a[148:151], v[188:191]
ds_read_b64_tr_b16 v[142:143], v20 offset:45056
v_mfma_f32_16x16x32_bf16 v[192:195], v[104:107], a[152:155], v[192:195]
s_waitcnt lgkmcnt(15)
buffer_load_dwordx4 a[104:107], v3, s[32:35], s16 offen sc1
v_mfma_f32_16x16x32_bf16 v[196:199], v[108:111], a[144:147], v[196:199]
v_mfma_f32_16x16x32_bf16 v[200:203], v[108:111], a[148:151], v[200:203]
v_mfma_f32_16x16x32_bf16 v[204:207], v[108:111], a[152:155], v[204:207]
s_waitcnt lgkmcnt(14)
v_mfma_f32_16x16x32_bf16 v[208:211], v[144:147], a[36:39], v[208:211]
s_add_u32 m0, s62, 73728
ds_read_b64_tr_b16 v[112:113], v10 offset:32768
v_mfma_f32_16x16x32_bf16 v[212:215], v[144:147], a[40:43], v[212:215]
buffer_load_dwordx4 v4, s[28:31], s79 offen lds
v_mfma_f32_16x16x32_bf16 v[216:219], v[144:147], a[44:47], v[216:219]
s_waitcnt lgkmcnt(13)
ds_read_b64_tr_b16 v[114:115], v10 offset:36864
v_mfma_f32_16x16x32_bf16 v[220:223], v[148:151], a[36:39], v[220:223]
ds_read_b64_tr_b16 v[116:117], v11 offset:32768
v_mfma_f32_16x16x32_bf16 v[224:227], v[148:151], a[40:43], v[224:227]
ds_read_b64_tr_b16 v[118:119], v11 offset:36864
v_mfma_f32_16x16x32_bf16 v[228:231], v[148:151], a[44:47], v[228:231]
s_waitcnt lgkmcnt(14)
buffer_load_dwordx4 v5, s[28:31], s79 offen offset:1024 lds
v_mfma_f32_16x16x32_bf16 v[232:235], v[152:155], a[36:39], v[232:235]
ds_read_b64_tr_b16 v[120:121], v12 offset:32768
v_mfma_f32_16x16x32_bf16 v[236:239], v[152:155], a[40:43], v[236:239]
ds_read_b64_tr_b16 v[122:123], v12 offset:36864
v_mfma_f32_16x16x32_bf16 v[240:243], v[152:155], a[44:47], v[240:243]
s_waitcnt lgkmcnt(14)
ds_read_b64_tr_b16 v[124:125], v13 offset:32768
v_mfma_f32_16x16x32_bf16 v[244:247], v[156:159], a[36:39], v[244:247]
ds_read_b64_tr_b16 v[126:127], v13 offset:36864
v_mfma_f32_16x16x32_bf16 v[248:251], v[156:159], a[40:43], v[248:251]
buffer_load_dwordx4 a[108:111], v1, s[32:35], s17 offen sc1
v_mfma_f32_16x16x32_bf16 v[252:255], v[156:159], a[44:47], v[252:255]
s_waitcnt lgkmcnt(14)
ds_read_b64_tr_b16 v[96:97], v17 offset:49152
v_mfma_f32_16x16x32_bf16 v[160:163], v[128:131], a[156:159], v[160:163]
ds_read_b64_tr_b16 v[98:99], v17 offset:53248
v_mfma_f32_16x16x32_bf16 v[164:167], v[128:131], a[160:163], v[164:167]
ds_read_b64_tr_b16 v[100:101], v18 offset:49152
v_mfma_f32_16x16x32_bf16 v[168:171], v[128:131], a[164:167], v[168:171]
s_waitcnt lgkmcnt(15)
ds_read_b64_tr_b16 v[102:103], v18 offset:53248
v_mfma_f32_16x16x32_bf16 v[172:175], v[132:135], a[156:159], v[172:175]
buffer_load_dwordx4 a[112:115], v2, s[32:35], s17 offen sc1
v_mfma_f32_16x16x32_bf16 v[176:179], v[132:135], a[160:163], v[176:179]
ds_read_b64_tr_b16 v[104:105], v19 offset:49152
v_mfma_f32_16x16x32_bf16 v[180:183], v[132:135], a[164:167], v[180:183]
s_waitcnt lgkmcnt(15)
ds_read_b64_tr_b16 v[106:107], v19 offset:53248
v_mfma_f32_16x16x32_bf16 v[184:187], v[136:139], a[156:159], v[184:187]
ds_read_b64_tr_b16 v[108:109], v20 offset:49152
v_mfma_f32_16x16x32_bf16 v[188:191], v[136:139], a[160:163], v[188:191]
ds_read_b64_tr_b16 v[110:111], v20 offset:53248
v_mfma_f32_16x16x32_bf16 v[192:195], v[136:139], a[164:167], v[192:195]
s_waitcnt lgkmcnt(15)
buffer_load_dwordx4 a[116:119], v3, s[32:35], s17 offen sc1
v_mfma_f32_16x16x32_bf16 v[196:199], v[140:143], a[156:159], v[196:199]
v_mfma_f32_16x16x32_bf16 v[200:203], v[140:143], a[160:163], v[200:203]
v_mfma_f32_16x16x32_bf16 v[204:207], v[140:143], a[164:167], v[204:207]
s_waitcnt vmcnt(18)
s_barrier
s_waitcnt lgkmcnt(14)
v_mfma_f32_16x16x32_bf16 v[208:211], v[112:115], a[48:51], v[208:211]
s_add_u32 m0, s62, 81920
ds_read_b64_tr_b16 v[144:145], v10 offset:40960
v_mfma_f32_16x16x32_bf16 v[212:215], v[112:115], a[52:55], v[212:215]
buffer_load_dwordx4 v4, s[28:31], s80 offen lds
v_mfma_f32_16x16x32_bf16 v[216:219], v[112:115], a[56:59], v[216:219]
s_waitcnt lgkmcnt(13)
ds_read_b64_tr_b16 v[146:147], v10 offset:45056
v_mfma_f32_16x16x32_bf16 v[220:223], v[116:119], a[48:51], v[220:223]
ds_read_b64_tr_b16 v[148:149], v11 offset:40960
v_mfma_f32_16x16x32_bf16 v[224:227], v[116:119], a[52:55], v[224:227]
ds_read_b64_tr_b16 v[150:151], v11 offset:45056
v_mfma_f32_16x16x32_bf16 v[228:231], v[116:119], a[56:59], v[228:231]
s_waitcnt lgkmcnt(14)
buffer_load_dwordx4 v5, s[28:31], s80 offen offset:1024 lds
v_mfma_f32_16x16x32_bf16 v[232:235], v[120:123], a[48:51], v[232:235]
ds_read_b64_tr_b16 v[152:153], v12 offset:40960
v_mfma_f32_16x16x32_bf16 v[236:239], v[120:123], a[52:55], v[236:239]
ds_read_b64_tr_b16 v[154:155], v12 offset:45056
v_mfma_f32_16x16x32_bf16 v[240:243], v[120:123], a[56:59], v[240:243]
s_waitcnt lgkmcnt(14)
ds_read_b64_tr_b16 v[156:157], v13 offset:40960
v_mfma_f32_16x16x32_bf16 v[244:247], v[124:127], a[48:51], v[244:247]
ds_read_b64_tr_b16 v[158:159], v13 offset:45056
v_mfma_f32_16x16x32_bf16 v[248:251], v[124:127], a[52:55], v[248:251]
buffer_load_dwordx4 a[120:123], v1, s[32:35], s18 offen sc1
v_mfma_f32_16x16x32_bf16 v[252:255], v[124:127], a[56:59], v[252:255]
s_waitcnt lgkmcnt(14)
ds_read_b64_tr_b16 v[128:129], v17 offset:57344
v_mfma_f32_16x16x32_bf16 v[160:163], v[96:99], a[168:171], v[160:163]
ds_read_b64_tr_b16 v[130:131], v17 offset:61440
v_mfma_f32_16x16x32_bf16 v[164:167], v[96:99], a[172:175], v[164:167]
ds_read_b64_tr_b16 v[132:133], v18 offset:57344
v_mfma_f32_16x16x32_bf16 v[168:171], v[96:99], a[176:179], v[168:171]
s_waitcnt lgkmcnt(15)
ds_read_b64_tr_b16 v[134:135], v18 offset:61440
v_mfma_f32_16x16x32_bf16 v[172:175], v[100:103], a[168:171], v[172:175]
buffer_load_dwordx4 a[124:127], v2, s[32:35], s18 offen sc1
v_mfma_f32_16x16x32_bf16 v[176:179], v[100:103], a[172:175], v[176:179]
ds_read_b64_tr_b16 v[136:137], v19 offset:57344
v_mfma_f32_16x16x32_bf16 v[180:183], v[100:103], a[176:179], v[180:183]
s_waitcnt lgkmcnt(15)
ds_read_b64_tr_b16 v[138:139], v19 offset:61440
v_mfma_f32_16x16x32_bf16 v[184:187], v[104:107], a[168:171], v[184:187]
ds_read_b64_tr_b16 v[140:141], v20 offset:57344
v_mfma_f32_16x16x32_bf16 v[188:191], v[104:107], a[172:175], v[188:191]
ds_read_b64_tr_b16 v[142:143], v20 offset:61440
v_mfma_f32_16x16x32_bf16 v[192:195], v[104:107], a[176:179], v[192:195]
s_waitcnt lgkmcnt(15)
buffer_load_dwordx4 a[128:131], v3, s[32:35], s18 offen sc1
v_mfma_f32_16x16x32_bf16 v[196:199], v[108:111], a[168:171], v[196:199]
v_mfma_f32_16x16x32_bf16 v[200:203], v[108:111], a[172:175], v[200:203]
v_mfma_f32_16x16x32_bf16 v[204:207], v[108:111], a[176:179], v[204:207]
s_waitcnt lgkmcnt(14)
v_mfma_f32_16x16x32_bf16 v[208:211], v[144:147], a[60:63], v[208:211]
s_add_u32 m0, s62, 90112
ds_read_b64_tr_b16 v[112:113], v10 offset:49152
v_mfma_f32_16x16x32_bf16 v[212:215], v[144:147], a[64:67], v[212:215]
buffer_load_dwordx4 v4, s[28:31], s81 offen lds
v_mfma_f32_16x16x32_bf16 v[216:219], v[144:147], a[68:71], v[216:219]
s_waitcnt lgkmcnt(13)
ds_read_b64_tr_b16 v[114:115], v10 offset:53248
v_mfma_f32_16x16x32_bf16 v[220:223], v[148:151], a[60:63], v[220:223]
ds_read_b64_tr_b16 v[116:117], v11 offset:49152
v_mfma_f32_16x16x32_bf16 v[224:227], v[148:151], a[64:67], v[224:227]
ds_read_b64_tr_b16 v[118:119], v11 offset:53248
v_mfma_f32_16x16x32_bf16 v[228:231], v[148:151], a[68:71], v[228:231]
s_waitcnt lgkmcnt(14)
buffer_load_dwordx4 v5, s[28:31], s81 offen offset:1024 lds
v_mfma_f32_16x16x32_bf16 v[232:235], v[152:155], a[60:63], v[232:235]
ds_read_b64_tr_b16 v[120:121], v12 offset:49152
v_mfma_f32_16x16x32_bf16 v[236:239], v[152:155], a[64:67], v[236:239]
ds_read_b64_tr_b16 v[122:123], v12 offset:53248
v_mfma_f32_16x16x32_bf16 v[240:243], v[152:155], a[68:71], v[240:243]
s_waitcnt lgkmcnt(14)
ds_read_b64_tr_b16 v[124:125], v13 offset:49152
v_mfma_f32_16x16x32_bf16 v[244:247], v[156:159], a[60:63], v[244:247]
ds_read_b64_tr_b16 v[126:127], v13 offset:53248
v_mfma_f32_16x16x32_bf16 v[248:251], v[156:159], a[64:67], v[248:251]
buffer_load_dwordx4 a[132:135], v1, s[32:35], s19 offen sc1
v_mfma_f32_16x16x32_bf16 v[252:255], v[156:159], a[68:71], v[252:255]
s_waitcnt lgkmcnt(14)
ds_read_b64_tr_b16 v[96:97], v28
v_mfma_f32_16x16x32_bf16 v[160:163], v[128:131], a[180:183], v[160:163]
ds_read_b64_tr_b16 v[98:99], v28 offset:4096
v_mfma_f32_16x16x32_bf16 v[164:167], v[128:131], a[184:187], v[164:167]
ds_read_b64_tr_b16 v[100:101], v29
v_mfma_f32_16x16x32_bf16 v[168:171], v[128:131], a[188:191], v[168:171]
s_waitcnt lgkmcnt(15)
ds_read_b64_tr_b16 v[102:103], v29 offset:4096
v_mfma_f32_16x16x32_bf16 v[172:175], v[132:135], a[180:183], v[172:175]
buffer_load_dwordx4 a[136:139], v2, s[32:35], s19 offen sc1
v_mfma_f32_16x16x32_bf16 v[176:179], v[132:135], a[184:187], v[176:179]
ds_read_b64_tr_b16 v[104:105], v30
v_mfma_f32_16x16x32_bf16 v[180:183], v[132:135], a[188:191], v[180:183]
s_waitcnt lgkmcnt(15)
ds_read_b64_tr_b16 v[106:107], v30 offset:4096
v_mfma_f32_16x16x32_bf16 v[184:187], v[136:139], a[180:183], v[184:187]
ds_read_b64_tr_b16 v[108:109], v31
v_mfma_f32_16x16x32_bf16 v[188:191], v[136:139], a[184:187], v[188:191]
ds_read_b64_tr_b16 v[110:111], v31 offset:4096
v_mfma_f32_16x16x32_bf16 v[192:195], v[136:139], a[188:191], v[192:195]
s_waitcnt lgkmcnt(15)
buffer_load_dwordx4 a[140:143], v3, s[32:35], s19 offen sc1
v_mfma_f32_16x16x32_bf16 v[196:199], v[140:143], a[180:183], v[196:199]
v_mfma_f32_16x16x32_bf16 v[200:203], v[140:143], a[184:187], v[200:203]
v_mfma_f32_16x16x32_bf16 v[204:207], v[140:143], a[188:191], v[204:207]
s_waitcnt vmcnt(18)
s_barrier
s_waitcnt lgkmcnt(14)
v_mfma_f32_16x16x32_bf16 v[208:211], v[112:115], a[72:75], v[208:211]
s_add_u32 m0, s62, 98304
ds_read_b64_tr_b16 v[144:145], v10 offset:57344
v_mfma_f32_16x16x32_bf16 v[212:215], v[112:115], a[76:79], v[212:215]
buffer_load_dwordx4 v4, s[28:31], s82 offen lds
v_mfma_f32_16x16x32_bf16 v[216:219], v[112:115], a[80:83], v[216:219]
s_waitcnt lgkmcnt(13)
ds_read_b64_tr_b16 v[146:147], v10 offset:61440
v_mfma_f32_16x16x32_bf16 v[220:223], v[116:119], a[72:75], v[220:223]
ds_read_b64_tr_b16 v[148:149], v11 offset:57344
v_mfma_f32_16x16x32_bf16 v[224:227], v[116:119], a[76:79], v[224:227]
ds_read_b64_tr_b16 v[150:151], v11 offset:61440
v_mfma_f32_16x16x32_bf16 v[228:231], v[116:119], a[80:83], v[228:231]
s_waitcnt lgkmcnt(14)
buffer_load_dwordx4 v5, s[28:31], s82 offen offset:1024 lds
v_mfma_f32_16x16x32_bf16 v[232:235], v[120:123], a[72:75], v[232:235]
ds_read_b64_tr_b16 v[152:153], v12 offset:57344
v_mfma_f32_16x16x32_bf16 v[236:239], v[120:123], a[76:79], v[236:239]
ds_read_b64_tr_b16 v[154:155], v12 offset:61440
v_mfma_f32_16x16x32_bf16 v[240:243], v[120:123], a[80:83], v[240:243]
s_waitcnt lgkmcnt(14)
ds_read_b64_tr_b16 v[156:157], v13 offset:57344
v_mfma_f32_16x16x32_bf16 v[244:247], v[124:127], a[72:75], v[244:247]
ds_read_b64_tr_b16 v[158:159], v13 offset:61440
v_mfma_f32_16x16x32_bf16 v[248:251], v[124:127], a[76:79], v[248:251]
buffer_load_dwordx4 a[144:147], v1, s[32:35], s20 offen sc1
v_mfma_f32_16x16x32_bf16 v[252:255], v[124:127], a[80:83], v[252:255]
s_waitcnt lgkmcnt(14)
ds_read_b64_tr_b16 v[128:129], v28 offset:8192
v_mfma_f32_16x16x32_bf16 v[160:163], v[96:99], a[192:195], v[160:163]
ds_read_b64_tr_b16 v[130:131], v28 offset:12288
v_mfma_f32_16x16x32_bf16 v[164:167], v[96:99], a[196:199], v[164:167]
ds_read_b64_tr_b16 v[132:133], v29 offset:8192
v_mfma_f32_16x16x32_bf16 v[168:171], v[96:99], a[200:203], v[168:171]
s_waitcnt lgkmcnt(15)
ds_read_b64_tr_b16 v[134:135], v29 offset:12288
v_mfma_f32_16x16x32_bf16 v[172:175], v[100:103], a[192:195], v[172:175]
buffer_load_dwordx4 a[148:151], v2, s[32:35], s20 offen sc1
v_mfma_f32_16x16x32_bf16 v[176:179], v[100:103], a[196:199], v[176:179]
ds_read_b64_tr_b16 v[136:137], v30 offset:8192
v_mfma_f32_16x16x32_bf16 v[180:183], v[100:103], a[200:203], v[180:183]
s_waitcnt lgkmcnt(15)
ds_read_b64_tr_b16 v[138:139], v30 offset:12288
v_mfma_f32_16x16x32_bf16 v[184:187], v[104:107], a[192:195], v[184:187]
ds_read_b64_tr_b16 v[140:141], v31 offset:8192
v_mfma_f32_16x16x32_bf16 v[188:191], v[104:107], a[196:199], v[188:191]
ds_read_b64_tr_b16 v[142:143], v31 offset:12288
v_mfma_f32_16x16x32_bf16 v[192:195], v[104:107], a[200:203], v[192:195]
s_waitcnt lgkmcnt(15)
buffer_load_dwordx4 a[152:155], v3, s[32:35], s20 offen sc1
v_mfma_f32_16x16x32_bf16 v[196:199], v[108:111], a[192:195], v[196:199]
v_mfma_f32_16x16x32_bf16 v[200:203], v[108:111], a[196:199], v[200:203]
v_mfma_f32_16x16x32_bf16 v[204:207], v[108:111], a[200:203], v[204:207]
s_waitcnt lgkmcnt(14)
v_mfma_f32_16x16x32_bf16 v[208:211], v[144:147], a[84:87], v[208:211]
s_add_u32 m0, s62, 106496
ds_read_b64_tr_b16 v[112:113], v21
v_mfma_f32_16x16x32_bf16 v[212:215], v[144:147], a[88:91], v[212:215]
buffer_load_dwordx4 v4, s[28:31], s83 offen lds
v_mfma_f32_16x16x32_bf16 v[216:219], v[144:147], a[92:95], v[216:219]
s_waitcnt lgkmcnt(13)
ds_read_b64_tr_b16 v[114:115], v21 offset:4096
v_mfma_f32_16x16x32_bf16 v[220:223], v[148:151], a[84:87], v[220:223]
ds_read_b64_tr_b16 v[116:117], v22
v_mfma_f32_16x16x32_bf16 v[224:227], v[148:151], a[88:91], v[224:227]
ds_read_b64_tr_b16 v[118:119], v22 offset:4096
v_mfma_f32_16x16x32_bf16 v[228:231], v[148:151], a[92:95], v[228:231]
s_waitcnt lgkmcnt(14)
buffer_load_dwordx4 v5, s[28:31], s83 offen offset:1024 lds
v_mfma_f32_16x16x32_bf16 v[232:235], v[152:155], a[84:87], v[232:235]
ds_read_b64_tr_b16 v[120:121], v23
v_mfma_f32_16x16x32_bf16 v[236:239], v[152:155], a[88:91], v[236:239]
ds_read_b64_tr_b16 v[122:123], v23 offset:4096
v_mfma_f32_16x16x32_bf16 v[240:243], v[152:155], a[92:95], v[240:243]
s_waitcnt lgkmcnt(14)
ds_read_b64_tr_b16 v[124:125], v24
v_mfma_f32_16x16x32_bf16 v[244:247], v[156:159], a[84:87], v[244:247]
ds_read_b64_tr_b16 v[126:127], v24 offset:4096
v_mfma_f32_16x16x32_bf16 v[248:251], v[156:159], a[88:91], v[248:251]
buffer_load_dwordx4 a[156:159], v1, s[32:35], s22 offen sc1
v_mfma_f32_16x16x32_bf16 v[252:255], v[156:159], a[92:95], v[252:255]
s_waitcnt lgkmcnt(14)
ds_read_b64_tr_b16 v[96:97], v28 offset:16384
v_mfma_f32_16x16x32_bf16 v[160:163], v[128:131], a[204:207], v[160:163]
ds_read_b64_tr_b16 v[98:99], v28 offset:20480
v_mfma_f32_16x16x32_bf16 v[164:167], v[128:131], a[208:211], v[164:167]
ds_read_b64_tr_b16 v[100:101], v29 offset:16384
v_mfma_f32_16x16x32_bf16 v[168:171], v[128:131], a[212:215], v[168:171]
s_waitcnt lgkmcnt(15)
ds_read_b64_tr_b16 v[102:103], v29 offset:20480
v_mfma_f32_16x16x32_bf16 v[172:175], v[132:135], a[204:207], v[172:175]
buffer_load_dwordx4 a[160:163], v2, s[32:35], s22 offen sc1
v_mfma_f32_16x16x32_bf16 v[176:179], v[132:135], a[208:211], v[176:179]
ds_read_b64_tr_b16 v[104:105], v30 offset:16384
v_mfma_f32_16x16x32_bf16 v[180:183], v[132:135], a[212:215], v[180:183]
s_waitcnt lgkmcnt(15)
ds_read_b64_tr_b16 v[106:107], v30 offset:20480
v_mfma_f32_16x16x32_bf16 v[184:187], v[136:139], a[204:207], v[184:187]
ds_read_b64_tr_b16 v[108:109], v31 offset:16384
v_mfma_f32_16x16x32_bf16 v[188:191], v[136:139], a[208:211], v[188:191]
ds_read_b64_tr_b16 v[110:111], v31 offset:20480
v_mfma_f32_16x16x32_bf16 v[192:195], v[136:139], a[212:215], v[192:195]
s_waitcnt lgkmcnt(15)
buffer_load_dwordx4 a[164:167], v3, s[32:35], s22 offen sc1
v_mfma_f32_16x16x32_bf16 v[196:199], v[140:143], a[204:207], v[196:199]
v_mfma_f32_16x16x32_bf16 v[200:203], v[140:143], a[208:211], v[200:203]
v_mfma_f32_16x16x32_bf16 v[204:207], v[140:143], a[212:215], v[204:207]
s_waitcnt vmcnt(18)
s_barrier
s_waitcnt lgkmcnt(14)
v_mfma_f32_16x16x32_bf16 v[208:211], v[112:115], a[96:99], v[208:211]
s_add_u32 m0, s62, 114688
ds_read_b64_tr_b16 v[144:145], v21 offset:8192
v_mfma_f32_16x16x32_bf16 v[212:215], v[112:115], a[100:103], v[212:215]
buffer_load_dwordx4 v4, s[28:31], s25 offen lds
v_mfma_f32_16x16x32_bf16 v[216:219], v[112:115], a[104:107], v[216:219]
s_waitcnt lgkmcnt(13)
ds_read_b64_tr_b16 v[146:147], v21 offset:12288
v_mfma_f32_16x16x32_bf16 v[220:223], v[116:119], a[96:99], v[220:223]
ds_read_b64_tr_b16 v[148:149], v22 offset:8192
v_mfma_f32_16x16x32_bf16 v[224:227], v[116:119], a[100:103], v[224:227]
ds_read_b64_tr_b16 v[150:151], v22 offset:12288
v_mfma_f32_16x16x32_bf16 v[228:231], v[116:119], a[104:107], v[228:231]
s_waitcnt lgkmcnt(14)
buffer_load_dwordx4 v5, s[28:31], s25 offen offset:1024 lds
v_mfma_f32_16x16x32_bf16 v[232:235], v[120:123], a[96:99], v[232:235]
ds_read_b64_tr_b16 v[152:153], v23 offset:8192
v_mfma_f32_16x16x32_bf16 v[236:239], v[120:123], a[100:103], v[236:239]
ds_read_b64_tr_b16 v[154:155], v23 offset:12288
v_mfma_f32_16x16x32_bf16 v[240:243], v[120:123], a[104:107], v[240:243]
s_waitcnt lgkmcnt(14)
ds_read_b64_tr_b16 v[156:157], v24 offset:8192
v_mfma_f32_16x16x32_bf16 v[244:247], v[124:127], a[96:99], v[244:247]
ds_read_b64_tr_b16 v[158:159], v24 offset:12288
v_mfma_f32_16x16x32_bf16 v[248:251], v[124:127], a[100:103], v[248:251]
buffer_load_dwordx4 a[168:171], v1, s[32:35], s23 offen sc1
v_mfma_f32_16x16x32_bf16 v[252:255], v[124:127], a[104:107], v[252:255]
s_waitcnt lgkmcnt(14)
ds_read_b64_tr_b16 v[128:129], v28 offset:24576
v_mfma_f32_16x16x32_bf16 v[160:163], v[96:99], a[216:219], v[160:163]
ds_read_b64_tr_b16 v[130:131], v28 offset:28672
v_mfma_f32_16x16x32_bf16 v[164:167], v[96:99], a[220:223], v[164:167]
ds_read_b64_tr_b16 v[132:133], v29 offset:24576
v_mfma_f32_16x16x32_bf16 v[168:171], v[96:99], a[224:227], v[168:171]
s_waitcnt lgkmcnt(15)
ds_read_b64_tr_b16 v[134:135], v29 offset:28672
v_mfma_f32_16x16x32_bf16 v[172:175], v[100:103], a[216:219], v[172:175]
buffer_load_dwordx4 a[172:175], v2, s[32:35], s23 offen sc1
v_mfma_f32_16x16x32_bf16 v[176:179], v[100:103], a[220:223], v[176:179]
ds_read_b64_tr_b16 v[136:137], v30 offset:24576
v_mfma_f32_16x16x32_bf16 v[180:183], v[100:103], a[224:227], v[180:183]
s_waitcnt lgkmcnt(15)
ds_read_b64_tr_b16 v[138:139], v30 offset:28672
v_mfma_f32_16x16x32_bf16 v[184:187], v[104:107], a[216:219], v[184:187]
ds_read_b64_tr_b16 v[140:141], v31 offset:24576
v_mfma_f32_16x16x32_bf16 v[188:191], v[104:107], a[220:223], v[188:191]
ds_read_b64_tr_b16 v[142:143], v31 offset:28672
v_mfma_f32_16x16x32_bf16 v[192:195], v[104:107], a[224:227], v[192:195]
s_waitcnt lgkmcnt(15)
buffer_load_dwordx4 a[176:179], v3, s[32:35], s23 offen sc1
v_mfma_f32_16x16x32_bf16 v[196:199], v[108:111], a[216:219], v[196:199]
v_mfma_f32_16x16x32_bf16 v[200:203], v[108:111], a[220:223], v[200:203]
v_mfma_f32_16x16x32_bf16 v[204:207], v[108:111], a[224:227], v[204:207]
s_waitcnt lgkmcnt(14)
v_mfma_f32_16x16x32_bf16 v[208:211], v[144:147], a[108:111], v[208:211]
s_add_u32 m0, s62, 122880
ds_read_b64_tr_b16 v[112:113], v21 offset:16384
v_mfma_f32_16x16x32_bf16 v[212:215], v[144:147], a[112:115], v[212:215]
buffer_load_dwordx4 v4, s[28:31], s49 offen lds
v_mfma_f32_16x16x32_bf16 v[216:219], v[144:147], a[116:119], v[216:219]
s_waitcnt lgkmcnt(13)
ds_read_b64_tr_b16 v[114:115], v21 offset:20480
v_mfma_f32_16x16x32_bf16 v[220:223], v[148:151], a[108:111], v[220:223]
ds_read_b64_tr_b16 v[116:117], v22 offset:16384
v_mfma_f32_16x16x32_bf16 v[224:227], v[148:151], a[112:115], v[224:227]
ds_read_b64_tr_b16 v[118:119], v22 offset:20480
v_mfma_f32_16x16x32_bf16 v[228:231], v[148:151], a[116:119], v[228:231]
s_waitcnt lgkmcnt(14)
buffer_load_dwordx4 v5, s[28:31], s49 offen offset:1024 lds
v_mfma_f32_16x16x32_bf16 v[232:235], v[152:155], a[108:111], v[232:235]
ds_read_b64_tr_b16 v[120:121], v23 offset:16384
v_mfma_f32_16x16x32_bf16 v[236:239], v[152:155], a[112:115], v[236:239]
ds_read_b64_tr_b16 v[122:123], v23 offset:20480
v_mfma_f32_16x16x32_bf16 v[240:243], v[152:155], a[116:119], v[240:243]
s_waitcnt lgkmcnt(14)
ds_read_b64_tr_b16 v[124:125], v24 offset:16384
v_mfma_f32_16x16x32_bf16 v[244:247], v[156:159], a[108:111], v[244:247]
ds_read_b64_tr_b16 v[126:127], v24 offset:20480
v_mfma_f32_16x16x32_bf16 v[248:251], v[156:159], a[112:115], v[248:251]
buffer_load_dwordx4 a[180:183], v1, s[32:35], s24 offen sc1
v_mfma_f32_16x16x32_bf16 v[252:255], v[156:159], a[116:119], v[252:255]
s_waitcnt lgkmcnt(14)
ds_read_b64_tr_b16 v[96:97], v6
v_mfma_f32_16x16x32_bf16 v[160:163], v[128:131], a[228:231], v[160:163]
ds_read_b64_tr_b16 v[98:99], v6 offset:4096
v_mfma_f32_16x16x32_bf16 v[164:167], v[128:131], a[232:235], v[164:167]
ds_read_b64_tr_b16 v[100:101], v7
v_mfma_f32_16x16x32_bf16 v[168:171], v[128:131], a[236:239], v[168:171]
s_waitcnt lgkmcnt(15)
ds_read_b64_tr_b16 v[102:103], v7 offset:4096
v_mfma_f32_16x16x32_bf16 v[172:175], v[132:135], a[228:231], v[172:175]
buffer_load_dwordx4 a[184:187], v2, s[32:35], s24 offen sc1
v_mfma_f32_16x16x32_bf16 v[176:179], v[132:135], a[232:235], v[176:179]
ds_read_b64_tr_b16 v[104:105], v8
v_mfma_f32_16x16x32_bf16 v[180:183], v[132:135], a[236:239], v[180:183]
s_waitcnt lgkmcnt(15)
ds_read_b64_tr_b16 v[106:107], v8 offset:4096
v_mfma_f32_16x16x32_bf16 v[184:187], v[136:139], a[228:231], v[184:187]
ds_read_b64_tr_b16 v[108:109], v9
v_mfma_f32_16x16x32_bf16 v[188:191], v[136:139], a[232:235], v[188:191]
ds_read_b64_tr_b16 v[110:111], v9 offset:4096
v_mfma_f32_16x16x32_bf16 v[192:195], v[136:139], a[236:239], v[192:195]
s_waitcnt lgkmcnt(15)
buffer_load_dwordx4 a[188:191], v3, s[32:35], s24 offen sc1
v_mfma_f32_16x16x32_bf16 v[196:199], v[140:143], a[228:231], v[196:199]
v_mfma_f32_16x16x32_bf16 v[200:203], v[140:143], a[232:235], v[200:203]
v_mfma_f32_16x16x32_bf16 v[204:207], v[140:143], a[236:239], v[204:207]
s_waitcnt vmcnt(18)
s_barrier
s_waitcnt lgkmcnt(14)
v_mfma_f32_16x16x32_bf16 v[208:211], v[112:115], a[120:123], v[208:211]
ds_read_b64_tr_b16 v[144:145], v21 offset:24576
v_mfma_f32_16x16x32_bf16 v[212:215], v[112:115], a[124:127], v[212:215]
s_add_u32 s28, s28, 491520
s_addc_u32 s29, s29, 0
s_sub_u32 s30, s30, 491520
s_add_u32 s32, s32, 110592
s_addc_u32 s33, s33, 0
s_sub_u32 s34, s34, 110592
s_add_u32 m0, s62, 131072
s_nop 0
buffer_load_dwordx4 v4, s[28:31], s60 offen lds
v_mfma_f32_16x16x32_bf16 v[216:219], v[112:115], a[128:131], v[216:219]
s_waitcnt lgkmcnt(13)
ds_read_b64_tr_b16 v[146:147], v21 offset:28672
v_mfma_f32_16x16x32_bf16 v[220:223], v[116:119], a[120:123], v[220:223]
ds_read_b64_tr_b16 v[148:149], v22 offset:24576
v_mfma_f32_16x16x32_bf16 v[224:227], v[116:119], a[124:127], v[224:227]
ds_read_b64_tr_b16 v[150:151], v22 offset:28672
v_mfma_f32_16x16x32_bf16 v[228:231], v[116:119], a[128:131], v[228:231]
s_waitcnt lgkmcnt(14)
buffer_load_dwordx4 v5, s[28:31], s60 offen offset:1024 lds
v_mfma_f32_16x16x32_bf16 v[232:235], v[120:123], a[120:123], v[232:235]
ds_read_b64_tr_b16 v[152:153], v23 offset:24576
v_mfma_f32_16x16x32_bf16 v[236:239], v[120:123], a[124:127], v[236:239]
ds_read_b64_tr_b16 v[154:155], v23 offset:28672
v_mfma_f32_16x16x32_bf16 v[240:243], v[120:123], a[128:131], v[240:243]
s_waitcnt lgkmcnt(14)
ds_read_b64_tr_b16 v[156:157], v24 offset:24576
v_mfma_f32_16x16x32_bf16 v[244:247], v[124:127], a[120:123], v[244:247]
ds_read_b64_tr_b16 v[158:159], v24 offset:28672
v_mfma_f32_16x16x32_bf16 v[248:251], v[124:127], a[124:127], v[248:251]
buffer_load_dwordx4 a[192:195], v1, s[32:35], s12 offen sc1
v_mfma_f32_16x16x32_bf16 v[252:255], v[124:127], a[128:131], v[252:255]
s_waitcnt lgkmcnt(14)
ds_read_b64_tr_b16 v[128:129], v6 offset:8192
v_mfma_f32_16x16x32_bf16 v[160:163], v[96:99], a[0:3], v[160:163]
ds_read_b64_tr_b16 v[130:131], v6 offset:12288
v_mfma_f32_16x16x32_bf16 v[164:167], v[96:99], a[4:7], v[164:167]
ds_read_b64_tr_b16 v[132:133], v7 offset:8192
v_mfma_f32_16x16x32_bf16 v[168:171], v[96:99], a[8:11], v[168:171]
s_waitcnt lgkmcnt(15)
ds_read_b64_tr_b16 v[134:135], v7 offset:12288
v_mfma_f32_16x16x32_bf16 v[172:175], v[100:103], a[0:3], v[172:175]
buffer_load_dwordx4 a[196:199], v2, s[32:35], s12 offen sc1
v_mfma_f32_16x16x32_bf16 v[176:179], v[100:103], a[4:7], v[176:179]
ds_read_b64_tr_b16 v[136:137], v8 offset:8192
v_mfma_f32_16x16x32_bf16 v[180:183], v[100:103], a[8:11], v[180:183]
s_waitcnt lgkmcnt(15)
ds_read_b64_tr_b16 v[138:139], v8 offset:12288
v_mfma_f32_16x16x32_bf16 v[184:187], v[104:107], a[0:3], v[184:187]
ds_read_b64_tr_b16 v[140:141], v9 offset:8192
v_mfma_f32_16x16x32_bf16 v[188:191], v[104:107], a[4:7], v[188:191]
ds_read_b64_tr_b16 v[142:143], v9 offset:12288
v_mfma_f32_16x16x32_bf16 v[192:195], v[104:107], a[8:11], v[192:195]
s_waitcnt lgkmcnt(15)
buffer_load_dwordx4 a[200:203], v3, s[32:35], s12 offen sc1
v_mfma_f32_16x16x32_bf16 v[196:199], v[108:111], a[0:3], v[196:199]
v_mfma_f32_16x16x32_bf16 v[200:203], v[108:111], a[4:7], v[200:203]
v_mfma_f32_16x16x32_bf16 v[204:207], v[108:111], a[8:11], v[204:207]
s_waitcnt lgkmcnt(14)
v_mfma_f32_16x16x32_bf16 v[208:211], v[144:147], a[132:135], v[208:211]
s_add_u32 m0, s62, 139264
ds_read_b64_tr_b16 v[112:113], v21 offset:32768
v_mfma_f32_16x16x32_bf16 v[212:215], v[144:147], a[136:139], v[212:215]
buffer_load_dwordx4 v4, s[28:31], s61 offen lds
v_mfma_f32_16x16x32_bf16 v[216:219], v[144:147], a[140:143], v[216:219]
s_waitcnt lgkmcnt(13)
ds_read_b64_tr_b16 v[114:115], v21 offset:36864
v_mfma_f32_16x16x32_bf16 v[220:223], v[148:151], a[132:135], v[220:223]
ds_read_b64_tr_b16 v[116:117], v22 offset:32768
v_mfma_f32_16x16x32_bf16 v[224:227], v[148:151], a[136:139], v[224:227]
ds_read_b64_tr_b16 v[118:119], v22 offset:36864
v_mfma_f32_16x16x32_bf16 v[228:231], v[148:151], a[140:143], v[228:231]
s_waitcnt lgkmcnt(14)
buffer_load_dwordx4 v5, s[28:31], s61 offen offset:1024 lds
v_mfma_f32_16x16x32_bf16 v[232:235], v[152:155], a[132:135], v[232:235]
ds_read_b64_tr_b16 v[120:121], v23 offset:32768
v_mfma_f32_16x16x32_bf16 v[236:239], v[152:155], a[136:139], v[236:239]
ds_read_b64_tr_b16 v[122:123], v23 offset:36864
v_mfma_f32_16x16x32_bf16 v[240:243], v[152:155], a[140:143], v[240:243]
s_waitcnt lgkmcnt(14)
ds_read_b64_tr_b16 v[124:125], v24 offset:32768
v_mfma_f32_16x16x32_bf16 v[244:247], v[156:159], a[132:135], v[244:247]
ds_read_b64_tr_b16 v[126:127], v24 offset:36864
v_mfma_f32_16x16x32_bf16 v[248:251], v[156:159], a[136:139], v[248:251]
buffer_load_dwordx4 a[204:207], v1, s[32:35], s13 offen sc1
v_mfma_f32_16x16x32_bf16 v[252:255], v[156:159], a[140:143], v[252:255]
s_waitcnt lgkmcnt(14)
ds_read_b64_tr_b16 v[96:97], v6 offset:16384
v_mfma_f32_16x16x32_bf16 v[160:163], v[128:131], a[12:15], v[160:163]
ds_read_b64_tr_b16 v[98:99], v6 offset:20480
v_mfma_f32_16x16x32_bf16 v[164:167], v[128:131], a[16:19], v[164:167]
ds_read_b64_tr_b16 v[100:101], v7 offset:16384
v_mfma_f32_16x16x32_bf16 v[168:171], v[128:131], a[20:23], v[168:171]
s_waitcnt lgkmcnt(15)
ds_read_b64_tr_b16 v[102:103], v7 offset:20480
v_mfma_f32_16x16x32_bf16 v[172:175], v[132:135], a[12:15], v[172:175]
buffer_load_dwordx4 a[208:211], v2, s[32:35], s13 offen sc1
v_mfma_f32_16x16x32_bf16 v[176:179], v[132:135], a[16:19], v[176:179]
ds_read_b64_tr_b16 v[104:105], v8 offset:16384
v_mfma_f32_16x16x32_bf16 v[180:183], v[132:135], a[20:23], v[180:183]
s_waitcnt lgkmcnt(15)
ds_read_b64_tr_b16 v[106:107], v8 offset:20480
v_mfma_f32_16x16x32_bf16 v[184:187], v[136:139], a[12:15], v[184:187]
ds_read_b64_tr_b16 v[108:109], v9 offset:16384
v_mfma_f32_16x16x32_bf16 v[188:191], v[136:139], a[16:19], v[188:191]
ds_read_b64_tr_b16 v[110:111], v9 offset:20480
v_mfma_f32_16x16x32_bf16 v[192:195], v[136:139], a[20:23], v[192:195]
s_waitcnt lgkmcnt(15)
buffer_load_dwordx4 a[212:215], v3, s[32:35], s13 offen sc1
v_mfma_f32_16x16x32_bf16 v[196:199], v[140:143], a[12:15], v[196:199]
v_mfma_f32_16x16x32_bf16 v[200:203], v[140:143], a[16:19], v[200:203]
v_mfma_f32_16x16x32_bf16 v[204:207], v[140:143], a[20:23], v[204:207]
s_waitcnt vmcnt(18)
s_barrier
s_waitcnt lgkmcnt(14)
v_mfma_f32_16x16x32_bf16 v[208:211], v[112:115], a[144:147], v[208:211]
s_add_u32 m0, s62, 147456
ds_read_b64_tr_b16 v[144:145], v21 offset:40960
v_mfma_f32_16x16x32_bf16 v[212:215], v[112:115], a[148:151], v[212:215]
buffer_load_dwordx4 v4, s[28:31], s69 offen lds
v_mfma_f32_16x16x32_bf16 v[216:219], v[112:115], a[152:155], v[216:219]
s_waitcnt lgkmcnt(13)
ds_read_b64_tr_b16 v[146:147], v21 offset:45056
v_mfma_f32_16x16x32_bf16 v[220:223], v[116:119], a[144:147], v[220:223]
ds_read_b64_tr_b16 v[148:149], v22 offset:40960
v_mfma_f32_16x16x32_bf16 v[224:227], v[116:119], a[148:151], v[224:227]
ds_read_b64_tr_b16 v[150:151], v22 offset:45056
v_mfma_f32_16x16x32_bf16 v[228:231], v[116:119], a[152:155], v[228:231]
s_waitcnt lgkmcnt(14)
buffer_load_dwordx4 v5, s[28:31], s69 offen offset:1024 lds
v_mfma_f32_16x16x32_bf16 v[232:235], v[120:123], a[144:147], v[232:235]
ds_read_b64_tr_b16 v[152:153], v23 offset:40960
v_mfma_f32_16x16x32_bf16 v[236:239], v[120:123], a[148:151], v[236:239]
ds_read_b64_tr_b16 v[154:155], v23 offset:45056
v_mfma_f32_16x16x32_bf16 v[240:243], v[120:123], a[152:155], v[240:243]
s_waitcnt lgkmcnt(14)
ds_read_b64_tr_b16 v[156:157], v24 offset:40960
v_mfma_f32_16x16x32_bf16 v[244:247], v[124:127], a[144:147], v[244:247]
ds_read_b64_tr_b16 v[158:159], v24 offset:45056
v_mfma_f32_16x16x32_bf16 v[248:251], v[124:127], a[148:151], v[248:251]
buffer_load_dwordx4 a[216:219], v1, s[32:35], s14 offen sc1
v_mfma_f32_16x16x32_bf16 v[252:255], v[124:127], a[152:155], v[252:255]
s_waitcnt lgkmcnt(14)
ds_read_b64_tr_b16 v[128:129], v6 offset:24576
v_mfma_f32_16x16x32_bf16 v[160:163], v[96:99], a[24:27], v[160:163]
ds_read_b64_tr_b16 v[130:131], v6 offset:28672
v_mfma_f32_16x16x32_bf16 v[164:167], v[96:99], a[28:31], v[164:167]
ds_read_b64_tr_b16 v[132:133], v7 offset:24576
v_mfma_f32_16x16x32_bf16 v[168:171], v[96:99], a[32:35], v[168:171]
s_waitcnt lgkmcnt(15)
ds_read_b64_tr_b16 v[134:135], v7 offset:28672
v_mfma_f32_16x16x32_bf16 v[172:175], v[100:103], a[24:27], v[172:175]
buffer_load_dwordx4 a[220:223], v2, s[32:35], s14 offen sc1
v_mfma_f32_16x16x32_bf16 v[176:179], v[100:103], a[28:31], v[176:179]
ds_read_b64_tr_b16 v[136:137], v8 offset:24576
v_mfma_f32_16x16x32_bf16 v[180:183], v[100:103], a[32:35], v[180:183]
s_waitcnt lgkmcnt(15)
ds_read_b64_tr_b16 v[138:139], v8 offset:28672
v_mfma_f32_16x16x32_bf16 v[184:187], v[104:107], a[24:27], v[184:187]
ds_read_b64_tr_b16 v[140:141], v9 offset:24576
v_mfma_f32_16x16x32_bf16 v[188:191], v[104:107], a[28:31], v[188:191]
ds_read_b64_tr_b16 v[142:143], v9 offset:28672
v_mfma_f32_16x16x32_bf16 v[192:195], v[104:107], a[32:35], v[192:195]
s_waitcnt lgkmcnt(15)
buffer_load_dwordx4 a[224:227], v3, s[32:35], s14 offen sc1
v_mfma_f32_16x16x32_bf16 v[196:199], v[108:111], a[24:27], v[196:199]
v_mfma_f32_16x16x32_bf16 v[200:203], v[108:111], a[28:31], v[200:203]
v_mfma_f32_16x16x32_bf16 v[204:207], v[108:111], a[32:35], v[204:207]
s_waitcnt lgkmcnt(14)
v_mfma_f32_16x16x32_bf16 v[208:211], v[144:147], a[156:159], v[208:211]
s_add_u32 m0, s62, 155648
ds_read_b64_tr_b16 v[112:113], v21 offset:49152
v_mfma_f32_16x16x32_bf16 v[212:215], v[144:147], a[160:163], v[212:215]
buffer_load_dwordx4 v4, s[28:31], s70 offen lds
v_mfma_f32_16x16x32_bf16 v[216:219], v[144:147], a[164:167], v[216:219]
s_waitcnt lgkmcnt(13)
ds_read_b64_tr_b16 v[114:115], v21 offset:53248
v_mfma_f32_16x16x32_bf16 v[220:223], v[148:151], a[156:159], v[220:223]
ds_read_b64_tr_b16 v[116:117], v22 offset:49152
v_mfma_f32_16x16x32_bf16 v[224:227], v[148:151], a[160:163], v[224:227]
ds_read_b64_tr_b16 v[118:119], v22 offset:53248
v_mfma_f32_16x16x32_bf16 v[228:231], v[148:151], a[164:167], v[228:231]
s_waitcnt lgkmcnt(14)
buffer_load_dwordx4 v5, s[28:31], s70 offen offset:1024 lds
v_mfma_f32_16x16x32_bf16 v[232:235], v[152:155], a[156:159], v[232:235]
ds_read_b64_tr_b16 v[120:121], v23 offset:49152
v_mfma_f32_16x16x32_bf16 v[236:239], v[152:155], a[160:163], v[236:239]
ds_read_b64_tr_b16 v[122:123], v23 offset:53248
v_mfma_f32_16x16x32_bf16 v[240:243], v[152:155], a[164:167], v[240:243]
s_waitcnt lgkmcnt(14)
ds_read_b64_tr_b16 v[124:125], v24 offset:49152
v_mfma_f32_16x16x32_bf16 v[244:247], v[156:159], a[156:159], v[244:247]
ds_read_b64_tr_b16 v[126:127], v24 offset:53248
v_mfma_f32_16x16x32_bf16 v[248:251], v[156:159], a[160:163], v[248:251]
buffer_load_dwordx4 a[228:231], v1, s[32:35], s15 offen sc1
v_mfma_f32_16x16x32_bf16 v[252:255], v[156:159], a[164:167], v[252:255]
s_waitcnt lgkmcnt(14)
ds_read_b64_tr_b16 v[96:97], v6 offset:32768
v_mfma_f32_16x16x32_bf16 v[160:163], v[128:131], a[36:39], v[160:163]
ds_read_b64_tr_b16 v[98:99], v6 offset:36864
v_mfma_f32_16x16x32_bf16 v[164:167], v[128:131], a[40:43], v[164:167]
ds_read_b64_tr_b16 v[100:101], v7 offset:32768
v_mfma_f32_16x16x32_bf16 v[168:171], v[128:131], a[44:47], v[168:171]
s_waitcnt lgkmcnt(15)
ds_read_b64_tr_b16 v[102:103], v7 offset:36864
v_mfma_f32_16x16x32_bf16 v[172:175], v[132:135], a[36:39], v[172:175]
buffer_load_dwordx4 a[232:235], v2, s[32:35], s15 offen sc1
v_mfma_f32_16x16x32_bf16 v[176:179], v[132:135], a[40:43], v[176:179]
ds_read_b64_tr_b16 v[104:105], v8 offset:32768
v_mfma_f32_16x16x32_bf16 v[180:183], v[132:135], a[44:47], v[180:183]
s_waitcnt lgkmcnt(15)
ds_read_b64_tr_b16 v[106:107], v8 offset:36864
v_mfma_f32_16x16x32_bf16 v[184:187], v[136:139], a[36:39], v[184:187]
ds_read_b64_tr_b16 v[108:109], v9 offset:32768
v_mfma_f32_16x16x32_bf16 v[188:191], v[136:139], a[40:43], v[188:191]
ds_read_b64_tr_b16 v[110:111], v9 offset:36864
v_mfma_f32_16x16x32_bf16 v[192:195], v[136:139], a[44:47], v[192:195]
s_waitcnt lgkmcnt(15)
buffer_load_dwordx4 a[236:239], v3, s[32:35], s15 offen sc1
v_mfma_f32_16x16x32_bf16 v[196:199], v[140:143], a[36:39], v[196:199]
v_mfma_f32_16x16x32_bf16 v[200:203], v[140:143], a[40:43], v[200:203]
v_mfma_f32_16x16x32_bf16 v[204:207], v[140:143], a[44:47], v[204:207]
s_waitcnt vmcnt(18)
s_barrier
s_waitcnt lgkmcnt(14)
v_mfma_f32_16x16x32_bf16 v[208:211], v[112:115], a[168:171], v[208:211]
s_add_u32 m0, s62, 0
ds_read_b64_tr_b16 v[144:145], v21 offset:57344
v_mfma_f32_16x16x32_bf16 v[212:215], v[112:115], a[172:175], v[212:215]
buffer_load_dwordx4 v4, s[28:31], s71 offen lds
v_mfma_f32_16x16x32_bf16 v[216:219], v[112:115], a[176:179], v[216:219]
s_waitcnt lgkmcnt(13)
ds_read_b64_tr_b16 v[146:147], v21 offset:61440
v_mfma_f32_16x16x32_bf16 v[220:223], v[116:119], a[168:171], v[220:223]
ds_read_b64_tr_b16 v[148:149], v22 offset:57344
v_mfma_f32_16x16x32_bf16 v[224:227], v[116:119], a[172:175], v[224:227]
ds_read_b64_tr_b16 v[150:151], v22 offset:61440
v_mfma_f32_16x16x32_bf16 v[228:231], v[116:119], a[176:179], v[228:231]
s_waitcnt lgkmcnt(14)
buffer_load_dwordx4 v5, s[28:31], s71 offen offset:1024 lds
v_mfma_f32_16x16x32_bf16 v[232:235], v[120:123], a[168:171], v[232:235]
ds_read_b64_tr_b16 v[152:153], v23 offset:57344
v_mfma_f32_16x16x32_bf16 v[236:239], v[120:123], a[172:175], v[236:239]
ds_read_b64_tr_b16 v[154:155], v23 offset:61440
v_mfma_f32_16x16x32_bf16 v[240:243], v[120:123], a[176:179], v[240:243]
s_waitcnt lgkmcnt(14)
ds_read_b64_tr_b16 v[156:157], v24 offset:57344
v_mfma_f32_16x16x32_bf16 v[244:247], v[124:127], a[168:171], v[244:247]
ds_read_b64_tr_b16 v[158:159], v24 offset:61440
v_mfma_f32_16x16x32_bf16 v[248:251], v[124:127], a[172:175], v[248:251]
buffer_load_dwordx4 a[0:3], v1, s[32:35], s16 offen sc1
v_mfma_f32_16x16x32_bf16 v[252:255], v[124:127], a[176:179], v[252:255]
s_waitcnt lgkmcnt(14)
ds_read_b64_tr_b16 v[128:129], v6 offset:40960
v_mfma_f32_16x16x32_bf16 v[160:163], v[96:99], a[48:51], v[160:163]
ds_read_b64_tr_b16 v[130:131], v6 offset:45056
v_mfma_f32_16x16x32_bf16 v[164:167], v[96:99], a[52:55], v[164:167]
ds_read_b64_tr_b16 v[132:133], v7 offset:40960
v_mfma_f32_16x16x32_bf16 v[168:171], v[96:99], a[56:59], v[168:171]
s_waitcnt lgkmcnt(15)
ds_read_b64_tr_b16 v[134:135], v7 offset:45056
v_mfma_f32_16x16x32_bf16 v[172:175], v[100:103], a[48:51], v[172:175]
buffer_load_dwordx4 a[4:7], v2, s[32:35], s16 offen sc1
v_mfma_f32_16x16x32_bf16 v[176:179], v[100:103], a[52:55], v[176:179]
ds_read_b64_tr_b16 v[136:137], v8 offset:40960
v_mfma_f32_16x16x32_bf16 v[180:183], v[100:103], a[56:59], v[180:183]
s_waitcnt lgkmcnt(15)
ds_read_b64_tr_b16 v[138:139], v8 offset:45056
v_mfma_f32_16x16x32_bf16 v[184:187], v[104:107], a[48:51], v[184:187]
ds_read_b64_tr_b16 v[140:141], v9 offset:40960
v_mfma_f32_16x16x32_bf16 v[188:191], v[104:107], a[52:55], v[188:191]
ds_read_b64_tr_b16 v[142:143], v9 offset:45056
v_mfma_f32_16x16x32_bf16 v[192:195], v[104:107], a[56:59], v[192:195]
s_waitcnt lgkmcnt(15)
buffer_load_dwordx4 a[8:11], v3, s[32:35], s16 offen sc1
v_mfma_f32_16x16x32_bf16 v[196:199], v[108:111], a[48:51], v[196:199]
v_mfma_f32_16x16x32_bf16 v[200:203], v[108:111], a[52:55], v[200:203]
v_mfma_f32_16x16x32_bf16 v[204:207], v[108:111], a[56:59], v[204:207]
s_waitcnt lgkmcnt(14)
v_mfma_f32_16x16x32_bf16 v[208:211], v[144:147], a[180:183], v[208:211]
s_add_u32 m0, s62, 8192
ds_read_b64_tr_b16 v[112:113], v32
v_mfma_f32_16x16x32_bf16 v[212:215], v[144:147], a[184:187], v[212:215]
buffer_load_dwordx4 v4, s[28:31], s79 offen lds
v_mfma_f32_16x16x32_bf16 v[216:219], v[144:147], a[188:191], v[216:219]
s_waitcnt lgkmcnt(13)
ds_read_b64_tr_b16 v[114:115], v32 offset:4096
v_mfma_f32_16x16x32_bf16 v[220:223], v[148:151], a[180:183], v[220:223]
ds_read_b64_tr_b16 v[116:117], v33
v_mfma_f32_16x16x32_bf16 v[224:227], v[148:151], a[184:187], v[224:227]
ds_read_b64_tr_b16 v[118:119], v33 offset:4096
v_mfma_f32_16x16x32_bf16 v[228:231], v[148:151], a[188:191], v[228:231]
s_waitcnt lgkmcnt(14)
buffer_load_dwordx4 v5, s[28:31], s79 offen offset:1024 lds
v_mfma_f32_16x16x32_bf16 v[232:235], v[152:155], a[180:183], v[232:235]
ds_read_b64_tr_b16 v[120:121], v34
v_mfma_f32_16x16x32_bf16 v[236:239], v[152:155], a[184:187], v[236:239]
ds_read_b64_tr_b16 v[122:123], v34 offset:4096
v_mfma_f32_16x16x32_bf16 v[240:243], v[152:155], a[188:191], v[240:243]
s_waitcnt lgkmcnt(14)
ds_read_b64_tr_b16 v[124:125], v35
v_mfma_f32_16x16x32_bf16 v[244:247], v[156:159], a[180:183], v[244:247]
ds_read_b64_tr_b16 v[126:127], v35 offset:4096
v_mfma_f32_16x16x32_bf16 v[248:251], v[156:159], a[184:187], v[248:251]
buffer_load_dwordx4 a[12:15], v1, s[32:35], s17 offen sc1
v_mfma_f32_16x16x32_bf16 v[252:255], v[156:159], a[188:191], v[252:255]
s_waitcnt lgkmcnt(14)
ds_read_b64_tr_b16 v[96:97], v6 offset:49152
v_mfma_f32_16x16x32_bf16 v[160:163], v[128:131], a[60:63], v[160:163]
ds_read_b64_tr_b16 v[98:99], v6 offset:53248
v_mfma_f32_16x16x32_bf16 v[164:167], v[128:131], a[64:67], v[164:167]
ds_read_b64_tr_b16 v[100:101], v7 offset:49152
v_mfma_f32_16x16x32_bf16 v[168:171], v[128:131], a[68:71], v[168:171]
s_waitcnt lgkmcnt(15)
ds_read_b64_tr_b16 v[102:103], v7 offset:53248
v_mfma_f32_16x16x32_bf16 v[172:175], v[132:135], a[60:63], v[172:175]
buffer_load_dwordx4 a[16:19], v2, s[32:35], s17 offen sc1
v_mfma_f32_16x16x32_bf16 v[176:179], v[132:135], a[64:67], v[176:179]
ds_read_b64_tr_b16 v[104:105], v8 offset:49152
v_mfma_f32_16x16x32_bf16 v[180:183], v[132:135], a[68:71], v[180:183]
s_waitcnt lgkmcnt(15)
ds_read_b64_tr_b16 v[106:107], v8 offset:53248
v_mfma_f32_16x16x32_bf16 v[184:187], v[136:139], a[60:63], v[184:187]
ds_read_b64_tr_b16 v[108:109], v9 offset:49152
v_mfma_f32_16x16x32_bf16 v[188:191], v[136:139], a[64:67], v[188:191]
ds_read_b64_tr_b16 v[110:111], v9 offset:53248
v_mfma_f32_16x16x32_bf16 v[192:195], v[136:139], a[68:71], v[192:195]
s_waitcnt lgkmcnt(15)
buffer_load_dwordx4 a[20:23], v3, s[32:35], s17 offen sc1
v_mfma_f32_16x16x32_bf16 v[196:199], v[140:143], a[60:63], v[196:199]
v_mfma_f32_16x16x32_bf16 v[200:203], v[140:143], a[64:67], v[200:203]
v_mfma_f32_16x16x32_bf16 v[204:207], v[140:143], a[68:71], v[204:207]
s_waitcnt vmcnt(18)
s_barrier
s_waitcnt lgkmcnt(14)
v_mfma_f32_16x16x32_bf16 v[208:211], v[112:115], a[192:195], v[208:211]
s_add_u32 m0, s62, 16384
ds_read_b64_tr_b16 v[144:145], v32 offset:8192
v_mfma_f32_16x16x32_bf16 v[212:215], v[112:115], a[196:199], v[212:215]
buffer_load_dwordx4 v4, s[28:31], s80 offen lds
v_mfma_f32_16x16x32_bf16 v[216:219], v[112:115], a[200:203], v[216:219]
s_waitcnt lgkmcnt(13)
ds_read_b64_tr_b16 v[146:147], v32 offset:12288
v_mfma_f32_16x16x32_bf16 v[220:223], v[116:119], a[192:195], v[220:223]
ds_read_b64_tr_b16 v[148:149], v33 offset:8192
v_mfma_f32_16x16x32_bf16 v[224:227], v[116:119], a[196:199], v[224:227]
ds_read_b64_tr_b16 v[150:151], v33 offset:12288
v_mfma_f32_16x16x32_bf16 v[228:231], v[116:119], a[200:203], v[228:231]
s_waitcnt lgkmcnt(14)
buffer_load_dwordx4 v5, s[28:31], s80 offen offset:1024 lds
v_mfma_f32_16x16x32_bf16 v[232:235], v[120:123], a[192:195], v[232:235]
ds_read_b64_tr_b16 v[152:153], v34 offset:8192
v_mfma_f32_16x16x32_bf16 v[236:239], v[120:123], a[196:199], v[236:239]
ds_read_b64_tr_b16 v[154:155], v34 offset:12288
v_mfma_f32_16x16x32_bf16 v[240:243], v[120:123], a[200:203], v[240:243]
s_waitcnt lgkmcnt(14)
ds_read_b64_tr_b16 v[156:157], v35 offset:8192
v_mfma_f32_16x16x32_bf16 v[244:247], v[124:127], a[192:195], v[244:247]
ds_read_b64_tr_b16 v[158:159], v35 offset:12288
v_mfma_f32_16x16x32_bf16 v[248:251], v[124:127], a[196:199], v[248:251]
buffer_load_dwordx4 a[24:27], v1, s[32:35], s18 offen sc1
v_mfma_f32_16x16x32_bf16 v[252:255], v[124:127], a[200:203], v[252:255]
s_waitcnt lgkmcnt(14)
ds_read_b64_tr_b16 v[128:129], v6 offset:57344
v_mfma_f32_16x16x32_bf16 v[160:163], v[96:99], a[72:75], v[160:163]
ds_read_b64_tr_b16 v[130:131], v6 offset:61440
v_mfma_f32_16x16x32_bf16 v[164:167], v[96:99], a[76:79], v[164:167]
ds_read_b64_tr_b16 v[132:133], v7 offset:57344
v_mfma_f32_16x16x32_bf16 v[168:171], v[96:99], a[80:83], v[168:171]
s_waitcnt lgkmcnt(15)
ds_read_b64_tr_b16 v[134:135], v7 offset:61440
v_mfma_f32_16x16x32_bf16 v[172:175], v[100:103], a[72:75], v[172:175]
buffer_load_dwordx4 a[28:31], v2, s[32:35], s18 offen sc1
v_mfma_f32_16x16x32_bf16 v[176:179], v[100:103], a[76:79], v[176:179]
ds_read_b64_tr_b16 v[136:137], v8 offset:57344
v_mfma_f32_16x16x32_bf16 v[180:183], v[100:103], a[80:83], v[180:183]
s_waitcnt lgkmcnt(15)
ds_read_b64_tr_b16 v[138:139], v8 offset:61440
v_mfma_f32_16x16x32_bf16 v[184:187], v[104:107], a[72:75], v[184:187]
ds_read_b64_tr_b16 v[140:141], v9 offset:57344
v_mfma_f32_16x16x32_bf16 v[188:191], v[104:107], a[76:79], v[188:191]
ds_read_b64_tr_b16 v[142:143], v9 offset:61440
v_mfma_f32_16x16x32_bf16 v[192:195], v[104:107], a[80:83], v[192:195]
s_waitcnt lgkmcnt(15)
buffer_load_dwordx4 a[32:35], v3, s[32:35], s18 offen sc1
v_mfma_f32_16x16x32_bf16 v[196:199], v[108:111], a[72:75], v[196:199]
v_mfma_f32_16x16x32_bf16 v[200:203], v[108:111], a[76:79], v[200:203]
v_mfma_f32_16x16x32_bf16 v[204:207], v[108:111], a[80:83], v[204:207]
s_waitcnt lgkmcnt(14)
v_mfma_f32_16x16x32_bf16 v[208:211], v[144:147], a[204:207], v[208:211]
s_add_u32 m0, s62, 24576
ds_read_b64_tr_b16 v[112:113], v32 offset:16384
v_mfma_f32_16x16x32_bf16 v[212:215], v[144:147], a[208:211], v[212:215]
buffer_load_dwordx4 v4, s[28:31], s81 offen lds
v_mfma_f32_16x16x32_bf16 v[216:219], v[144:147], a[212:215], v[216:219]
s_waitcnt lgkmcnt(13)
ds_read_b64_tr_b16 v[114:115], v32 offset:20480
v_mfma_f32_16x16x32_bf16 v[220:223], v[148:151], a[204:207], v[220:223]
ds_read_b64_tr_b16 v[116:117], v33 offset:16384
v_mfma_f32_16x16x32_bf16 v[224:227], v[148:151], a[208:211], v[224:227]
ds_read_b64_tr_b16 v[118:119], v33 offset:20480
v_mfma_f32_16x16x32_bf16 v[228:231], v[148:151], a[212:215], v[228:231]
s_waitcnt lgkmcnt(14)
buffer_load_dwordx4 v5, s[28:31], s81 offen offset:1024 lds
v_mfma_f32_16x16x32_bf16 v[232:235], v[152:155], a[204:207], v[232:235]
ds_read_b64_tr_b16 v[120:121], v34 offset:16384
v_mfma_f32_16x16x32_bf16 v[236:239], v[152:155], a[208:211], v[236:239]
ds_read_b64_tr_b16 v[122:123], v34 offset:20480
v_mfma_f32_16x16x32_bf16 v[240:243], v[152:155], a[212:215], v[240:243]
s_waitcnt lgkmcnt(14)
ds_read_b64_tr_b16 v[124:125], v35 offset:16384
v_mfma_f32_16x16x32_bf16 v[244:247], v[156:159], a[204:207], v[244:247]
ds_read_b64_tr_b16 v[126:127], v35 offset:20480
v_mfma_f32_16x16x32_bf16 v[248:251], v[156:159], a[208:211], v[248:251]
buffer_load_dwordx4 a[36:39], v1, s[32:35], s19 offen sc1
v_mfma_f32_16x16x32_bf16 v[252:255], v[156:159], a[212:215], v[252:255]
s_waitcnt lgkmcnt(14)
ds_read_b64_tr_b16 v[96:97], v17
v_mfma_f32_16x16x32_bf16 v[160:163], v[128:131], a[84:87], v[160:163]
ds_read_b64_tr_b16 v[98:99], v17 offset:4096
v_mfma_f32_16x16x32_bf16 v[164:167], v[128:131], a[88:91], v[164:167]
ds_read_b64_tr_b16 v[100:101], v18
v_mfma_f32_16x16x32_bf16 v[168:171], v[128:131], a[92:95], v[168:171]
s_waitcnt lgkmcnt(15)
ds_read_b64_tr_b16 v[102:103], v18 offset:4096
v_mfma_f32_16x16x32_bf16 v[172:175], v[132:135], a[84:87], v[172:175]
buffer_load_dwordx4 a[40:43], v2, s[32:35], s19 offen sc1
v_mfma_f32_16x16x32_bf16 v[176:179], v[132:135], a[88:91], v[176:179]
ds_read_b64_tr_b16 v[104:105], v19
v_mfma_f32_16x16x32_bf16 v[180:183], v[132:135], a[92:95], v[180:183]
s_waitcnt lgkmcnt(15)
ds_read_b64_tr_b16 v[106:107], v19 offset:4096
v_mfma_f32_16x16x32_bf16 v[184:187], v[136:139], a[84:87], v[184:187]
ds_read_b64_tr_b16 v[108:109], v20
v_mfma_f32_16x16x32_bf16 v[188:191], v[136:139], a[88:91], v[188:191]
ds_read_b64_tr_b16 v[110:111], v20 offset:4096
v_mfma_f32_16x16x32_bf16 v[192:195], v[136:139], a[92:95], v[192:195]
s_waitcnt lgkmcnt(15)
buffer_load_dwordx4 a[44:47], v3, s[32:35], s19 offen sc1
v_mfma_f32_16x16x32_bf16 v[196:199], v[140:143], a[84:87], v[196:199]
v_mfma_f32_16x16x32_bf16 v[200:203], v[140:143], a[88:91], v[200:203]
v_mfma_f32_16x16x32_bf16 v[204:207], v[140:143], a[92:95], v[204:207]
s_waitcnt vmcnt(18)
s_barrier
s_waitcnt lgkmcnt(14)
v_mfma_f32_16x16x32_bf16 v[208:211], v[112:115], a[216:219], v[208:211]
s_add_u32 m0, s62, 32768
ds_read_b64_tr_b16 v[144:145], v32 offset:24576
v_mfma_f32_16x16x32_bf16 v[212:215], v[112:115], a[220:223], v[212:215]
buffer_load_dwordx4 v4, s[28:31], s82 offen lds
v_mfma_f32_16x16x32_bf16 v[216:219], v[112:115], a[224:227], v[216:219]
s_waitcnt lgkmcnt(13)
ds_read_b64_tr_b16 v[146:147], v32 offset:28672
v_mfma_f32_16x16x32_bf16 v[220:223], v[116:119], a[216:219], v[220:223]
ds_read_b64_tr_b16 v[148:149], v33 offset:24576
v_mfma_f32_16x16x32_bf16 v[224:227], v[116:119], a[220:223], v[224:227]
ds_read_b64_tr_b16 v[150:151], v33 offset:28672
v_mfma_f32_16x16x32_bf16 v[228:231], v[116:119], a[224:227], v[228:231]
s_waitcnt lgkmcnt(14)
buffer_load_dwordx4 v5, s[28:31], s82 offen offset:1024 lds
v_mfma_f32_16x16x32_bf16 v[232:235], v[120:123], a[216:219], v[232:235]
ds_read_b64_tr_b16 v[152:153], v34 offset:24576
v_mfma_f32_16x16x32_bf16 v[236:239], v[120:123], a[220:223], v[236:239]
ds_read_b64_tr_b16 v[154:155], v34 offset:28672
v_mfma_f32_16x16x32_bf16 v[240:243], v[120:123], a[224:227], v[240:243]
s_waitcnt lgkmcnt(14)
ds_read_b64_tr_b16 v[156:157], v35 offset:24576
v_mfma_f32_16x16x32_bf16 v[244:247], v[124:127], a[216:219], v[244:247]
ds_read_b64_tr_b16 v[158:159], v35 offset:28672
v_mfma_f32_16x16x32_bf16 v[248:251], v[124:127], a[220:223], v[248:251]
buffer_load_dwordx4 a[48:51], v1, s[32:35], s20 offen sc1
v_mfma_f32_16x16x32_bf16 v[252:255], v[124:127], a[224:227], v[252:255]
s_waitcnt lgkmcnt(14)
ds_read_b64_tr_b16 v[128:129], v17 offset:8192
v_mfma_f32_16x16x32_bf16 v[160:163], v[96:99], a[96:99], v[160:163]
ds_read_b64_tr_b16 v[130:131], v17 offset:12288
v_mfma_f32_16x16x32_bf16 v[164:167], v[96:99], a[100:103], v[164:167]
ds_read_b64_tr_b16 v[132:133], v18 offset:8192
v_mfma_f32_16x16x32_bf16 v[168:171], v[96:99], a[104:107], v[168:171]
s_waitcnt lgkmcnt(15)
ds_read_b64_tr_b16 v[134:135], v18 offset:12288
v_mfma_f32_16x16x32_bf16 v[172:175], v[100:103], a[96:99], v[172:175]
buffer_load_dwordx4 a[52:55], v2, s[32:35], s20 offen sc1
v_mfma_f32_16x16x32_bf16 v[176:179], v[100:103], a[100:103], v[176:179]
ds_read_b64_tr_b16 v[136:137], v19 offset:8192
v_mfma_f32_16x16x32_bf16 v[180:183], v[100:103], a[104:107], v[180:183]
s_waitcnt lgkmcnt(15)
ds_read_b64_tr_b16 v[138:139], v19 offset:12288
v_mfma_f32_16x16x32_bf16 v[184:187], v[104:107], a[96:99], v[184:187]
ds_read_b64_tr_b16 v[140:141], v20 offset:8192
v_mfma_f32_16x16x32_bf16 v[188:191], v[104:107], a[100:103], v[188:191]
ds_read_b64_tr_b16 v[142:143], v20 offset:12288
v_mfma_f32_16x16x32_bf16 v[192:195], v[104:107], a[104:107], v[192:195]
s_waitcnt lgkmcnt(15)
buffer_load_dwordx4 a[56:59], v3, s[32:35], s20 offen sc1
v_mfma_f32_16x16x32_bf16 v[196:199], v[108:111], a[96:99], v[196:199]
v_mfma_f32_16x16x32_bf16 v[200:203], v[108:111], a[100:103], v[200:203]
v_mfma_f32_16x16x32_bf16 v[204:207], v[108:111], a[104:107], v[204:207]
s_waitcnt lgkmcnt(14)
v_mfma_f32_16x16x32_bf16 v[208:211], v[144:147], a[228:231], v[208:211]
s_add_u32 m0, s62, 40960
ds_read_b64_tr_b16 v[112:113], v10
v_mfma_f32_16x16x32_bf16 v[212:215], v[144:147], a[232:235], v[212:215]
buffer_load_dwordx4 v4, s[28:31], s83 offen lds
v_mfma_f32_16x16x32_bf16 v[216:219], v[144:147], a[236:239], v[216:219]
s_waitcnt lgkmcnt(13)
ds_read_b64_tr_b16 v[114:115], v10 offset:4096
v_mfma_f32_16x16x32_bf16 v[220:223], v[148:151], a[228:231], v[220:223]
ds_read_b64_tr_b16 v[116:117], v11
v_mfma_f32_16x16x32_bf16 v[224:227], v[148:151], a[232:235], v[224:227]
ds_read_b64_tr_b16 v[118:119], v11 offset:4096
v_mfma_f32_16x16x32_bf16 v[228:231], v[148:151], a[236:239], v[228:231]
s_waitcnt lgkmcnt(14)
buffer_load_dwordx4 v5, s[28:31], s83 offen offset:1024 lds
v_mfma_f32_16x16x32_bf16 v[232:235], v[152:155], a[228:231], v[232:235]
ds_read_b64_tr_b16 v[120:121], v12
v_mfma_f32_16x16x32_bf16 v[236:239], v[152:155], a[232:235], v[236:239]
ds_read_b64_tr_b16 v[122:123], v12 offset:4096
v_mfma_f32_16x16x32_bf16 v[240:243], v[152:155], a[236:239], v[240:243]
s_waitcnt lgkmcnt(14)
ds_read_b64_tr_b16 v[124:125], v13
v_mfma_f32_16x16x32_bf16 v[244:247], v[156:159], a[228:231], v[244:247]
ds_read_b64_tr_b16 v[126:127], v13 offset:4096
v_mfma_f32_16x16x32_bf16 v[248:251], v[156:159], a[232:235], v[248:251]
buffer_load_dwordx4 a[60:63], v1, s[32:35], s22 offen sc1
v_mfma_f32_16x16x32_bf16 v[252:255], v[156:159], a[236:239], v[252:255]
s_waitcnt lgkmcnt(14)
ds_read_b64_tr_b16 v[96:97], v17 offset:16384
v_mfma_f32_16x16x32_bf16 v[160:163], v[128:131], a[108:111], v[160:163]
ds_read_b64_tr_b16 v[98:99], v17 offset:20480
v_mfma_f32_16x16x32_bf16 v[164:167], v[128:131], a[112:115], v[164:167]
ds_read_b64_tr_b16 v[100:101], v18 offset:16384
v_mfma_f32_16x16x32_bf16 v[168:171], v[128:131], a[116:119], v[168:171]
s_waitcnt lgkmcnt(15)
ds_read_b64_tr_b16 v[102:103], v18 offset:20480
v_mfma_f32_16x16x32_bf16 v[172:175], v[132:135], a[108:111], v[172:175]
buffer_load_dwordx4 a[64:67], v2, s[32:35], s22 offen sc1
v_mfma_f32_16x16x32_bf16 v[176:179], v[132:135], a[112:115], v[176:179]
ds_read_b64_tr_b16 v[104:105], v19 offset:16384
v_mfma_f32_16x16x32_bf16 v[180:183], v[132:135], a[116:119], v[180:183]
s_waitcnt lgkmcnt(15)
ds_read_b64_tr_b16 v[106:107], v19 offset:20480
v_mfma_f32_16x16x32_bf16 v[184:187], v[136:139], a[108:111], v[184:187]
ds_read_b64_tr_b16 v[108:109], v20 offset:16384
v_mfma_f32_16x16x32_bf16 v[188:191], v[136:139], a[112:115], v[188:191]
ds_read_b64_tr_b16 v[110:111], v20 offset:20480
v_mfma_f32_16x16x32_bf16 v[192:195], v[136:139], a[116:119], v[192:195]
s_waitcnt lgkmcnt(15)
buffer_load_dwordx4 a[68:71], v3, s[32:35], s22 offen sc1
v_mfma_f32_16x16x32_bf16 v[196:199], v[140:143], a[108:111], v[196:199]
v_mfma_f32_16x16x32_bf16 v[200:203], v[140:143], a[112:115], v[200:203]
v_mfma_f32_16x16x32_bf16 v[204:207], v[140:143], a[116:119], v[204:207]
s_waitcnt vmcnt(18)
s_barrier
s_waitcnt lgkmcnt(14)
v_mfma_f32_16x16x32_bf16 v[208:211], v[112:115], a[0:3], v[208:211]
s_add_u32 m0, s62, 49152
ds_read_b64_tr_b16 v[144:145], v10 offset:8192
v_mfma_f32_16x16x32_bf16 v[212:215], v[112:115], a[4:7], v[212:215]
buffer_load_dwordx4 v4, s[28:31], s25 offen lds
v_mfma_f32_16x16x32_bf16 v[216:219], v[112:115], a[8:11], v[216:219]
s_waitcnt lgkmcnt(13)
ds_read_b64_tr_b16 v[146:147], v10 offset:12288
v_mfma_f32_16x16x32_bf16 v[220:223], v[116:119], a[0:3], v[220:223]
ds_read_b64_tr_b16 v[148:149], v11 offset:8192
v_mfma_f32_16x16x32_bf16 v[224:227], v[116:119], a[4:7], v[224:227]
ds_read_b64_tr_b16 v[150:151], v11 offset:12288
v_mfma_f32_16x16x32_bf16 v[228:231], v[116:119], a[8:11], v[228:231]
s_waitcnt lgkmcnt(14)
buffer_load_dwordx4 v5, s[28:31], s25 offen offset:1024 lds
v_mfma_f32_16x16x32_bf16 v[232:235], v[120:123], a[0:3], v[232:235]
ds_read_b64_tr_b16 v[152:153], v12 offset:8192
v_mfma_f32_16x16x32_bf16 v[236:239], v[120:123], a[4:7], v[236:239]
ds_read_b64_tr_b16 v[154:155], v12 offset:12288
v_mfma_f32_16x16x32_bf16 v[240:243], v[120:123], a[8:11], v[240:243]
s_waitcnt lgkmcnt(14)
ds_read_b64_tr_b16 v[156:157], v13 offset:8192
v_mfma_f32_16x16x32_bf16 v[244:247], v[124:127], a[0:3], v[244:247]
ds_read_b64_tr_b16 v[158:159], v13 offset:12288
v_mfma_f32_16x16x32_bf16 v[248:251], v[124:127], a[4:7], v[248:251]
buffer_load_dwordx4 a[72:75], v1, s[32:35], s23 offen sc1
v_mfma_f32_16x16x32_bf16 v[252:255], v[124:127], a[8:11], v[252:255]
s_waitcnt lgkmcnt(14)
ds_read_b64_tr_b16 v[128:129], v17 offset:24576
v_mfma_f32_16x16x32_bf16 v[160:163], v[96:99], a[120:123], v[160:163]
ds_read_b64_tr_b16 v[130:131], v17 offset:28672
v_mfma_f32_16x16x32_bf16 v[164:167], v[96:99], a[124:127], v[164:167]
ds_read_b64_tr_b16 v[132:133], v18 offset:24576
v_mfma_f32_16x16x32_bf16 v[168:171], v[96:99], a[128:131], v[168:171]
s_waitcnt lgkmcnt(15)
ds_read_b64_tr_b16 v[134:135], v18 offset:28672
v_mfma_f32_16x16x32_bf16 v[172:175], v[100:103], a[120:123], v[172:175]
buffer_load_dwordx4 a[76:79], v2, s[32:35], s23 offen sc1
v_mfma_f32_16x16x32_bf16 v[176:179], v[100:103], a[124:127], v[176:179]
ds_read_b64_tr_b16 v[136:137], v19 offset:24576
v_mfma_f32_16x16x32_bf16 v[180:183], v[100:103], a[128:131], v[180:183]
s_waitcnt lgkmcnt(15)
ds_read_b64_tr_b16 v[138:139], v19 offset:28672
v_mfma_f32_16x16x32_bf16 v[184:187], v[104:107], a[120:123], v[184:187]
ds_read_b64_tr_b16 v[140:141], v20 offset:24576
v_mfma_f32_16x16x32_bf16 v[188:191], v[104:107], a[124:127], v[188:191]
ds_read_b64_tr_b16 v[142:143], v20 offset:28672
v_mfma_f32_16x16x32_bf16 v[192:195], v[104:107], a[128:131], v[192:195]
s_waitcnt lgkmcnt(15)
buffer_load_dwordx4 a[80:83], v3, s[32:35], s23 offen sc1
v_mfma_f32_16x16x32_bf16 v[196:199], v[108:111], a[120:123], v[196:199]
v_mfma_f32_16x16x32_bf16 v[200:203], v[108:111], a[124:127], v[200:203]
v_mfma_f32_16x16x32_bf16 v[204:207], v[108:111], a[128:131], v[204:207]
s_waitcnt lgkmcnt(14)
v_mfma_f32_16x16x32_bf16 v[208:211], v[144:147], a[12:15], v[208:211]
s_add_u32 m0, s62, 57344
ds_read_b64_tr_b16 v[112:113], v10 offset:16384
v_mfma_f32_16x16x32_bf16 v[212:215], v[144:147], a[16:19], v[212:215]
buffer_load_dwordx4 v4, s[28:31], s49 offen lds
v_mfma_f32_16x16x32_bf16 v[216:219], v[144:147], a[20:23], v[216:219]
s_waitcnt lgkmcnt(13)
ds_read_b64_tr_b16 v[114:115], v10 offset:20480
v_mfma_f32_16x16x32_bf16 v[220:223], v[148:151], a[12:15], v[220:223]
ds_read_b64_tr_b16 v[116:117], v11 offset:16384
v_mfma_f32_16x16x32_bf16 v[224:227], v[148:151], a[16:19], v[224:227]
ds_read_b64_tr_b16 v[118:119], v11 offset:20480
v_mfma_f32_16x16x32_bf16 v[228:231], v[148:151], a[20:23], v[228:231]
s_waitcnt lgkmcnt(14)
buffer_load_dwordx4 v5, s[28:31], s49 offen offset:1024 lds
v_mfma_f32_16x16x32_bf16 v[232:235], v[152:155], a[12:15], v[232:235]
ds_read_b64_tr_b16 v[120:121], v12 offset:16384
v_mfma_f32_16x16x32_bf16 v[236:239], v[152:155], a[16:19], v[236:239]
ds_read_b64_tr_b16 v[122:123], v12 offset:20480
v_mfma_f32_16x16x32_bf16 v[240:243], v[152:155], a[20:23], v[240:243]
s_waitcnt lgkmcnt(14)
ds_read_b64_tr_b16 v[124:125], v13 offset:16384
v_mfma_f32_16x16x32_bf16 v[244:247], v[156:159], a[12:15], v[244:247]
ds_read_b64_tr_b16 v[126:127], v13 offset:20480
v_mfma_f32_16x16x32_bf16 v[248:251], v[156:159], a[16:19], v[248:251]
buffer_load_dwordx4 a[84:87], v1, s[32:35], s24 offen sc1
v_mfma_f32_16x16x32_bf16 v[252:255], v[156:159], a[20:23], v[252:255]
s_waitcnt lgkmcnt(14)
ds_read_b64_tr_b16 v[96:97], v17 offset:32768
v_mfma_f32_16x16x32_bf16 v[160:163], v[128:131], a[132:135], v[160:163]
ds_read_b64_tr_b16 v[98:99], v17 offset:36864
v_mfma_f32_16x16x32_bf16 v[164:167], v[128:131], a[136:139], v[164:167]
ds_read_b64_tr_b16 v[100:101], v18 offset:32768
v_mfma_f32_16x16x32_bf16 v[168:171], v[128:131], a[140:143], v[168:171]
s_waitcnt lgkmcnt(15)
ds_read_b64_tr_b16 v[102:103], v18 offset:36864
v_mfma_f32_16x16x32_bf16 v[172:175], v[132:135], a[132:135], v[172:175]
buffer_load_dwordx4 a[88:91], v2, s[32:35], s24 offen sc1
v_mfma_f32_16x16x32_bf16 v[176:179], v[132:135], a[136:139], v[176:179]
ds_read_b64_tr_b16 v[104:105], v19 offset:32768
v_mfma_f32_16x16x32_bf16 v[180:183], v[132:135], a[140:143], v[180:183]
s_waitcnt lgkmcnt(15)
ds_read_b64_tr_b16 v[106:107], v19 offset:36864
v_mfma_f32_16x16x32_bf16 v[184:187], v[136:139], a[132:135], v[184:187]
ds_read_b64_tr_b16 v[108:109], v20 offset:32768
v_mfma_f32_16x16x32_bf16 v[188:191], v[136:139], a[136:139], v[188:191]
ds_read_b64_tr_b16 v[110:111], v20 offset:36864
v_mfma_f32_16x16x32_bf16 v[192:195], v[136:139], a[140:143], v[192:195]
s_waitcnt lgkmcnt(15)
buffer_load_dwordx4 a[92:95], v3, s[32:35], s24 offen sc1
v_mfma_f32_16x16x32_bf16 v[196:199], v[140:143], a[132:135], v[196:199]
v_mfma_f32_16x16x32_bf16 v[200:203], v[140:143], a[136:139], v[200:203]
v_mfma_f32_16x16x32_bf16 v[204:207], v[140:143], a[140:143], v[204:207]
s_waitcnt vmcnt(18)
s_barrier
s_waitcnt lgkmcnt(14)
v_mfma_f32_16x16x32_bf16 v[208:211], v[112:115], a[24:27], v[208:211]
ds_read_b64_tr_b16 v[144:145], v10 offset:24576
v_mfma_f32_16x16x32_bf16 v[212:215], v[112:115], a[28:31], v[212:215]
s_add_u32 s28, s28, 491520
s_addc_u32 s29, s29, 0
s_sub_u32 s30, s30, 491520
s_add_u32 s32, s32, 110592
s_addc_u32 s33, s33, 0
s_sub_u32 s34, s34, 110592
s_add_u32 m0, s62, 65536
s_nop 0
buffer_load_dwordx4 v4, s[28:31], s60 offen lds
v_mfma_f32_16x16x32_bf16 v[216:219], v[112:115], a[32:35], v[216:219]
s_waitcnt lgkmcnt(13)
ds_read_b64_tr_b16 v[146:147], v10 offset:28672
v_mfma_f32_16x16x32_bf16 v[220:223], v[116:119], a[24:27], v[220:223]
ds_read_b64_tr_b16 v[148:149], v11 offset:24576
v_mfma_f32_16x16x32_bf16 v[224:227], v[116:119], a[28:31], v[224:227]
ds_read_b64_tr_b16 v[150:151], v11 offset:28672
v_mfma_f32_16x16x32_bf16 v[228:231], v[116:119], a[32:35], v[228:231]
s_waitcnt lgkmcnt(14)
buffer_load_dwordx4 v5, s[28:31], s60 offen offset:1024 lds
v_mfma_f32_16x16x32_bf16 v[232:235], v[120:123], a[24:27], v[232:235]
ds_read_b64_tr_b16 v[152:153], v12 offset:24576
v_mfma_f32_16x16x32_bf16 v[236:239], v[120:123], a[28:31], v[236:239]
ds_read_b64_tr_b16 v[154:155], v12 offset:28672
v_mfma_f32_16x16x32_bf16 v[240:243], v[120:123], a[32:35], v[240:243]
s_waitcnt lgkmcnt(14)
ds_read_b64_tr_b16 v[156:157], v13 offset:24576
v_mfma_f32_16x16x32_bf16 v[244:247], v[124:127], a[24:27], v[244:247]
ds_read_b64_tr_b16 v[158:159], v13 offset:28672
v_mfma_f32_16x16x32_bf16 v[248:251], v[124:127], a[28:31], v[248:251]
buffer_load_dwordx4 a[96:99], v1, s[32:35], s12 offen sc1
v_mfma_f32_16x16x32_bf16 v[252:255], v[124:127], a[32:35], v[252:255]
s_waitcnt lgkmcnt(14)
ds_read_b64_tr_b16 v[128:129], v17 offset:40960
v_mfma_f32_16x16x32_bf16 v[160:163], v[96:99], a[144:147], v[160:163]
ds_read_b64_tr_b16 v[130:131], v17 offset:45056
v_mfma_f32_16x16x32_bf16 v[164:167], v[96:99], a[148:151], v[164:167]
ds_read_b64_tr_b16 v[132:133], v18 offset:40960
v_mfma_f32_16x16x32_bf16 v[168:171], v[96:99], a[152:155], v[168:171]
s_waitcnt lgkmcnt(15)
ds_read_b64_tr_b16 v[134:135], v18 offset:45056
v_mfma_f32_16x16x32_bf16 v[172:175], v[100:103], a[144:147], v[172:175]
buffer_load_dwordx4 a[100:103], v2, s[32:35], s12 offen sc1
v_mfma_f32_16x16x32_bf16 v[176:179], v[100:103], a[148:151], v[176:179]
ds_read_b64_tr_b16 v[136:137], v19 offset:40960
v_mfma_f32_16x16x32_bf16 v[180:183], v[100:103], a[152:155], v[180:183]
s_waitcnt lgkmcnt(15)
ds_read_b64_tr_b16 v[138:139], v19 offset:45056
v_mfma_f32_16x16x32_bf16 v[184:187], v[104:107], a[144:147], v[184:187]
ds_read_b64_tr_b16 v[140:141], v20 offset:40960
v_mfma_f32_16x16x32_bf16 v[188:191], v[104:107], a[148:151], v[188:191]
ds_read_b64_tr_b16 v[142:143], v20 offset:45056
v_mfma_f32_16x16x32_bf16 v[192:195], v[104:107], a[152:155], v[192:195]
s_waitcnt lgkmcnt(15)
buffer_load_dwordx4 a[104:107], v3, s[32:35], s12 offen sc1
v_mfma_f32_16x16x32_bf16 v[196:199], v[108:111], a[144:147], v[196:199]
v_mfma_f32_16x16x32_bf16 v[200:203], v[108:111], a[148:151], v[200:203]
v_mfma_f32_16x16x32_bf16 v[204:207], v[108:111], a[152:155], v[204:207]
s_waitcnt lgkmcnt(14)
v_mfma_f32_16x16x32_bf16 v[208:211], v[144:147], a[36:39], v[208:211]
s_add_u32 m0, s62, 73728
ds_read_b64_tr_b16 v[112:113], v10 offset:32768
v_mfma_f32_16x16x32_bf16 v[212:215], v[144:147], a[40:43], v[212:215]
buffer_load_dwordx4 v4, s[28:31], s61 offen lds
v_mfma_f32_16x16x32_bf16 v[216:219], v[144:147], a[44:47], v[216:219]
s_waitcnt lgkmcnt(13)
ds_read_b64_tr_b16 v[114:115], v10 offset:36864
v_mfma_f32_16x16x32_bf16 v[220:223], v[148:151], a[36:39], v[220:223]
ds_read_b64_tr_b16 v[116:117], v11 offset:32768
v_mfma_f32_16x16x32_bf16 v[224:227], v[148:151], a[40:43], v[224:227]
ds_read_b64_tr_b16 v[118:119], v11 offset:36864
v_mfma_f32_16x16x32_bf16 v[228:231], v[148:151], a[44:47], v[228:231]
s_waitcnt lgkmcnt(14)
buffer_load_dwordx4 v5, s[28:31], s61 offen offset:1024 lds
v_mfma_f32_16x16x32_bf16 v[232:235], v[152:155], a[36:39], v[232:235]
ds_read_b64_tr_b16 v[120:121], v12 offset:32768
v_mfma_f32_16x16x32_bf16 v[236:239], v[152:155], a[40:43], v[236:239]
ds_read_b64_tr_b16 v[122:123], v12 offset:36864
v_mfma_f32_16x16x32_bf16 v[240:243], v[152:155], a[44:47], v[240:243]
s_waitcnt lgkmcnt(14)
ds_read_b64_tr_b16 v[124:125], v13 offset:32768
v_mfma_f32_16x16x32_bf16 v[244:247], v[156:159], a[36:39], v[244:247]
ds_read_b64_tr_b16 v[126:127], v13 offset:36864
v_mfma_f32_16x16x32_bf16 v[248:251], v[156:159], a[40:43], v[248:251]
buffer_load_dwordx4 a[108:111], v1, s[32:35], s13 offen sc1
v_mfma_f32_16x16x32_bf16 v[252:255], v[156:159], a[44:47], v[252:255]
s_waitcnt lgkmcnt(14)
ds_read_b64_tr_b16 v[96:97], v17 offset:49152
v_mfma_f32_16x16x32_bf16 v[160:163], v[128:131], a[156:159], v[160:163]
ds_read_b64_tr_b16 v[98:99], v17 offset:53248
v_mfma_f32_16x16x32_bf16 v[164:167], v[128:131], a[160:163], v[164:167]
ds_read_b64_tr_b16 v[100:101], v18 offset:49152
v_mfma_f32_16x16x32_bf16 v[168:171], v[128:131], a[164:167], v[168:171]
s_waitcnt lgkmcnt(15)
ds_read_b64_tr_b16 v[102:103], v18 offset:53248
v_mfma_f32_16x16x32_bf16 v[172:175], v[132:135], a[156:159], v[172:175]
buffer_load_dwordx4 a[112:115], v2, s[32:35], s13 offen sc1
v_mfma_f32_16x16x32_bf16 v[176:179], v[132:135], a[160:163], v[176:179]
ds_read_b64_tr_b16 v[104:105], v19 offset:49152
v_mfma_f32_16x16x32_bf16 v[180:183], v[132:135], a[164:167], v[180:183]
s_waitcnt lgkmcnt(15)
ds_read_b64_tr_b16 v[106:107], v19 offset:53248
v_mfma_f32_16x16x32_bf16 v[184:187], v[136:139], a[156:159], v[184:187]
ds_read_b64_tr_b16 v[108:109], v20 offset:49152
v_mfma_f32_16x16x32_bf16 v[188:191], v[136:139], a[160:163], v[188:191]
ds_read_b64_tr_b16 v[110:111], v20 offset:53248
v_mfma_f32_16x16x32_bf16 v[192:195], v[136:139], a[164:167], v[192:195]
s_waitcnt lgkmcnt(15)
buffer_load_dwordx4 a[116:119], v3, s[32:35], s13 offen sc1
v_mfma_f32_16x16x32_bf16 v[196:199], v[140:143], a[156:159], v[196:199]
v_mfma_f32_16x16x32_bf16 v[200:203], v[140:143], a[160:163], v[200:203]
v_mfma_f32_16x16x32_bf16 v[204:207], v[140:143], a[164:167], v[204:207]
s_waitcnt vmcnt(18)
s_barrier
s_waitcnt lgkmcnt(14)
v_mfma_f32_16x16x32_bf16 v[208:211], v[112:115], a[48:51], v[208:211]
s_add_u32 m0, s62, 81920
ds_read_b64_tr_b16 v[144:145], v10 offset:40960
v_mfma_f32_16x16x32_bf16 v[212:215], v[112:115], a[52:55], v[212:215]
buffer_load_dwordx4 v4, s[28:31], s69 offen lds
v_mfma_f32_16x16x32_bf16 v[216:219], v[112:115], a[56:59], v[216:219]
s_waitcnt lgkmcnt(13)
ds_read_b64_tr_b16 v[146:147], v10 offset:45056
v_mfma_f32_16x16x32_bf16 v[220:223], v[116:119], a[48:51], v[220:223]
ds_read_b64_tr_b16 v[148:149], v11 offset:40960
v_mfma_f32_16x16x32_bf16 v[224:227], v[116:119], a[52:55], v[224:227]
ds_read_b64_tr_b16 v[150:151], v11 offset:45056
v_mfma_f32_16x16x32_bf16 v[228:231], v[116:119], a[56:59], v[228:231]
s_waitcnt lgkmcnt(14)
buffer_load_dwordx4 v5, s[28:31], s69 offen offset:1024 lds
v_mfma_f32_16x16x32_bf16 v[232:235], v[120:123], a[48:51], v[232:235]
ds_read_b64_tr_b16 v[152:153], v12 offset:40960
v_mfma_f32_16x16x32_bf16 v[236:239], v[120:123], a[52:55], v[236:239]
ds_read_b64_tr_b16 v[154:155], v12 offset:45056
v_mfma_f32_16x16x32_bf16 v[240:243], v[120:123], a[56:59], v[240:243]
s_waitcnt lgkmcnt(14)
ds_read_b64_tr_b16 v[156:157], v13 offset:40960
v_mfma_f32_16x16x32_bf16 v[244:247], v[124:127], a[48:51], v[244:247]
ds_read_b64_tr_b16 v[158:159], v13 offset:45056
v_mfma_f32_16x16x32_bf16 v[248:251], v[124:127], a[52:55], v[248:251]
buffer_load_dwordx4 a[120:123], v1, s[32:35], s14 offen sc1
v_mfma_f32_16x16x32_bf16 v[252:255], v[124:127], a[56:59], v[252:255]
s_waitcnt lgkmcnt(14)
ds_read_b64_tr_b16 v[128:129], v17 offset:57344
v_mfma_f32_16x16x32_bf16 v[160:163], v[96:99], a[168:171], v[160:163]
ds_read_b64_tr_b16 v[130:131], v17 offset:61440
v_mfma_f32_16x16x32_bf16 v[164:167], v[96:99], a[172:175], v[164:167]
ds_read_b64_tr_b16 v[132:133], v18 offset:57344
v_mfma_f32_16x16x32_bf16 v[168:171], v[96:99], a[176:179], v[168:171]
s_waitcnt lgkmcnt(15)
ds_read_b64_tr_b16 v[134:135], v18 offset:61440
v_mfma_f32_16x16x32_bf16 v[172:175], v[100:103], a[168:171], v[172:175]
buffer_load_dwordx4 a[124:127], v2, s[32:35], s14 offen sc1
v_mfma_f32_16x16x32_bf16 v[176:179], v[100:103], a[172:175], v[176:179]
ds_read_b64_tr_b16 v[136:137], v19 offset:57344
v_mfma_f32_16x16x32_bf16 v[180:183], v[100:103], a[176:179], v[180:183]
s_waitcnt lgkmcnt(15)
ds_read_b64_tr_b16 v[138:139], v19 offset:61440
v_mfma_f32_16x16x32_bf16 v[184:187], v[104:107], a[168:171], v[184:187]
ds_read_b64_tr_b16 v[140:141], v20 offset:57344
v_mfma_f32_16x16x32_bf16 v[188:191], v[104:107], a[172:175], v[188:191]
ds_read_b64_tr_b16 v[142:143], v20 offset:61440
v_mfma_f32_16x16x32_bf16 v[192:195], v[104:107], a[176:179], v[192:195]
s_waitcnt lgkmcnt(15)
buffer_load_dwordx4 a[128:131], v3, s[32:35], s14 offen sc1
v_mfma_f32_16x16x32_bf16 v[196:199], v[108:111], a[168:171], v[196:199]
v_mfma_f32_16x16x32_bf16 v[200:203], v[108:111], a[172:175], v[200:203]
v_mfma_f32_16x16x32_bf16 v[204:207], v[108:111], a[176:179], v[204:207]
s_waitcnt lgkmcnt(14)
v_mfma_f32_16x16x32_bf16 v[208:211], v[144:147], a[60:63], v[208:211]
s_add_u32 m0, s62, 90112
ds_read_b64_tr_b16 v[112:113], v10 offset:49152
v_mfma_f32_16x16x32_bf16 v[212:215], v[144:147], a[64:67], v[212:215]
buffer_load_dwordx4 v4, s[28:31], s70 offen lds
v_mfma_f32_16x16x32_bf16 v[216:219], v[144:147], a[68:71], v[216:219]
s_waitcnt lgkmcnt(13)
ds_read_b64_tr_b16 v[114:115], v10 offset:53248
v_mfma_f32_16x16x32_bf16 v[220:223], v[148:151], a[60:63], v[220:223]
ds_read_b64_tr_b16 v[116:117], v11 offset:49152
v_mfma_f32_16x16x32_bf16 v[224:227], v[148:151], a[64:67], v[224:227]
ds_read_b64_tr_b16 v[118:119], v11 offset:53248
v_mfma_f32_16x16x32_bf16 v[228:231], v[148:151], a[68:71], v[228:231]
s_waitcnt lgkmcnt(14)
buffer_load_dwordx4 v5, s[28:31], s70 offen offset:1024 lds
v_mfma_f32_16x16x32_bf16 v[232:235], v[152:155], a[60:63], v[232:235]
ds_read_b64_tr_b16 v[120:121], v12 offset:49152
v_mfma_f32_16x16x32_bf16 v[236:239], v[152:155], a[64:67], v[236:239]
ds_read_b64_tr_b16 v[122:123], v12 offset:53248
v_mfma_f32_16x16x32_bf16 v[240:243], v[152:155], a[68:71], v[240:243]
s_waitcnt lgkmcnt(14)
ds_read_b64_tr_b16 v[124:125], v13 offset:49152
v_mfma_f32_16x16x32_bf16 v[244:247], v[156:159], a[60:63], v[244:247]
ds_read_b64_tr_b16 v[126:127], v13 offset:53248
v_mfma_f32_16x16x32_bf16 v[248:251], v[156:159], a[64:67], v[248:251]
buffer_load_dwordx4 a[132:135], v1, s[32:35], s15 offen sc1
v_mfma_f32_16x16x32_bf16 v[252:255], v[156:159], a[68:71], v[252:255]
s_waitcnt lgkmcnt(14)
ds_read_b64_tr_b16 v[96:97], v28
v_mfma_f32_16x16x32_bf16 v[160:163], v[128:131], a[180:183], v[160:163]
ds_read_b64_tr_b16 v[98:99], v28 offset:4096
v_mfma_f32_16x16x32_bf16 v[164:167], v[128:131], a[184:187], v[164:167]
ds_read_b64_tr_b16 v[100:101], v29
v_mfma_f32_16x16x32_bf16 v[168:171], v[128:131], a[188:191], v[168:171]
s_waitcnt lgkmcnt(15)
ds_read_b64_tr_b16 v[102:103], v29 offset:4096
v_mfma_f32_16x16x32_bf16 v[172:175], v[132:135], a[180:183], v[172:175]
buffer_load_dwordx4 a[136:139], v2, s[32:35], s15 offen sc1
v_mfma_f32_16x16x32_bf16 v[176:179], v[132:135], a[184:187], v[176:179]
ds_read_b64_tr_b16 v[104:105], v30
v_mfma_f32_16x16x32_bf16 v[180:183], v[132:135], a[188:191], v[180:183]
s_waitcnt lgkmcnt(15)
ds_read_b64_tr_b16 v[106:107], v30 offset:4096
v_mfma_f32_16x16x32_bf16 v[184:187], v[136:139], a[180:183], v[184:187]
ds_read_b64_tr_b16 v[108:109], v31
v_mfma_f32_16x16x32_bf16 v[188:191], v[136:139], a[184:187], v[188:191]
ds_read_b64_tr_b16 v[110:111], v31 offset:4096
v_mfma_f32_16x16x32_bf16 v[192:195], v[136:139], a[188:191], v[192:195]
s_waitcnt lgkmcnt(15)
buffer_load_dwordx4 a[140:143], v3, s[32:35], s15 offen sc1
v_mfma_f32_16x16x32_bf16 v[196:199], v[140:143], a[180:183], v[196:199]
v_mfma_f32_16x16x32_bf16 v[200:203], v[140:143], a[184:187], v[200:203]
v_mfma_f32_16x16x32_bf16 v[204:207], v[140:143], a[188:191], v[204:207]
s_waitcnt vmcnt(18)
s_barrier
s_waitcnt lgkmcnt(14)
v_mfma_f32_16x16x32_bf16 v[208:211], v[112:115], a[72:75], v[208:211]
s_add_u32 m0, s62, 98304
ds_read_b64_tr_b16 v[144:145], v10 offset:57344
v_mfma_f32_16x16x32_bf16 v[212:215], v[112:115], a[76:79], v[212:215]
buffer_load_dwordx4 v4, s[28:31], s71 offen lds
v_mfma_f32_16x16x32_bf16 v[216:219], v[112:115], a[80:83], v[216:219]
s_waitcnt lgkmcnt(13)
ds_read_b64_tr_b16 v[146:147], v10 offset:61440
v_mfma_f32_16x16x32_bf16 v[220:223], v[116:119], a[72:75], v[220:223]
ds_read_b64_tr_b16 v[148:149], v11 offset:57344
v_mfma_f32_16x16x32_bf16 v[224:227], v[116:119], a[76:79], v[224:227]
ds_read_b64_tr_b16 v[150:151], v11 offset:61440
v_mfma_f32_16x16x32_bf16 v[228:231], v[116:119], a[80:83], v[228:231]
s_waitcnt lgkmcnt(14)
buffer_load_dwordx4 v5, s[28:31], s71 offen offset:1024 lds
v_mfma_f32_16x16x32_bf16 v[232:235], v[120:123], a[72:75], v[232:235]
ds_read_b64_tr_b16 v[152:153], v12 offset:57344
v_mfma_f32_16x16x32_bf16 v[236:239], v[120:123], a[76:79], v[236:239]
ds_read_b64_tr_b16 v[154:155], v12 offset:61440
v_mfma_f32_16x16x32_bf16 v[240:243], v[120:123], a[80:83], v[240:243]
s_waitcnt lgkmcnt(14)
ds_read_b64_tr_b16 v[156:157], v13 offset:57344
v_mfma_f32_16x16x32_bf16 v[244:247], v[124:127], a[72:75], v[244:247]
ds_read_b64_tr_b16 v[158:159], v13 offset:61440
v_mfma_f32_16x16x32_bf16 v[248:251], v[124:127], a[76:79], v[248:251]
buffer_load_dwordx4 a[144:147], v1, s[32:35], s16 offen sc1
v_mfma_f32_16x16x32_bf16 v[252:255], v[124:127], a[80:83], v[252:255]
s_waitcnt lgkmcnt(14)
ds_read_b64_tr_b16 v[128:129], v28 offset:8192
v_mfma_f32_16x16x32_bf16 v[160:163], v[96:99], a[192:195], v[160:163]
ds_read_b64_tr_b16 v[130:131], v28 offset:12288
v_mfma_f32_16x16x32_bf16 v[164:167], v[96:99], a[196:199], v[164:167]
ds_read_b64_tr_b16 v[132:133], v29 offset:8192
v_mfma_f32_16x16x32_bf16 v[168:171], v[96:99], a[200:203], v[168:171]
s_waitcnt lgkmcnt(15)
ds_read_b64_tr_b16 v[134:135], v29 offset:12288
v_mfma_f32_16x16x32_bf16 v[172:175], v[100:103], a[192:195], v[172:175]
buffer_load_dwordx4 a[148:151], v2, s[32:35], s16 offen sc1
v_mfma_f32_16x16x32_bf16 v[176:179], v[100:103], a[196:199], v[176:179]
ds_read_b64_tr_b16 v[136:137], v30 offset:8192
v_mfma_f32_16x16x32_bf16 v[180:183], v[100:103], a[200:203], v[180:183]
s_waitcnt lgkmcnt(15)
ds_read_b64_tr_b16 v[138:139], v30 offset:12288
v_mfma_f32_16x16x32_bf16 v[184:187], v[104:107], a[192:195], v[184:187]
ds_read_b64_tr_b16 v[140:141], v31 offset:8192
v_mfma_f32_16x16x32_bf16 v[188:191], v[104:107], a[196:199], v[188:191]
ds_read_b64_tr_b16 v[142:143], v31 offset:12288
v_mfma_f32_16x16x32_bf16 v[192:195], v[104:107], a[200:203], v[192:195]
s_waitcnt lgkmcnt(15)
buffer_load_dwordx4 a[152:155], v3, s[32:35], s16 offen sc1
v_mfma_f32_16x16x32_bf16 v[196:199], v[108:111], a[192:195], v[196:199]
v_mfma_f32_16x16x32_bf16 v[200:203], v[108:111], a[196:199], v[200:203]
v_mfma_f32_16x16x32_bf16 v[204:207], v[108:111], a[200:203], v[204:207]
s_waitcnt lgkmcnt(14)
v_mfma_f32_16x16x32_bf16 v[208:211], v[144:147], a[84:87], v[208:211]
s_add_u32 m0, s62, 106496
ds_read_b64_tr_b16 v[112:113], v21
v_mfma_f32_16x16x32_bf16 v[212:215], v[144:147], a[88:91], v[212:215]
buffer_load_dwordx4 v4, s[28:31], s79 offen lds
v_mfma_f32_16x16x32_bf16 v[216:219], v[144:147], a[92:95], v[216:219]
s_waitcnt lgkmcnt(13)
ds_read_b64_tr_b16 v[114:115], v21 offset:4096
v_mfma_f32_16x16x32_bf16 v[220:223], v[148:151], a[84:87], v[220:223]
ds_read_b64_tr_b16 v[116:117], v22
v_mfma_f32_16x16x32_bf16 v[224:227], v[148:151], a[88:91], v[224:227]
ds_read_b64_tr_b16 v[118:119], v22 offset:4096
v_mfma_f32_16x16x32_bf16 v[228:231], v[148:151], a[92:95], v[228:231]
s_waitcnt lgkmcnt(14)
buffer_load_dwordx4 v5, s[28:31], s79 offen offset:1024 lds
v_mfma_f32_16x16x32_bf16 v[232:235], v[152:155], a[84:87], v[232:235]
ds_read_b64_tr_b16 v[120:121], v23
v_mfma_f32_16x16x32_bf16 v[236:239], v[152:155], a[88:91], v[236:239]
ds_read_b64_tr_b16 v[122:123], v23 offset:4096
v_mfma_f32_16x16x32_bf16 v[240:243], v[152:155], a[92:95], v[240:243]
s_waitcnt lgkmcnt(14)
ds_read_b64_tr_b16 v[124:125], v24
v_mfma_f32_16x16x32_bf16 v[244:247], v[156:159], a[84:87], v[244:247]
ds_read_b64_tr_b16 v[126:127], v24 offset:4096
v_mfma_f32_16x16x32_bf16 v[248:251], v[156:159], a[88:91], v[248:251]
buffer_load_dwordx4 a[156:159], v1, s[32:35], s17 offen sc1
v_mfma_f32_16x16x32_bf16 v[252:255], v[156:159], a[92:95], v[252:255]
s_waitcnt lgkmcnt(14)
ds_read_b64_tr_b16 v[96:97], v28 offset:16384
v_mfma_f32_16x16x32_bf16 v[160:163], v[128:131], a[204:207], v[160:163]
ds_read_b64_tr_b16 v[98:99], v28 offset:20480
v_mfma_f32_16x16x32_bf16 v[164:167], v[128:131], a[208:211], v[164:167]
ds_read_b64_tr_b16 v[100:101], v29 offset:16384
v_mfma_f32_16x16x32_bf16 v[168:171], v[128:131], a[212:215], v[168:171]
s_waitcnt lgkmcnt(15)
ds_read_b64_tr_b16 v[102:103], v29 offset:20480
v_mfma_f32_16x16x32_bf16 v[172:175], v[132:135], a[204:207], v[172:175]
buffer_load_dwordx4 a[160:163], v2, s[32:35], s17 offen sc1
v_mfma_f32_16x16x32_bf16 v[176:179], v[132:135], a[208:211], v[176:179]
ds_read_b64_tr_b16 v[104:105], v30 offset:16384
v_mfma_f32_16x16x32_bf16 v[180:183], v[132:135], a[212:215], v[180:183]
s_waitcnt lgkmcnt(15)
ds_read_b64_tr_b16 v[106:107], v30 offset:20480
v_mfma_f32_16x16x32_bf16 v[184:187], v[136:139], a[204:207], v[184:187]
ds_read_b64_tr_b16 v[108:109], v31 offset:16384
v_mfma_f32_16x16x32_bf16 v[188:191], v[136:139], a[208:211], v[188:191]
ds_read_b64_tr_b16 v[110:111], v31 offset:20480
v_mfma_f32_16x16x32_bf16 v[192:195], v[136:139], a[212:215], v[192:195]
s_waitcnt lgkmcnt(15)
buffer_load_dwordx4 a[164:167], v3, s[32:35], s17 offen sc1
v_mfma_f32_16x16x32_bf16 v[196:199], v[140:143], a[204:207], v[196:199]
v_mfma_f32_16x16x32_bf16 v[200:203], v[140:143], a[208:211], v[200:203]
v_mfma_f32_16x16x32_bf16 v[204:207], v[140:143], a[212:215], v[204:207]
s_waitcnt vmcnt(18)
s_barrier
s_waitcnt lgkmcnt(14)
v_mfma_f32_16x16x32_bf16 v[208:211], v[112:115], a[96:99], v[208:211]
s_add_u32 m0, s62, 114688
ds_read_b64_tr_b16 v[144:145], v21 offset:8192
v_mfma_f32_16x16x32_bf16 v[212:215], v[112:115], a[100:103], v[212:215]
buffer_load_dwordx4 v4, s[28:31], s80 offen lds
v_mfma_f32_16x16x32_bf16 v[216:219], v[112:115], a[104:107], v[216:219]
s_waitcnt lgkmcnt(13)
ds_read_b64_tr_b16 v[146:147], v21 offset:12288
v_mfma_f32_16x16x32_bf16 v[220:223], v[116:119], a[96:99], v[220:223]
ds_read_b64_tr_b16 v[148:149], v22 offset:8192
v_mfma_f32_16x16x32_bf16 v[224:227], v[116:119], a[100:103], v[224:227]
ds_read_b64_tr_b16 v[150:151], v22 offset:12288
v_mfma_f32_16x16x32_bf16 v[228:231], v[116:119], a[104:107], v[228:231]
s_waitcnt lgkmcnt(14)
buffer_load_dwordx4 v5, s[28:31], s80 offen offset:1024 lds
v_mfma_f32_16x16x32_bf16 v[232:235], v[120:123], a[96:99], v[232:235]
ds_read_b64_tr_b16 v[152:153], v23 offset:8192
v_mfma_f32_16x16x32_bf16 v[236:239], v[120:123], a[100:103], v[236:239]
ds_read_b64_tr_b16 v[154:155], v23 offset:12288
v_mfma_f32_16x16x32_bf16 v[240:243], v[120:123], a[104:107], v[240:243]
s_waitcnt lgkmcnt(14)
ds_read_b64_tr_b16 v[156:157], v24 offset:8192
v_mfma_f32_16x16x32_bf16 v[244:247], v[124:127], a[96:99], v[244:247]
ds_read_b64_tr_b16 v[158:159], v24 offset:12288
v_mfma_f32_16x16x32_bf16 v[248:251], v[124:127], a[100:103], v[248:251]
buffer_load_dwordx4 a[168:171], v1, s[32:35], s18 offen sc1
v_mfma_f32_16x16x32_bf16 v[252:255], v[124:127], a[104:107], v[252:255]
s_waitcnt lgkmcnt(14)
ds_read_b64_tr_b16 v[128:129], v28 offset:24576
v_mfma_f32_16x16x32_bf16 v[160:163], v[96:99], a[216:219], v[160:163]
ds_read_b64_tr_b16 v[130:131], v28 offset:28672
v_mfma_f32_16x16x32_bf16 v[164:167], v[96:99], a[220:223], v[164:167]
ds_read_b64_tr_b16 v[132:133], v29 offset:24576
v_mfma_f32_16x16x32_bf16 v[168:171], v[96:99], a[224:227], v[168:171]
s_waitcnt lgkmcnt(15)
ds_read_b64_tr_b16 v[134:135], v29 offset:28672
v_mfma_f32_16x16x32_bf16 v[172:175], v[100:103], a[216:219], v[172:175]
buffer_load_dwordx4 a[172:175], v2, s[32:35], s18 offen sc1
v_mfma_f32_16x16x32_bf16 v[176:179], v[100:103], a[220:223], v[176:179]
ds_read_b64_tr_b16 v[136:137], v30 offset:24576
v_mfma_f32_16x16x32_bf16 v[180:183], v[100:103], a[224:227], v[180:183]
s_waitcnt lgkmcnt(15)
ds_read_b64_tr_b16 v[138:139], v30 offset:28672
v_mfma_f32_16x16x32_bf16 v[184:187], v[104:107], a[216:219], v[184:187]
ds_read_b64_tr_b16 v[140:141], v31 offset:24576
v_mfma_f32_16x16x32_bf16 v[188:191], v[104:107], a[220:223], v[188:191]
ds_read_b64_tr_b16 v[142:143], v31 offset:28672
v_mfma_f32_16x16x32_bf16 v[192:195], v[104:107], a[224:227], v[192:195]
s_waitcnt lgkmcnt(15)
buffer_load_dwordx4 a[176:179], v3, s[32:35], s18 offen sc1
v_mfma_f32_16x16x32_bf16 v[196:199], v[108:111], a[216:219], v[196:199]
v_mfma_f32_16x16x32_bf16 v[200:203], v[108:111], a[220:223], v[200:203]
v_mfma_f32_16x16x32_bf16 v[204:207], v[108:111], a[224:227], v[204:207]
s_waitcnt lgkmcnt(14)
v_mfma_f32_16x16x32_bf16 v[208:211], v[144:147], a[108:111], v[208:211]
s_add_u32 m0, s62, 122880
ds_read_b64_tr_b16 v[112:113], v21 offset:16384
v_mfma_f32_16x16x32_bf16 v[212:215], v[144:147], a[112:115], v[212:215]
buffer_load_dwordx4 v4, s[28:31], s81 offen lds
v_mfma_f32_16x16x32_bf16 v[216:219], v[144:147], a[116:119], v[216:219]
s_waitcnt lgkmcnt(13)
ds_read_b64_tr_b16 v[114:115], v21 offset:20480
v_mfma_f32_16x16x32_bf16 v[220:223], v[148:151], a[108:111], v[220:223]
ds_read_b64_tr_b16 v[116:117], v22 offset:16384
v_mfma_f32_16x16x32_bf16 v[224:227], v[148:151], a[112:115], v[224:227]
ds_read_b64_tr_b16 v[118:119], v22 offset:20480
v_mfma_f32_16x16x32_bf16 v[228:231], v[148:151], a[116:119], v[228:231]
s_waitcnt lgkmcnt(14)
buffer_load_dwordx4 v5, s[28:31], s81 offen offset:1024 lds
v_mfma_f32_16x16x32_bf16 v[232:235], v[152:155], a[108:111], v[232:235]
ds_read_b64_tr_b16 v[120:121], v23 offset:16384
v_mfma_f32_16x16x32_bf16 v[236:239], v[152:155], a[112:115], v[236:239]
ds_read_b64_tr_b16 v[122:123], v23 offset:20480
v_mfma_f32_16x16x32_bf16 v[240:243], v[152:155], a[116:119], v[240:243]
s_waitcnt lgkmcnt(14)
ds_read_b64_tr_b16 v[124:125], v24 offset:16384
v_mfma_f32_16x16x32_bf16 v[244:247], v[156:159], a[108:111], v[244:247]
ds_read_b64_tr_b16 v[126:127], v24 offset:20480
v_mfma_f32_16x16x32_bf16 v[248:251], v[156:159], a[112:115], v[248:251]
buffer_load_dwordx4 a[180:183], v1, s[32:35], s19 offen sc1
v_mfma_f32_16x16x32_bf16 v[252:255], v[156:159], a[116:119], v[252:255]
s_waitcnt lgkmcnt(14)
ds_read_b64_tr_b16 v[96:97], v6
v_mfma_f32_16x16x32_bf16 v[160:163], v[128:131], a[228:231], v[160:163]
ds_read_b64_tr_b16 v[98:99], v6 offset:4096
v_mfma_f32_16x16x32_bf16 v[164:167], v[128:131], a[232:235], v[164:167]
ds_read_b64_tr_b16 v[100:101], v7
v_mfma_f32_16x16x32_bf16 v[168:171], v[128:131], a[236:239], v[168:171]
s_waitcnt lgkmcnt(15)
ds_read_b64_tr_b16 v[102:103], v7 offset:4096
v_mfma_f32_16x16x32_bf16 v[172:175], v[132:135], a[228:231], v[172:175]
buffer_load_dwordx4 a[184:187], v2, s[32:35], s19 offen sc1
v_mfma_f32_16x16x32_bf16 v[176:179], v[132:135], a[232:235], v[176:179]
ds_read_b64_tr_b16 v[104:105], v8
v_mfma_f32_16x16x32_bf16 v[180:183], v[132:135], a[236:239], v[180:183]
s_waitcnt lgkmcnt(15)
ds_read_b64_tr_b16 v[106:107], v8 offset:4096
v_mfma_f32_16x16x32_bf16 v[184:187], v[136:139], a[228:231], v[184:187]
ds_read_b64_tr_b16 v[108:109], v9
v_mfma_f32_16x16x32_bf16 v[188:191], v[136:139], a[232:235], v[188:191]
ds_read_b64_tr_b16 v[110:111], v9 offset:4096
v_mfma_f32_16x16x32_bf16 v[192:195], v[136:139], a[236:239], v[192:195]
s_waitcnt lgkmcnt(15)
buffer_load_dwordx4 a[188:191], v3, s[32:35], s19 offen sc1
v_mfma_f32_16x16x32_bf16 v[196:199], v[140:143], a[228:231], v[196:199]
v_mfma_f32_16x16x32_bf16 v[200:203], v[140:143], a[232:235], v[200:203]
v_mfma_f32_16x16x32_bf16 v[204:207], v[140:143], a[236:239], v[204:207]
s_waitcnt vmcnt(18)
s_barrier
s_waitcnt lgkmcnt(14)
v_mfma_f32_16x16x32_bf16 v[208:211], v[112:115], a[120:123], v[208:211]
s_add_u32 m0, s62, 131072
ds_read_b64_tr_b16 v[144:145], v21 offset:24576
v_mfma_f32_16x16x32_bf16 v[212:215], v[112:115], a[124:127], v[212:215]
buffer_load_dwordx4 v4, s[28:31], s82 offen lds
v_mfma_f32_16x16x32_bf16 v[216:219], v[112:115], a[128:131], v[216:219]
s_waitcnt lgkmcnt(13)
ds_read_b64_tr_b16 v[146:147], v21 offset:28672
v_mfma_f32_16x16x32_bf16 v[220:223], v[116:119], a[120:123], v[220:223]
ds_read_b64_tr_b16 v[148:149], v22 offset:24576
v_mfma_f32_16x16x32_bf16 v[224:227], v[116:119], a[124:127], v[224:227]
ds_read_b64_tr_b16 v[150:151], v22 offset:28672
v_mfma_f32_16x16x32_bf16 v[228:231], v[116:119], a[128:131], v[228:231]
s_waitcnt lgkmcnt(14)
buffer_load_dwordx4 v5, s[28:31], s82 offen offset:1024 lds
v_mfma_f32_16x16x32_bf16 v[232:235], v[120:123], a[120:123], v[232:235]
ds_read_b64_tr_b16 v[152:153], v23 offset:24576
v_mfma_f32_16x16x32_bf16 v[236:239], v[120:123], a[124:127], v[236:239]
ds_read_b64_tr_b16 v[154:155], v23 offset:28672
v_mfma_f32_16x16x32_bf16 v[240:243], v[120:123], a[128:131], v[240:243]
s_waitcnt lgkmcnt(14)
ds_read_b64_tr_b16 v[156:157], v24 offset:24576
v_mfma_f32_16x16x32_bf16 v[244:247], v[124:127], a[120:123], v[244:247]
ds_read_b64_tr_b16 v[158:159], v24 offset:28672
v_mfma_f32_16x16x32_bf16 v[248:251], v[124:127], a[124:127], v[248:251]
buffer_load_dwordx4 a[192:195], v1, s[32:35], s20 offen sc1
v_mfma_f32_16x16x32_bf16 v[252:255], v[124:127], a[128:131], v[252:255]
s_waitcnt lgkmcnt(14)
ds_read_b64_tr_b16 v[128:129], v6 offset:8192
v_mfma_f32_16x16x32_bf16 v[160:163], v[96:99], a[0:3], v[160:163]
ds_read_b64_tr_b16 v[130:131], v6 offset:12288
v_mfma_f32_16x16x32_bf16 v[164:167], v[96:99], a[4:7], v[164:167]
ds_read_b64_tr_b16 v[132:133], v7 offset:8192
v_mfma_f32_16x16x32_bf16 v[168:171], v[96:99], a[8:11], v[168:171]
s_waitcnt lgkmcnt(15)
ds_read_b64_tr_b16 v[134:135], v7 offset:12288
v_mfma_f32_16x16x32_bf16 v[172:175], v[100:103], a[0:3], v[172:175]
buffer_load_dwordx4 a[196:199], v2, s[32:35], s20 offen sc1
v_mfma_f32_16x16x32_bf16 v[176:179], v[100:103], a[4:7], v[176:179]
ds_read_b64_tr_b16 v[136:137], v8 offset:8192
v_mfma_f32_16x16x32_bf16 v[180:183], v[100:103], a[8:11], v[180:183]
s_waitcnt lgkmcnt(15)
ds_read_b64_tr_b16 v[138:139], v8 offset:12288
v_mfma_f32_16x16x32_bf16 v[184:187], v[104:107], a[0:3], v[184:187]
ds_read_b64_tr_b16 v[140:141], v9 offset:8192
v_mfma_f32_16x16x32_bf16 v[188:191], v[104:107], a[4:7], v[188:191]
ds_read_b64_tr_b16 v[142:143], v9 offset:12288
v_mfma_f32_16x16x32_bf16 v[192:195], v[104:107], a[8:11], v[192:195]
s_waitcnt lgkmcnt(15)
buffer_load_dwordx4 a[200:203], v3, s[32:35], s20 offen sc1
v_mfma_f32_16x16x32_bf16 v[196:199], v[108:111], a[0:3], v[196:199]
v_mfma_f32_16x16x32_bf16 v[200:203], v[108:111], a[4:7], v[200:203]
v_mfma_f32_16x16x32_bf16 v[204:207], v[108:111], a[8:11], v[204:207]
s_waitcnt lgkmcnt(14)
v_mfma_f32_16x16x32_bf16 v[208:211], v[144:147], a[132:135], v[208:211]
s_add_u32 m0, s62, 139264
ds_read_b64_tr_b16 v[112:113], v21 offset:32768
v_mfma_f32_16x16x32_bf16 v[212:215], v[144:147], a[136:139], v[212:215]
buffer_load_dwordx4 v4, s[28:31], s83 offen lds
v_mfma_f32_16x16x32_bf16 v[216:219], v[144:147], a[140:143], v[216:219]
s_waitcnt lgkmcnt(13)
ds_read_b64_tr_b16 v[114:115], v21 offset:36864
v_mfma_f32_16x16x32_bf16 v[220:223], v[148:151], a[132:135], v[220:223]
ds_read_b64_tr_b16 v[116:117], v22 offset:32768
v_mfma_f32_16x16x32_bf16 v[224:227], v[148:151], a[136:139], v[224:227]
ds_read_b64_tr_b16 v[118:119], v22 offset:36864
v_mfma_f32_16x16x32_bf16 v[228:231], v[148:151], a[140:143], v[228:231]
s_waitcnt lgkmcnt(14)
buffer_load_dwordx4 v5, s[28:31], s83 offen offset:1024 lds
v_mfma_f32_16x16x32_bf16 v[232:235], v[152:155], a[132:135], v[232:235]
ds_read_b64_tr_b16 v[120:121], v23 offset:32768
v_mfma_f32_16x16x32_bf16 v[236:239], v[152:155], a[136:139], v[236:239]
ds_read_b64_tr_b16 v[122:123], v23 offset:36864
v_mfma_f32_16x16x32_bf16 v[240:243], v[152:155], a[140:143], v[240:243]
s_waitcnt lgkmcnt(14)
ds_read_b64_tr_b16 v[124:125], v24 offset:32768
v_mfma_f32_16x16x32_bf16 v[244:247], v[156:159], a[132:135], v[244:247]
ds_read_b64_tr_b16 v[126:127], v24 offset:36864
v_mfma_f32_16x16x32_bf16 v[248:251], v[156:159], a[136:139], v[248:251]
buffer_load_dwordx4 a[204:207], v1, s[32:35], s22 offen sc1
v_mfma_f32_16x16x32_bf16 v[252:255], v[156:159], a[140:143], v[252:255]
s_waitcnt lgkmcnt(14)
ds_read_b64_tr_b16 v[96:97], v6 offset:16384
v_mfma_f32_16x16x32_bf16 v[160:163], v[128:131], a[12:15], v[160:163]
ds_read_b64_tr_b16 v[98:99], v6 offset:20480
v_mfma_f32_16x16x32_bf16 v[164:167], v[128:131], a[16:19], v[164:167]
ds_read_b64_tr_b16 v[100:101], v7 offset:16384
v_mfma_f32_16x16x32_bf16 v[168:171], v[128:131], a[20:23], v[168:171]
s_waitcnt lgkmcnt(15)
ds_read_b64_tr_b16 v[102:103], v7 offset:20480
v_mfma_f32_16x16x32_bf16 v[172:175], v[132:135], a[12:15], v[172:175]
buffer_load_dwordx4 a[208:211], v2, s[32:35], s22 offen sc1
v_mfma_f32_16x16x32_bf16 v[176:179], v[132:135], a[16:19], v[176:179]
ds_read_b64_tr_b16 v[104:105], v8 offset:16384
v_mfma_f32_16x16x32_bf16 v[180:183], v[132:135], a[20:23], v[180:183]
s_waitcnt lgkmcnt(15)
ds_read_b64_tr_b16 v[106:107], v8 offset:20480
v_mfma_f32_16x16x32_bf16 v[184:187], v[136:139], a[12:15], v[184:187]
ds_read_b64_tr_b16 v[108:109], v9 offset:16384
v_mfma_f32_16x16x32_bf16 v[188:191], v[136:139], a[16:19], v[188:191]
ds_read_b64_tr_b16 v[110:111], v9 offset:20480
v_mfma_f32_16x16x32_bf16 v[192:195], v[136:139], a[20:23], v[192:195]
s_waitcnt lgkmcnt(15)
buffer_load_dwordx4 a[212:215], v3, s[32:35], s22 offen sc1
v_mfma_f32_16x16x32_bf16 v[196:199], v[140:143], a[12:15], v[196:199]
v_mfma_f32_16x16x32_bf16 v[200:203], v[140:143], a[16:19], v[200:203]
v_mfma_f32_16x16x32_bf16 v[204:207], v[140:143], a[20:23], v[204:207]
s_waitcnt vmcnt(18)
s_barrier
s_waitcnt lgkmcnt(14)
v_mfma_f32_16x16x32_bf16 v[208:211], v[112:115], a[144:147], v[208:211]
s_add_u32 m0, s62, 147456
ds_read_b64_tr_b16 v[144:145], v21 offset:40960
v_mfma_f32_16x16x32_bf16 v[212:215], v[112:115], a[148:151], v[212:215]
buffer_load_dwordx4 v4, s[28:31], s25 offen lds
v_mfma_f32_16x16x32_bf16 v[216:219], v[112:115], a[152:155], v[216:219]
s_waitcnt lgkmcnt(13)
ds_read_b64_tr_b16 v[146:147], v21 offset:45056
v_mfma_f32_16x16x32_bf16 v[220:223], v[116:119], a[144:147], v[220:223]
ds_read_b64_tr_b16 v[148:149], v22 offset:40960
v_mfma_f32_16x16x32_bf16 v[224:227], v[116:119], a[148:151], v[224:227]
ds_read_b64_tr_b16 v[150:151], v22 offset:45056
v_mfma_f32_16x16x32_bf16 v[228:231], v[116:119], a[152:155], v[228:231]
s_waitcnt lgkmcnt(14)
buffer_load_dwordx4 v5, s[28:31], s25 offen offset:1024 lds
v_mfma_f32_16x16x32_bf16 v[232:235], v[120:123], a[144:147], v[232:235]
ds_read_b64_tr_b16 v[152:153], v23 offset:40960
v_mfma_f32_16x16x32_bf16 v[236:239], v[120:123], a[148:151], v[236:239]
ds_read_b64_tr_b16 v[154:155], v23 offset:45056
v_mfma_f32_16x16x32_bf16 v[240:243], v[120:123], a[152:155], v[240:243]
s_waitcnt lgkmcnt(14)
ds_read_b64_tr_b16 v[156:157], v24 offset:40960
v_mfma_f32_16x16x32_bf16 v[244:247], v[124:127], a[144:147], v[244:247]
ds_read_b64_tr_b16 v[158:159], v24 offset:45056
v_mfma_f32_16x16x32_bf16 v[248:251], v[124:127], a[148:151], v[248:251]
buffer_load_dwordx4 a[216:219], v1, s[32:35], s23 offen sc1
v_mfma_f32_16x16x32_bf16 v[252:255], v[124:127], a[152:155], v[252:255]
s_waitcnt lgkmcnt(14)
ds_read_b64_tr_b16 v[128:129], v6 offset:24576
v_mfma_f32_16x16x32_bf16 v[160:163], v[96:99], a[24:27], v[160:163]
ds_read_b64_tr_b16 v[130:131], v6 offset:28672
v_mfma_f32_16x16x32_bf16 v[164:167], v[96:99], a[28:31], v[164:167]
ds_read_b64_tr_b16 v[132:133], v7 offset:24576
v_mfma_f32_16x16x32_bf16 v[168:171], v[96:99], a[32:35], v[168:171]
s_waitcnt lgkmcnt(15)
ds_read_b64_tr_b16 v[134:135], v7 offset:28672
v_mfma_f32_16x16x32_bf16 v[172:175], v[100:103], a[24:27], v[172:175]
buffer_load_dwordx4 a[220:223], v2, s[32:35], s23 offen sc1
v_mfma_f32_16x16x32_bf16 v[176:179], v[100:103], a[28:31], v[176:179]
ds_read_b64_tr_b16 v[136:137], v8 offset:24576
v_mfma_f32_16x16x32_bf16 v[180:183], v[100:103], a[32:35], v[180:183]
s_waitcnt lgkmcnt(15)
ds_read_b64_tr_b16 v[138:139], v8 offset:28672
v_mfma_f32_16x16x32_bf16 v[184:187], v[104:107], a[24:27], v[184:187]
ds_read_b64_tr_b16 v[140:141], v9 offset:24576
v_mfma_f32_16x16x32_bf16 v[188:191], v[104:107], a[28:31], v[188:191]
ds_read_b64_tr_b16 v[142:143], v9 offset:28672
v_mfma_f32_16x16x32_bf16 v[192:195], v[104:107], a[32:35], v[192:195]
s_waitcnt lgkmcnt(15)
buffer_load_dwordx4 a[224:227], v3, s[32:35], s23 offen sc1
v_mfma_f32_16x16x32_bf16 v[196:199], v[108:111], a[24:27], v[196:199]
v_mfma_f32_16x16x32_bf16 v[200:203], v[108:111], a[28:31], v[200:203]
v_mfma_f32_16x16x32_bf16 v[204:207], v[108:111], a[32:35], v[204:207]
s_waitcnt lgkmcnt(14)
v_mfma_f32_16x16x32_bf16 v[208:211], v[144:147], a[156:159], v[208:211]
s_add_u32 m0, s62, 155648
ds_read_b64_tr_b16 v[112:113], v21 offset:49152
v_mfma_f32_16x16x32_bf16 v[212:215], v[144:147], a[160:163], v[212:215]
buffer_load_dwordx4 v4, s[28:31], s49 offen lds
v_mfma_f32_16x16x32_bf16 v[216:219], v[144:147], a[164:167], v[216:219]
s_waitcnt lgkmcnt(13)
ds_read_b64_tr_b16 v[114:115], v21 offset:53248
v_mfma_f32_16x16x32_bf16 v[220:223], v[148:151], a[156:159], v[220:223]
ds_read_b64_tr_b16 v[116:117], v22 offset:49152
v_mfma_f32_16x16x32_bf16 v[224:227], v[148:151], a[160:163], v[224:227]
ds_read_b64_tr_b16 v[118:119], v22 offset:53248
v_mfma_f32_16x16x32_bf16 v[228:231], v[148:151], a[164:167], v[228:231]
s_waitcnt lgkmcnt(14)
buffer_load_dwordx4 v5, s[28:31], s49 offen offset:1024 lds
v_mfma_f32_16x16x32_bf16 v[232:235], v[152:155], a[156:159], v[232:235]
ds_read_b64_tr_b16 v[120:121], v23 offset:49152
v_mfma_f32_16x16x32_bf16 v[236:239], v[152:155], a[160:163], v[236:239]
ds_read_b64_tr_b16 v[122:123], v23 offset:53248
v_mfma_f32_16x16x32_bf16 v[240:243], v[152:155], a[164:167], v[240:243]
s_waitcnt lgkmcnt(14)
ds_read_b64_tr_b16 v[124:125], v24 offset:49152
v_mfma_f32_16x16x32_bf16 v[244:247], v[156:159], a[156:159], v[244:247]
ds_read_b64_tr_b16 v[126:127], v24 offset:53248
v_mfma_f32_16x16x32_bf16 v[248:251], v[156:159], a[160:163], v[248:251]
buffer_load_dwordx4 a[228:231], v1, s[32:35], s24 offen sc1
v_mfma_f32_16x16x32_bf16 v[252:255], v[156:159], a[164:167], v[252:255]
s_waitcnt lgkmcnt(14)
ds_read_b64_tr_b16 v[96:97], v6 offset:32768
v_mfma_f32_16x16x32_bf16 v[160:163], v[128:131], a[36:39], v[160:163]
ds_read_b64_tr_b16 v[98:99], v6 offset:36864
v_mfma_f32_16x16x32_bf16 v[164:167], v[128:131], a[40:43], v[164:167]
ds_read_b64_tr_b16 v[100:101], v7 offset:32768
v_mfma_f32_16x16x32_bf16 v[168:171], v[128:131], a[44:47], v[168:171]
s_waitcnt lgkmcnt(15)
ds_read_b64_tr_b16 v[102:103], v7 offset:36864
v_mfma_f32_16x16x32_bf16 v[172:175], v[132:135], a[36:39], v[172:175]
buffer_load_dwordx4 a[232:235], v2, s[32:35], s24 offen sc1
v_mfma_f32_16x16x32_bf16 v[176:179], v[132:135], a[40:43], v[176:179]
ds_read_b64_tr_b16 v[104:105], v8 offset:32768
v_mfma_f32_16x16x32_bf16 v[180:183], v[132:135], a[44:47], v[180:183]
s_waitcnt lgkmcnt(15)
ds_read_b64_tr_b16 v[106:107], v8 offset:36864
v_mfma_f32_16x16x32_bf16 v[184:187], v[136:139], a[36:39], v[184:187]
ds_read_b64_tr_b16 v[108:109], v9 offset:32768
v_mfma_f32_16x16x32_bf16 v[188:191], v[136:139], a[40:43], v[188:191]
ds_read_b64_tr_b16 v[110:111], v9 offset:36864
v_mfma_f32_16x16x32_bf16 v[192:195], v[136:139], a[44:47], v[192:195]
s_waitcnt lgkmcnt(15)
buffer_load_dwordx4 a[236:239], v3, s[32:35], s24 offen sc1
v_mfma_f32_16x16x32_bf16 v[196:199], v[140:143], a[36:39], v[196:199]
v_mfma_f32_16x16x32_bf16 v[200:203], v[140:143], a[40:43], v[200:203]
v_mfma_f32_16x16x32_bf16 v[204:207], v[140:143], a[44:47], v[204:207]
s_waitcnt vmcnt(18)
s_barrier
s_waitcnt lgkmcnt(14)
v_mfma_f32_16x16x32_bf16 v[208:211], v[112:115], a[168:171], v[208:211]
ds_read_b64_tr_b16 v[144:145], v21 offset:57344
v_mfma_f32_16x16x32_bf16 v[212:215], v[112:115], a[172:175], v[212:215]
s_add_u32 s28, s28, 491520
s_addc_u32 s29, s29, 0
s_sub_u32 s30, s30, 491520
s_add_u32 s32, s32, 110592
s_addc_u32 s33, s33, 0
s_sub_u32 s34, s34, 110592
s_add_u32 m0, s62, 0
s_nop 0
buffer_load_dwordx4 v4, s[28:31], s60 offen lds
v_mfma_f32_16x16x32_bf16 v[216:219], v[112:115], a[176:179], v[216:219]
s_waitcnt lgkmcnt(13)
ds_read_b64_tr_b16 v[146:147], v21 offset:61440
v_mfma_f32_16x16x32_bf16 v[220:223], v[116:119], a[168:171], v[220:223]
ds_read_b64_tr_b16 v[148:149], v22 offset:57344
v_mfma_f32_16x16x32_bf16 v[224:227], v[116:119], a[172:175], v[224:227]
ds_read_b64_tr_b16 v[150:151], v22 offset:61440
v_mfma_f32_16x16x32_bf16 v[228:231], v[116:119], a[176:179], v[228:231]
s_waitcnt lgkmcnt(14)
buffer_load_dwordx4 v5, s[28:31], s60 offen offset:1024 lds
v_mfma_f32_16x16x32_bf16 v[232:235], v[120:123], a[168:171], v[232:235]
ds_read_b64_tr_b16 v[152:153], v23 offset:57344
v_mfma_f32_16x16x32_bf16 v[236:239], v[120:123], a[172:175], v[236:239]
ds_read_b64_tr_b16 v[154:155], v23 offset:61440
v_mfma_f32_16x16x32_bf16 v[240:243], v[120:123], a[176:179], v[240:243]
s_waitcnt lgkmcnt(14)
ds_read_b64_tr_b16 v[156:157], v24 offset:57344
v_mfma_f32_16x16x32_bf16 v[244:247], v[124:127], a[168:171], v[244:247]
ds_read_b64_tr_b16 v[158:159], v24 offset:61440
v_mfma_f32_16x16x32_bf16 v[248:251], v[124:127], a[172:175], v[248:251]
buffer_load_dwordx4 a[0:3], v1, s[32:35], s12 offen sc1
v_mfma_f32_16x16x32_bf16 v[252:255], v[124:127], a[176:179], v[252:255]
s_waitcnt lgkmcnt(14)
ds_read_b64_tr_b16 v[128:129], v6 offset:40960
v_mfma_f32_16x16x32_bf16 v[160:163], v[96:99], a[48:51], v[160:163]
ds_read_b64_tr_b16 v[130:131], v6 offset:45056
v_mfma_f32_16x16x32_bf16 v[164:167], v[96:99], a[52:55], v[164:167]
ds_read_b64_tr_b16 v[132:133], v7 offset:40960
v_mfma_f32_16x16x32_bf16 v[168:171], v[96:99], a[56:59], v[168:171]
s_waitcnt lgkmcnt(15)
ds_read_b64_tr_b16 v[134:135], v7 offset:45056
v_mfma_f32_16x16x32_bf16 v[172:175], v[100:103], a[48:51], v[172:175]
buffer_load_dwordx4 a[4:7], v2, s[32:35], s12 offen sc1
v_mfma_f32_16x16x32_bf16 v[176:179], v[100:103], a[52:55], v[176:179]
ds_read_b64_tr_b16 v[136:137], v8 offset:40960
v_mfma_f32_16x16x32_bf16 v[180:183], v[100:103], a[56:59], v[180:183]
s_waitcnt lgkmcnt(15)
ds_read_b64_tr_b16 v[138:139], v8 offset:45056
v_mfma_f32_16x16x32_bf16 v[184:187], v[104:107], a[48:51], v[184:187]
ds_read_b64_tr_b16 v[140:141], v9 offset:40960
v_mfma_f32_16x16x32_bf16 v[188:191], v[104:107], a[52:55], v[188:191]
ds_read_b64_tr_b16 v[142:143], v9 offset:45056
v_mfma_f32_16x16x32_bf16 v[192:195], v[104:107], a[56:59], v[192:195]
s_waitcnt lgkmcnt(15)
buffer_load_dwordx4 a[8:11], v3, s[32:35], s12 offen sc1
v_mfma_f32_16x16x32_bf16 v[196:199], v[108:111], a[48:51], v[196:199]
v_mfma_f32_16x16x32_bf16 v[200:203], v[108:111], a[52:55], v[200:203]
v_mfma_f32_16x16x32_bf16 v[204:207], v[108:111], a[56:59], v[204:207]
s_waitcnt lgkmcnt(14)
v_mfma_f32_16x16x32_bf16 v[208:211], v[144:147], a[180:183], v[208:211]
s_add_u32 m0, s62, 8192
ds_read_b64_tr_b16 v[112:113], v32
v_mfma_f32_16x16x32_bf16 v[212:215], v[144:147], a[184:187], v[212:215]
buffer_load_dwordx4 v4, s[28:31], s61 offen lds
v_mfma_f32_16x16x32_bf16 v[216:219], v[144:147], a[188:191], v[216:219]
s_waitcnt lgkmcnt(13)
ds_read_b64_tr_b16 v[114:115], v32 offset:4096
v_mfma_f32_16x16x32_bf16 v[220:223], v[148:151], a[180:183], v[220:223]
ds_read_b64_tr_b16 v[116:117], v33
v_mfma_f32_16x16x32_bf16 v[224:227], v[148:151], a[184:187], v[224:227]
ds_read_b64_tr_b16 v[118:119], v33 offset:4096
v_mfma_f32_16x16x32_bf16 v[228:231], v[148:151], a[188:191], v[228:231]
s_waitcnt lgkmcnt(14)
buffer_load_dwordx4 v5, s[28:31], s61 offen offset:1024 lds
v_mfma_f32_16x16x32_bf16 v[232:235], v[152:155], a[180:183], v[232:235]
ds_read_b64_tr_b16 v[120:121], v34
v_mfma_f32_16x16x32_bf16 v[236:239], v[152:155], a[184:187], v[236:239]
ds_read_b64_tr_b16 v[122:123], v34 offset:4096
v_mfma_f32_16x16x32_bf16 v[240:243], v[152:155], a[188:191], v[240:243]
s_waitcnt lgkmcnt(14)
ds_read_b64_tr_b16 v[124:125], v35
v_mfma_f32_16x16x32_bf16 v[244:247], v[156:159], a[180:183], v[244:247]
ds_read_b64_tr_b16 v[126:127], v35 offset:4096
v_mfma_f32_16x16x32_bf16 v[248:251], v[156:159], a[184:187], v[248:251]
buffer_load_dwordx4 a[12:15], v1, s[32:35], s13 offen sc1
v_mfma_f32_16x16x32_bf16 v[252:255], v[156:159], a[188:191], v[252:255]
s_waitcnt lgkmcnt(14)
ds_read_b64_tr_b16 v[96:97], v6 offset:49152
v_mfma_f32_16x16x32_bf16 v[160:163], v[128:131], a[60:63], v[160:163]
ds_read_b64_tr_b16 v[98:99], v6 offset:53248
v_mfma_f32_16x16x32_bf16 v[164:167], v[128:131], a[64:67], v[164:167]
ds_read_b64_tr_b16 v[100:101], v7 offset:49152
v_mfma_f32_16x16x32_bf16 v[168:171], v[128:131], a[68:71], v[168:171]
s_waitcnt lgkmcnt(15)
ds_read_b64_tr_b16 v[102:103], v7 offset:53248
v_mfma_f32_16x16x32_bf16 v[172:175], v[132:135], a[60:63], v[172:175]
buffer_load_dwordx4 a[16:19], v2, s[32:35], s13 offen sc1
v_mfma_f32_16x16x32_bf16 v[176:179], v[132:135], a[64:67], v[176:179]
ds_read_b64_tr_b16 v[104:105], v8 offset:49152
v_mfma_f32_16x16x32_bf16 v[180:183], v[132:135], a[68:71], v[180:183]
s_waitcnt lgkmcnt(15)
ds_read_b64_tr_b16 v[106:107], v8 offset:53248
v_mfma_f32_16x16x32_bf16 v[184:187], v[136:139], a[60:63], v[184:187]
ds_read_b64_tr_b16 v[108:109], v9 offset:49152
v_mfma_f32_16x16x32_bf16 v[188:191], v[136:139], a[64:67], v[188:191]
ds_read_b64_tr_b16 v[110:111], v9 offset:53248
v_mfma_f32_16x16x32_bf16 v[192:195], v[136:139], a[68:71], v[192:195]
s_waitcnt lgkmcnt(15)
buffer_load_dwordx4 a[20:23], v3, s[32:35], s13 offen sc1
v_mfma_f32_16x16x32_bf16 v[196:199], v[140:143], a[60:63], v[196:199]
v_mfma_f32_16x16x32_bf16 v[200:203], v[140:143], a[64:67], v[200:203]
v_mfma_f32_16x16x32_bf16 v[204:207], v[140:143], a[68:71], v[204:207]
s_waitcnt vmcnt(18)
s_barrier
s_waitcnt lgkmcnt(14)
v_mfma_f32_16x16x32_bf16 v[208:211], v[112:115], a[192:195], v[208:211]
s_add_u32 m0, s62, 16384
ds_read_b64_tr_b16 v[144:145], v32 offset:8192
v_mfma_f32_16x16x32_bf16 v[212:215], v[112:115], a[196:199], v[212:215]
buffer_load_dwordx4 v4, s[28:31], s69 offen lds
v_mfma_f32_16x16x32_bf16 v[216:219], v[112:115], a[200:203], v[216:219]
s_waitcnt lgkmcnt(13)
ds_read_b64_tr_b16 v[146:147], v32 offset:12288
v_mfma_f32_16x16x32_bf16 v[220:223], v[116:119], a[192:195], v[220:223]
ds_read_b64_tr_b16 v[148:149], v33 offset:8192
v_mfma_f32_16x16x32_bf16 v[224:227], v[116:119], a[196:199], v[224:227]
ds_read_b64_tr_b16 v[150:151], v33 offset:12288
v_mfma_f32_16x16x32_bf16 v[228:231], v[116:119], a[200:203], v[228:231]
s_waitcnt lgkmcnt(14)
buffer_load_dwordx4 v5, s[28:31], s69 offen offset:1024 lds
v_mfma_f32_16x16x32_bf16 v[232:235], v[120:123], a[192:195], v[232:235]
ds_read_b64_tr_b16 v[152:153], v34 offset:8192
v_mfma_f32_16x16x32_bf16 v[236:239], v[120:123], a[196:199], v[236:239]
ds_read_b64_tr_b16 v[154:155], v34 offset:12288
v_mfma_f32_16x16x32_bf16 v[240:243], v[120:123], a[200:203], v[240:243]
s_waitcnt lgkmcnt(14)
ds_read_b64_tr_b16 v[156:157], v35 offset:8192
v_mfma_f32_16x16x32_bf16 v[244:247], v[124:127], a[192:195], v[244:247]
ds_read_b64_tr_b16 v[158:159], v35 offset:12288
v_mfma_f32_16x16x32_bf16 v[248:251], v[124:127], a[196:199], v[248:251]
buffer_load_dwordx4 a[24:27], v1, s[32:35], s14 offen sc1
v_mfma_f32_16x16x32_bf16 v[252:255], v[124:127], a[200:203], v[252:255]
s_waitcnt lgkmcnt(14)
ds_read_b64_tr_b16 v[128:129], v6 offset:57344
v_mfma_f32_16x16x32_bf16 v[160:163], v[96:99], a[72:75], v[160:163]
ds_read_b64_tr_b16 v[130:131], v6 offset:61440
v_mfma_f32_16x16x32_bf16 v[164:167], v[96:99], a[76:79], v[164:167]
ds_read_b64_tr_b16 v[132:133], v7 offset:57344
v_mfma_f32_16x16x32_bf16 v[168:171], v[96:99], a[80:83], v[168:171]
s_waitcnt lgkmcnt(15)
ds_read_b64_tr_b16 v[134:135], v7 offset:61440
v_mfma_f32_16x16x32_bf16 v[172:175], v[100:103], a[72:75], v[172:175]
buffer_load_dwordx4 a[28:31], v2, s[32:35], s14 offen sc1
v_mfma_f32_16x16x32_bf16 v[176:179], v[100:103], a[76:79], v[176:179]
ds_read_b64_tr_b16 v[136:137], v8 offset:57344
v_mfma_f32_16x16x32_bf16 v[180:183], v[100:103], a[80:83], v[180:183]
s_waitcnt lgkmcnt(15)
ds_read_b64_tr_b16 v[138:139], v8 offset:61440
v_mfma_f32_16x16x32_bf16 v[184:187], v[104:107], a[72:75], v[184:187]
ds_read_b64_tr_b16 v[140:141], v9 offset:57344
v_mfma_f32_16x16x32_bf16 v[188:191], v[104:107], a[76:79], v[188:191]
ds_read_b64_tr_b16 v[142:143], v9 offset:61440
v_mfma_f32_16x16x32_bf16 v[192:195], v[104:107], a[80:83], v[192:195]
s_waitcnt lgkmcnt(15)
buffer_load_dwordx4 a[32:35], v3, s[32:35], s14 offen sc1
v_mfma_f32_16x16x32_bf16 v[196:199], v[108:111], a[72:75], v[196:199]
v_mfma_f32_16x16x32_bf16 v[200:203], v[108:111], a[76:79], v[200:203]
v_mfma_f32_16x16x32_bf16 v[204:207], v[108:111], a[80:83], v[204:207]
s_waitcnt lgkmcnt(14)
v_mfma_f32_16x16x32_bf16 v[208:211], v[144:147], a[204:207], v[208:211]
s_add_u32 m0, s62, 24576
ds_read_b64_tr_b16 v[112:113], v32 offset:16384
v_mfma_f32_16x16x32_bf16 v[212:215], v[144:147], a[208:211], v[212:215]
buffer_load_dwordx4 v4, s[28:31], s70 offen lds
v_mfma_f32_16x16x32_bf16 v[216:219], v[144:147], a[212:215], v[216:219]
s_waitcnt lgkmcnt(13)
ds_read_b64_tr_b16 v[114:115], v32 offset:20480
v_mfma_f32_16x16x32_bf16 v[220:223], v[148:151], a[204:207], v[220:223]
ds_read_b64_tr_b16 v[116:117], v33 offset:16384
v_mfma_f32_16x16x32_bf16 v[224:227], v[148:151], a[208:211], v[224:227]
ds_read_b64_tr_b16 v[118:119], v33 offset:20480
v_mfma_f32_16x16x32_bf16 v[228:231], v[148:151], a[212:215], v[228:231]
s_waitcnt lgkmcnt(14)
buffer_load_dwordx4 v5, s[28:31], s70 offen offset:1024 lds
v_mfma_f32_16x16x32_bf16 v[232:235], v[152:155], a[204:207], v[232:235]
ds_read_b64_tr_b16 v[120:121], v34 offset:16384
v_mfma_f32_16x16x32_bf16 v[236:239], v[152:155], a[208:211], v[236:239]
ds_read_b64_tr_b16 v[122:123], v34 offset:20480
v_mfma_f32_16x16x32_bf16 v[240:243], v[152:155], a[212:215], v[240:243]
s_waitcnt lgkmcnt(14)
ds_read_b64_tr_b16 v[124:125], v35 offset:16384
v_mfma_f32_16x16x32_bf16 v[244:247], v[156:159], a[204:207], v[244:247]
ds_read_b64_tr_b16 v[126:127], v35 offset:20480
v_mfma_f32_16x16x32_bf16 v[248:251], v[156:159], a[208:211], v[248:251]
buffer_load_dwordx4 a[36:39], v1, s[32:35], s15 offen sc1
v_mfma_f32_16x16x32_bf16 v[252:255], v[156:159], a[212:215], v[252:255]
s_waitcnt lgkmcnt(14)
ds_read_b64_tr_b16 v[96:97], v17
v_mfma_f32_16x16x32_bf16 v[160:163], v[128:131], a[84:87], v[160:163]
ds_read_b64_tr_b16 v[98:99], v17 offset:4096
v_mfma_f32_16x16x32_bf16 v[164:167], v[128:131], a[88:91], v[164:167]
ds_read_b64_tr_b16 v[100:101], v18
v_mfma_f32_16x16x32_bf16 v[168:171], v[128:131], a[92:95], v[168:171]
s_waitcnt lgkmcnt(15)
ds_read_b64_tr_b16 v[102:103], v18 offset:4096
v_mfma_f32_16x16x32_bf16 v[172:175], v[132:135], a[84:87], v[172:175]
buffer_load_dwordx4 a[40:43], v2, s[32:35], s15 offen sc1
v_mfma_f32_16x16x32_bf16 v[176:179], v[132:135], a[88:91], v[176:179]
ds_read_b64_tr_b16 v[104:105], v19
v_mfma_f32_16x16x32_bf16 v[180:183], v[132:135], a[92:95], v[180:183]
s_waitcnt lgkmcnt(15)
ds_read_b64_tr_b16 v[106:107], v19 offset:4096
v_mfma_f32_16x16x32_bf16 v[184:187], v[136:139], a[84:87], v[184:187]
ds_read_b64_tr_b16 v[108:109], v20
v_mfma_f32_16x16x32_bf16 v[188:191], v[136:139], a[88:91], v[188:191]
ds_read_b64_tr_b16 v[110:111], v20 offset:4096
v_mfma_f32_16x16x32_bf16 v[192:195], v[136:139], a[92:95], v[192:195]
s_waitcnt lgkmcnt(15)
buffer_load_dwordx4 a[44:47], v3, s[32:35], s15 offen sc1
v_mfma_f32_16x16x32_bf16 v[196:199], v[140:143], a[84:87], v[196:199]
v_mfma_f32_16x16x32_bf16 v[200:203], v[140:143], a[88:91], v[200:203]
v_mfma_f32_16x16x32_bf16 v[204:207], v[140:143], a[92:95], v[204:207]
s_waitcnt vmcnt(18)
s_barrier
s_waitcnt lgkmcnt(14)
v_mfma_f32_16x16x32_bf16 v[208:211], v[112:115], a[216:219], v[208:211]
s_add_u32 m0, s62, 32768
ds_read_b64_tr_b16 v[144:145], v32 offset:24576
v_mfma_f32_16x16x32_bf16 v[212:215], v[112:115], a[220:223], v[212:215]
buffer_load_dwordx4 v4, s[28:31], s71 offen lds
v_mfma_f32_16x16x32_bf16 v[216:219], v[112:115], a[224:227], v[216:219]
s_waitcnt lgkmcnt(13)
ds_read_b64_tr_b16 v[146:147], v32 offset:28672
v_mfma_f32_16x16x32_bf16 v[220:223], v[116:119], a[216:219], v[220:223]
ds_read_b64_tr_b16 v[148:149], v33 offset:24576
v_mfma_f32_16x16x32_bf16 v[224:227], v[116:119], a[220:223], v[224:227]
ds_read_b64_tr_b16 v[150:151], v33 offset:28672
v_mfma_f32_16x16x32_bf16 v[228:231], v[116:119], a[224:227], v[228:231]
s_waitcnt lgkmcnt(14)
buffer_load_dwordx4 v5, s[28:31], s71 offen offset:1024 lds
v_mfma_f32_16x16x32_bf16 v[232:235], v[120:123], a[216:219], v[232:235]
ds_read_b64_tr_b16 v[152:153], v34 offset:24576
v_mfma_f32_16x16x32_bf16 v[236:239], v[120:123], a[220:223], v[236:239]
ds_read_b64_tr_b16 v[154:155], v34 offset:28672
v_mfma_f32_16x16x32_bf16 v[240:243], v[120:123], a[224:227], v[240:243]
s_waitcnt lgkmcnt(14)
ds_read_b64_tr_b16 v[156:157], v35 offset:24576
v_mfma_f32_16x16x32_bf16 v[244:247], v[124:127], a[216:219], v[244:247]
ds_read_b64_tr_b16 v[158:159], v35 offset:28672
v_mfma_f32_16x16x32_bf16 v[248:251], v[124:127], a[220:223], v[248:251]
buffer_load_dwordx4 a[48:51], v1, s[32:35], s16 offen sc1
v_mfma_f32_16x16x32_bf16 v[252:255], v[124:127], a[224:227], v[252:255]
s_waitcnt lgkmcnt(14)
ds_read_b64_tr_b16 v[128:129], v17 offset:8192
v_mfma_f32_16x16x32_bf16 v[160:163], v[96:99], a[96:99], v[160:163]
ds_read_b64_tr_b16 v[130:131], v17 offset:12288
v_mfma_f32_16x16x32_bf16 v[164:167], v[96:99], a[100:103], v[164:167]
ds_read_b64_tr_b16 v[132:133], v18 offset:8192
v_mfma_f32_16x16x32_bf16 v[168:171], v[96:99], a[104:107], v[168:171]
s_waitcnt lgkmcnt(15)
ds_read_b64_tr_b16 v[134:135], v18 offset:12288
v_mfma_f32_16x16x32_bf16 v[172:175], v[100:103], a[96:99], v[172:175]
buffer_load_dwordx4 a[52:55], v2, s[32:35], s16 offen sc1
v_mfma_f32_16x16x32_bf16 v[176:179], v[100:103], a[100:103], v[176:179]
ds_read_b64_tr_b16 v[136:137], v19 offset:8192
v_mfma_f32_16x16x32_bf16 v[180:183], v[100:103], a[104:107], v[180:183]
s_waitcnt lgkmcnt(15)
ds_read_b64_tr_b16 v[138:139], v19 offset:12288
v_mfma_f32_16x16x32_bf16 v[184:187], v[104:107], a[96:99], v[184:187]
ds_read_b64_tr_b16 v[140:141], v20 offset:8192
v_mfma_f32_16x16x32_bf16 v[188:191], v[104:107], a[100:103], v[188:191]
ds_read_b64_tr_b16 v[142:143], v20 offset:12288
v_mfma_f32_16x16x32_bf16 v[192:195], v[104:107], a[104:107], v[192:195]
s_waitcnt lgkmcnt(15)
buffer_load_dwordx4 a[56:59], v3, s[32:35], s16 offen sc1
v_mfma_f32_16x16x32_bf16 v[196:199], v[108:111], a[96:99], v[196:199]
v_mfma_f32_16x16x32_bf16 v[200:203], v[108:111], a[100:103], v[200:203]
v_mfma_f32_16x16x32_bf16 v[204:207], v[108:111], a[104:107], v[204:207]
s_waitcnt lgkmcnt(14)
v_mfma_f32_16x16x32_bf16 v[208:211], v[144:147], a[228:231], v[208:211]
s_add_u32 m0, s62, 40960
ds_read_b64_tr_b16 v[112:113], v10
v_mfma_f32_16x16x32_bf16 v[212:215], v[144:147], a[232:235], v[212:215]
buffer_load_dwordx4 v4, s[28:31], s79 offen lds
v_mfma_f32_16x16x32_bf16 v[216:219], v[144:147], a[236:239], v[216:219]
s_waitcnt lgkmcnt(13)
ds_read_b64_tr_b16 v[114:115], v10 offset:4096
v_mfma_f32_16x16x32_bf16 v[220:223], v[148:151], a[228:231], v[220:223]
ds_read_b64_tr_b16 v[116:117], v11
v_mfma_f32_16x16x32_bf16 v[224:227], v[148:151], a[232:235], v[224:227]
ds_read_b64_tr_b16 v[118:119], v11 offset:4096
v_mfma_f32_16x16x32_bf16 v[228:231], v[148:151], a[236:239], v[228:231]
s_waitcnt lgkmcnt(14)
buffer_load_dwordx4 v5, s[28:31], s79 offen offset:1024 lds
v_mfma_f32_16x16x32_bf16 v[232:235], v[152:155], a[228:231], v[232:235]
ds_read_b64_tr_b16 v[120:121], v12
v_mfma_f32_16x16x32_bf16 v[236:239], v[152:155], a[232:235], v[236:239]
ds_read_b64_tr_b16 v[122:123], v12 offset:4096
v_mfma_f32_16x16x32_bf16 v[240:243], v[152:155], a[236:239], v[240:243]
s_waitcnt lgkmcnt(14)
ds_read_b64_tr_b16 v[124:125], v13
v_mfma_f32_16x16x32_bf16 v[244:247], v[156:159], a[228:231], v[244:247]
ds_read_b64_tr_b16 v[126:127], v13 offset:4096
v_mfma_f32_16x16x32_bf16 v[248:251], v[156:159], a[232:235], v[248:251]
buffer_load_dwordx4 a[60:63], v1, s[32:35], s17 offen sc1
v_mfma_f32_16x16x32_bf16 v[252:255], v[156:159], a[236:239], v[252:255]
s_waitcnt lgkmcnt(14)
ds_read_b64_tr_b16 v[96:97], v17 offset:16384
v_mfma_f32_16x16x32_bf16 v[160:163], v[128:131], a[108:111], v[160:163]
ds_read_b64_tr_b16 v[98:99], v17 offset:20480
v_mfma_f32_16x16x32_bf16 v[164:167], v[128:131], a[112:115], v[164:167]
ds_read_b64_tr_b16 v[100:101], v18 offset:16384
v_mfma_f32_16x16x32_bf16 v[168:171], v[128:131], a[116:119], v[168:171]
s_waitcnt lgkmcnt(15)
ds_read_b64_tr_b16 v[102:103], v18 offset:20480
v_mfma_f32_16x16x32_bf16 v[172:175], v[132:135], a[108:111], v[172:175]
buffer_load_dwordx4 a[64:67], v2, s[32:35], s17 offen sc1
v_mfma_f32_16x16x32_bf16 v[176:179], v[132:135], a[112:115], v[176:179]
ds_read_b64_tr_b16 v[104:105], v19 offset:16384
v_mfma_f32_16x16x32_bf16 v[180:183], v[132:135], a[116:119], v[180:183]
s_waitcnt lgkmcnt(15)
ds_read_b64_tr_b16 v[106:107], v19 offset:20480
v_mfma_f32_16x16x32_bf16 v[184:187], v[136:139], a[108:111], v[184:187]
ds_read_b64_tr_b16 v[108:109], v20 offset:16384
v_mfma_f32_16x16x32_bf16 v[188:191], v[136:139], a[112:115], v[188:191]
ds_read_b64_tr_b16 v[110:111], v20 offset:20480
v_mfma_f32_16x16x32_bf16 v[192:195], v[136:139], a[116:119], v[192:195]
s_waitcnt lgkmcnt(15)
buffer_load_dwordx4 a[68:71], v3, s[32:35], s17 offen sc1
v_mfma_f32_16x16x32_bf16 v[196:199], v[140:143], a[108:111], v[196:199]
v_mfma_f32_16x16x32_bf16 v[200:203], v[140:143], a[112:115], v[200:203]
v_mfma_f32_16x16x32_bf16 v[204:207], v[140:143], a[116:119], v[204:207]
s_waitcnt vmcnt(18)
s_barrier
s_mov_b64 exec, 3
buffer_load_dword v38, v36, s[72:75], 0 offen sc1
s_mov_b64 exec, -1
s_waitcnt lgkmcnt(14)
v_mfma_f32_16x16x32_bf16 v[208:211], v[112:115], a[0:3], v[208:211]
s_add_u32 m0, s62, 49152
ds_read_b64_tr_b16 v[144:145], v10 offset:8192
v_mfma_f32_16x16x32_bf16 v[212:215], v[112:115], a[4:7], v[212:215]
buffer_load_dwordx4 v4, s[28:31], s80 offen lds
v_mfma_f32_16x16x32_bf16 v[216:219], v[112:115], a[8:11], v[216:219]
s_waitcnt lgkmcnt(13)
ds_read_b64_tr_b16 v[146:147], v10 offset:12288
v_mfma_f32_16x16x32_bf16 v[220:223], v[116:119], a[0:3], v[220:223]
ds_read_b64_tr_b16 v[148:149], v11 offset:8192
v_mfma_f32_16x16x32_bf16 v[224:227], v[116:119], a[4:7], v[224:227]
ds_read_b64_tr_b16 v[150:151], v11 offset:12288
v_mfma_f32_16x16x32_bf16 v[228:231], v[116:119], a[8:11], v[228:231]
s_waitcnt lgkmcnt(14)
buffer_load_dwordx4 v5, s[28:31], s80 offen offset:1024 lds
v_mfma_f32_16x16x32_bf16 v[232:235], v[120:123], a[0:3], v[232:235]
ds_read_b64_tr_b16 v[152:153], v12 offset:8192
v_mfma_f32_16x16x32_bf16 v[236:239], v[120:123], a[4:7], v[236:239]
ds_read_b64_tr_b16 v[154:155], v12 offset:12288
v_mfma_f32_16x16x32_bf16 v[240:243], v[120:123], a[8:11], v[240:243]
s_waitcnt lgkmcnt(14)
ds_read_b64_tr_b16 v[156:157], v13 offset:8192
v_mfma_f32_16x16x32_bf16 v[244:247], v[124:127], a[0:3], v[244:247]
ds_read_b64_tr_b16 v[158:159], v13 offset:12288
v_mfma_f32_16x16x32_bf16 v[248:251], v[124:127], a[4:7], v[248:251]
buffer_load_dwordx4 a[72:75], v1, s[32:35], s18 offen sc1
v_mfma_f32_16x16x32_bf16 v[252:255], v[124:127], a[8:11], v[252:255]
s_waitcnt lgkmcnt(14)
ds_read_b64_tr_b16 v[128:129], v17 offset:24576
v_mfma_f32_16x16x32_bf16 v[160:163], v[96:99], a[120:123], v[160:163]
ds_read_b64_tr_b16 v[130:131], v17 offset:28672
v_mfma_f32_16x16x32_bf16 v[164:167], v[96:99], a[124:127], v[164:167]
ds_read_b64_tr_b16 v[132:133], v18 offset:24576
v_mfma_f32_16x16x32_bf16 v[168:171], v[96:99], a[128:131], v[168:171]
s_waitcnt lgkmcnt(15)
ds_read_b64_tr_b16 v[134:135], v18 offset:28672
v_mfma_f32_16x16x32_bf16 v[172:175], v[100:103], a[120:123], v[172:175]
buffer_load_dwordx4 a[76:79], v2, s[32:35], s18 offen sc1
v_mfma_f32_16x16x32_bf16 v[176:179], v[100:103], a[124:127], v[176:179]
ds_read_b64_tr_b16 v[136:137], v19 offset:24576
v_mfma_f32_16x16x32_bf16 v[180:183], v[100:103], a[128:131], v[180:183]
s_waitcnt lgkmcnt(15)
ds_read_b64_tr_b16 v[138:139], v19 offset:28672
v_mfma_f32_16x16x32_bf16 v[184:187], v[104:107], a[120:123], v[184:187]
ds_read_b64_tr_b16 v[140:141], v20 offset:24576
v_mfma_f32_16x16x32_bf16 v[188:191], v[104:107], a[124:127], v[188:191]
ds_read_b64_tr_b16 v[142:143], v20 offset:28672
v_mfma_f32_16x16x32_bf16 v[192:195], v[104:107], a[128:131], v[192:195]
s_waitcnt lgkmcnt(15)
buffer_load_dwordx4 a[80:83], v3, s[32:35], s18 offen sc1
v_mfma_f32_16x16x32_bf16 v[196:199], v[108:111], a[120:123], v[196:199]
v_mfma_f32_16x16x32_bf16 v[200:203], v[108:111], a[124:127], v[200:203]
v_mfma_f32_16x16x32_bf16 v[204:207], v[108:111], a[128:131], v[204:207]
s_waitcnt lgkmcnt(14)
v_mfma_f32_16x16x32_bf16 v[208:211], v[144:147], a[12:15], v[208:211]
s_add_u32 m0, s62, 57344
ds_read_b64_tr_b16 v[112:113], v10 offset:16384
v_mfma_f32_16x16x32_bf16 v[212:215], v[144:147], a[16:19], v[212:215]
buffer_load_dwordx4 v4, s[28:31], s81 offen lds
v_mfma_f32_16x16x32_bf16 v[216:219], v[144:147], a[20:23], v[216:219]
s_waitcnt lgkmcnt(13)
ds_read_b64_tr_b16 v[114:115], v10 offset:20480
v_mfma_f32_16x16x32_bf16 v[220:223], v[148:151], a[12:15], v[220:223]
ds_read_b64_tr_b16 v[116:117], v11 offset:16384
v_mfma_f32_16x16x32_bf16 v[224:227], v[148:151], a[16:19], v[224:227]
ds_read_b64_tr_b16 v[118:119], v11 offset:20480
v_mfma_f32_16x16x32_bf16 v[228:231], v[148:151], a[20:23], v[228:231]
s_waitcnt lgkmcnt(14)
buffer_load_dwordx4 v5, s[28:31], s81 offen offset:1024 lds
v_mfma_f32_16x16x32_bf16 v[232:235], v[152:155], a[12:15], v[232:235]
ds_read_b64_tr_b16 v[120:121], v12 offset:16384
v_mfma_f32_16x16x32_bf16 v[236:239], v[152:155], a[16:19], v[236:239]
ds_read_b64_tr_b16 v[122:123], v12 offset:20480
v_mfma_f32_16x16x32_bf16 v[240:243], v[152:155], a[20:23], v[240:243]
s_waitcnt lgkmcnt(14)
ds_read_b64_tr_b16 v[124:125], v13 offset:16384
v_mfma_f32_16x16x32_bf16 v[244:247], v[156:159], a[12:15], v[244:247]
ds_read_b64_tr_b16 v[126:127], v13 offset:20480
v_mfma_f32_16x16x32_bf16 v[248:251], v[156:159], a[16:19], v[248:251]
buffer_load_dwordx4 a[84:87], v1, s[32:35], s19 offen sc1
v_mfma_f32_16x16x32_bf16 v[252:255], v[156:159], a[20:23], v[252:255]
s_waitcnt lgkmcnt(14)
ds_read_b64_tr_b16 v[96:97], v17 offset:32768
v_mfma_f32_16x16x32_bf16 v[160:163], v[128:131], a[132:135], v[160:163]
ds_read_b64_tr_b16 v[98:99], v17 offset:36864
v_mfma_f32_16x16x32_bf16 v[164:167], v[128:131], a[136:139], v[164:167]
ds_read_b64_tr_b16 v[100:101], v18 offset:32768
v_mfma_f32_16x16x32_bf16 v[168:171], v[128:131], a[140:143], v[168:171]
s_waitcnt lgkmcnt(15)
ds_read_b64_tr_b16 v[102:103], v18 offset:36864
v_mfma_f32_16x16x32_bf16 v[172:175], v[132:135], a[132:135], v[172:175]
buffer_load_dwordx4 a[88:91], v2, s[32:35], s19 offen sc1
v_mfma_f32_16x16x32_bf16 v[176:179], v[132:135], a[136:139], v[176:179]
ds_read_b64_tr_b16 v[104:105], v19 offset:32768
v_mfma_f32_16x16x32_bf16 v[180:183], v[132:135], a[140:143], v[180:183]
s_waitcnt lgkmcnt(15)
ds_read_b64_tr_b16 v[106:107], v19 offset:36864
v_mfma_f32_16x16x32_bf16 v[184:187], v[136:139], a[132:135], v[184:187]
ds_read_b64_tr_b16 v[108:109], v20 offset:32768
v_mfma_f32_16x16x32_bf16 v[188:191], v[136:139], a[136:139], v[188:191]
ds_read_b64_tr_b16 v[110:111], v20 offset:36864
v_mfma_f32_16x16x32_bf16 v[192:195], v[136:139], a[140:143], v[192:195]
s_waitcnt lgkmcnt(15)
buffer_load_dwordx4 a[92:95], v3, s[32:35], s19 offen sc1
v_mfma_f32_16x16x32_bf16 v[196:199], v[140:143], a[132:135], v[196:199]
v_mfma_f32_16x16x32_bf16 v[200:203], v[140:143], a[136:139], v[200:203]
v_mfma_f32_16x16x32_bf16 v[204:207], v[140:143], a[140:143], v[204:207]
s_waitcnt vmcnt(19)
s_barrier
s_waitcnt lgkmcnt(14)
v_mfma_f32_16x16x32_bf16 v[208:211], v[112:115], a[24:27], v[208:211]
s_add_u32 m0, s62, 65536
ds_read_b64_tr_b16 v[144:145], v10 offset:24576
v_mfma_f32_16x16x32_bf16 v[212:215], v[112:115], a[28:31], v[212:215]
buffer_load_dwordx4 v4, s[28:31], s82 offen lds
v_mfma_f32_16x16x32_bf16 v[216:219], v[112:115], a[32:35], v[216:219]
s_waitcnt lgkmcnt(13)
ds_read_b64_tr_b16 v[146:147], v10 offset:28672
v_mfma_f32_16x16x32_bf16 v[220:223], v[116:119], a[24:27], v[220:223]
ds_read_b64_tr_b16 v[148:149], v11 offset:24576
v_mfma_f32_16x16x32_bf16 v[224:227], v[116:119], a[28:31], v[224:227]
ds_read_b64_tr_b16 v[150:151], v11 offset:28672
v_mfma_f32_16x16x32_bf16 v[228:231], v[116:119], a[32:35], v[228:231]
s_waitcnt lgkmcnt(14)
buffer_load_dwordx4 v5, s[28:31], s82 offen offset:1024 lds
v_mfma_f32_16x16x32_bf16 v[232:235], v[120:123], a[24:27], v[232:235]
ds_read_b64_tr_b16 v[152:153], v12 offset:24576
v_mfma_f32_16x16x32_bf16 v[236:239], v[120:123], a[28:31], v[236:239]
ds_read_b64_tr_b16 v[154:155], v12 offset:28672
v_mfma_f32_16x16x32_bf16 v[240:243], v[120:123], a[32:35], v[240:243]
s_waitcnt lgkmcnt(14)
ds_read_b64_tr_b16 v[156:157], v13 offset:24576
v_mfma_f32_16x16x32_bf16 v[244:247], v[124:127], a[24:27], v[244:247]
ds_read_b64_tr_b16 v[158:159], v13 offset:28672
v_mfma_f32_16x16x32_bf16 v[248:251], v[124:127], a[28:31], v[248:251]
buffer_load_dwordx4 a[96:99], v1, s[32:35], s20 offen sc1
v_mfma_f32_16x16x32_bf16 v[252:255], v[124:127], a[32:35], v[252:255]
s_waitcnt lgkmcnt(14)
ds_read_b64_tr_b16 v[128:129], v17 offset:40960
v_mfma_f32_16x16x32_bf16 v[160:163], v[96:99], a[144:147], v[160:163]
ds_read_b64_tr_b16 v[130:131], v17 offset:45056
v_mfma_f32_16x16x32_bf16 v[164:167], v[96:99], a[148:151], v[164:167]
ds_read_b64_tr_b16 v[132:133], v18 offset:40960
v_mfma_f32_16x16x32_bf16 v[168:171], v[96:99], a[152:155], v[168:171]
s_waitcnt lgkmcnt(15)
ds_read_b64_tr_b16 v[134:135], v18 offset:45056
v_mfma_f32_16x16x32_bf16 v[172:175], v[100:103], a[144:147], v[172:175]
buffer_load_dwordx4 a[100:103], v2, s[32:35], s20 offen sc1
v_mfma_f32_16x16x32_bf16 v[176:179], v[100:103], a[148:151], v[176:179]
ds_read_b64_tr_b16 v[136:137], v19 offset:40960
v_mfma_f32_16x16x32_bf16 v[180:183], v[100:103], a[152:155], v[180:183]
s_waitcnt lgkmcnt(15)
ds_read_b64_tr_b16 v[138:139], v19 offset:45056
v_mfma_f32_16x16x32_bf16 v[184:187], v[104:107], a[144:147], v[184:187]
ds_read_b64_tr_b16 v[140:141], v20 offset:40960
v_mfma_f32_16x16x32_bf16 v[188:191], v[104:107], a[148:151], v[188:191]
ds_read_b64_tr_b16 v[142:143], v20 offset:45056
v_mfma_f32_16x16x32_bf16 v[192:195], v[104:107], a[152:155], v[192:195]
s_waitcnt lgkmcnt(15)
buffer_load_dwordx4 a[104:107], v3, s[32:35], s20 offen sc1
v_mfma_f32_16x16x32_bf16 v[196:199], v[108:111], a[144:147], v[196:199]
v_mfma_f32_16x16x32_bf16 v[200:203], v[108:111], a[148:151], v[200:203]
v_mfma_f32_16x16x32_bf16 v[204:207], v[108:111], a[152:155], v[204:207]
s_waitcnt lgkmcnt(14)
v_mfma_f32_16x16x32_bf16 v[208:211], v[144:147], a[36:39], v[208:211]
s_add_u32 m0, s62, 73728
ds_read_b64_tr_b16 v[112:113], v10 offset:32768
v_mfma_f32_16x16x32_bf16 v[212:215], v[144:147], a[40:43], v[212:215]
buffer_load_dwordx4 v4, s[28:31], s83 offen lds
v_mfma_f32_16x16x32_bf16 v[216:219], v[144:147], a[44:47], v[216:219]
s_waitcnt lgkmcnt(13)
ds_read_b64_tr_b16 v[114:115], v10 offset:36864
v_mfma_f32_16x16x32_bf16 v[220:223], v[148:151], a[36:39], v[220:223]
ds_read_b64_tr_b16 v[116:117], v11 offset:32768
v_mfma_f32_16x16x32_bf16 v[224:227], v[148:151], a[40:43], v[224:227]
ds_read_b64_tr_b16 v[118:119], v11 offset:36864
v_mfma_f32_16x16x32_bf16 v[228:231], v[148:151], a[44:47], v[228:231]
s_waitcnt lgkmcnt(14)
buffer_load_dwordx4 v5, s[28:31], s83 offen offset:1024 lds
v_mfma_f32_16x16x32_bf16 v[232:235], v[152:155], a[36:39], v[232:235]
ds_read_b64_tr_b16 v[120:121], v12 offset:32768
v_mfma_f32_16x16x32_bf16 v[236:239], v[152:155], a[40:43], v[236:239]
ds_read_b64_tr_b16 v[122:123], v12 offset:36864
v_mfma_f32_16x16x32_bf16 v[240:243], v[152:155], a[44:47], v[240:243]
s_waitcnt lgkmcnt(14)
ds_read_b64_tr_b16 v[124:125], v13 offset:32768
v_mfma_f32_16x16x32_bf16 v[244:247], v[156:159], a[36:39], v[244:247]
ds_read_b64_tr_b16 v[126:127], v13 offset:36864
v_mfma_f32_16x16x32_bf16 v[248:251], v[156:159], a[40:43], v[248:251]
buffer_load_dwordx4 a[108:111], v1, s[32:35], s22 offen sc1
v_mfma_f32_16x16x32_bf16 v[252:255], v[156:159], a[44:47], v[252:255]
s_waitcnt lgkmcnt(14)
ds_read_b64_tr_b16 v[96:97], v17 offset:49152
v_mfma_f32_16x16x32_bf16 v[160:163], v[128:131], a[156:159], v[160:163]
ds_read_b64_tr_b16 v[98:99], v17 offset:53248
v_mfma_f32_16x16x32_bf16 v[164:167], v[128:131], a[160:163], v[164:167]
ds_read_b64_tr_b16 v[100:101], v18 offset:49152
v_mfma_f32_16x16x32_bf16 v[168:171], v[128:131], a[164:167], v[168:171]
s_waitcnt lgkmcnt(15)
ds_read_b64_tr_b16 v[102:103], v18 offset:53248
v_mfma_f32_16x16x32_bf16 v[172:175], v[132:135], a[156:159], v[172:175]
buffer_load_dwordx4 a[112:115], v2, s[32:35], s22 offen sc1
v_mfma_f32_16x16x32_bf16 v[176:179], v[132:135], a[160:163], v[176:179]
ds_read_b64_tr_b16 v[104:105], v19 offset:49152
v_mfma_f32_16x16x32_bf16 v[180:183], v[132:135], a[164:167], v[180:183]
s_waitcnt lgkmcnt(15)
ds_read_b64_tr_b16 v[106:107], v19 offset:53248
v_mfma_f32_16x16x32_bf16 v[184:187], v[136:139], a[156:159], v[184:187]
ds_read_b64_tr_b16 v[108:109], v20 offset:49152
v_mfma_f32_16x16x32_bf16 v[188:191], v[136:139], a[160:163], v[188:191]
ds_read_b64_tr_b16 v[110:111], v20 offset:53248
v_mfma_f32_16x16x32_bf16 v[192:195], v[136:139], a[164:167], v[192:195]
s_waitcnt lgkmcnt(15)
buffer_load_dwordx4 a[116:119], v3, s[32:35], s22 offen sc1
v_mfma_f32_16x16x32_bf16 v[196:199], v[140:143], a[156:159], v[196:199]
v_mfma_f32_16x16x32_bf16 v[200:203], v[140:143], a[160:163], v[200:203]
v_mfma_f32_16x16x32_bf16 v[204:207], v[140:143], a[164:167], v[204:207]
s_waitcnt vmcnt(18)
s_barrier
s_waitcnt lgkmcnt(14)
v_mfma_f32_16x16x32_bf16 v[208:211], v[112:115], a[48:51], v[208:211]
s_add_u32 m0, s62, 81920
ds_read_b64_tr_b16 v[144:145], v10 offset:40960
v_mfma_f32_16x16x32_bf16 v[212:215], v[112:115], a[52:55], v[212:215]
buffer_load_dwordx4 v4, s[28:31], s25 offen lds
v_mfma_f32_16x16x32_bf16 v[216:219], v[112:115], a[56:59], v[216:219]
s_waitcnt lgkmcnt(13)
ds_read_b64_tr_b16 v[146:147], v10 offset:45056
v_mfma_f32_16x16x32_bf16 v[220:223], v[116:119], a[48:51], v[220:223]
ds_read_b64_tr_b16 v[148:149], v11 offset:40960
v_mfma_f32_16x16x32_bf16 v[224:227], v[116:119], a[52:55], v[224:227]
ds_read_b64_tr_b16 v[150:151], v11 offset:45056
v_mfma_f32_16x16x32_bf16 v[228:231], v[116:119], a[56:59], v[228:231]
s_waitcnt lgkmcnt(14)
buffer_load_dwordx4 v5, s[28:31], s25 offen offset:1024 lds
v_mfma_f32_16x16x32_bf16 v[232:235], v[120:123], a[48:51], v[232:235]
ds_read_b64_tr_b16 v[152:153], v12 offset:40960
v_mfma_f32_16x16x32_bf16 v[236:239], v[120:123], a[52:55], v[236:239]
ds_read_b64_tr_b16 v[154:155], v12 offset:45056
v_mfma_f32_16x16x32_bf16 v[240:243], v[120:123], a[56:59], v[240:243]
s_waitcnt lgkmcnt(14)
ds_read_b64_tr_b16 v[156:157], v13 offset:40960
v_mfma_f32_16x16x32_bf16 v[244:247], v[124:127], a[48:51], v[244:247]
ds_read_b64_tr_b16 v[158:159], v13 offset:45056
v_mfma_f32_16x16x32_bf16 v[248:251], v[124:127], a[52:55], v[248:251]
buffer_load_dwordx4 a[120:123], v1, s[32:35], s23 offen sc1
v_mfma_f32_16x16x32_bf16 v[252:255], v[124:127], a[56:59], v[252:255]
s_waitcnt lgkmcnt(14)
ds_read_b64_tr_b16 v[128:129], v17 offset:57344
v_mfma_f32_16x16x32_bf16 v[160:163], v[96:99], a[168:171], v[160:163]
ds_read_b64_tr_b16 v[130:131], v17 offset:61440
v_mfma_f32_16x16x32_bf16 v[164:167], v[96:99], a[172:175], v[164:167]
ds_read_b64_tr_b16 v[132:133], v18 offset:57344
v_mfma_f32_16x16x32_bf16 v[168:171], v[96:99], a[176:179], v[168:171]
s_waitcnt lgkmcnt(15)
ds_read_b64_tr_b16 v[134:135], v18 offset:61440
v_mfma_f32_16x16x32_bf16 v[172:175], v[100:103], a[168:171], v[172:175]
buffer_load_dwordx4 a[124:127], v2, s[32:35], s23 offen sc1
v_mfma_f32_16x16x32_bf16 v[176:179], v[100:103], a[172:175], v[176:179]
ds_read_b64_tr_b16 v[136:137], v19 offset:57344
v_mfma_f32_16x16x32_bf16 v[180:183], v[100:103], a[176:179], v[180:183]
s_waitcnt lgkmcnt(15)
ds_read_b64_tr_b16 v[138:139], v19 offset:61440
v_mfma_f32_16x16x32_bf16 v[184:187], v[104:107], a[168:171], v[184:187]
ds_read_b64_tr_b16 v[140:141], v20 offset:57344
v_mfma_f32_16x16x32_bf16 v[188:191], v[104:107], a[172:175], v[188:191]
ds_read_b64_tr_b16 v[142:143], v20 offset:61440
v_mfma_f32_16x16x32_bf16 v[192:195], v[104:107], a[176:179], v[192:195]
s_waitcnt lgkmcnt(15)
buffer_load_dwordx4 a[128:131], v3, s[32:35], s23 offen sc1
v_mfma_f32_16x16x32_bf16 v[196:199], v[108:111], a[168:171], v[196:199]
v_mfma_f32_16x16x32_bf16 v[200:203], v[108:111], a[172:175], v[200:203]
v_mfma_f32_16x16x32_bf16 v[204:207], v[108:111], a[176:179], v[204:207]
s_waitcnt lgkmcnt(14)
v_mfma_f32_16x16x32_bf16 v[208:211], v[144:147], a[60:63], v[208:211]
s_add_u32 m0, s62, 90112
ds_read_b64_tr_b16 v[112:113], v10 offset:49152
v_mfma_f32_16x16x32_bf16 v[212:215], v[144:147], a[64:67], v[212:215]
buffer_load_dwordx4 v4, s[28:31], s49 offen lds
v_mfma_f32_16x16x32_bf16 v[216:219], v[144:147], a[68:71], v[216:219]
s_waitcnt lgkmcnt(13)
ds_read_b64_tr_b16 v[114:115], v10 offset:53248
v_mfma_f32_16x16x32_bf16 v[220:223], v[148:151], a[60:63], v[220:223]
ds_read_b64_tr_b16 v[116:117], v11 offset:49152
v_mfma_f32_16x16x32_bf16 v[224:227], v[148:151], a[64:67], v[224:227]
ds_read_b64_tr_b16 v[118:119], v11 offset:53248
v_mfma_f32_16x16x32_bf16 v[228:231], v[148:151], a[68:71], v[228:231]
s_waitcnt lgkmcnt(14)
buffer_load_dwordx4 v5, s[28:31], s49 offen offset:1024 lds
v_mfma_f32_16x16x32_bf16 v[232:235], v[152:155], a[60:63], v[232:235]
ds_read_b64_tr_b16 v[120:121], v12 offset:49152
v_mfma_f32_16x16x32_bf16 v[236:239], v[152:155], a[64:67], v[236:239]
ds_read_b64_tr_b16 v[122:123], v12 offset:53248
v_mfma_f32_16x16x32_bf16 v[240:243], v[152:155], a[68:71], v[240:243]
s_waitcnt lgkmcnt(14)
ds_read_b64_tr_b16 v[124:125], v13 offset:49152
v_mfma_f32_16x16x32_bf16 v[244:247], v[156:159], a[60:63], v[244:247]
ds_read_b64_tr_b16 v[126:127], v13 offset:53248
v_mfma_f32_16x16x32_bf16 v[248:251], v[156:159], a[64:67], v[248:251]
buffer_load_dwordx4 a[132:135], v1, s[32:35], s24 offen sc1
v_mfma_f32_16x16x32_bf16 v[252:255], v[156:159], a[68:71], v[252:255]
s_waitcnt lgkmcnt(14)
ds_read_b64_tr_b16 v[96:97], v28
v_mfma_f32_16x16x32_bf16 v[160:163], v[128:131], a[180:183], v[160:163]
ds_read_b64_tr_b16 v[98:99], v28 offset:4096
v_mfma_f32_16x16x32_bf16 v[164:167], v[128:131], a[184:187], v[164:167]
ds_read_b64_tr_b16 v[100:101], v29
v_mfma_f32_16x16x32_bf16 v[168:171], v[128:131], a[188:191], v[168:171]
s_waitcnt lgkmcnt(15)
ds_read_b64_tr_b16 v[102:103], v29 offset:4096
v_mfma_f32_16x16x32_bf16 v[172:175], v[132:135], a[180:183], v[172:175]
buffer_load_dwordx4 a[136:139], v2, s[32:35], s24 offen sc1
v_mfma_f32_16x16x32_bf16 v[176:179], v[132:135], a[184:187], v[176:179]
ds_read_b64_tr_b16 v[104:105], v30
v_mfma_f32_16x16x32_bf16 v[180:183], v[132:135], a[188:191], v[180:183]
s_waitcnt lgkmcnt(15)
ds_read_b64_tr_b16 v[106:107], v30 offset:4096
v_mfma_f32_16x16x32_bf16 v[184:187], v[136:139], a[180:183], v[184:187]
ds_read_b64_tr_b16 v[108:109], v31
v_mfma_f32_16x16x32_bf16 v[188:191], v[136:139], a[184:187], v[188:191]
ds_read_b64_tr_b16 v[110:111], v31 offset:4096
v_mfma_f32_16x16x32_bf16 v[192:195], v[136:139], a[188:191], v[192:195]
s_waitcnt lgkmcnt(15)
buffer_load_dwordx4 a[140:143], v3, s[32:35], s24 offen sc1
v_mfma_f32_16x16x32_bf16 v[196:199], v[140:143], a[180:183], v[196:199]
v_mfma_f32_16x16x32_bf16 v[200:203], v[140:143], a[184:187], v[200:203]
v_mfma_f32_16x16x32_bf16 v[204:207], v[140:143], a[188:191], v[204:207]
s_waitcnt vmcnt(18)
s_barrier
s_nop 0
s_cmp_lg_u32 s3, 0
s_cbranch_scc1 L2_djb
s_mov_b32 s52, -1
s_mov_b32 s50, 4000
v_mov_b32 v37, 0xff
v_writelane_b32 v37, s52, 0
s_mov_b64 exec, 3
L2_dpb:
v_xor_b32 v38, 0x20202020, v38
v_and_b32 v38, v37, v38
v_cmp_ne_u32 vcc, 0, v38
s_nop 3
s_cmp_eq_u64 vcc, 0
s_cbranch_scc1 L2_dgb
s_sleep 16
buffer_load_dword v38, v36, s[72:75], 0 offen sc1
s_waitcnt vmcnt(0)
s_sub_u32 s50, s50, 1
s_cbranch_scc0 L2_dpb
L2_dgb:
s_mov_b64 exec, -1
L2_djb:
s_barrier
s_waitcnt lgkmcnt(14)
v_mfma_f32_16x16x32_bf16 v[208:211], v[112:115], a[72:75], v[208:211]
ds_read_b64_tr_b16 v[144:145], v10 offset:57344
v_mfma_f32_16x16x32_bf16 v[212:215], v[112:115], a[76:79], v[212:215]
s_add_u32 s28, s28, 491520
s_addc_u32 s29, s29, 0
s_sub_u32 s30, s30, 491520
s_add_u32 s32, s32, 110592
s_addc_u32 s33, s33, 0
s_sub_u32 s34, s34, 110592
s_add_u32 m0, s62, 98304
s_nop 0
buffer_load_dwordx4 v4, s[28:31], s60 offen lds
v_mfma_f32_16x16x32_bf16 v[216:219], v[112:115], a[80:83], v[216:219]
s_waitcnt lgkmcnt(13)
ds_read_b64_tr_b16 v[146:147], v10 offset:61440
v_mfma_f32_16x16x32_bf16 v[220:223], v[116:119], a[72:75], v[220:223]
ds_read_b64_tr_b16 v[148:149], v11 offset:57344
v_mfma_f32_16x16x32_bf16 v[224:227], v[116:119], a[76:79], v[224:227]
ds_read_b64_tr_b16 v[150:151], v11 offset:61440
v_mfma_f32_16x16x32_bf16 v[228:231], v[116:119], a[80:83], v[228:231]
s_waitcnt lgkmcnt(14)
buffer_load_dwordx4 v5, s[28:31], s60 offen offset:1024 lds
v_mfma_f32_16x16x32_bf16 v[232:235], v[120:123], a[72:75], v[232:235]
ds_read_b64_tr_b16 v[152:153], v12 offset:57344
v_mfma_f32_16x16x32_bf16 v[236:239], v[120:123], a[76:79], v[236:239]
ds_read_b64_tr_b16 v[154:155], v12 offset:61440
v_mfma_f32_16x16x32_bf16 v[240:243], v[120:123], a[80:83], v[240:243]
s_waitcnt lgkmcnt(14)
ds_read_b64_tr_b16 v[156:157], v13 offset:57344
v_mfma_f32_16x16x32_bf16 v[244:247], v[124:127], a[72:75], v[244:247]
ds_read_b64_tr_b16 v[158:159], v13 offset:61440
v_mfma_f32_16x16x32_bf16 v[248:251], v[124:127], a[76:79], v[248:251]
buffer_load_dwordx4 a[144:147], v1, s[32:35], s12 offen sc1
v_mfma_f32_16x16x32_bf16 v[252:255], v[124:127], a[80:83], v[252:255]
s_waitcnt lgkmcnt(14)
ds_read_b64_tr_b16 v[128:129], v28 offset:8192
v_mfma_f32_16x16x32_bf16 v[160:163], v[96:99], a[192:195], v[160:163]
ds_read_b64_tr_b16 v[130:131], v28 offset:12288
v_mfma_f32_16x16x32_bf16 v[164:167], v[96:99], a[196:199], v[164:167]
ds_read_b64_tr_b16 v[132:133], v29 offset:8192
v_mfma_f32_16x16x32_bf16 v[168:171], v[96:99], a[200:203], v[168:171]
s_waitcnt lgkmcnt(15)
ds_read_b64_tr_b16 v[134:135], v29 offset:12288
v_mfma_f32_16x16x32_bf16 v[172:175], v[100:103], a[192:195], v[172:175]
buffer_load_dwordx4 a[148:151], v2, s[32:35], s12 offen sc1
v_mfma_f32_16x16x32_bf16 v[176:179], v[100:103], a[196:199], v[176:179]
ds_read_b64_tr_b16 v[136:137], v30 offset:8192
v_mfma_f32_16x16x32_bf16 v[180:183], v[100:103], a[200:203], v[180:183]
s_waitcnt lgkmcnt(15)
ds_read_b64_tr_b16 v[138:139], v30 offset:12288
v_mfma_f32_16x16x32_bf16 v[184:187], v[104:107], a[192:195], v[184:187]
ds_read_b64_tr_b16 v[140:141], v31 offset:8192
v_mfma_f32_16x16x32_bf16 v[188:191], v[104:107], a[196:199], v[188:191]
ds_read_b64_tr_b16 v[142:143], v31 offset:12288
v_mfma_f32_16x16x32_bf16 v[192:195], v[104:107], a[200:203], v[192:195]
s_waitcnt lgkmcnt(15)
buffer_load_dwordx4 a[152:155], v3, s[32:35], s12 offen sc1
v_mfma_f32_16x16x32_bf16 v[196:199], v[108:111], a[192:195], v[196:199]
v_mfma_f32_16x16x32_bf16 v[200:203], v[108:111], a[196:199], v[200:203]
v_mfma_f32_16x16x32_bf16 v[204:207], v[108:111], a[200:203], v[204:207]
s_waitcnt lgkmcnt(14)
v_mfma_f32_16x16x32_bf16 v[208:211], v[144:147], a[84:87], v[208:211]
s_add_u32 m0, s62, 106496
ds_read_b64_tr_b16 v[112:113], v21
v_mfma_f32_16x16x32_bf16 v[212:215], v[144:147], a[88:91], v[212:215]
buffer_load_dwordx4 v4, s[28:31], s61 offen lds
v_mfma_f32_16x16x32_bf16 v[216:219], v[144:147], a[92:95], v[216:219]
s_waitcnt lgkmcnt(13)
ds_read_b64_tr_b16 v[114:115], v21 offset:4096
v_mfma_f32_16x16x32_bf16 v[220:223], v[148:151], a[84:87], v[220:223]
ds_read_b64_tr_b16 v[116:117], v22
v_mfma_f32_16x16x32_bf16 v[224:227], v[148:151], a[88:91], v[224:227]
ds_read_b64_tr_b16 v[118:119], v22 offset:4096
v_mfma_f32_16x16x32_bf16 v[228:231], v[148:151], a[92:95], v[228:231]
s_waitcnt lgkmcnt(14)
buffer_load_dwordx4 v5, s[28:31], s61 offen offset:1024 lds
v_mfma_f32_16x16x32_bf16 v[232:235], v[152:155], a[84:87], v[232:235]
ds_read_b64_tr_b16 v[120:121], v23
v_mfma_f32_16x16x32_bf16 v[236:239], v[152:155], a[88:91], v[236:239]
ds_read_b64_tr_b16 v[122:123], v23 offset:4096
v_mfma_f32_16x16x32_bf16 v[240:243], v[152:155], a[92:95], v[240:243]
s_waitcnt lgkmcnt(14)
ds_read_b64_tr_b16 v[124:125], v24
v_mfma_f32_16x16x32_bf16 v[244:247], v[156:159], a[84:87], v[244:247]
ds_read_b64_tr_b16 v[126:127], v24 offset:4096
v_mfma_f32_16x16x32_bf16 v[248:251], v[156:159], a[88:91], v[248:251]
buffer_load_dwordx4 a[156:159], v1, s[32:35], s13 offen sc1
v_mfma_f32_16x16x32_bf16 v[252:255], v[156:159], a[92:95], v[252:255]
s_waitcnt lgkmcnt(14)
ds_read_b64_tr_b16 v[96:97], v28 offset:16384
v_mfma_f32_16x16x32_bf16 v[160:163], v[128:131], a[204:207], v[160:163]
ds_read_b64_tr_b16 v[98:99], v28 offset:20480
v_mfma_f32_16x16x32_bf16 v[164:167], v[128:131], a[208:211], v[164:167]
ds_read_b64_tr_b16 v[100:101], v29 offset:16384
v_mfma_f32_16x16x32_bf16 v[168:171], v[128:131], a[212:215], v[168:171]
s_waitcnt lgkmcnt(15)
ds_read_b64_tr_b16 v[102:103], v29 offset:20480
v_mfma_f32_16x16x32_bf16 v[172:175], v[132:135], a[204:207], v[172:175]
buffer_load_dwordx4 a[160:163], v2, s[32:35], s13 offen sc1
v_mfma_f32_16x16x32_bf16 v[176:179], v[132:135], a[208:211], v[176:179]
ds_read_b64_tr_b16 v[104:105], v30 offset:16384
v_mfma_f32_16x16x32_bf16 v[180:183], v[132:135], a[212:215], v[180:183]
s_waitcnt lgkmcnt(15)
ds_read_b64_tr_b16 v[106:107], v30 offset:20480
v_mfma_f32_16x16x32_bf16 v[184:187], v[136:139], a[204:207], v[184:187]
ds_read_b64_tr_b16 v[108:109], v31 offset:16384
v_mfma_f32_16x16x32_bf16 v[188:191], v[136:139], a[208:211], v[188:191]
ds_read_b64_tr_b16 v[110:111], v31 offset:20480
v_mfma_f32_16x16x32_bf16 v[192:195], v[136:139], a[212:215], v[192:195]
s_waitcnt lgkmcnt(15)
buffer_load_dwordx4 a[164:167], v3, s[32:35], s13 offen sc1
v_mfma_f32_16x16x32_bf16 v[196:199], v[140:143], a[204:207], v[196:199]
v_mfma_f32_16x16x32_bf16 v[200:203], v[140:143], a[208:211], v[200:203]
v_mfma_f32_16x16x32_bf16 v[204:207], v[140:143], a[212:215], v[204:207]
s_waitcnt vmcnt(18)
s_barrier
s_waitcnt lgkmcnt(14)
v_mfma_f32_16x16x32_bf16 v[208:211], v[112:115], a[96:99], v[208:211]
s_add_u32 m0, s62, 114688
ds_read_b64_tr_b16 v[144:145], v21 offset:8192
v_mfma_f32_16x16x32_bf16 v[212:215], v[112:115], a[100:103], v[212:215]
buffer_load_dwordx4 v4, s[28:31], s69 offen lds
v_mfma_f32_16x16x32_bf16 v[216:219], v[112:115], a[104:107], v[216:219]
s_waitcnt lgkmcnt(13)
ds_read_b64_tr_b16 v[146:147], v21 offset:12288
v_mfma_f32_16x16x32_bf16 v[220:223], v[116:119], a[96:99], v[220:223]
ds_read_b64_tr_b16 v[148:149], v22 offset:8192
v_mfma_f32_16x16x32_bf16 v[224:227], v[116:119], a[100:103], v[224:227]
ds_read_b64_tr_b16 v[150:151], v22 offset:12288
v_mfma_f32_16x16x32_bf16 v[228:231], v[116:119], a[104:107], v[228:231]
s_waitcnt lgkmcnt(14)
buffer_load_dwordx4 v5, s[28:31], s69 offen offset:1024 lds
v_mfma_f32_16x16x32_bf16 v[232:235], v[120:123], a[96:99], v[232:235]
ds_read_b64_tr_b16 v[152:153], v23 offset:8192
v_mfma_f32_16x16x32_bf16 v[236:239], v[120:123], a[100:103], v[236:239]
ds_read_b64_tr_b16 v[154:155], v23 offset:12288
v_mfma_f32_16x16x32_bf16 v[240:243], v[120:123], a[104:107], v[240:243]
s_waitcnt lgkmcnt(14)
ds_read_b64_tr_b16 v[156:157], v24 offset:8192
v_mfma_f32_16x16x32_bf16 v[244:247], v[124:127], a[96:99], v[244:247]
ds_read_b64_tr_b16 v[158:159], v24 offset:12288
v_mfma_f32_16x16x32_bf16 v[248:251], v[124:127], a[100:103], v[248:251]
buffer_load_dwordx4 a[168:171], v1, s[32:35], s14 offen sc1
v_mfma_f32_16x16x32_bf16 v[252:255], v[124:127], a[104:107], v[252:255]
s_waitcnt lgkmcnt(14)
ds_read_b64_tr_b16 v[128:129], v28 offset:24576
v_mfma_f32_16x16x32_bf16 v[160:163], v[96:99], a[216:219], v[160:163]
ds_read_b64_tr_b16 v[130:131], v28 offset:28672
v_mfma_f32_16x16x32_bf16 v[164:167], v[96:99], a[220:223], v[164:167]
ds_read_b64_tr_b16 v[132:133], v29 offset:24576
v_mfma_f32_16x16x32_bf16 v[168:171], v[96:99], a[224:227], v[168:171]
s_waitcnt lgkmcnt(15)
ds_read_b64_tr_b16 v[134:135], v29 offset:28672
v_mfma_f32_16x16x32_bf16 v[172:175], v[100:103], a[216:219], v[172:175]
buffer_load_dwordx4 a[172:175], v2, s[32:35], s14 offen sc1
v_mfma_f32_16x16x32_bf16 v[176:179], v[100:103], a[220:223], v[176:179]
ds_read_b64_tr_b16 v[136:137], v30 offset:24576
v_mfma_f32_16x16x32_bf16 v[180:183], v[100:103], a[224:227], v[180:183]
s_waitcnt lgkmcnt(15)
ds_read_b64_tr_b16 v[138:139], v30 offset:28672
v_mfma_f32_16x16x32_bf16 v[184:187], v[104:107], a[216:219], v[184:187]
ds_read_b64_tr_b16 v[140:141], v31 offset:24576
v_mfma_f32_16x16x32_bf16 v[188:191], v[104:107], a[220:223], v[188:191]
ds_read_b64_tr_b16 v[142:143], v31 offset:28672
v_mfma_f32_16x16x32_bf16 v[192:195], v[104:107], a[224:227], v[192:195]
s_waitcnt lgkmcnt(15)
buffer_load_dwordx4 a[176:179], v3, s[32:35], s14 offen sc1
v_mfma_f32_16x16x32_bf16 v[196:199], v[108:111], a[216:219], v[196:199]
v_mfma_f32_16x16x32_bf16 v[200:203], v[108:111], a[220:223], v[200:203]
v_mfma_f32_16x16x32_bf16 v[204:207], v[108:111], a[224:227], v[204:207]
s_waitcnt lgkmcnt(14)
v_mfma_f32_16x16x32_bf16 v[208:211], v[144:147], a[108:111], v[208:211]
s_add_u32 m0, s62, 122880
ds_read_b64_tr_b16 v[112:113], v21 offset:16384
v_mfma_f32_16x16x32_bf16 v[212:215], v[144:147], a[112:115], v[212:215]
buffer_load_dwordx4 v4, s[28:31], s70 offen lds
v_mfma_f32_16x16x32_bf16 v[216:219], v[144:147], a[116:119], v[216:219]
s_waitcnt lgkmcnt(13)
ds_read_b64_tr_b16 v[114:115], v21 offset:20480
v_mfma_f32_16x16x32_bf16 v[220:223], v[148:151], a[108:111], v[220:223]
ds_read_b64_tr_b16 v[116:117], v22 offset:16384
v_mfma_f32_16x16x32_bf16 v[224:227], v[148:151], a[112:115], v[224:227]
ds_read_b64_tr_b16 v[118:119], v22 offset:20480
v_mfma_f32_16x16x32_bf16 v[228:231], v[148:151], a[116:119], v[228:231]
s_waitcnt lgkmcnt(14)
buffer_load_dwordx4 v5, s[28:31], s70 offen offset:1024 lds
v_mfma_f32_16x16x32_bf16 v[232:235], v[152:155], a[108:111], v[232:235]
ds_read_b64_tr_b16 v[120:121], v23 offset:16384
v_mfma_f32_16x16x32_bf16 v[236:239], v[152:155], a[112:115], v[236:239]
ds_read_b64_tr_b16 v[122:123], v23 offset:20480
v_mfma_f32_16x16x32_bf16 v[240:243], v[152:155], a[116:119], v[240:243]
s_waitcnt lgkmcnt(14)
ds_read_b64_tr_b16 v[124:125], v24 offset:16384
v_mfma_f32_16x16x32_bf16 v[244:247], v[156:159], a[108:111], v[244:247]
ds_read_b64_tr_b16 v[126:127], v24 offset:20480
v_mfma_f32_16x16x32_bf16 v[248:251], v[156:159], a[112:115], v[248:251]
buffer_load_dwordx4 a[180:183], v1, s[32:35], s15 offen sc1
v_mfma_f32_16x16x32_bf16 v[252:255], v[156:159], a[116:119], v[252:255]
s_waitcnt lgkmcnt(14)
ds_read_b64_tr_b16 v[96:97], v6
v_mfma_f32_16x16x32_bf16 v[160:163], v[128:131], a[228:231], v[160:163]
ds_read_b64_tr_b16 v[98:99], v6 offset:4096
v_mfma_f32_16x16x32_bf16 v[164:167], v[128:131], a[232:235], v[164:167]
ds_read_b64_tr_b16 v[100:101], v7
v_mfma_f32_16x16x32_bf16 v[168:171], v[128:131], a[236:239], v[168:171]
s_waitcnt lgkmcnt(15)
ds_read_b64_tr_b16 v[102:103], v7 offset:4096
v_mfma_f32_16x16x32_bf16 v[172:175], v[132:135], a[228:231], v[172:175]
buffer_load_dwordx4 a[184:187], v2, s[32:35], s15 offen sc1
v_mfma_f32_16x16x32_bf16 v[176:179], v[132:135], a[232:235], v[176:179]
ds_read_b64_tr_b16 v[104:105], v8
v_mfma_f32_16x16x32_bf16 v[180:183], v[132:135], a[236:239], v[180:183]
s_waitcnt lgkmcnt(15)
ds_read_b64_tr_b16 v[106:107], v8 offset:4096
v_mfma_f32_16x16x32_bf16 v[184:187], v[136:139], a[228:231], v[184:187]
ds_read_b64_tr_b16 v[108:109], v9
v_mfma_f32_16x16x32_bf16 v[188:191], v[136:139], a[232:235], v[188:191]
ds_read_b64_tr_b16 v[110:111], v9 offset:4096
v_mfma_f32_16x16x32_bf16 v[192:195], v[136:139], a[236:239], v[192:195]
s_waitcnt lgkmcnt(15)
buffer_load_dwordx4 a[188:191], v3, s[32:35], s15 offen sc1
v_mfma_f32_16x16x32_bf16 v[196:199], v[140:143], a[228:231], v[196:199]
v_mfma_f32_16x16x32_bf16 v[200:203], v[140:143], a[232:235], v[200:203]
v_mfma_f32_16x16x32_bf16 v[204:207], v[140:143], a[236:239], v[204:207]
s_waitcnt vmcnt(18)
s_barrier
s_waitcnt lgkmcnt(14)
v_mfma_f32_16x16x32_bf16 v[208:211], v[112:115], a[120:123], v[208:211]
s_add_u32 m0, s62, 131072
ds_read_b64_tr_b16 v[144:145], v21 offset:24576
v_mfma_f32_16x16x32_bf16 v[212:215], v[112:115], a[124:127], v[212:215]
buffer_load_dwordx4 v4, s[28:31], s71 offen lds
v_mfma_f32_16x16x32_bf16 v[216:219], v[112:115], a[128:131], v[216:219]
s_waitcnt lgkmcnt(13)
ds_read_b64_tr_b16 v[146:147], v21 offset:28672
v_mfma_f32_16x16x32_bf16 v[220:223], v[116:119], a[120:123], v[220:223]
ds_read_b64_tr_b16 v[148:149], v22 offset:24576
v_mfma_f32_16x16x32_bf16 v[224:227], v[116:119], a[124:127], v[224:227]
ds_read_b64_tr_b16 v[150:151], v22 offset:28672
v_mfma_f32_16x16x32_bf16 v[228:231], v[116:119], a[128:131], v[228:231]
s_waitcnt lgkmcnt(14)
buffer_load_dwordx4 v5, s[28:31], s71 offen offset:1024 lds
v_mfma_f32_16x16x32_bf16 v[232:235], v[120:123], a[120:123], v[232:235]
ds_read_b64_tr_b16 v[152:153], v23 offset:24576
v_mfma_f32_16x16x32_bf16 v[236:239], v[120:123], a[124:127], v[236:239]
ds_read_b64_tr_b16 v[154:155], v23 offset:28672
v_mfma_f32_16x16x32_bf16 v[240:243], v[120:123], a[128:131], v[240:243]
s_waitcnt lgkmcnt(14)
ds_read_b64_tr_b16 v[156:157], v24 offset:24576
v_mfma_f32_16x16x32_bf16 v[244:247], v[124:127], a[120:123], v[244:247]
ds_read_b64_tr_b16 v[158:159], v24 offset:28672
v_mfma_f32_16x16x32_bf16 v[248:251], v[124:127], a[124:127], v[248:251]
buffer_load_dwordx4 a[192:195], v1, s[32:35], s16 offen sc1
v_mfma_f32_16x16x32_bf16 v[252:255], v[124:127], a[128:131], v[252:255]
s_waitcnt lgkmcnt(14)
ds_read_b64_tr_b16 v[128:129], v6 offset:8192
v_mfma_f32_16x16x32_bf16 v[160:163], v[96:99], a[0:3], v[160:163]
ds_read_b64_tr_b16 v[130:131], v6 offset:12288
v_mfma_f32_16x16x32_bf16 v[164:167], v[96:99], a[4:7], v[164:167]
ds_read_b64_tr_b16 v[132:133], v7 offset:8192
v_mfma_f32_16x16x32_bf16 v[168:171], v[96:99], a[8:11], v[168:171]
s_waitcnt lgkmcnt(15)
ds_read_b64_tr_b16 v[134:135], v7 offset:12288
v_mfma_f32_16x16x32_bf16 v[172:175], v[100:103], a[0:3], v[172:175]
buffer_load_dwordx4 a[196:199], v2, s[32:35], s16 offen sc1
v_mfma_f32_16x16x32_bf16 v[176:179], v[100:103], a[4:7], v[176:179]
ds_read_b64_tr_b16 v[136:137], v8 offset:8192
v_mfma_f32_16x16x32_bf16 v[180:183], v[100:103], a[8:11], v[180:183]
s_waitcnt lgkmcnt(15)
ds_read_b64_tr_b16 v[138:139], v8 offset:12288
v_mfma_f32_16x16x32_bf16 v[184:187], v[104:107], a[0:3], v[184:187]
ds_read_b64_tr_b16 v[140:141], v9 offset:8192
v_mfma_f32_16x16x32_bf16 v[188:191], v[104:107], a[4:7], v[188:191]
ds_read_b64_tr_b16 v[142:143], v9 offset:12288
v_mfma_f32_16x16x32_bf16 v[192:195], v[104:107], a[8:11], v[192:195]
s_waitcnt lgkmcnt(15)
buffer_load_dwordx4 a[200:203], v3, s[32:35], s16 offen sc1
v_mfma_f32_16x16x32_bf16 v[196:199], v[108:111], a[0:3], v[196:199]
v_mfma_f32_16x16x32_bf16 v[200:203], v[108:111], a[4:7], v[200:203]
v_mfma_f32_16x16x32_bf16 v[204:207], v[108:111], a[8:11], v[204:207]
s_waitcnt lgkmcnt(14)
v_mfma_f32_16x16x32_bf16 v[208:211], v[144:147], a[132:135], v[208:211]
s_add_u32 m0, s62, 139264
ds_read_b64_tr_b16 v[112:113], v21 offset:32768
v_mfma_f32_16x16x32_bf16 v[212:215], v[144:147], a[136:139], v[212:215]
buffer_load_dwordx4 v4, s[28:31], s79 offen lds
v_mfma_f32_16x16x32_bf16 v[216:219], v[144:147], a[140:143], v[216:219]
s_waitcnt lgkmcnt(13)
ds_read_b64_tr_b16 v[114:115], v21 offset:36864
v_mfma_f32_16x16x32_bf16 v[220:223], v[148:151], a[132:135], v[220:223]
ds_read_b64_tr_b16 v[116:117], v22 offset:32768
v_mfma_f32_16x16x32_bf16 v[224:227], v[148:151], a[136:139], v[224:227]
ds_read_b64_tr_b16 v[118:119], v22 offset:36864
v_mfma_f32_16x16x32_bf16 v[228:231], v[148:151], a[140:143], v[228:231]
s_waitcnt lgkmcnt(14)
buffer_load_dwordx4 v5, s[28:31], s79 offen offset:1024 lds
v_mfma_f32_16x16x32_bf16 v[232:235], v[152:155], a[132:135], v[232:235]
ds_read_b64_tr_b16 v[120:121], v23 offset:32768
v_mfma_f32_16x16x32_bf16 v[236:239], v[152:155], a[136:139], v[236:239]
ds_read_b64_tr_b16 v[122:123], v23 offset:36864
v_mfma_f32_16x16x32_bf16 v[240:243], v[152:155], a[140:143], v[240:243]
s_waitcnt lgkmcnt(14)
ds_read_b64_tr_b16 v[124:125], v24 offset:32768
v_mfma_f32_16x16x32_bf16 v[244:247], v[156:159], a[132:135], v[244:247]
ds_read_b64_tr_b16 v[126:127], v24 offset:36864
v_mfma_f32_16x16x32_bf16 v[248:251], v[156:159], a[136:139], v[248:251]
buffer_load_dwordx4 a[204:207], v1, s[32:35], s17 offen sc1
v_mfma_f32_16x16x32_bf16 v[252:255], v[156:159], a[140:143], v[252:255]
s_waitcnt lgkmcnt(14)
ds_read_b64_tr_b16 v[96:97], v6 offset:16384
v_mfma_f32_16x16x32_bf16 v[160:163], v[128:131], a[12:15], v[160:163]
ds_read_b64_tr_b16 v[98:99], v6 offset:20480
v_mfma_f32_16x16x32_bf16 v[164:167], v[128:131], a[16:19], v[164:167]
ds_read_b64_tr_b16 v[100:101], v7 offset:16384
v_mfma_f32_16x16x32_bf16 v[168:171], v[128:131], a[20:23], v[168:171]
s_waitcnt lgkmcnt(15)
ds_read_b64_tr_b16 v[102:103], v7 offset:20480
v_mfma_f32_16x16x32_bf16 v[172:175], v[132:135], a[12:15], v[172:175]
buffer_load_dwordx4 a[208:211], v2, s[32:35], s17 offen sc1
v_mfma_f32_16x16x32_bf16 v[176:179], v[132:135], a[16:19], v[176:179]
ds_read_b64_tr_b16 v[104:105], v8 offset:16384
v_mfma_f32_16x16x32_bf16 v[180:183], v[132:135], a[20:23], v[180:183]
s_waitcnt lgkmcnt(15)
ds_read_b64_tr_b16 v[106:107], v8 offset:20480
v_mfma_f32_16x16x32_bf16 v[184:187], v[136:139], a[12:15], v[184:187]
ds_read_b64_tr_b16 v[108:109], v9 offset:16384
v_mfma_f32_16x16x32_bf16 v[188:191], v[136:139], a[16:19], v[188:191]
ds_read_b64_tr_b16 v[110:111], v9 offset:20480
v_mfma_f32_16x16x32_bf16 v[192:195], v[136:139], a[20:23], v[192:195]
s_waitcnt lgkmcnt(15)
buffer_load_dwordx4 a[212:215], v3, s[32:35], s17 offen sc1
v_mfma_f32_16x16x32_bf16 v[196:199], v[140:143], a[12:15], v[196:199]
v_mfma_f32_16x16x32_bf16 v[200:203], v[140:143], a[16:19], v[200:203]
v_mfma_f32_16x16x32_bf16 v[204:207], v[140:143], a[20:23], v[204:207]
s_waitcnt vmcnt(18)
s_barrier
s_waitcnt lgkmcnt(14)
v_mfma_f32_16x16x32_bf16 v[208:211], v[112:115], a[144:147], v[208:211]
s_add_u32 m0, s62, 147456
ds_read_b64_tr_b16 v[144:145], v21 offset:40960
v_mfma_f32_16x16x32_bf16 v[212:215], v[112:115], a[148:151], v[212:215]
buffer_load_dwordx4 v4, s[28:31], s80 offen lds
v_mfma_f32_16x16x32_bf16 v[216:219], v[112:115], a[152:155], v[216:219]
s_waitcnt lgkmcnt(13)
ds_read_b64_tr_b16 v[146:147], v21 offset:45056
v_mfma_f32_16x16x32_bf16 v[220:223], v[116:119], a[144:147], v[220:223]
ds_read_b64_tr_b16 v[148:149], v22 offset:40960
v_mfma_f32_16x16x32_bf16 v[224:227], v[116:119], a[148:151], v[224:227]
ds_read_b64_tr_b16 v[150:151], v22 offset:45056
v_mfma_f32_16x16x32_bf16 v[228:231], v[116:119], a[152:155], v[228:231]
s_waitcnt lgkmcnt(14)
buffer_load_dwordx4 v5, s[28:31], s80 offen offset:1024 lds
v_mfma_f32_16x16x32_bf16 v[232:235], v[120:123], a[144:147], v[232:235]
ds_read_b64_tr_b16 v[152:153], v23 offset:40960
v_mfma_f32_16x16x32_bf16 v[236:239], v[120:123], a[148:151], v[236:239]
ds_read_b64_tr_b16 v[154:155], v23 offset:45056
v_mfma_f32_16x16x32_bf16 v[240:243], v[120:123], a[152:155], v[240:243]
s_waitcnt lgkmcnt(14)
ds_read_b64_tr_b16 v[156:157], v24 offset:40960
v_mfma_f32_16x16x32_bf16 v[244:247], v[124:127], a[144:147], v[244:247]
ds_read_b64_tr_b16 v[158:159], v24 offset:45056
v_mfma_f32_16x16x32_bf16 v[248:251], v[124:127], a[148:151], v[248:251]
buffer_load_dwordx4 a[216:219], v1, s[32:35], s18 offen sc1
v_mfma_f32_16x16x32_bf16 v[252:255], v[124:127], a[152:155], v[252:255]
s_waitcnt lgkmcnt(14)
ds_read_b64_tr_b16 v[128:129], v6 offset:24576
v_mfma_f32_16x16x32_bf16 v[160:163], v[96:99], a[24:27], v[160:163]
ds_read_b64_tr_b16 v[130:131], v6 offset:28672
v_mfma_f32_16x16x32_bf16 v[164:167], v[96:99], a[28:31], v[164:167]
ds_read_b64_tr_b16 v[132:133], v7 offset:24576
v_mfma_f32_16x16x32_bf16 v[168:171], v[96:99], a[32:35], v[168:171]
s_waitcnt lgkmcnt(15)
ds_read_b64_tr_b16 v[134:135], v7 offset:28672
v_mfma_f32_16x16x32_bf16 v[172:175], v[100:103], a[24:27], v[172:175]
buffer_load_dwordx4 a[220:223], v2, s[32:35], s18 offen sc1
v_mfma_f32_16x16x32_bf16 v[176:179], v[100:103], a[28:31], v[176:179]
ds_read_b64_tr_b16 v[136:137], v8 offset:24576
v_mfma_f32_16x16x32_bf16 v[180:183], v[100:103], a[32:35], v[180:183]
s_waitcnt lgkmcnt(15)
ds_read_b64_tr_b16 v[138:139], v8 offset:28672
v_mfma_f32_16x16x32_bf16 v[184:187], v[104:107], a[24:27], v[184:187]
ds_read_b64_tr_b16 v[140:141], v9 offset:24576
v_mfma_f32_16x16x32_bf16 v[188:191], v[104:107], a[28:31], v[188:191]
ds_read_b64_tr_b16 v[142:143], v9 offset:28672
v_mfma_f32_16x16x32_bf16 v[192:195], v[104:107], a[32:35], v[192:195]
s_waitcnt lgkmcnt(15)
buffer_load_dwordx4 a[224:227], v3, s[32:35], s18 offen sc1
v_mfma_f32_16x16x32_bf16 v[196:199], v[108:111], a[24:27], v[196:199]
v_mfma_f32_16x16x32_bf16 v[200:203], v[108:111], a[28:31], v[200:203]
v_mfma_f32_16x16x32_bf16 v[204:207], v[108:111], a[32:35], v[204:207]
s_waitcnt lgkmcnt(14)
v_mfma_f32_16x16x32_bf16 v[208:211], v[144:147], a[156:159], v[208:211]
s_add_u32 m0, s62, 155648
ds_read_b64_tr_b16 v[112:113], v21 offset:49152
v_mfma_f32_16x16x32_bf16 v[212:215], v[144:147], a[160:163], v[212:215]
buffer_load_dwordx4 v4, s[28:31], s81 offen lds
v_mfma_f32_16x16x32_bf16 v[216:219], v[144:147], a[164:167], v[216:219]
s_waitcnt lgkmcnt(13)
ds_read_b64_tr_b16 v[114:115], v21 offset:53248
v_mfma_f32_16x16x32_bf16 v[220:223], v[148:151], a[156:159], v[220:223]
ds_read_b64_tr_b16 v[116:117], v22 offset:49152
v_mfma_f32_16x16x32_bf16 v[224:227], v[148:151], a[160:163], v[224:227]
ds_read_b64_tr_b16 v[118:119], v22 offset:53248
v_mfma_f32_16x16x32_bf16 v[228:231], v[148:151], a[164:167], v[228:231]
s_waitcnt lgkmcnt(14)
buffer_load_dwordx4 v5, s[28:31], s81 offen offset:1024 lds
v_mfma_f32_16x16x32_bf16 v[232:235], v[152:155], a[156:159], v[232:235]
ds_read_b64_tr_b16 v[120:121], v23 offset:49152
v_mfma_f32_16x16x32_bf16 v[236:239], v[152:155], a[160:163], v[236:239]
ds_read_b64_tr_b16 v[122:123], v23 offset:53248
v_mfma_f32_16x16x32_bf16 v[240:243], v[152:155], a[164:167], v[240:243]
s_waitcnt lgkmcnt(14)
ds_read_b64_tr_b16 v[124:125], v24 offset:49152
v_mfma_f32_16x16x32_bf16 v[244:247], v[156:159], a[156:159], v[244:247]
ds_read_b64_tr_b16 v[126:127], v24 offset:53248
v_mfma_f32_16x16x32_bf16 v[248:251], v[156:159], a[160:163], v[248:251]
buffer_load_dwordx4 a[228:231], v1, s[32:35], s19 offen sc1
v_mfma_f32_16x16x32_bf16 v[252:255], v[156:159], a[164:167], v[252:255]
s_waitcnt lgkmcnt(14)
ds_read_b64_tr_b16 v[96:97], v6 offset:32768
v_mfma_f32_16x16x32_bf16 v[160:163], v[128:131], a[36:39], v[160:163]
ds_read_b64_tr_b16 v[98:99], v6 offset:36864
v_mfma_f32_16x16x32_bf16 v[164:167], v[128:131], a[40:43], v[164:167]
ds_read_b64_tr_b16 v[100:101], v7 offset:32768
v_mfma_f32_16x16x32_bf16 v[168:171], v[128:131], a[44:47], v[168:171]
s_waitcnt lgkmcnt(15)
ds_read_b64_tr_b16 v[102:103], v7 offset:36864
v_mfma_f32_16x16x32_bf16 v[172:175], v[132:135], a[36:39], v[172:175]
buffer_load_dwordx4 a[232:235], v2, s[32:35], s19 offen sc1
v_mfma_f32_16x16x32_bf16 v[176:179], v[132:135], a[40:43], v[176:179]
ds_read_b64_tr_b16 v[104:105], v8 offset:32768
v_mfma_f32_16x16x32_bf16 v[180:183], v[132:135], a[44:47], v[180:183]
s_waitcnt lgkmcnt(15)
ds_read_b64_tr_b16 v[106:107], v8 offset:36864
v_mfma_f32_16x16x32_bf16 v[184:187], v[136:139], a[36:39], v[184:187]
ds_read_b64_tr_b16 v[108:109], v9 offset:32768
v_mfma_f32_16x16x32_bf16 v[188:191], v[136:139], a[40:43], v[188:191]
ds_read_b64_tr_b16 v[110:111], v9 offset:36864
v_mfma_f32_16x16x32_bf16 v[192:195], v[136:139], a[44:47], v[192:195]
s_waitcnt lgkmcnt(15)
buffer_load_dwordx4 a[236:239], v3, s[32:35], s19 offen sc1
v_mfma_f32_16x16x32_bf16 v[196:199], v[140:143], a[36:39], v[196:199]
v_mfma_f32_16x16x32_bf16 v[200:203], v[140:143], a[40:43], v[200:203]
v_mfma_f32_16x16x32_bf16 v[204:207], v[140:143], a[44:47], v[204:207]
s_waitcnt vmcnt(18)
s_barrier
s_waitcnt lgkmcnt(14)
v_mfma_f32_16x16x32_bf16 v[208:211], v[112:115], a[168:171], v[208:211]
s_add_u32 m0, s62, 0
ds_read_b64_tr_b16 v[144:145], v21 offset:57344
v_mfma_f32_16x16x32_bf16 v[212:215], v[112:115], a[172:175], v[212:215]
buffer_load_dwordx4 v4, s[28:31], s82 offen lds
v_mfma_f32_16x16x32_bf16 v[216:219], v[112:115], a[176:179], v[216:219]
s_waitcnt lgkmcnt(13)
ds_read_b64_tr_b16 v[146:147], v21 offset:61440
v_mfma_f32_16x16x32_bf16 v[220:223], v[116:119], a[168:171], v[220:223]
ds_read_b64_tr_b16 v[148:149], v22 offset:57344
v_mfma_f32_16x16x32_bf16 v[224:227], v[116:119], a[172:175], v[224:227]
ds_read_b64_tr_b16 v[150:151], v22 offset:61440
v_mfma_f32_16x16x32_bf16 v[228:231], v[116:119], a[176:179], v[228:231]
s_waitcnt lgkmcnt(14)
buffer_load_dwordx4 v5, s[28:31], s82 offen offset:1024 lds
v_mfma_f32_16x16x32_bf16 v[232:235], v[120:123], a[168:171], v[232:235]
ds_read_b64_tr_b16 v[152:153], v23 offset:57344
v_mfma_f32_16x16x32_bf16 v[236:239], v[120:123], a[172:175], v[236:239]
ds_read_b64_tr_b16 v[154:155], v23 offset:61440
v_mfma_f32_16x16x32_bf16 v[240:243], v[120:123], a[176:179], v[240:243]
s_waitcnt lgkmcnt(14)
ds_read_b64_tr_b16 v[156:157], v24 offset:57344
v_mfma_f32_16x16x32_bf16 v[244:247], v[124:127], a[168:171], v[244:247]
ds_read_b64_tr_b16 v[158:159], v24 offset:61440
v_mfma_f32_16x16x32_bf16 v[248:251], v[124:127], a[172:175], v[248:251]
buffer_load_dwordx4 a[0:3], v1, s[32:35], s20 offen sc1
v_mfma_f32_16x16x32_bf16 v[252:255], v[124:127], a[176:179], v[252:255]
s_waitcnt lgkmcnt(14)
ds_read_b64_tr_b16 v[128:129], v6 offset:40960
v_mfma_f32_16x16x32_bf16 v[160:163], v[96:99], a[48:51], v[160:163]
ds_read_b64_tr_b16 v[130:131], v6 offset:45056
v_mfma_f32_16x16x32_bf16 v[164:167], v[96:99], a[52:55], v[164:167]
ds_read_b64_tr_b16 v[132:133], v7 offset:40960
v_mfma_f32_16x16x32_bf16 v[168:171], v[96:99], a[56:59], v[168:171]
s_waitcnt lgkmcnt(15)
ds_read_b64_tr_b16 v[134:135], v7 offset:45056
v_mfma_f32_16x16x32_bf16 v[172:175], v[100:103], a[48:51], v[172:175]
buffer_load_dwordx4 a[4:7], v2, s[32:35], s20 offen sc1
v_mfma_f32_16x16x32_bf16 v[176:179], v[100:103], a[52:55], v[176:179]
ds_read_b64_tr_b16 v[136:137], v8 offset:40960
v_mfma_f32_16x16x32_bf16 v[180:183], v[100:103], a[56:59], v[180:183]
s_waitcnt lgkmcnt(15)
ds_read_b64_tr_b16 v[138:139], v8 offset:45056
v_mfma_f32_16x16x32_bf16 v[184:187], v[104:107], a[48:51], v[184:187]
ds_read_b64_tr_b16 v[140:141], v9 offset:40960
v_mfma_f32_16x16x32_bf16 v[188:191], v[104:107], a[52:55], v[188:191]
ds_read_b64_tr_b16 v[142:143], v9 offset:45056
v_mfma_f32_16x16x32_bf16 v[192:195], v[104:107], a[56:59], v[192:195]
s_waitcnt lgkmcnt(15)
buffer_load_dwordx4 a[8:11], v3, s[32:35], s20 offen sc1
v_mfma_f32_16x16x32_bf16 v[196:199], v[108:111], a[48:51], v[196:199]
v_mfma_f32_16x16x32_bf16 v[200:203], v[108:111], a[52:55], v[200:203]
v_mfma_f32_16x16x32_bf16 v[204:207], v[108:111], a[56:59], v[204:207]
s_waitcnt lgkmcnt(14)
v_mfma_f32_16x16x32_bf16 v[208:211], v[144:147], a[180:183], v[208:211]
s_add_u32 m0, s62, 8192
ds_read_b64_tr_b16 v[112:113], v32
v_mfma_f32_16x16x32_bf16 v[212:215], v[144:147], a[184:187], v[212:215]
buffer_load_dwordx4 v4, s[28:31], s83 offen lds
v_mfma_f32_16x16x32_bf16 v[216:219], v[144:147], a[188:191], v[216:219]
s_waitcnt lgkmcnt(13)
ds_read_b64_tr_b16 v[114:115], v32 offset:4096
v_mfma_f32_16x16x32_bf16 v[220:223], v[148:151], a[180:183], v[220:223]
ds_read_b64_tr_b16 v[116:117], v33
v_mfma_f32_16x16x32_bf16 v[224:227], v[148:151], a[184:187], v[224:227]
ds_read_b64_tr_b16 v[118:119], v33 offset:4096
v_mfma_f32_16x16x32_bf16 v[228:231], v[148:151], a[188:191], v[228:231]
s_waitcnt lgkmcnt(14)
buffer_load_dwordx4 v5, s[28:31], s83 offen offset:1024 lds
v_mfma_f32_16x16x32_bf16 v[232:235], v[152:155], a[180:183], v[232:235]
ds_read_b64_tr_b16 v[120:121], v34
v_mfma_f32_16x16x32_bf16 v[236:239], v[152:155], a[184:187], v[236:239]
ds_read_b64_tr_b16 v[122:123], v34 offset:4096
v_mfma_f32_16x16x32_bf16 v[240:243], v[152:155], a[188:191], v[240:243]
s_waitcnt lgkmcnt(14)
ds_read_b64_tr_b16 v[124:125], v35
v_mfma_f32_16x16x32_bf16 v[244:247], v[156:159], a[180:183], v[244:247]
ds_read_b64_tr_b16 v[126:127], v35 offset:4096
v_mfma_f32_16x16x32_bf16 v[248:251], v[156:159], a[184:187], v[248:251]
buffer_load_dwordx4 a[12:15], v1, s[32:35], s22 offen sc1
v_mfma_f32_16x16x32_bf16 v[252:255], v[156:159], a[188:191], v[252:255]
s_waitcnt lgkmcnt(14)
ds_read_b64_tr_b16 v[96:97], v6 offset:49152
v_mfma_f32_16x16x32_bf16 v[160:163], v[128:131], a[60:63], v[160:163]
ds_read_b64_tr_b16 v[98:99], v6 offset:53248
v_mfma_f32_16x16x32_bf16 v[164:167], v[128:131], a[64:67], v[164:167]
ds_read_b64_tr_b16 v[100:101], v7 offset:49152
v_mfma_f32_16x16x32_bf16 v[168:171], v[128:131], a[68:71], v[168:171]
s_waitcnt lgkmcnt(15)
ds_read_b64_tr_b16 v[102:103], v7 offset:53248
v_mfma_f32_16x16x32_bf16 v[172:175], v[132:135], a[60:63], v[172:175]
buffer_load_dwordx4 a[16:19], v2, s[32:35], s22 offen sc1
v_mfma_f32_16x16x32_bf16 v[176:179], v[132:135], a[64:67], v[176:179]
ds_read_b64_tr_b16 v[104:105], v8 offset:49152
v_mfma_f32_16x16x32_bf16 v[180:183], v[132:135], a[68:71], v[180:183]
s_waitcnt lgkmcnt(15)
ds_read_b64_tr_b16 v[106:107], v8 offset:53248
v_mfma_f32_16x16x32_bf16 v[184:187], v[136:139], a[60:63], v[184:187]
ds_read_b64_tr_b16 v[108:109], v9 offset:49152
v_mfma_f32_16x16x32_bf16 v[188:191], v[136:139], a[64:67], v[188:191]
ds_read_b64_tr_b16 v[110:111], v9 offset:53248
v_mfma_f32_16x16x32_bf16 v[192:195], v[136:139], a[68:71], v[192:195]
s_waitcnt lgkmcnt(15)
buffer_load_dwordx4 a[20:23], v3, s[32:35], s22 offen sc1
v_mfma_f32_16x16x32_bf16 v[196:199], v[140:143], a[60:63], v[196:199]
v_mfma_f32_16x16x32_bf16 v[200:203], v[140:143], a[64:67], v[200:203]
v_mfma_f32_16x16x32_bf16 v[204:207], v[140:143], a[68:71], v[204:207]
s_waitcnt vmcnt(18)
s_barrier
s_waitcnt lgkmcnt(14)
v_mfma_f32_16x16x32_bf16 v[208:211], v[112:115], a[192:195], v[208:211]
s_add_u32 m0, s62, 16384
ds_read_b64_tr_b16 v[144:145], v32 offset:8192
v_mfma_f32_16x16x32_bf16 v[212:215], v[112:115], a[196:199], v[212:215]
buffer_load_dwordx4 v4, s[28:31], s25 offen lds
v_mfma_f32_16x16x32_bf16 v[216:219], v[112:115], a[200:203], v[216:219]
s_waitcnt lgkmcnt(13)
ds_read_b64_tr_b16 v[146:147], v32 offset:12288
v_mfma_f32_16x16x32_bf16 v[220:223], v[116:119], a[192:195], v[220:223]
ds_read_b64_tr_b16 v[148:149], v33 offset:8192
v_mfma_f32_16x16x32_bf16 v[224:227], v[116:119], a[196:199], v[224:227]
ds_read_b64_tr_b16 v[150:151], v33 offset:12288
v_mfma_f32_16x16x32_bf16 v[228:231], v[116:119], a[200:203], v[228:231]
s_waitcnt lgkmcnt(14)
buffer_load_dwordx4 v5, s[28:31], s25 offen offset:1024 lds
v_mfma_f32_16x16x32_bf16 v[232:235], v[120:123], a[192:195], v[232:235]
ds_read_b64_tr_b16 v[152:153], v34 offset:8192
v_mfma_f32_16x16x32_bf16 v[236:239], v[120:123], a[196:199], v[236:239]
ds_read_b64_tr_b16 v[154:155], v34 offset:12288
v_mfma_f32_16x16x32_bf16 v[240:243], v[120:123], a[200:203], v[240:243]
s_waitcnt lgkmcnt(14)
ds_read_b64_tr_b16 v[156:157], v35 offset:8192
v_mfma_f32_16x16x32_bf16 v[244:247], v[124:127], a[192:195], v[244:247]
ds_read_b64_tr_b16 v[158:159], v35 offset:12288
v_mfma_f32_16x16x32_bf16 v[248:251], v[124:127], a[196:199], v[248:251]
buffer_load_dwordx4 a[24:27], v1, s[32:35], s23 offen sc1
v_mfma_f32_16x16x32_bf16 v[252:255], v[124:127], a[200:203], v[252:255]
s_waitcnt lgkmcnt(14)
ds_read_b64_tr_b16 v[128:129], v6 offset:57344
v_mfma_f32_16x16x32_bf16 v[160:163], v[96:99], a[72:75], v[160:163]
ds_read_b64_tr_b16 v[130:131], v6 offset:61440
v_mfma_f32_16x16x32_bf16 v[164:167], v[96:99], a[76:79], v[164:167]
ds_read_b64_tr_b16 v[132:133], v7 offset:57344
v_mfma_f32_16x16x32_bf16 v[168:171], v[96:99], a[80:83], v[168:171]
s_waitcnt lgkmcnt(15)
ds_read_b64_tr_b16 v[134:135], v7 offset:61440
v_mfma_f32_16x16x32_bf16 v[172:175], v[100:103], a[72:75], v[172:175]
buffer_load_dwordx4 a[28:31], v2, s[32:35], s23 offen sc1
v_mfma_f32_16x16x32_bf16 v[176:179], v[100:103], a[76:79], v[176:179]
ds_read_b64_tr_b16 v[136:137], v8 offset:57344
v_mfma_f32_16x16x32_bf16 v[180:183], v[100:103], a[80:83], v[180:183]
s_waitcnt lgkmcnt(15)
ds_read_b64_tr_b16 v[138:139], v8 offset:61440
v_mfma_f32_16x16x32_bf16 v[184:187], v[104:107], a[72:75], v[184:187]
ds_read_b64_tr_b16 v[140:141], v9 offset:57344
v_mfma_f32_16x16x32_bf16 v[188:191], v[104:107], a[76:79], v[188:191]
ds_read_b64_tr_b16 v[142:143], v9 offset:61440
v_mfma_f32_16x16x32_bf16 v[192:195], v[104:107], a[80:83], v[192:195]
s_waitcnt lgkmcnt(15)
buffer_load_dwordx4 a[32:35], v3, s[32:35], s23 offen sc1
v_mfma_f32_16x16x32_bf16 v[196:199], v[108:111], a[72:75], v[196:199]
v_mfma_f32_16x16x32_bf16 v[200:203], v[108:111], a[76:79], v[200:203]
v_mfma_f32_16x16x32_bf16 v[204:207], v[108:111], a[80:83], v[204:207]
s_waitcnt lgkmcnt(14)
v_mfma_f32_16x16x32_bf16 v[208:211], v[144:147], a[204:207], v[208:211]
s_add_u32 m0, s62, 24576
ds_read_b64_tr_b16 v[112:113], v32 offset:16384
v_mfma_f32_16x16x32_bf16 v[212:215], v[144:147], a[208:211], v[212:215]
buffer_load_dwordx4 v4, s[28:31], s49 offen lds
v_mfma_f32_16x16x32_bf16 v[216:219], v[144:147], a[212:215], v[216:219]
s_waitcnt lgkmcnt(13)
ds_read_b64_tr_b16 v[114:115], v32 offset:20480
v_mfma_f32_16x16x32_bf16 v[220:223], v[148:151], a[204:207], v[220:223]
ds_read_b64_tr_b16 v[116:117], v33 offset:16384
v_mfma_f32_16x16x32_bf16 v[224:227], v[148:151], a[208:211], v[224:227]
ds_read_b64_tr_b16 v[118:119], v33 offset:20480
v_mfma_f32_16x16x32_bf16 v[228:231], v[148:151], a[212:215], v[228:231]
s_waitcnt lgkmcnt(14)
buffer_load_dwordx4 v5, s[28:31], s49 offen offset:1024 lds
v_mfma_f32_16x16x32_bf16 v[232:235], v[152:155], a[204:207], v[232:235]
ds_read_b64_tr_b16 v[120:121], v34 offset:16384
v_mfma_f32_16x16x32_bf16 v[236:239], v[152:155], a[208:211], v[236:239]
ds_read_b64_tr_b16 v[122:123], v34 offset:20480
v_mfma_f32_16x16x32_bf16 v[240:243], v[152:155], a[212:215], v[240:243]
s_waitcnt lgkmcnt(14)
ds_read_b64_tr_b16 v[124:125], v35 offset:16384
v_mfma_f32_16x16x32_bf16 v[244:247], v[156:159], a[204:207], v[244:247]
ds_read_b64_tr_b16 v[126:127], v35 offset:20480
v_mfma_f32_16x16x32_bf16 v[248:251], v[156:159], a[208:211], v[248:251]
buffer_load_dwordx4 a[36:39], v1, s[32:35], s24 offen sc1
v_mfma_f32_16x16x32_bf16 v[252:255], v[156:159], a[212:215], v[252:255]
s_waitcnt lgkmcnt(14)
ds_read_b64_tr_b16 v[96:97], v17
v_mfma_f32_16x16x32_bf16 v[160:163], v[128:131], a[84:87], v[160:163]
ds_read_b64_tr_b16 v[98:99], v17 offset:4096
v_mfma_f32_16x16x32_bf16 v[164:167], v[128:131], a[88:91], v[164:167]
ds_read_b64_tr_b16 v[100:101], v18
v_mfma_f32_16x16x32_bf16 v[168:171], v[128:131], a[92:95], v[168:171]
s_waitcnt lgkmcnt(15)
ds_read_b64_tr_b16 v[102:103], v18 offset:4096
v_mfma_f32_16x16x32_bf16 v[172:175], v[132:135], a[84:87], v[172:175]
buffer_load_dwordx4 a[40:43], v2, s[32:35], s24 offen sc1
v_mfma_f32_16x16x32_bf16 v[176:179], v[132:135], a[88:91], v[176:179]
ds_read_b64_tr_b16 v[104:105], v19
v_mfma_f32_16x16x32_bf16 v[180:183], v[132:135], a[92:95], v[180:183]
s_waitcnt lgkmcnt(15)
ds_read_b64_tr_b16 v[106:107], v19 offset:4096
v_mfma_f32_16x16x32_bf16 v[184:187], v[136:139], a[84:87], v[184:187]
ds_read_b64_tr_b16 v[108:109], v20
v_mfma_f32_16x16x32_bf16 v[188:191], v[136:139], a[88:91], v[188:191]
ds_read_b64_tr_b16 v[110:111], v20 offset:4096
v_mfma_f32_16x16x32_bf16 v[192:195], v[136:139], a[92:95], v[192:195]
s_waitcnt lgkmcnt(15)
buffer_load_dwordx4 a[44:47], v3, s[32:35], s24 offen sc1
v_mfma_f32_16x16x32_bf16 v[196:199], v[140:143], a[84:87], v[196:199]
v_mfma_f32_16x16x32_bf16 v[200:203], v[140:143], a[88:91], v[200:203]
v_mfma_f32_16x16x32_bf16 v[204:207], v[140:143], a[92:95], v[204:207]
s_waitcnt vmcnt(18)
s_barrier
s_waitcnt lgkmcnt(14)
v_mfma_f32_16x16x32_bf16 v[208:211], v[112:115], a[216:219], v[208:211]
ds_read_b64_tr_b16 v[144:145], v32 offset:24576
v_mfma_f32_16x16x32_bf16 v[212:215], v[112:115], a[220:223], v[212:215]
s_add_u32 s28, s28, 491520
s_addc_u32 s29, s29, 0
s_sub_u32 s30, s30, 491520
s_add_u32 s32, s32, 110592
s_addc_u32 s33, s33, 0
s_sub_u32 s34, s34, 110592
s_add_u32 m0, s62, 32768
s_nop 0
buffer_load_dwordx4 v4, s[28:31], s60 offen lds
v_mfma_f32_16x16x32_bf16 v[216:219], v[112:115], a[224:227], v[216:219]
s_waitcnt lgkmcnt(13)
ds_read_b64_tr_b16 v[146:147], v32 offset:28672
v_mfma_f32_16x16x32_bf16 v[220:223], v[116:119], a[216:219], v[220:223]
ds_read_b64_tr_b16 v[148:149], v33 offset:24576
v_mfma_f32_16x16x32_bf16 v[224:227], v[116:119], a[220:223], v[224:227]
ds_read_b64_tr_b16 v[150:151], v33 offset:28672
v_mfma_f32_16x16x32_bf16 v[228:231], v[116:119], a[224:227], v[228:231]
s_waitcnt lgkmcnt(14)
buffer_load_dwordx4 v5, s[28:31], s60 offen offset:1024 lds
v_mfma_f32_16x16x32_bf16 v[232:235], v[120:123], a[216:219], v[232:235]
ds_read_b64_tr_b16 v[152:153], v34 offset:24576
v_mfma_f32_16x16x32_bf16 v[236:239], v[120:123], a[220:223], v[236:239]
ds_read_b64_tr_b16 v[154:155], v34 offset:28672
v_mfma_f32_16x16x32_bf16 v[240:243], v[120:123], a[224:227], v[240:243]
s_waitcnt lgkmcnt(14)
ds_read_b64_tr_b16 v[156:157], v35 offset:24576
v_mfma_f32_16x16x32_bf16 v[244:247], v[124:127], a[216:219], v[244:247]
ds_read_b64_tr_b16 v[158:159], v35 offset:28672
v_mfma_f32_16x16x32_bf16 v[248:251], v[124:127], a[220:223], v[248:251]
buffer_load_dwordx4 a[48:51], v1, s[32:35], s12 offen sc1
v_mfma_f32_16x16x32_bf16 v[252:255], v[124:127], a[224:227], v[252:255]
s_waitcnt lgkmcnt(14)
ds_read_b64_tr_b16 v[128:129], v17 offset:8192
v_mfma_f32_16x16x32_bf16 v[160:163], v[96:99], a[96:99], v[160:163]
ds_read_b64_tr_b16 v[130:131], v17 offset:12288
v_mfma_f32_16x16x32_bf16 v[164:167], v[96:99], a[100:103], v[164:167]
ds_read_b64_tr_b16 v[132:133], v18 offset:8192
v_mfma_f32_16x16x32_bf16 v[168:171], v[96:99], a[104:107], v[168:171]
s_waitcnt lgkmcnt(15)
ds_read_b64_tr_b16 v[134:135], v18 offset:12288
v_mfma_f32_16x16x32_bf16 v[172:175], v[100:103], a[96:99], v[172:175]
buffer_load_dwordx4 a[52:55], v2, s[32:35], s12 offen sc1
v_mfma_f32_16x16x32_bf16 v[176:179], v[100:103], a[100:103], v[176:179]
ds_read_b64_tr_b16 v[136:137], v19 offset:8192
v_mfma_f32_16x16x32_bf16 v[180:183], v[100:103], a[104:107], v[180:183]
s_waitcnt lgkmcnt(15)
ds_read_b64_tr_b16 v[138:139], v19 offset:12288
v_mfma_f32_16x16x32_bf16 v[184:187], v[104:107], a[96:99], v[184:187]
ds_read_b64_tr_b16 v[140:141], v20 offset:8192
v_mfma_f32_16x16x32_bf16 v[188:191], v[104:107], a[100:103], v[188:191]
ds_read_b64_tr_b16 v[142:143], v20 offset:12288
v_mfma_f32_16x16x32_bf16 v[192:195], v[104:107], a[104:107], v[192:195]
s_waitcnt lgkmcnt(15)
buffer_load_dwordx4 a[56:59], v3, s[32:35], s12 offen sc1
v_mfma_f32_16x16x32_bf16 v[196:199], v[108:111], a[96:99], v[196:199]
v_mfma_f32_16x16x32_bf16 v[200:203], v[108:111], a[100:103], v[200:203]
v_mfma_f32_16x16x32_bf16 v[204:207], v[108:111], a[104:107], v[204:207]
s_waitcnt lgkmcnt(14)
v_mfma_f32_16x16x32_bf16 v[208:211], v[144:147], a[228:231], v[208:211]
s_add_u32 m0, s62, 40960
ds_read_b64_tr_b16 v[112:113], v10
v_mfma_f32_16x16x32_bf16 v[212:215], v[144:147], a[232:235], v[212:215]
buffer_load_dwordx4 v4, s[28:31], s61 offen lds
v_mfma_f32_16x16x32_bf16 v[216:219], v[144:147], a[236:239], v[216:219]
s_waitcnt lgkmcnt(13)
ds_read_b64_tr_b16 v[114:115], v10 offset:4096
v_mfma_f32_16x16x32_bf16 v[220:223], v[148:151], a[228:231], v[220:223]
ds_read_b64_tr_b16 v[116:117], v11
v_mfma_f32_16x16x32_bf16 v[224:227], v[148:151], a[232:235], v[224:227]
ds_read_b64_tr_b16 v[118:119], v11 offset:4096
v_mfma_f32_16x16x32_bf16 v[228:231], v[148:151], a[236:239], v[228:231]
s_waitcnt lgkmcnt(14)
buffer_load_dwordx4 v5, s[28:31], s61 offen offset:1024 lds
v_mfma_f32_16x16x32_bf16 v[232:235], v[152:155], a[228:231], v[232:235]
ds_read_b64_tr_b16 v[120:121], v12
v_mfma_f32_16x16x32_bf16 v[236:239], v[152:155], a[232:235], v[236:239]
ds_read_b64_tr_b16 v[122:123], v12 offset:4096
v_mfma_f32_16x16x32_bf16 v[240:243], v[152:155], a[236:239], v[240:243]
s_waitcnt lgkmcnt(14)
ds_read_b64_tr_b16 v[124:125], v13
v_mfma_f32_16x16x32_bf16 v[244:247], v[156:159], a[228:231], v[244:247]
ds_read_b64_tr_b16 v[126:127], v13 offset:4096
v_mfma_f32_16x16x32_bf16 v[248:251], v[156:159], a[232:235], v[248:251]
buffer_load_dwordx4 a[60:63], v1, s[32:35], s13 offen sc1
v_mfma_f32_16x16x32_bf16 v[252:255], v[156:159], a[236:239], v[252:255]
s_waitcnt lgkmcnt(14)
ds_read_b64_tr_b16 v[96:97], v17 offset:16384
v_mfma_f32_16x16x32_bf16 v[160:163], v[128:131], a[108:111], v[160:163]
ds_read_b64_tr_b16 v[98:99], v17 offset:20480
v_mfma_f32_16x16x32_bf16 v[164:167], v[128:131], a[112:115], v[164:167]
ds_read_b64_tr_b16 v[100:101], v18 offset:16384
v_mfma_f32_16x16x32_bf16 v[168:171], v[128:131], a[116:119], v[168:171]
s_waitcnt lgkmcnt(15)
ds_read_b64_tr_b16 v[102:103], v18 offset:20480
v_mfma_f32_16x16x32_bf16 v[172:175], v[132:135], a[108:111], v[172:175]
buffer_load_dwordx4 a[64:67], v2, s[32:35], s13 offen sc1
v_mfma_f32_16x16x32_bf16 v[176:179], v[132:135], a[112:115], v[176:179]
ds_read_b64_tr_b16 v[104:105], v19 offset:16384
v_mfma_f32_16x16x32_bf16 v[180:183], v[132:135], a[116:119], v[180:183]
s_waitcnt lgkmcnt(15)
ds_read_b64_tr_b16 v[106:107], v19 offset:20480
v_mfma_f32_16x16x32_bf16 v[184:187], v[136:139], a[108:111], v[184:187]
ds_read_b64_tr_b16 v[108:109], v20 offset:16384
v_mfma_f32_16x16x32_bf16 v[188:191], v[136:139], a[112:115], v[188:191]
ds_read_b64_tr_b16 v[110:111], v20 offset:20480
v_mfma_f32_16x16x32_bf16 v[192:195], v[136:139], a[116:119], v[192:195]
s_waitcnt lgkmcnt(15)
buffer_load_dwordx4 a[68:71], v3, s[32:35], s13 offen sc1
v_mfma_f32_16x16x32_bf16 v[196:199], v[140:143], a[108:111], v[196:199]
v_mfma_f32_16x16x32_bf16 v[200:203], v[140:143], a[112:115], v[200:203]
v_mfma_f32_16x16x32_bf16 v[204:207], v[140:143], a[116:119], v[204:207]
s_waitcnt vmcnt(18)
s_barrier
s_waitcnt lgkmcnt(14)
v_mfma_f32_16x16x32_bf16 v[208:211], v[112:115], a[0:3], v[208:211]
s_add_u32 m0, s62, 49152
ds_read_b64_tr_b16 v[144:145], v10 offset:8192
v_mfma_f32_16x16x32_bf16 v[212:215], v[112:115], a[4:7], v[212:215]
buffer_load_dwordx4 v4, s[28:31], s69 offen lds
v_mfma_f32_16x16x32_bf16 v[216:219], v[112:115], a[8:11], v[216:219]
s_waitcnt lgkmcnt(13)
ds_read_b64_tr_b16 v[146:147], v10 offset:12288
v_mfma_f32_16x16x32_bf16 v[220:223], v[116:119], a[0:3], v[220:223]
ds_read_b64_tr_b16 v[148:149], v11 offset:8192
v_mfma_f32_16x16x32_bf16 v[224:227], v[116:119], a[4:7], v[224:227]
ds_read_b64_tr_b16 v[150:151], v11 offset:12288
v_mfma_f32_16x16x32_bf16 v[228:231], v[116:119], a[8:11], v[228:231]
s_waitcnt lgkmcnt(14)
buffer_load_dwordx4 v5, s[28:31], s69 offen offset:1024 lds
v_mfma_f32_16x16x32_bf16 v[232:235], v[120:123], a[0:3], v[232:235]
ds_read_b64_tr_b16 v[152:153], v12 offset:8192
v_mfma_f32_16x16x32_bf16 v[236:239], v[120:123], a[4:7], v[236:239]
ds_read_b64_tr_b16 v[154:155], v12 offset:12288
v_mfma_f32_16x16x32_bf16 v[240:243], v[120:123], a[8:11], v[240:243]
s_waitcnt lgkmcnt(14)
ds_read_b64_tr_b16 v[156:157], v13 offset:8192
v_mfma_f32_16x16x32_bf16 v[244:247], v[124:127], a[0:3], v[244:247]
ds_read_b64_tr_b16 v[158:159], v13 offset:12288
v_mfma_f32_16x16x32_bf16 v[248:251], v[124:127], a[4:7], v[248:251]
buffer_load_dwordx4 a[72:75], v1, s[32:35], s14 offen sc1
v_mfma_f32_16x16x32_bf16 v[252:255], v[124:127], a[8:11], v[252:255]
s_waitcnt lgkmcnt(14)
ds_read_b64_tr_b16 v[128:129], v17 offset:24576
v_mfma_f32_16x16x32_bf16 v[160:163], v[96:99], a[120:123], v[160:163]
ds_read_b64_tr_b16 v[130:131], v17 offset:28672
v_mfma_f32_16x16x32_bf16 v[164:167], v[96:99], a[124:127], v[164:167]
ds_read_b64_tr_b16 v[132:133], v18 offset:24576
v_mfma_f32_16x16x32_bf16 v[168:171], v[96:99], a[128:131], v[168:171]
s_waitcnt lgkmcnt(15)
ds_read_b64_tr_b16 v[134:135], v18 offset:28672
v_mfma_f32_16x16x32_bf16 v[172:175], v[100:103], a[120:123], v[172:175]
buffer_load_dwordx4 a[76:79], v2, s[32:35], s14 offen sc1
v_mfma_f32_16x16x32_bf16 v[176:179], v[100:103], a[124:127], v[176:179]
ds_read_b64_tr_b16 v[136:137], v19 offset:24576
v_mfma_f32_16x16x32_bf16 v[180:183], v[100:103], a[128:131], v[180:183]
s_waitcnt lgkmcnt(15)
ds_read_b64_tr_b16 v[138:139], v19 offset:28672
v_mfma_f32_16x16x32_bf16 v[184:187], v[104:107], a[120:123], v[184:187]
ds_read_b64_tr_b16 v[140:141], v20 offset:24576
v_mfma_f32_16x16x32_bf16 v[188:191], v[104:107], a[124:127], v[188:191]
ds_read_b64_tr_b16 v[142:143], v20 offset:28672
v_mfma_f32_16x16x32_bf16 v[192:195], v[104:107], a[128:131], v[192:195]
s_waitcnt lgkmcnt(15)
buffer_load_dwordx4 a[80:83], v3, s[32:35], s14 offen sc1
v_mfma_f32_16x16x32_bf16 v[196:199], v[108:111], a[120:123], v[196:199]
v_mfma_f32_16x16x32_bf16 v[200:203], v[108:111], a[124:127], v[200:203]
v_mfma_f32_16x16x32_bf16 v[204:207], v[108:111], a[128:131], v[204:207]
s_waitcnt lgkmcnt(14)
v_mfma_f32_16x16x32_bf16 v[208:211], v[144:147], a[12:15], v[208:211]
s_add_u32 m0, s62, 57344
ds_read_b64_tr_b16 v[112:113], v10 offset:16384
v_mfma_f32_16x16x32_bf16 v[212:215], v[144:147], a[16:19], v[212:215]
buffer_load_dwordx4 v4, s[28:31], s70 offen lds
v_mfma_f32_16x16x32_bf16 v[216:219], v[144:147], a[20:23], v[216:219]
s_waitcnt lgkmcnt(13)
ds_read_b64_tr_b16 v[114:115], v10 offset:20480
v_mfma_f32_16x16x32_bf16 v[220:223], v[148:151], a[12:15], v[220:223]
ds_read_b64_tr_b16 v[116:117], v11 offset:16384
v_mfma_f32_16x16x32_bf16 v[224:227], v[148:151], a[16:19], v[224:227]
ds_read_b64_tr_b16 v[118:119], v11 offset:20480
v_mfma_f32_16x16x32_bf16 v[228:231], v[148:151], a[20:23], v[228:231]
s_waitcnt lgkmcnt(14)
buffer_load_dwordx4 v5, s[28:31], s70 offen offset:1024 lds
v_mfma_f32_16x16x32_bf16 v[232:235], v[152:155], a[12:15], v[232:235]
ds_read_b64_tr_b16 v[120:121], v12 offset:16384
v_mfma_f32_16x16x32_bf16 v[236:239], v[152:155], a[16:19], v[236:239]
ds_read_b64_tr_b16 v[122:123], v12 offset:20480
v_mfma_f32_16x16x32_bf16 v[240:243], v[152:155], a[20:23], v[240:243]
s_waitcnt lgkmcnt(14)
ds_read_b64_tr_b16 v[124:125], v13 offset:16384
v_mfma_f32_16x16x32_bf16 v[244:247], v[156:159], a[12:15], v[244:247]
ds_read_b64_tr_b16 v[126:127], v13 offset:20480
v_mfma_f32_16x16x32_bf16 v[248:251], v[156:159], a[16:19], v[248:251]
buffer_load_dwordx4 a[84:87], v1, s[32:35], s15 offen sc1
v_mfma_f32_16x16x32_bf16 v[252:255], v[156:159], a[20:23], v[252:255]
s_waitcnt lgkmcnt(14)
ds_read_b64_tr_b16 v[96:97], v17 offset:32768
v_mfma_f32_16x16x32_bf16 v[160:163], v[128:131], a[132:135], v[160:163]
ds_read_b64_tr_b16 v[98:99], v17 offset:36864
v_mfma_f32_16x16x32_bf16 v[164:167], v[128:131], a[136:139], v[164:167]
ds_read_b64_tr_b16 v[100:101], v18 offset:32768
v_mfma_f32_16x16x32_bf16 v[168:171], v[128:131], a[140:143], v[168:171]
s_waitcnt lgkmcnt(15)
ds_read_b64_tr_b16 v[102:103], v18 offset:36864
v_mfma_f32_16x16x32_bf16 v[172:175], v[132:135], a[132:135], v[172:175]
buffer_load_dwordx4 a[88:91], v2, s[32:35], s15 offen sc1
v_mfma_f32_16x16x32_bf16 v[176:179], v[132:135], a[136:139], v[176:179]
ds_read_b64_tr_b16 v[104:105], v19 offset:32768
v_mfma_f32_16x16x32_bf16 v[180:183], v[132:135], a[140:143], v[180:183]
s_waitcnt lgkmcnt(15)
ds_read_b64_tr_b16 v[106:107], v19 offset:36864
v_mfma_f32_16x16x32_bf16 v[184:187], v[136:139], a[132:135], v[184:187]
ds_read_b64_tr_b16 v[108:109], v20 offset:32768
v_mfma_f32_16x16x32_bf16 v[188:191], v[136:139], a[136:139], v[188:191]
ds_read_b64_tr_b16 v[110:111], v20 offset:36864
v_mfma_f32_16x16x32_bf16 v[192:195], v[136:139], a[140:143], v[192:195]
s_waitcnt lgkmcnt(15)
buffer_load_dwordx4 a[92:95], v3, s[32:35], s15 offen sc1
v_mfma_f32_16x16x32_bf16 v[196:199], v[140:143], a[132:135], v[196:199]
v_mfma_f32_16x16x32_bf16 v[200:203], v[140:143], a[136:139], v[200:203]
v_mfma_f32_16x16x32_bf16 v[204:207], v[140:143], a[140:143], v[204:207]
s_waitcnt vmcnt(18)
s_barrier
s_waitcnt lgkmcnt(14)
v_mfma_f32_16x16x32_bf16 v[208:211], v[112:115], a[24:27], v[208:211]
s_add_u32 m0, s62, 65536
ds_read_b64_tr_b16 v[144:145], v10 offset:24576
v_mfma_f32_16x16x32_bf16 v[212:215], v[112:115], a[28:31], v[212:215]
buffer_load_dwordx4 v4, s[28:31], s71 offen lds
v_mfma_f32_16x16x32_bf16 v[216:219], v[112:115], a[32:35], v[216:219]
s_waitcnt lgkmcnt(13)
ds_read_b64_tr_b16 v[146:147], v10 offset:28672
v_mfma_f32_16x16x32_bf16 v[220:223], v[116:119], a[24:27], v[220:223]
ds_read_b64_tr_b16 v[148:149], v11 offset:24576
v_mfma_f32_16x16x32_bf16 v[224:227], v[116:119], a[28:31], v[224:227]
ds_read_b64_tr_b16 v[150:151], v11 offset:28672
v_mfma_f32_16x16x32_bf16 v[228:231], v[116:119], a[32:35], v[228:231]
s_waitcnt lgkmcnt(14)
buffer_load_dwordx4 v5, s[28:31], s71 offen offset:1024 lds
v_mfma_f32_16x16x32_bf16 v[232:235], v[120:123], a[24:27], v[232:235]
ds_read_b64_tr_b16 v[152:153], v12 offset:24576
v_mfma_f32_16x16x32_bf16 v[236:239], v[120:123], a[28:31], v[236:239]
ds_read_b64_tr_b16 v[154:155], v12 offset:28672
v_mfma_f32_16x16x32_bf16 v[240:243], v[120:123], a[32:35], v[240:243]
s_waitcnt lgkmcnt(14)
ds_read_b64_tr_b16 v[156:157], v13 offset:24576
v_mfma_f32_16x16x32_bf16 v[244:247], v[124:127], a[24:27], v[244:247]
ds_read_b64_tr_b16 v[158:159], v13 offset:28672
v_mfma_f32_16x16x32_bf16 v[248:251], v[124:127], a[28:31], v[248:251]
buffer_load_dwordx4 a[96:99], v1, s[32:35], s16 offen sc1
v_mfma_f32_16x16x32_bf16 v[252:255], v[124:127], a[32:35], v[252:255]
s_waitcnt lgkmcnt(14)
ds_read_b64_tr_b16 v[128:129], v17 offset:40960
v_mfma_f32_16x16x32_bf16 v[160:163], v[96:99], a[144:147], v[160:163]
ds_read_b64_tr_b16 v[130:131], v17 offset:45056
v_mfma_f32_16x16x32_bf16 v[164:167], v[96:99], a[148:151], v[164:167]
ds_read_b64_tr_b16 v[132:133], v18 offset:40960
v_mfma_f32_16x16x32_bf16 v[168:171], v[96:99], a[152:155], v[168:171]
s_waitcnt lgkmcnt(15)
ds_read_b64_tr_b16 v[134:135], v18 offset:45056
v_mfma_f32_16x16x32_bf16 v[172:175], v[100:103], a[144:147], v[172:175]
buffer_load_dwordx4 a[100:103], v2, s[32:35], s16 offen sc1
v_mfma_f32_16x16x32_bf16 v[176:179], v[100:103], a[148:151], v[176:179]
ds_read_b64_tr_b16 v[136:137], v19 offset:40960
v_mfma_f32_16x16x32_bf16 v[180:183], v[100:103], a[152:155], v[180:183]
s_waitcnt lgkmcnt(15)
ds_read_b64_tr_b16 v[138:139], v19 offset:45056
v_mfma_f32_16x16x32_bf16 v[184:187], v[104:107], a[144:147], v[184:187]
ds_read_b64_tr_b16 v[140:141], v20 offset:40960
v_mfma_f32_16x16x32_bf16 v[188:191], v[104:107], a[148:151], v[188:191]
ds_read_b64_tr_b16 v[142:143], v20 offset:45056
v_mfma_f32_16x16x32_bf16 v[192:195], v[104:107], a[152:155], v[192:195]
s_waitcnt lgkmcnt(15)
buffer_load_dwordx4 a[104:107], v3, s[32:35], s16 offen sc1
v_mfma_f32_16x16x32_bf16 v[196:199], v[108:111], a[144:147], v[196:199]
v_mfma_f32_16x16x32_bf16 v[200:203], v[108:111], a[148:151], v[200:203]
v_mfma_f32_16x16x32_bf16 v[204:207], v[108:111], a[152:155], v[204:207]
s_waitcnt lgkmcnt(14)
v_mfma_f32_16x16x32_bf16 v[208:211], v[144:147], a[36:39], v[208:211]
s_add_u32 m0, s62, 73728
ds_read_b64_tr_b16 v[112:113], v10 offset:32768
v_mfma_f32_16x16x32_bf16 v[212:215], v[144:147], a[40:43], v[212:215]
buffer_load_dwordx4 v4, s[28:31], s79 offen lds
v_mfma_f32_16x16x32_bf16 v[216:219], v[144:147], a[44:47], v[216:219]
s_waitcnt lgkmcnt(13)
ds_read_b64_tr_b16 v[114:115], v10 offset:36864
v_mfma_f32_16x16x32_bf16 v[220:223], v[148:151], a[36:39], v[220:223]
ds_read_b64_tr_b16 v[116:117], v11 offset:32768
v_mfma_f32_16x16x32_bf16 v[224:227], v[148:151], a[40:43], v[224:227]
ds_read_b64_tr_b16 v[118:119], v11 offset:36864
v_mfma_f32_16x16x32_bf16 v[228:231], v[148:151], a[44:47], v[228:231]
s_waitcnt lgkmcnt(14)
buffer_load_dwordx4 v5, s[28:31], s79 offen offset:1024 lds
v_mfma_f32_16x16x32_bf16 v[232:235], v[152:155], a[36:39], v[232:235]
ds_read_b64_tr_b16 v[120:121], v12 offset:32768
v_mfma_f32_16x16x32_bf16 v[236:239], v[152:155], a[40:43], v[236:239]
ds_read_b64_tr_b16 v[122:123], v12 offset:36864
v_mfma_f32_16x16x32_bf16 v[240:243], v[152:155], a[44:47], v[240:243]
s_waitcnt lgkmcnt(14)
ds_read_b64_tr_b16 v[124:125], v13 offset:32768
v_mfma_f32_16x16x32_bf16 v[244:247], v[156:159], a[36:39], v[244:247]
ds_read_b64_tr_b16 v[126:127], v13 offset:36864
v_mfma_f32_16x16x32_bf16 v[248:251], v[156:159], a[40:43], v[248:251]
buffer_load_dwordx4 a[108:111], v1, s[32:35], s17 offen sc1
v_mfma_f32_16x16x32_bf16 v[252:255], v[156:159], a[44:47], v[252:255]
s_waitcnt lgkmcnt(14)
ds_read_b64_tr_b16 v[96:97], v17 offset:49152
v_mfma_f32_16x16x32_bf16 v[160:163], v[128:131], a[156:159], v[160:163]
ds_read_b64_tr_b16 v[98:99], v17 offset:53248
v_mfma_f32_16x16x32_bf16 v[164:167], v[128:131], a[160:163], v[164:167]
ds_read_b64_tr_b16 v[100:101], v18 offset:49152
v_mfma_f32_16x16x32_bf16 v[168:171], v[128:131], a[164:167], v[168:171]
s_waitcnt lgkmcnt(15)
ds_read_b64_tr_b16 v[102:103], v18 offset:53248
v_mfma_f32_16x16x32_bf16 v[172:175], v[132:135], a[156:159], v[172:175]
buffer_load_dwordx4 a[112:115], v2, s[32:35], s17 offen sc1
v_mfma_f32_16x16x32_bf16 v[176:179], v[132:135], a[160:163], v[176:179]
ds_read_b64_tr_b16 v[104:105], v19 offset:49152
v_mfma_f32_16x16x32_bf16 v[180:183], v[132:135], a[164:167], v[180:183]
s_waitcnt lgkmcnt(15)
ds_read_b64_tr_b16 v[106:107], v19 offset:53248
v_mfma_f32_16x16x32_bf16 v[184:187], v[136:139], a[156:159], v[184:187]
ds_read_b64_tr_b16 v[108:109], v20 offset:49152
v_mfma_f32_16x16x32_bf16 v[188:191], v[136:139], a[160:163], v[188:191]
ds_read_b64_tr_b16 v[110:111], v20 offset:53248
v_mfma_f32_16x16x32_bf16 v[192:195], v[136:139], a[164:167], v[192:195]
s_waitcnt lgkmcnt(15)
buffer_load_dwordx4 a[116:119], v3, s[32:35], s17 offen sc1
v_mfma_f32_16x16x32_bf16 v[196:199], v[140:143], a[156:159], v[196:199]
v_mfma_f32_16x16x32_bf16 v[200:203], v[140:143], a[160:163], v[200:203]
v_mfma_f32_16x16x32_bf16 v[204:207], v[140:143], a[164:167], v[204:207]
s_waitcnt vmcnt(18)
s_barrier
s_waitcnt lgkmcnt(14)
v_mfma_f32_16x16x32_bf16 v[208:211], v[112:115], a[48:51], v[208:211]
s_add_u32 m0, s62, 81920
ds_read_b64_tr_b16 v[144:145], v10 offset:40960
v_mfma_f32_16x16x32_bf16 v[212:215], v[112:115], a[52:55], v[212:215]
buffer_load_dwordx4 v4, s[28:31], s80 offen lds
v_mfma_f32_16x16x32_bf16 v[216:219], v[112:115], a[56:59], v[216:219]
s_waitcnt lgkmcnt(13)
ds_read_b64_tr_b16 v[146:147], v10 offset:45056
v_mfma_f32_16x16x32_bf16 v[220:223], v[116:119], a[48:51], v[220:223]
ds_read_b64_tr_b16 v[148:149], v11 offset:40960
v_mfma_f32_16x16x32_bf16 v[224:227], v[116:119], a[52:55], v[224:227]
ds_read_b64_tr_b16 v[150:151], v11 offset:45056
v_mfma_f32_16x16x32_bf16 v[228:231], v[116:119], a[56:59], v[228:231]
s_waitcnt lgkmcnt(14)
buffer_load_dwordx4 v5, s[28:31], s80 offen offset:1024 lds
v_mfma_f32_16x16x32_bf16 v[232:235], v[120:123], a[48:51], v[232:235]
ds_read_b64_tr_b16 v[152:153], v12 offset:40960
v_mfma_f32_16x16x32_bf16 v[236:239], v[120:123], a[52:55], v[236:239]
ds_read_b64_tr_b16 v[154:155], v12 offset:45056
v_mfma_f32_16x16x32_bf16 v[240:243], v[120:123], a[56:59], v[240:243]
s_waitcnt lgkmcnt(14)
ds_read_b64_tr_b16 v[156:157], v13 offset:40960
v_mfma_f32_16x16x32_bf16 v[244:247], v[124:127], a[48:51], v[244:247]
ds_read_b64_tr_b16 v[158:159], v13 offset:45056
v_mfma_f32_16x16x32_bf16 v[248:251], v[124:127], a[52:55], v[248:251]
buffer_load_dwordx4 a[120:123], v1, s[32:35], s18 offen sc1
v_mfma_f32_16x16x32_bf16 v[252:255], v[124:127], a[56:59], v[252:255]
s_waitcnt lgkmcnt(14)
ds_read_b64_tr_b16 v[128:129], v17 offset:57344
v_mfma_f32_16x16x32_bf16 v[160:163], v[96:99], a[168:171], v[160:163]
ds_read_b64_tr_b16 v[130:131], v17 offset:61440
v_mfma_f32_16x16x32_bf16 v[164:167], v[96:99], a[172:175], v[164:167]
ds_read_b64_tr_b16 v[132:133], v18 offset:57344
v_mfma_f32_16x16x32_bf16 v[168:171], v[96:99], a[176:179], v[168:171]
s_waitcnt lgkmcnt(15)
ds_read_b64_tr_b16 v[134:135], v18 offset:61440
v_mfma_f32_16x16x32_bf16 v[172:175], v[100:103], a[168:171], v[172:175]
buffer_load_dwordx4 a[124:127], v2, s[32:35], s18 offen sc1
v_mfma_f32_16x16x32_bf16 v[176:179], v[100:103], a[172:175], v[176:179]
ds_read_b64_tr_b16 v[136:137], v19 offset:57344
v_mfma_f32_16x16x32_bf16 v[180:183], v[100:103], a[176:179], v[180:183]
s_waitcnt lgkmcnt(15)
ds_read_b64_tr_b16 v[138:139], v19 offset:61440
v_mfma_f32_16x16x32_bf16 v[184:187], v[104:107], a[168:171], v[184:187]
ds_read_b64_tr_b16 v[140:141], v20 offset:57344
v_mfma_f32_16x16x32_bf16 v[188:191], v[104:107], a[172:175], v[188:191]
ds_read_b64_tr_b16 v[142:143], v20 offset:61440
v_mfma_f32_16x16x32_bf16 v[192:195], v[104:107], a[176:179], v[192:195]
s_waitcnt lgkmcnt(15)
buffer_load_dwordx4 a[128:131], v3, s[32:35], s18 offen sc1
v_mfma_f32_16x16x32_bf16 v[196:199], v[108:111], a[168:171], v[196:199]
v_mfma_f32_16x16x32_bf16 v[200:203], v[108:111], a[172:175], v[200:203]
v_mfma_f32_16x16x32_bf16 v[204:207], v[108:111], a[176:179], v[204:207]
s_waitcnt lgkmcnt(14)
v_mfma_f32_16x16x32_bf16 v[208:211], v[144:147], a[60:63], v[208:211]
s_add_u32 m0, s62, 90112
ds_read_b64_tr_b16 v[112:113], v10 offset:49152
v_mfma_f32_16x16x32_bf16 v[212:215], v[144:147], a[64:67], v[212:215]
buffer_load_dwordx4 v4, s[28:31], s81 offen lds
v_mfma_f32_16x16x32_bf16 v[216:219], v[144:147], a[68:71], v[216:219]
s_waitcnt lgkmcnt(13)
ds_read_b64_tr_b16 v[114:115], v10 offset:53248
v_mfma_f32_16x16x32_bf16 v[220:223], v[148:151], a[60:63], v[220:223]
ds_read_b64_tr_b16 v[116:117], v11 offset:49152
v_mfma_f32_16x16x32_bf16 v[224:227], v[148:151], a[64:67], v[224:227]
ds_read_b64_tr_b16 v[118:119], v11 offset:53248
v_mfma_f32_16x16x32_bf16 v[228:231], v[148:151], a[68:71], v[228:231]
s_waitcnt lgkmcnt(14)
buffer_load_dwordx4 v5, s[28:31], s81 offen offset:1024 lds
v_mfma_f32_16x16x32_bf16 v[232:235], v[152:155], a[60:63], v[232:235]
ds_read_b64_tr_b16 v[120:121], v12 offset:49152
v_mfma_f32_16x16x32_bf16 v[236:239], v[152:155], a[64:67], v[236:239]
ds_read_b64_tr_b16 v[122:123], v12 offset:53248
v_mfma_f32_16x16x32_bf16 v[240:243], v[152:155], a[68:71], v[240:243]
s_waitcnt lgkmcnt(14)
ds_read_b64_tr_b16 v[124:125], v13 offset:49152
v_mfma_f32_16x16x32_bf16 v[244:247], v[156:159], a[60:63], v[244:247]
ds_read_b64_tr_b16 v[126:127], v13 offset:53248
v_mfma_f32_16x16x32_bf16 v[248:251], v[156:159], a[64:67], v[248:251]
buffer_load_dwordx4 a[132:135], v1, s[32:35], s19 offen sc1
v_mfma_f32_16x16x32_bf16 v[252:255], v[156:159], a[68:71], v[252:255]
s_waitcnt lgkmcnt(14)
ds_read_b64_tr_b16 v[96:97], v28
v_mfma_f32_16x16x32_bf16 v[160:163], v[128:131], a[180:183], v[160:163]
ds_read_b64_tr_b16 v[98:99], v28 offset:4096
v_mfma_f32_16x16x32_bf16 v[164:167], v[128:131], a[184:187], v[164:167]
ds_read_b64_tr_b16 v[100:101], v29
v_mfma_f32_16x16x32_bf16 v[168:171], v[128:131], a[188:191], v[168:171]
s_waitcnt lgkmcnt(15)
ds_read_b64_tr_b16 v[102:103], v29 offset:4096
v_mfma_f32_16x16x32_bf16 v[172:175], v[132:135], a[180:183], v[172:175]
buffer_load_dwordx4 a[136:139], v2, s[32:35], s19 offen sc1
v_mfma_f32_16x16x32_bf16 v[176:179], v[132:135], a[184:187], v[176:179]
ds_read_b64_tr_b16 v[104:105], v30
v_mfma_f32_16x16x32_bf16 v[180:183], v[132:135], a[188:191], v[180:183]
s_waitcnt lgkmcnt(15)
ds_read_b64_tr_b16 v[106:107], v30 offset:4096
v_mfma_f32_16x16x32_bf16 v[184:187], v[136:139], a[180:183], v[184:187]
ds_read_b64_tr_b16 v[108:109], v31
v_mfma_f32_16x16x32_bf16 v[188:191], v[136:139], a[184:187], v[188:191]
ds_read_b64_tr_b16 v[110:111], v31 offset:4096
v_mfma_f32_16x16x32_bf16 v[192:195], v[136:139], a[188:191], v[192:195]
s_waitcnt lgkmcnt(15)
buffer_load_dwordx4 a[140:143], v3, s[32:35], s19 offen sc1
v_mfma_f32_16x16x32_bf16 v[196:199], v[140:143], a[180:183], v[196:199]
v_mfma_f32_16x16x32_bf16 v[200:203], v[140:143], a[184:187], v[200:203]
v_mfma_f32_16x16x32_bf16 v[204:207], v[140:143], a[188:191], v[204:207]
s_waitcnt vmcnt(18)
s_barrier
s_waitcnt lgkmcnt(14)
v_mfma_f32_16x16x32_bf16 v[208:211], v[112:115], a[72:75], v[208:211]
s_add_u32 m0, s62, 98304
ds_read_b64_tr_b16 v[144:145], v10 offset:57344
v_mfma_f32_16x16x32_bf16 v[212:215], v[112:115], a[76:79], v[212:215]
buffer_load_dwordx4 v4, s[28:31], s82 offen lds
v_mfma_f32_16x16x32_bf16 v[216:219], v[112:115], a[80:83], v[216:219]
s_waitcnt lgkmcnt(13)
ds_read_b64_tr_b16 v[146:147], v10 offset:61440
v_mfma_f32_16x16x32_bf16 v[220:223], v[116:119], a[72:75], v[220:223]
ds_read_b64_tr_b16 v[148:149], v11 offset:57344
v_mfma_f32_16x16x32_bf16 v[224:227], v[116:119], a[76:79], v[224:227]
ds_read_b64_tr_b16 v[150:151], v11 offset:61440
v_mfma_f32_16x16x32_bf16 v[228:231], v[116:119], a[80:83], v[228:231]
s_waitcnt lgkmcnt(14)
buffer_load_dwordx4 v5, s[28:31], s82 offen offset:1024 lds
v_mfma_f32_16x16x32_bf16 v[232:235], v[120:123], a[72:75], v[232:235]
ds_read_b64_tr_b16 v[152:153], v12 offset:57344
v_mfma_f32_16x16x32_bf16 v[236:239], v[120:123], a[76:79], v[236:239]
ds_read_b64_tr_b16 v[154:155], v12 offset:61440
v_mfma_f32_16x16x32_bf16 v[240:243], v[120:123], a[80:83], v[240:243]
s_waitcnt lgkmcnt(14)
ds_read_b64_tr_b16 v[156:157], v13 offset:57344
v_mfma_f32_16x16x32_bf16 v[244:247], v[124:127], a[72:75], v[244:247]
ds_read_b64_tr_b16 v[158:159], v13 offset:61440
v_mfma_f32_16x16x32_bf16 v[248:251], v[124:127], a[76:79], v[248:251]
buffer_load_dwordx4 a[144:147], v1, s[32:35], s20 offen sc1
v_mfma_f32_16x16x32_bf16 v[252:255], v[124:127], a[80:83], v[252:255]
s_waitcnt lgkmcnt(14)
ds_read_b64_tr_b16 v[128:129], v28 offset:8192
v_mfma_f32_16x16x32_bf16 v[160:163], v[96:99], a[192:195], v[160:163]
ds_read_b64_tr_b16 v[130:131], v28 offset:12288
v_mfma_f32_16x16x32_bf16 v[164:167], v[96:99], a[196:199], v[164:167]
ds_read_b64_tr_b16 v[132:133], v29 offset:8192
v_mfma_f32_16x16x32_bf16 v[168:171], v[96:99], a[200:203], v[168:171]
s_waitcnt lgkmcnt(15)
ds_read_b64_tr_b16 v[134:135], v29 offset:12288
v_mfma_f32_16x16x32_bf16 v[172:175], v[100:103], a[192:195], v[172:175]
buffer_load_dwordx4 a[148:151], v2, s[32:35], s20 offen sc1
v_mfma_f32_16x16x32_bf16 v[176:179], v[100:103], a[196:199], v[176:179]
ds_read_b64_tr_b16 v[136:137], v30 offset:8192
v_mfma_f32_16x16x32_bf16 v[180:183], v[100:103], a[200:203], v[180:183]
s_waitcnt lgkmcnt(15)
ds_read_b64_tr_b16 v[138:139], v30 offset:12288
v_mfma_f32_16x16x32_bf16 v[184:187], v[104:107], a[192:195], v[184:187]
ds_read_b64_tr_b16 v[140:141], v31 offset:8192
v_mfma_f32_16x16x32_bf16 v[188:191], v[104:107], a[196:199], v[188:191]
ds_read_b64_tr_b16 v[142:143], v31 offset:12288
v_mfma_f32_16x16x32_bf16 v[192:195], v[104:107], a[200:203], v[192:195]
s_waitcnt lgkmcnt(15)
buffer_load_dwordx4 a[152:155], v3, s[32:35], s20 offen sc1
v_mfma_f32_16x16x32_bf16 v[196:199], v[108:111], a[192:195], v[196:199]
v_mfma_f32_16x16x32_bf16 v[200:203], v[108:111], a[196:199], v[200:203]
v_mfma_f32_16x16x32_bf16 v[204:207], v[108:111], a[200:203], v[204:207]
s_waitcnt lgkmcnt(14)
v_mfma_f32_16x16x32_bf16 v[208:211], v[144:147], a[84:87], v[208:211]
s_add_u32 m0, s62, 106496
ds_read_b64_tr_b16 v[112:113], v21
v_mfma_f32_16x16x32_bf16 v[212:215], v[144:147], a[88:91], v[212:215]
buffer_load_dwordx4 v4, s[28:31], s83 offen lds
v_mfma_f32_16x16x32_bf16 v[216:219], v[144:147], a[92:95], v[216:219]
s_waitcnt lgkmcnt(13)
ds_read_b64_tr_b16 v[114:115], v21 offset:4096
v_mfma_f32_16x16x32_bf16 v[220:223], v[148:151], a[84:87], v[220:223]
ds_read_b64_tr_b16 v[116:117], v22
v_mfma_f32_16x16x32_bf16 v[224:227], v[148:151], a[88:91], v[224:227]
ds_read_b64_tr_b16 v[118:119], v22 offset:4096
v_mfma_f32_16x16x32_bf16 v[228:231], v[148:151], a[92:95], v[228:231]
s_waitcnt lgkmcnt(14)
buffer_load_dwordx4 v5, s[28:31], s83 offen offset:1024 lds
v_mfma_f32_16x16x32_bf16 v[232:235], v[152:155], a[84:87], v[232:235]
ds_read_b64_tr_b16 v[120:121], v23
v_mfma_f32_16x16x32_bf16 v[236:239], v[152:155], a[88:91], v[236:239]
ds_read_b64_tr_b16 v[122:123], v23 offset:4096
v_mfma_f32_16x16x32_bf16 v[240:243], v[152:155], a[92:95], v[240:243]
s_waitcnt lgkmcnt(14)
ds_read_b64_tr_b16 v[124:125], v24
v_mfma_f32_16x16x32_bf16 v[244:247], v[156:159], a[84:87], v[244:247]
ds_read_b64_tr_b16 v[126:127], v24 offset:4096
v_mfma_f32_16x16x32_bf16 v[248:251], v[156:159], a[88:91], v[248:251]
buffer_load_dwordx4 a[156:159], v1, s[32:35], s22 offen sc1
v_mfma_f32_16x16x32_bf16 v[252:255], v[156:159], a[92:95], v[252:255]
s_waitcnt lgkmcnt(14)
ds_read_b64_tr_b16 v[96:97], v28 offset:16384
v_mfma_f32_16x16x32_bf16 v[160:163], v[128:131], a[204:207], v[160:163]
ds_read_b64_tr_b16 v[98:99], v28 offset:20480
v_mfma_f32_16x16x32_bf16 v[164:167], v[128:131], a[208:211], v[164:167]
ds_read_b64_tr_b16 v[100:101], v29 offset:16384
v_mfma_f32_16x16x32_bf16 v[168:171], v[128:131], a[212:215], v[168:171]
s_waitcnt lgkmcnt(15)
ds_read_b64_tr_b16 v[102:103], v29 offset:20480
v_mfma_f32_16x16x32_bf16 v[172:175], v[132:135], a[204:207], v[172:175]
buffer_load_dwordx4 a[160:163], v2, s[32:35], s22 offen sc1
v_mfma_f32_16x16x32_bf16 v[176:179], v[132:135], a[208:211], v[176:179]
ds_read_b64_tr_b16 v[104:105], v30 offset:16384
v_mfma_f32_16x16x32_bf16 v[180:183], v[132:135], a[212:215], v[180:183]
s_waitcnt lgkmcnt(15)
ds_read_b64_tr_b16 v[106:107], v30 offset:20480
v_mfma_f32_16x16x32_bf16 v[184:187], v[136:139], a[204:207], v[184:187]
ds_read_b64_tr_b16 v[108:109], v31 offset:16384
v_mfma_f32_16x16x32_bf16 v[188:191], v[136:139], a[208:211], v[188:191]
ds_read_b64_tr_b16 v[110:111], v31 offset:20480
v_mfma_f32_16x16x32_bf16 v[192:195], v[136:139], a[212:215], v[192:195]
s_waitcnt lgkmcnt(15)
buffer_load_dwordx4 a[164:167], v3, s[32:35], s22 offen sc1
v_mfma_f32_16x16x32_bf16 v[196:199], v[140:143], a[204:207], v[196:199]
v_mfma_f32_16x16x32_bf16 v[200:203], v[140:143], a[208:211], v[200:203]
v_mfma_f32_16x16x32_bf16 v[204:207], v[140:143], a[212:215], v[204:207]
s_waitcnt vmcnt(18)
s_barrier
s_waitcnt lgkmcnt(14)
v_mfma_f32_16x16x32_bf16 v[208:211], v[112:115], a[96:99], v[208:211]
s_add_u32 m0, s62, 114688
ds_read_b64_tr_b16 v[144:145], v21 offset:8192
v_mfma_f32_16x16x32_bf16 v[212:215], v[112:115], a[100:103], v[212:215]
buffer_load_dwordx4 v4, s[28:31], s25 offen lds
v_mfma_f32_16x16x32_bf16 v[216:219], v[112:115], a[104:107], v[216:219]
s_waitcnt lgkmcnt(13)
ds_read_b64_tr_b16 v[146:147], v21 offset:12288
v_mfma_f32_16x16x32_bf16 v[220:223], v[116:119], a[96:99], v[220:223]
ds_read_b64_tr_b16 v[148:149], v22 offset:8192
v_mfma_f32_16x16x32_bf16 v[224:227], v[116:119], a[100:103], v[224:227]
ds_read_b64_tr_b16 v[150:151], v22 offset:12288
v_mfma_f32_16x16x32_bf16 v[228:231], v[116:119], a[104:107], v[228:231]
s_waitcnt lgkmcnt(14)
buffer_load_dwordx4 v5, s[28:31], s25 offen offset:1024 lds
v_mfma_f32_16x16x32_bf16 v[232:235], v[120:123], a[96:99], v[232:235]
ds_read_b64_tr_b16 v[152:153], v23 offset:8192
v_mfma_f32_16x16x32_bf16 v[236:239], v[120:123], a[100:103], v[236:239]
ds_read_b64_tr_b16 v[154:155], v23 offset:12288
v_mfma_f32_16x16x32_bf16 v[240:243], v[120:123], a[104:107], v[240:243]
s_waitcnt lgkmcnt(14)
ds_read_b64_tr_b16 v[156:157], v24 offset:8192
v_mfma_f32_16x16x32_bf16 v[244:247], v[124:127], a[96:99], v[244:247]
ds_read_b64_tr_b16 v[158:159], v24 offset:12288
v_mfma_f32_16x16x32_bf16 v[248:251], v[124:127], a[100:103], v[248:251]
buffer_load_dwordx4 a[168:171], v1, s[32:35], s23 offen sc1
v_mfma_f32_16x16x32_bf16 v[252:255], v[124:127], a[104:107], v[252:255]
s_waitcnt lgkmcnt(14)
ds_read_b64_tr_b16 v[128:129], v28 offset:24576
v_mfma_f32_16x16x32_bf16 v[160:163], v[96:99], a[216:219], v[160:163]
ds_read_b64_tr_b16 v[130:131], v28 offset:28672
v_mfma_f32_16x16x32_bf16 v[164:167], v[96:99], a[220:223], v[164:167]
ds_read_b64_tr_b16 v[132:133], v29 offset:24576
v_mfma_f32_16x16x32_bf16 v[168:171], v[96:99], a[224:227], v[168:171]
s_waitcnt lgkmcnt(15)
ds_read_b64_tr_b16 v[134:135], v29 offset:28672
v_mfma_f32_16x16x32_bf16 v[172:175], v[100:103], a[216:219], v[172:175]
buffer_load_dwordx4 a[172:175], v2, s[32:35], s23 offen sc1
v_mfma_f32_16x16x32_bf16 v[176:179], v[100:103], a[220:223], v[176:179]
ds_read_b64_tr_b16 v[136:137], v30 offset:24576
v_mfma_f32_16x16x32_bf16 v[180:183], v[100:103], a[224:227], v[180:183]
s_waitcnt lgkmcnt(15)
ds_read_b64_tr_b16 v[138:139], v30 offset:28672
v_mfma_f32_16x16x32_bf16 v[184:187], v[104:107], a[216:219], v[184:187]
ds_read_b64_tr_b16 v[140:141], v31 offset:24576
v_mfma_f32_16x16x32_bf16 v[188:191], v[104:107], a[220:223], v[188:191]
ds_read_b64_tr_b16 v[142:143], v31 offset:28672
v_mfma_f32_16x16x32_bf16 v[192:195], v[104:107], a[224:227], v[192:195]
s_waitcnt lgkmcnt(15)
buffer_load_dwordx4 a[176:179], v3, s[32:35], s23 offen sc1
v_mfma_f32_16x16x32_bf16 v[196:199], v[108:111], a[216:219], v[196:199]
v_mfma_f32_16x16x32_bf16 v[200:203], v[108:111], a[220:223], v[200:203]
v_mfma_f32_16x16x32_bf16 v[204:207], v[108:111], a[224:227], v[204:207]
s_waitcnt lgkmcnt(14)
v_mfma_f32_16x16x32_bf16 v[208:211], v[144:147], a[108:111], v[208:211]
s_add_u32 m0, s62, 122880
ds_read_b64_tr_b16 v[112:113], v21 offset:16384
v_mfma_f32_16x16x32_bf16 v[212:215], v[144:147], a[112:115], v[212:215]
buffer_load_dwordx4 v4, s[28:31], s49 offen lds
v_mfma_f32_16x16x32_bf16 v[216:219], v[144:147], a[116:119], v[216:219]
s_waitcnt lgkmcnt(13)
ds_read_b64_tr_b16 v[114:115], v21 offset:20480
v_mfma_f32_16x16x32_bf16 v[220:223], v[148:151], a[108:111], v[220:223]
ds_read_b64_tr_b16 v[116:117], v22 offset:16384
v_mfma_f32_16x16x32_bf16 v[224:227], v[148:151], a[112:115], v[224:227]
ds_read_b64_tr_b16 v[118:119], v22 offset:20480
v_mfma_f32_16x16x32_bf16 v[228:231], v[148:151], a[116:119], v[228:231]
s_waitcnt lgkmcnt(14)
buffer_load_dwordx4 v5, s[28:31], s49 offen offset:1024 lds
v_mfma_f32_16x16x32_bf16 v[232:235], v[152:155], a[108:111], v[232:235]
ds_read_b64_tr_b16 v[120:121], v23 offset:16384
v_mfma_f32_16x16x32_bf16 v[236:239], v[152:155], a[112:115], v[236:239]
ds_read_b64_tr_b16 v[122:123], v23 offset:20480
v_mfma_f32_16x16x32_bf16 v[240:243], v[152:155], a[116:119], v[240:243]
s_waitcnt lgkmcnt(14)
ds_read_b64_tr_b16 v[124:125], v24 offset:16384
v_mfma_f32_16x16x32_bf16 v[244:247], v[156:159], a[108:111], v[244:247]
ds_read_b64_tr_b16 v[126:127], v24 offset:20480
v_mfma_f32_16x16x32_bf16 v[248:251], v[156:159], a[112:115], v[248:251]
buffer_load_dwordx4 a[180:183], v1, s[32:35], s24 offen sc1
v_mfma_f32_16x16x32_bf16 v[252:255], v[156:159], a[116:119], v[252:255]
s_waitcnt lgkmcnt(14)
ds_read_b64_tr_b16 v[96:97], v6
v_mfma_f32_16x16x32_bf16 v[160:163], v[128:131], a[228:231], v[160:163]
ds_read_b64_tr_b16 v[98:99], v6 offset:4096
v_mfma_f32_16x16x32_bf16 v[164:167], v[128:131], a[232:235], v[164:167]
ds_read_b64_tr_b16 v[100:101], v7
v_mfma_f32_16x16x32_bf16 v[168:171], v[128:131], a[236:239], v[168:171]
s_waitcnt lgkmcnt(15)
ds_read_b64_tr_b16 v[102:103], v7 offset:4096
v_mfma_f32_16x16x32_bf16 v[172:175], v[132:135], a[228:231], v[172:175]
buffer_load_dwordx4 a[184:187], v2, s[32:35], s24 offen sc1
v_mfma_f32_16x16x32_bf16 v[176:179], v[132:135], a[232:235], v[176:179]
ds_read_b64_tr_b16 v[104:105], v8
v_mfma_f32_16x16x32_bf16 v[180:183], v[132:135], a[236:239], v[180:183]
s_waitcnt lgkmcnt(15)
ds_read_b64_tr_b16 v[106:107], v8 offset:4096
v_mfma_f32_16x16x32_bf16 v[184:187], v[136:139], a[228:231], v[184:187]
ds_read_b64_tr_b16 v[108:109], v9
v_mfma_f32_16x16x32_bf16 v[188:191], v[136:139], a[232:235], v[188:191]
ds_read_b64_tr_b16 v[110:111], v9 offset:4096
v_mfma_f32_16x16x32_bf16 v[192:195], v[136:139], a[236:239], v[192:195]
s_waitcnt lgkmcnt(15)
buffer_load_dwordx4 a[188:191], v3, s[32:35], s24 offen sc1
v_mfma_f32_16x16x32_bf16 v[196:199], v[140:143], a[228:231], v[196:199]
v_mfma_f32_16x16x32_bf16 v[200:203], v[140:143], a[232:235], v[200:203]
v_mfma_f32_16x16x32_bf16 v[204:207], v[140:143], a[236:239], v[204:207]
s_waitcnt vmcnt(18)
s_barrier
s_waitcnt lgkmcnt(14)
v_mfma_f32_16x16x32_bf16 v[208:211], v[112:115], a[120:123], v[208:211]
ds_read_b64_tr_b16 v[144:145], v21 offset:24576
v_mfma_f32_16x16x32_bf16 v[212:215], v[112:115], a[124:127], v[212:215]
ds_read_b64_tr_b16 v[146:147], v21 offset:28672
v_mfma_f32_16x16x32_bf16 v[216:219], v[112:115], a[128:131], v[216:219]
s_waitcnt lgkmcnt(14)
ds_read_b64_tr_b16 v[148:149], v22 offset:24576
v_mfma_f32_16x16x32_bf16 v[220:223], v[116:119], a[120:123], v[220:223]
ds_read_b64_tr_b16 v[150:151], v22 offset:28672
v_mfma_f32_16x16x32_bf16 v[224:227], v[116:119], a[124:127], v[224:227]
ds_read_b64_tr_b16 v[152:153], v23 offset:24576
v_mfma_f32_16x16x32_bf16 v[228:231], v[116:119], a[128:131], v[228:231]
s_waitcnt lgkmcnt(15)
ds_read_b64_tr_b16 v[154:155], v23 offset:28672
v_mfma_f32_16x16x32_bf16 v[232:235], v[120:123], a[120:123], v[232:235]
ds_read_b64_tr_b16 v[156:157], v24 offset:24576
v_mfma_f32_16x16x32_bf16 v[236:239], v[120:123], a[124:127], v[236:239]
ds_read_b64_tr_b16 v[158:159], v24 offset:28672
v_mfma_f32_16x16x32_bf16 v[240:243], v[120:123], a[128:131], v[240:243]
s_waitcnt lgkmcnt(15)
ds_read_b64_tr_b16 v[128:129], v6 offset:8192
v_mfma_f32_16x16x32_bf16 v[244:247], v[124:127], a[120:123], v[244:247]
ds_read_b64_tr_b16 v[130:131], v6 offset:12288
v_mfma_f32_16x16x32_bf16 v[248:251], v[124:127], a[124:127], v[248:251]
ds_read_b64_tr_b16 v[132:133], v7 offset:8192
v_mfma_f32_16x16x32_bf16 v[252:255], v[124:127], a[128:131], v[252:255]
s_waitcnt lgkmcnt(15)
ds_read_b64_tr_b16 v[134:135], v7 offset:12288
v_mfma_f32_16x16x32_bf16 v[160:163], v[96:99], a[0:3], v[160:163]
ds_read_b64_tr_b16 v[136:137], v8 offset:8192
v_mfma_f32_16x16x32_bf16 v[164:167], v[96:99], a[4:7], v[164:167]
ds_read_b64_tr_b16 v[138:139], v8 offset:12288
v_mfma_f32_16x16x32_bf16 v[168:171], v[96:99], a[8:11], v[168:171]
ds_read_b64_tr_b16 v[140:141], v9 offset:8192
v_mfma_f32_16x16x32_bf16 v[172:175], v[100:103], a[0:3], v[172:175]
ds_read_b64_tr_b16 v[142:143], v9 offset:12288
v_mfma_f32_16x16x32_bf16 v[176:179], v[100:103], a[4:7], v[176:179]
v_mfma_f32_16x16x32_bf16 v[180:183], v[100:103], a[8:11], v[180:183]
s_waitcnt lgkmcnt(15)
v_mfma_f32_16x16x32_bf16 v[184:187], v[104:107], a[0:3], v[184:187]
v_mfma_f32_16x16x32_bf16 v[188:191], v[104:107], a[4:7], v[188:191]
v_mfma_f32_16x16x32_bf16 v[192:195], v[104:107], a[8:11], v[192:195]
v_mfma_f32_16x16x32_bf16 v[196:199], v[108:111], a[0:3], v[196:199]
v_mfma_f32_16x16x32_bf16 v[200:203], v[108:111], a[4:7], v[200:203]
v_mfma_f32_16x16x32_bf16 v[204:207], v[108:111], a[8:11], v[204:207]
s_waitcnt lgkmcnt(14)
v_mfma_f32_16x16x32_bf16 v[208:211], v[144:147], a[132:135], v[208:211]
ds_read_b64_tr_b16 v[112:113], v21 offset:32768
v_mfma_f32_16x16x32_bf16 v[212:215], v[144:147], a[136:139], v[212:215]
ds_read_b64_tr_b16 v[114:115], v21 offset:36864
v_mfma_f32_16x16x32_bf16 v[216:219], v[144:147], a[140:143], v[216:219]
s_waitcnt lgkmcnt(14)
ds_read_b64_tr_b16 v[116:117], v22 offset:32768
v_mfma_f32_16x16x32_bf16 v[220:223], v[148:151], a[132:135], v[220:223]
ds_read_b64_tr_b16 v[118:119], v22 offset:36864
v_mfma_f32_16x16x32_bf16 v[224:227], v[148:151], a[136:139], v[224:227]
ds_read_b64_tr_b16 v[120:121], v23 offset:32768
v_mfma_f32_16x16x32_bf16 v[228:231], v[148:151], a[140:143], v[228:231]
s_waitcnt lgkmcnt(15)
ds_read_b64_tr_b16 v[122:123], v23 offset:36864
v_mfma_f32_16x16x32_bf16 v[232:235], v[152:155], a[132:135], v[232:235]
ds_read_b64_tr_b16 v[124:125], v24 offset:32768
v_mfma_f32_16x16x32_bf16 v[236:239], v[152:155], a[136:139], v[236:239]
ds_read_b64_tr_b16 v[126:127], v24 offset:36864
v_mfma_f32_16x16x32_bf16 v[240:243], v[152:155], a[140:143], v[240:243]
s_waitcnt lgkmcnt(15)
ds_read_b64_tr_b16 v[96:97], v6 offset:16384
v_mfma_f32_16x16x32_bf16 v[244:247], v[156:159], a[132:135], v[244:247]
ds_read_b64_tr_b16 v[98:99], v6 offset:20480
v_mfma_f32_16x16x32_bf16 v[248:251], v[156:159], a[136:139], v[248:251]
ds_read_b64_tr_b16 v[100:101], v7 offset:16384
v_mfma_f32_16x16x32_bf16 v[252:255], v[156:159], a[140:143], v[252:255]
s_waitcnt lgkmcnt(15)
ds_read_b64_tr_b16 v[102:103], v7 offset:20480
v_mfma_f32_16x16x32_bf16 v[160:163], v[128:131], a[12:15], v[160:163]
ds_read_b64_tr_b16 v[104:105], v8 offset:16384
v_mfma_f32_16x16x32_bf16 v[164:167], v[128:131], a[16:19], v[164:167]
ds_read_b64_tr_b16 v[106:107], v8 offset:20480
v_mfma_f32_16x16x32_bf16 v[168:171], v[128:131], a[20:23], v[168:171]
ds_read_b64_tr_b16 v[108:109], v9 offset:16384
v_mfma_f32_16x16x32_bf16 v[172:175], v[132:135], a[12:15], v[172:175]
ds_read_b64_tr_b16 v[110:111], v9 offset:20480
v_mfma_f32_16x16x32_bf16 v[176:179], v[132:135], a[16:19], v[176:179]
v_mfma_f32_16x16x32_bf16 v[180:183], v[132:135], a[20:23], v[180:183]
s_waitcnt lgkmcnt(15)
v_mfma_f32_16x16x32_bf16 v[184:187], v[136:139], a[12:15], v[184:187]
v_mfma_f32_16x16x32_bf16 v[188:191], v[136:139], a[16:19], v[188:191]
v_mfma_f32_16x16x32_bf16 v[192:195], v[136:139], a[20:23], v[192:195]
v_mfma_f32_16x16x32_bf16 v[196:199], v[140:143], a[12:15], v[196:199]
v_mfma_f32_16x16x32_bf16 v[200:203], v[140:143], a[16:19], v[200:203]
v_mfma_f32_16x16x32_bf16 v[204:207], v[140:143], a[20:23], v[204:207]
s_waitcnt vmcnt(8)
s_barrier
s_waitcnt lgkmcnt(14)
v_mfma_f32_16x16x32_bf16 v[208:211], v[112:115], a[144:147], v[208:211]
ds_read_b64_tr_b16 v[144:145], v21 offset:40960
v_mfma_f32_16x16x32_bf16 v[212:215], v[112:115], a[148:151], v[212:215]
ds_read_b64_tr_b16 v[146:147], v21 offset:45056
v_mfma_f32_16x16x32_bf16 v[216:219], v[112:115], a[152:155], v[216:219]
s_waitcnt lgkmcnt(14)
ds_read_b64_tr_b16 v[148:149], v22 offset:40960
v_mfma_f32_16x16x32_bf16 v[220:223], v[116:119], a[144:147], v[220:223]
ds_read_b64_tr_b16 v[150:151], v22 offset:45056
v_mfma_f32_16x16x32_bf16 v[224:227], v[116:119], a[148:151], v[224:227]
ds_read_b64_tr_b16 v[152:153], v23 offset:40960
v_mfma_f32_16x16x32_bf16 v[228:231], v[116:119], a[152:155], v[228:231]
s_waitcnt lgkmcnt(15)
ds_read_b64_tr_b16 v[154:155], v23 offset:45056
v_mfma_f32_16x16x32_bf16 v[232:235], v[120:123], a[144:147], v[232:235]
ds_read_b64_tr_b16 v[156:157], v24 offset:40960
v_mfma_f32_16x16x32_bf16 v[236:239], v[120:123], a[148:151], v[236:239]
ds_read_b64_tr_b16 v[158:159], v24 offset:45056
v_mfma_f32_16x16x32_bf16 v[240:243], v[120:123], a[152:155], v[240:243]
s_waitcnt lgkmcnt(15)
ds_read_b64_tr_b16 v[128:129], v6 offset:24576
v_mfma_f32_16x16x32_bf16 v[244:247], v[124:127], a[144:147], v[244:247]
ds_read_b64_tr_b16 v[130:131], v6 offset:28672
v_mfma_f32_16x16x32_bf16 v[248:251], v[124:127], a[148:151], v[248:251]
ds_read_b64_tr_b16 v[132:133], v7 offset:24576
v_mfma_f32_16x16x32_bf16 v[252:255], v[124:127], a[152:155], v[252:255]
s_waitcnt lgkmcnt(15)
ds_read_b64_tr_b16 v[134:135], v7 offset:28672
v_mfma_f32_16x16x32_bf16 v[160:163], v[96:99], a[24:27], v[160:163]
ds_read_b64_tr_b16 v[136:137], v8 offset:24576
v_mfma_f32_16x16x32_bf16 v[164:167], v[96:99], a[28:31], v[164:167]
ds_read_b64_tr_b16 v[138:139], v8 offset:28672
v_mfma_f32_16x16x32_bf16 v[168:171], v[96:99], a[32:35], v[168:171]
ds_read_b64_tr_b16 v[140:141], v9 offset:24576
v_mfma_f32_16x16x32_bf16 v[172:175], v[100:103], a[24:27], v[172:175]
ds_read_b64_tr_b16 v[142:143], v9 offset:28672
v_mfma_f32_16x16x32_bf16 v[176:179], v[100:103], a[28:31], v[176:179]
v_mfma_f32_16x16x32_bf16 v[180:183], v[100:103], a[32:35], v[180:183]
s_waitcnt lgkmcnt(15)
v_mfma_f32_16x16x32_bf16 v[184:187], v[104:107], a[24:27], v[184:187]
v_mfma_f32_16x16x32_bf16 v[188:191], v[104:107], a[28:31], v[188:191]
v_mfma_f32_16x16x32_bf16 v[192:195], v[104:107], a[32:35], v[192:195]
v_mfma_f32_16x16x32_bf16 v[196:199], v[108:111], a[24:27], v[196:199]
v_mfma_f32_16x16x32_bf16 v[200:203], v[108:111], a[28:31], v[200:203]
v_mfma_f32_16x16x32_bf16 v[204:207], v[108:111], a[32:35], v[204:207]
s_waitcnt lgkmcnt(14)
v_mfma_f32_16x16x32_bf16 v[208:211], v[144:147], a[156:159], v[208:211]
ds_read_b64_tr_b16 v[112:113], v21 offset:49152
v_mfma_f32_16x16x32_bf16 v[212:215], v[144:147], a[160:163], v[212:215]
ds_read_b64_tr_b16 v[114:115], v21 offset:53248
v_mfma_f32_16x16x32_bf16 v[216:219], v[144:147], a[164:167], v[216:219]
s_waitcnt lgkmcnt(14)
ds_read_b64_tr_b16 v[116:117], v22 offset:49152
v_mfma_f32_16x16x32_bf16 v[220:223], v[148:151], a[156:159], v[220:223]
ds_read_b64_tr_b16 v[118:119], v22 offset:53248
v_mfma_f32_16x16x32_bf16 v[224:227], v[148:151], a[160:163], v[224:227]
ds_read_b64_tr_b16 v[120:121], v23 offset:49152
v_mfma_f32_16x16x32_bf16 v[228:231], v[148:151], a[164:167], v[228:231]
s_waitcnt lgkmcnt(15)
ds_read_b64_tr_b16 v[122:123], v23 offset:53248
v_mfma_f32_16x16x32_bf16 v[232:235], v[152:155], a[156:159], v[232:235]
ds_read_b64_tr_b16 v[124:125], v24 offset:49152
v_mfma_f32_16x16x32_bf16 v[236:239], v[152:155], a[160:163], v[236:239]
ds_read_b64_tr_b16 v[126:127], v24 offset:53248
v_mfma_f32_16x16x32_bf16 v[240:243], v[152:155], a[164:167], v[240:243]
s_waitcnt lgkmcnt(15)
ds_read_b64_tr_b16 v[96:97], v6 offset:32768
v_mfma_f32_16x16x32_bf16 v[244:247], v[156:159], a[156:159], v[244:247]
ds_read_b64_tr_b16 v[98:99], v6 offset:36864
v_mfma_f32_16x16x32_bf16 v[248:251], v[156:159], a[160:163], v[248:251]
ds_read_b64_tr_b16 v[100:101], v7 offset:32768
v_mfma_f32_16x16x32_bf16 v[252:255], v[156:159], a[164:167], v[252:255]
s_waitcnt lgkmcnt(15)
ds_read_b64_tr_b16 v[102:103], v7 offset:36864
v_mfma_f32_16x16x32_bf16 v[160:163], v[128:131], a[36:39], v[160:163]
ds_read_b64_tr_b16 v[104:105], v8 offset:32768
v_mfma_f32_16x16x32_bf16 v[164:167], v[128:131], a[40:43], v[164:167]
ds_read_b64_tr_b16 v[106:107], v8 offset:36864
v_mfma_f32_16x16x32_bf16 v[168:171], v[128:131], a[44:47], v[168:171]
ds_read_b64_tr_b16 v[108:109], v9 offset:32768
v_mfma_f32_16x16x32_bf16 v[172:175], v[132:135], a[36:39], v[172:175]
ds_read_b64_tr_b16 v[110:111], v9 offset:36864
v_mfma_f32_16x16x32_bf16 v[176:179], v[132:135], a[40:43], v[176:179]
v_mfma_f32_16x16x32_bf16 v[180:183], v[132:135], a[44:47], v[180:183]
s_waitcnt lgkmcnt(15)
v_mfma_f32_16x16x32_bf16 v[184:187], v[136:139], a[36:39], v[184:187]
v_mfma_f32_16x16x32_bf16 v[188:191], v[136:139], a[40:43], v[188:191]
v_mfma_f32_16x16x32_bf16 v[192:195], v[136:139], a[44:47], v[192:195]
v_mfma_f32_16x16x32_bf16 v[196:199], v[140:143], a[36:39], v[196:199]
v_mfma_f32_16x16x32_bf16 v[200:203], v[140:143], a[40:43], v[200:203]
v_mfma_f32_16x16x32_bf16 v[204:207], v[140:143], a[44:47], v[204:207]
s_waitcnt vmcnt(3)
s_barrier
s_waitcnt lgkmcnt(14)
v_mfma_f32_16x16x32_bf16 v[208:211], v[112:115], a[168:171], v[208:211]
ds_read_b64_tr_b16 v[144:145], v21 offset:57344
v_mfma_f32_16x16x32_bf16 v[212:215], v[112:115], a[172:175], v[212:215]
ds_read_b64_tr_b16 v[146:147], v21 offset:61440
v_mfma_f32_16x16x32_bf16 v[216:219], v[112:115], a[176:179], v[216:219]
s_waitcnt lgkmcnt(14)
ds_read_b64_tr_b16 v[148:149], v22 offset:57344
v_mfma_f32_16x16x32_bf16 v[220:223], v[116:119], a[168:171], v[220:223]
ds_read_b64_tr_b16 v[150:151], v22 offset:61440
v_mfma_f32_16x16x32_bf16 v[224:227], v[116:119], a[172:175], v[224:227]
ds_read_b64_tr_b16 v[152:153], v23 offset:57344
v_mfma_f32_16x16x32_bf16 v[228:231], v[116:119], a[176:179], v[228:231]
s_waitcnt lgkmcnt(15)
ds_read_b64_tr_b16 v[154:155], v23 offset:61440
v_mfma_f32_16x16x32_bf16 v[232:235], v[120:123], a[168:171], v[232:235]
ds_read_b64_tr_b16 v[156:157], v24 offset:57344
v_mfma_f32_16x16x32_bf16 v[236:239], v[120:123], a[172:175], v[236:239]
ds_read_b64_tr_b16 v[158:159], v24 offset:61440
v_mfma_f32_16x16x32_bf16 v[240:243], v[120:123], a[176:179], v[240:243]
s_waitcnt lgkmcnt(15)
ds_read_b64_tr_b16 v[128:129], v6 offset:40960
v_mfma_f32_16x16x32_bf16 v[244:247], v[124:127], a[168:171], v[244:247]
ds_read_b64_tr_b16 v[130:131], v6 offset:45056
v_mfma_f32_16x16x32_bf16 v[248:251], v[124:127], a[172:175], v[248:251]
ds_read_b64_tr_b16 v[132:133], v7 offset:40960
v_mfma_f32_16x16x32_bf16 v[252:255], v[124:127], a[176:179], v[252:255]
s_waitcnt lgkmcnt(15)
ds_read_b64_tr_b16 v[134:135], v7 offset:45056
v_mfma_f32_16x16x32_bf16 v[160:163], v[96:99], a[48:51], v[160:163]
ds_read_b64_tr_b16 v[136:137], v8 offset:40960
v_mfma_f32_16x16x32_bf16 v[164:167], v[96:99], a[52:55], v[164:167]
ds_read_b64_tr_b16 v[138:139], v8 offset:45056
v_mfma_f32_16x16x32_bf16 v[168:171], v[96:99], a[56:59], v[168:171]
ds_read_b64_tr_b16 v[140:141], v9 offset:40960
v_mfma_f32_16x16x32_bf16 v[172:175], v[100:103], a[48:51], v[172:175]
ds_read_b64_tr_b16 v[142:143], v9 offset:45056
v_mfma_f32_16x16x32_bf16 v[176:179], v[100:103], a[52:55], v[176:179]
v_mfma_f32_16x16x32_bf16 v[180:183], v[100:103], a[56:59], v[180:183]
s_waitcnt lgkmcnt(15)
v_mfma_f32_16x16x32_bf16 v[184:187], v[104:107], a[48:51], v[184:187]
v_mfma_f32_16x16x32_bf16 v[188:191], v[104:107], a[52:55], v[188:191]
v_mfma_f32_16x16x32_bf16 v[192:195], v[104:107], a[56:59], v[192:195]
v_mfma_f32_16x16x32_bf16 v[196:199], v[108:111], a[48:51], v[196:199]
v_mfma_f32_16x16x32_bf16 v[200:203], v[108:111], a[52:55], v[200:203]
v_mfma_f32_16x16x32_bf16 v[204:207], v[108:111], a[56:59], v[204:207]
s_waitcnt vmcnt(2) lgkmcnt(14)
v_mfma_f32_16x16x32_bf16 v[208:211], v[144:147], a[180:183], v[208:211]
s_waitcnt vmcnt(1)
ds_read_b64_tr_b16 v[96:97], v6 offset:49152
v_mfma_f32_16x16x32_bf16 v[212:215], v[144:147], a[184:187], v[212:215]
s_waitcnt vmcnt(0)
ds_read_b64_tr_b16 v[98:99], v6 offset:53248
v_mfma_f32_16x16x32_bf16 v[216:219], v[144:147], a[188:191], v[216:219]
s_waitcnt lgkmcnt(14)
ds_read_b64_tr_b16 v[100:101], v7 offset:49152
v_mfma_f32_16x16x32_bf16 v[220:223], v[148:151], a[180:183], v[220:223]
ds_read_b64_tr_b16 v[102:103], v7 offset:53248
v_mfma_f32_16x16x32_bf16 v[224:227], v[148:151], a[184:187], v[224:227]
ds_read_b64_tr_b16 v[104:105], v8 offset:49152
v_mfma_f32_16x16x32_bf16 v[228:231], v[148:151], a[188:191], v[228:231]
s_waitcnt lgkmcnt(15)
ds_read_b64_tr_b16 v[106:107], v8 offset:53248
v_mfma_f32_16x16x32_bf16 v[232:235], v[152:155], a[180:183], v[232:235]
ds_read_b64_tr_b16 v[108:109], v9 offset:49152
v_mfma_f32_16x16x32_bf16 v[236:239], v[152:155], a[184:187], v[236:239]
ds_read_b64_tr_b16 v[110:111], v9 offset:53248
v_mfma_f32_16x16x32_bf16 v[240:243], v[152:155], a[188:191], v[240:243]
s_waitcnt lgkmcnt(15)
v_mfma_f32_16x16x32_bf16 v[244:247], v[156:159], a[180:183], v[244:247]
v_mfma_f32_16x16x32_bf16 v[248:251], v[156:159], a[184:187], v[248:251]
v_mfma_f32_16x16x32_bf16 v[252:255], v[156:159], a[188:191], v[252:255]
s_waitcnt lgkmcnt(14)
v_mfma_f32_16x16x32_bf16 v[160:163], v[128:131], a[60:63], v[160:163]
v_mfma_f32_16x16x32_bf16 v[164:167], v[128:131], a[64:67], v[164:167]
v_mfma_f32_16x16x32_bf16 v[168:171], v[128:131], a[68:71], v[168:171]
s_waitcnt lgkmcnt(12)
v_mfma_f32_16x16x32_bf16 v[172:175], v[132:135], a[60:63], v[172:175]
v_mfma_f32_16x16x32_bf16 v[176:179], v[132:135], a[64:67], v[176:179]
v_mfma_f32_16x16x32_bf16 v[180:183], v[132:135], a[68:71], v[180:183]
s_waitcnt lgkmcnt(10)
v_mfma_f32_16x16x32_bf16 v[184:187], v[136:139], a[60:63], v[184:187]
v_mfma_f32_16x16x32_bf16 v[188:191], v[136:139], a[64:67], v[188:191]
v_mfma_f32_16x16x32_bf16 v[192:195], v[136:139], a[68:71], v[192:195]
s_waitcnt lgkmcnt(8)
v_mfma_f32_16x16x32_bf16 v[196:199], v[140:143], a[60:63], v[196:199]
v_mfma_f32_16x16x32_bf16 v[200:203], v[140:143], a[64:67], v[200:203]
v_mfma_f32_16x16x32_bf16 v[204:207], v[140:143], a[68:71], v[204:207]
s_waitcnt lgkmcnt(6)
s_mul_i32 s51, s78, 49152
s_mul_i32 s52, s3, 12288
s_add_u32 s51, s51, s52
s_add_u32 s53, s51, 4096
s_add_u32 s54, s51, 8192
v_mfma_f32_16x16x32_bf16 v[160:163], v[96:99], a[72:75], v[160:163]
buffer_store_dwordx4 v[208:211], v14, s[40:43], s51 offen sc1
v_mfma_f32_16x16x32_bf16 v[164:167], v[96:99], a[76:79], v[164:167]
ds_read_b64_tr_b16 v[128:129], v6 offset:57344
v_mfma_f32_16x16x32_bf16 v[168:171], v[96:99], a[80:83], v[168:171]
s_waitcnt lgkmcnt(5)
ds_read_b64_tr_b16 v[130:131], v6 offset:61440
v_mfma_f32_16x16x32_bf16 v[172:175], v[100:103], a[72:75], v[172:175]
buffer_store_dwordx4 v[212:215], v14, s[40:43], s51 offen offset:1024 sc1
v_mfma_f32_16x16x32_bf16 v[176:179], v[100:103], a[76:79], v[176:179]
ds_read_b64_tr_b16 v[132:133], v7 offset:57344
v_mfma_f32_16x16x32_bf16 v[180:183], v[100:103], a[80:83], v[180:183]
s_waitcnt lgkmcnt(5)
ds_read_b64_tr_b16 v[134:135], v7 offset:61440
v_mfma_f32_16x16x32_bf16 v[184:187], v[104:107], a[72:75], v[184:187]
buffer_store_dwordx4 v[216:219], v14, s[40:43], s51 offen offset:2048 sc1
v_mfma_f32_16x16x32_bf16 v[188:191], v[104:107], a[76:79], v[188:191]
ds_read_b64_tr_b16 v[136:137], v8 offset:57344
v_mfma_f32_16x16x32_bf16 v[192:195], v[104:107], a[80:83], v[192:195]
s_waitcnt lgkmcnt(5)
ds_read_b64_tr_b16 v[138:139], v8 offset:61440
v_mfma_f32_16x16x32_bf16 v[196:199], v[108:111], a[72:75], v[196:199]
buffer_store_dwordx4 v[220:223], v14, s[40:43], s51 offen offset:3072 sc1
v_mfma_f32_16x16x32_bf16 v[200:203], v[108:111], a[76:79], v[200:203]
ds_read_b64_tr_b16 v[140:141], v9 offset:57344
v_mfma_f32_16x16x32_bf16 v[204:207], v[108:111], a[80:83], v[204:207]
s_waitcnt lgkmcnt(5)
ds_read_b64_tr_b16 v[142:143], v9 offset:61440
v_mfma_f32_16x16x32_bf16 v[160:163], v[128:131], a[84:87], v[160:163]
buffer_store_dwordx4 v[224:227], v14, s[40:43], s53 offen sc1
v_mfma_f32_16x16x32_bf16 v[164:167], v[128:131], a[88:91], v[164:167]
ds_read_b64_tr_b16 v[96:97], v17
v_mfma_f32_16x16x32_bf16 v[168:171], v[128:131], a[92:95], v[168:171]
s_waitcnt lgkmcnt(5)
ds_read_b64_tr_b16 v[98:99], v17 offset:4096
v_mfma_f32_16x16x32_bf16 v[172:175], v[132:135], a[84:87], v[172:175]
buffer_store_dwordx4 v[228:231], v14, s[40:43], s53 offen offset:1024 sc1
v_mfma_f32_16x16x32_bf16 v[176:179], v[132:135], a[88:91], v[176:179]
ds_read_b64_tr_b16 v[100:101], v18
v_mfma_f32_16x16x32_bf16 v[180:183], v[132:135], a[92:95], v[180:183]
s_waitcnt lgkmcnt(5)
ds_read_b64_tr_b16 v[102:103], v18 offset:4096
v_mfma_f32_16x16x32_bf16 v[184:187], v[136:139], a[84:87], v[184:187]
buffer_store_dwordx4 v[232:235], v14, s[40:43], s53 offen offset:2048 sc1
v_mfma_f32_16x16x32_bf16 v[188:191], v[136:139], a[88:91], v[188:191]
ds_read_b64_tr_b16 v[104:105], v19
v_mfma_f32_16x16x32_bf16 v[192:195], v[136:139], a[92:95], v[192:195]
s_waitcnt lgkmcnt(5)
ds_read_b64_tr_b16 v[106:107], v19 offset:4096
v_mfma_f32_16x16x32_bf16 v[196:199], v[140:143], a[84:87], v[196:199]
buffer_store_dwordx4 v[236:239], v14, s[40:43], s53 offen offset:3072 sc1
v_mfma_f32_16x16x32_bf16 v[200:203], v[140:143], a[88:91], v[200:203]
ds_read_b64_tr_b16 v[108:109], v20
v_mfma_f32_16x16x32_bf16 v[204:207], v[140:143], a[92:95], v[204:207]
s_waitcnt lgkmcnt(5)
ds_read_b64_tr_b16 v[110:111], v20 offset:4096
v_mfma_f32_16x16x32_bf16 v[160:163], v[96:99], a[96:99], v[160:163]
buffer_store_dwordx4 v[240:243], v14, s[40:43], s54 offen sc1
v_mfma_f32_16x16x32_bf16 v[164:167], v[96:99], a[100:103], v[164:167]
ds_read_b64_tr_b16 v[128:129], v17 offset:8192
v_mfma_f32_16x16x32_bf16 v[168:171], v[96:99], a[104:107], v[168:171]
s_waitcnt lgkmcnt(5)
ds_read_b64_tr_b16 v[130:131], v17 offset:12288
v_mfma_f32_16x16x32_bf16 v[172:175], v[100:103], a[96:99], v[172:175]
buffer_store_dwordx4 v[244:247], v14, s[40:43], s54 offen offset:1024 sc1
v_mfma_f32_16x16x32_bf16 v[176:179], v[100:103], a[100:103], v[176:179]
ds_read_b64_tr_b16 v[132:133], v18 offset:8192
v_mfma_f32_16x16x32_bf16 v[180:183], v[100:103], a[104:107], v[180:183]
s_waitcnt lgkmcnt(5)
ds_read_b64_tr_b16 v[134:135], v18 offset:12288
v_mfma_f32_16x16x32_bf16 v[184:187], v[104:107], a[96:99], v[184:187]
buffer_store_dwordx4 v[248:251], v14, s[40:43], s54 offen offset:2048 sc1
v_mfma_f32_16x16x32_bf16 v[188:191], v[104:107], a[100:103], v[188:191]
ds_read_b64_tr_b16 v[136:137], v19 offset:8192
v_mfma_f32_16x16x32_bf16 v[192:195], v[104:107], a[104:107], v[192:195]
s_waitcnt lgkmcnt(5)
ds_read_b64_tr_b16 v[138:139], v19 offset:12288
v_mfma_f32_16x16x32_bf16 v[196:199], v[108:111], a[96:99], v[196:199]
buffer_store_dwordx4 v[252:255], v14, s[40:43], s54 offen offset:3072 sc1
v_mfma_f32_16x16x32_bf16 v[200:203], v[108:111], a[100:103], v[200:203]
ds_read_b64_tr_b16 v[140:141], v20 offset:8192
v_mfma_f32_16x16x32_bf16 v[204:207], v[108:111], a[104:107], v[204:207]
s_waitcnt lgkmcnt(5)
ds_read_b64_tr_b16 v[142:143], v20 offset:12288
v_mfma_f32_16x16x32_bf16 v[160:163], v[128:131], a[108:111], v[160:163]
ds_read_b64_tr_b16 v[96:97], v17 offset:16384
v_mfma_f32_16x16x32_bf16 v[164:167], v[128:131], a[112:115], v[164:167]
ds_read_b64_tr_b16 v[98:99], v17 offset:20480
v_mfma_f32_16x16x32_bf16 v[168:171], v[128:131], a[116:119], v[168:171]
s_waitcnt lgkmcnt(6)
ds_read_b64_tr_b16 v[100:101], v18 offset:16384
v_mfma_f32_16x16x32_bf16 v[172:175], v[132:135], a[108:111], v[172:175]
ds_read_b64_tr_b16 v[102:103], v18 offset:20480
v_mfma_f32_16x16x32_bf16 v[176:179], v[132:135], a[112:115], v[176:179]
ds_read_b64_tr_b16 v[104:105], v19 offset:16384
v_mfma_f32_16x16x32_bf16 v[180:183], v[132:135], a[116:119], v[180:183]
s_waitcnt lgkmcnt(7)
ds_read_b64_tr_b16 v[106:107], v19 offset:20480
v_mfma_f32_16x16x32_bf16 v[184:187], v[136:139], a[108:111], v[184:187]
ds_read_b64_tr_b16 v[108:109], v20 offset:16384
v_mfma_f32_16x16x32_bf16 v[188:191], v[136:139], a[112:115], v[188:191]
ds_read_b64_tr_b16 v[110:111], v20 offset:20480
v_mfma_f32_16x16x32_bf16 v[192:195], v[136:139], a[116:119], v[192:195]
s_waitcnt lgkmcnt(8)
v_mfma_f32_16x16x32_bf16 v[196:199], v[140:143], a[108:111], v[196:199]
v_mfma_f32_16x16x32_bf16 v[200:203], v[140:143], a[112:115], v[200:203]
v_mfma_f32_16x16x32_bf16 v[204:207], v[140:143], a[116:119], v[204:207]
s_waitcnt lgkmcnt(6)
v_mfma_f32_16x16x32_bf16 v[160:163], v[96:99], a[120:123], v[160:163]
ds_read_b64_tr_b16 v[128:129], v17 offset:24576
v_mfma_f32_16x16x32_bf16 v[164:167], v[96:99], a[124:127], v[164:167]
ds_read_b64_tr_b16 v[130:131], v17 offset:28672
v_mfma_f32_16x16x32_bf16 v[168:171], v[96:99], a[128:131], v[168:171]
s_waitcnt lgkmcnt(6)
ds_read_b64_tr_b16 v[132:133], v18 offset:24576
v_mfma_f32_16x16x32_bf16 v[172:175], v[100:103], a[120:123], v[172:175]
ds_read_b64_tr_b16 v[134:135], v18 offset:28672
v_mfma_f32_16x16x32_bf16 v[176:179], v[100:103], a[124:127], v[176:179]
ds_read_b64_tr_b16 v[136:137], v19 offset:24576
v_mfma_f32_16x16x32_bf16 v[180:183], v[100:103], a[128:131], v[180:183]
s_waitcnt lgkmcnt(7)
ds_read_b64_tr_b16 v[138:139], v19 offset:28672
v_mfma_f32_16x16x32_bf16 v[184:187], v[104:107], a[120:123], v[184:187]
ds_read_b64_tr_b16 v[140:141], v20 offset:24576
v_mfma_f32_16x16x32_bf16 v[188:191], v[104:107], a[124:127], v[188:191]
ds_read_b64_tr_b16 v[142:143], v20 offset:28672
v_mfma_f32_16x16x32_bf16 v[192:195], v[104:107], a[128:131], v[192:195]
s_waitcnt lgkmcnt(8)
v_mfma_f32_16x16x32_bf16 v[196:199], v[108:111], a[120:123], v[196:199]
v_mfma_f32_16x16x32_bf16 v[200:203], v[108:111], a[124:127], v[200:203]
v_mfma_f32_16x16x32_bf16 v[204:207], v[108:111], a[128:131], v[204:207]
s_lshl_b32 s51, s78, 7
s_add_u32 s51, s51, 33554432
s_lshl_b32 s52, s76, 7
s_add_u32 s52, s52, 33554432
v_mov_b32 v64, 1
s_cmp_eq_u32 s3, 0
s_cselect_b32 s51, s51, 0x7fffff00
s_waitcnt vmcnt(0)
s_barrier
s_mov_b64 exec, 1
buffer_store_dword v64, v16, s[40:43], s51 offen sc1
s_mov_b64 exec, -1
s_waitcnt lgkmcnt(6)
v_mfma_f32_16x16x32_bf16 v[160:163], v[128:131], a[132:135], v[160:163]
ds_read_b64_tr_b16 v[96:97], v17 offset:32768
v_mfma_f32_16x16x32_bf16 v[164:167], v[128:131], a[136:139], v[164:167]
ds_read_b64_tr_b16 v[98:99], v17 offset:36864
v_mfma_f32_16x16x32_bf16 v[168:171], v[128:131], a[140:143], v[168:171]
s_waitcnt lgkmcnt(6)
ds_read_b64_tr_b16 v[100:101], v18 offset:32768
v_mfma_f32_16x16x32_bf16 v[172:175], v[132:135], a[132:135], v[172:175]
ds_read_b64_tr_b16 v[102:103], v18 offset:36864
v_mfma_f32_16x16x32_bf16 v[176:179], v[132:135], a[136:139], v[176:179]
ds_read_b64_tr_b16 v[104:105], v19 offset:32768
v_mfma_f32_16x16x32_bf16 v[180:183], v[132:135], a[140:143], v[180:183]
s_waitcnt lgkmcnt(7)
ds_read_b64_tr_b16 v[106:107], v19 offset:36864
v_mfma_f32_16x16x32_bf16 v[184:187], v[136:139], a[132:135], v[184:187]
ds_read_b64_tr_b16 v[108:109], v20 offset:32768
v_mfma_f32_16x16x32_bf16 v[188:191], v[136:139], a[136:139], v[188:191]
ds_read_b64_tr_b16 v[110:111], v20 offset:36864
v_mfma_f32_16x16x32_bf16 v[192:195], v[136:139], a[140:143], v[192:195]
s_waitcnt lgkmcnt(8)
v_mfma_f32_16x16x32_bf16 v[196:199], v[140:143], a[132:135], v[196:199]
v_mfma_f32_16x16x32_bf16 v[200:203], v[140:143], a[136:139], v[200:203]
v_mfma_f32_16x16x32_bf16 v[204:207], v[140:143], a[140:143], v[204:207]
s_waitcnt lgkmcnt(6)
v_mfma_f32_16x16x32_bf16 v[160:163], v[96:99], a[144:147], v[160:163]
ds_read_b64_tr_b16 v[128:129], v17 offset:40960
v_mfma_f32_16x16x32_bf16 v[164:167], v[96:99], a[148:151], v[164:167]
ds_read_b64_tr_b16 v[130:131], v17 offset:45056
v_mfma_f32_16x16x32_bf16 v[168:171], v[96:99], a[152:155], v[168:171]
s_waitcnt lgkmcnt(6)
ds_read_b64_tr_b16 v[132:133], v18 offset:40960
v_mfma_f32_16x16x32_bf16 v[172:175], v[100:103], a[144:147], v[172:175]
ds_read_b64_tr_b16 v[134:135], v18 offset:45056
v_mfma_f32_16x16x32_bf16 v[176:179], v[100:103], a[148:151], v[176:179]
ds_read_b64_tr_b16 v[136:137], v19 offset:40960
v_mfma_f32_16x16x32_bf16 v[180:183], v[100:103], a[152:155], v[180:183]
s_waitcnt lgkmcnt(7)
ds_read_b64_tr_b16 v[138:139], v19 offset:45056
v_mfma_f32_16x16x32_bf16 v[184:187], v[104:107], a[144:147], v[184:187]
ds_read_b64_tr_b16 v[140:141], v20 offset:40960
v_mfma_f32_16x16x32_bf16 v[188:191], v[104:107], a[148:151], v[188:191]
ds_read_b64_tr_b16 v[142:143], v20 offset:45056
v_mfma_f32_16x16x32_bf16 v[192:195], v[104:107], a[152:155], v[192:195]
s_waitcnt lgkmcnt(8)
v_mfma_f32_16x16x32_bf16 v[196:199], v[108:111], a[144:147], v[196:199]
v_mfma_f32_16x16x32_bf16 v[200:203], v[108:111], a[148:151], v[200:203]
v_mfma_f32_16x16x32_bf16 v[204:207], v[108:111], a[152:155], v[204:207]
s_waitcnt lgkmcnt(6)
v_mfma_f32_16x16x32_bf16 v[160:163], v[128:131], a[156:159], v[160:163]
ds_read_b64_tr_b16 v[96:97], v17 offset:49152
v_mfma_f32_16x16x32_bf16 v[164:167], v[128:131], a[160:163], v[164:167]
ds_read_b64_tr_b16 v[98:99], v17 offset:53248
v_mfma_f32_16x16x32_bf16 v[168:171], v[128:131], a[164:167], v[168:171]
s_waitcnt lgkmcnt(6)
ds_read_b64_tr_b16 v[100:101], v18 offset:49152
v_mfma_f32_16x16x32_bf16 v[172:175], v[132:135], a[156:159], v[172:175]
ds_read_b64_tr_b16 v[102:103], v18 offset:53248
v_mfma_f32_16x16x32_bf16 v[176:179], v[132:135], a[160:163], v[176:179]
ds_read_b64_tr_b16 v[104:105], v19 offset:49152
v_mfma_f32_16x16x32_bf16 v[180:183], v[132:135], a[164:167], v[180:183]
s_waitcnt lgkmcnt(7)
ds_read_b64_tr_b16 v[106:107], v19 offset:53248
v_mfma_f32_16x16x32_bf16 v[184:187], v[136:139], a[156:159], v[184:187]
ds_read_b64_tr_b16 v[108:109], v20 offset:49152
v_mfma_f32_16x16x32_bf16 v[188:191], v[136:139], a[160:163], v[188:191]
ds_read_b64_tr_b16 v[110:111], v20 offset:53248
v_mfma_f32_16x16x32_bf16 v[192:195], v[136:139], a[164:167], v[192:195]
s_waitcnt lgkmcnt(8)
v_mfma_f32_16x16x32_bf16 v[196:199], v[140:143], a[156:159], v[196:199]
v_mfma_f32_16x16x32_bf16 v[200:203], v[140:143], a[160:163], v[200:203]
v_mfma_f32_16x16x32_bf16 v[204:207], v[140:143], a[164:167], v[204:207]
s_waitcnt lgkmcnt(6)
v_mfma_f32_16x16x32_bf16 v[160:163], v[96:99], a[168:171], v[160:163]
ds_read_b64_tr_b16 v[128:129], v17 offset:57344
v_mfma_f32_16x16x32_bf16 v[164:167], v[96:99], a[172:175], v[164:167]
ds_read_b64_tr_b16 v[130:131], v17 offset:61440
v_mfma_f32_16x16x32_bf16 v[168:171], v[96:99], a[176:179], v[168:171]
s_waitcnt lgkmcnt(6)
ds_read_b64_tr_b16 v[132:133], v18 offset:57344
v_mfma_f32_16x16x32_bf16 v[172:175], v[100:103], a[168:171], v[172:175]
ds_read_b64_tr_b16 v[134:135], v18 offset:61440
v_mfma_f32_16x16x32_bf16 v[176:179], v[100:103], a[172:175], v[176:179]
ds_read_b64_tr_b16 v[136:137], v19 offset:57344
v_mfma_f32_16x16x32_bf16 v[180:183], v[100:103], a[176:179], v[180:183]
s_waitcnt lgkmcnt(7)
ds_read_b64_tr_b16 v[138:139], v19 offset:61440
v_mfma_f32_16x16x32_bf16 v[184:187], v[104:107], a[168:171], v[184:187]
ds_read_b64_tr_b16 v[140:141], v20 offset:57344
v_mfma_f32_16x16x32_bf16 v[188:191], v[104:107], a[172:175], v[188:191]
ds_read_b64_tr_b16 v[142:143], v20 offset:61440
v_mfma_f32_16x16x32_bf16 v[192:195], v[104:107], a[176:179], v[192:195]
s_waitcnt lgkmcnt(8)
v_mfma_f32_16x16x32_bf16 v[196:199], v[108:111], a[168:171], v[196:199]
v_mfma_f32_16x16x32_bf16 v[200:203], v[108:111], a[172:175], v[200:203]
v_mfma_f32_16x16x32_bf16 v[204:207], v[108:111], a[176:179], v[204:207]
s_waitcnt lgkmcnt(6)
v_mfma_f32_16x16x32_bf16 v[160:163], v[128:131], a[180:183], v[160:163]
v_mfma_f32_16x16x32_bf16 v[164:167], v[128:131], a[184:187], v[164:167]
v_mfma_f32_16x16x32_bf16 v[168:171], v[128:131], a[188:191], v[168:171]
s_waitcnt lgkmcnt(4)
v_mfma_f32_16x16x32_bf16 v[172:175], v[132:135], a[180:183], v[172:175]
v_mfma_f32_16x16x32_bf16 v[176:179], v[132:135], a[184:187], v[176:179]
v_mfma_f32_16x16x32_bf16 v[180:183], v[132:135], a[188:191], v[180:183]
s_waitcnt lgkmcnt(2)
v_mfma_f32_16x16x32_bf16 v[184:187], v[136:139], a[180:183], v[184:187]
v_mfma_f32_16x16x32_bf16 v[188:191], v[136:139], a[184:187], v[188:191]
v_mfma_f32_16x16x32_bf16 v[192:195], v[136:139], a[188:191], v[192:195]
s_waitcnt lgkmcnt(0)
v_mfma_f32_16x16x32_bf16 v[196:199], v[140:143], a[180:183], v[196:199]
v_mfma_f32_16x16x32_bf16 v[200:203], v[140:143], a[184:187], v[200:203]
v_mfma_f32_16x16x32_bf16 v[204:207], v[140:143], a[188:191], v[204:207]
s_waitcnt vmcnt(0)
s_mov_b32 s50, 4000
s_cmp_lg_u32 s3, 0
s_cbranch_scc1 L2_join
s_mov_b64 exec, 1
L2_poll:
buffer_load_dword v65, v16, s[40:43], s52 offen sc1
s_waitcnt vmcnt(0)
v_readfirstlane_b32 s53, v65
s_nop 1
s_cmp_eq_u32 s53, 1
s_cbranch_scc1 L2_got
s_sleep 2
s_sub_u32 s50, s50, 1
s_cbranch_scc0 L2_poll
L2_got:
s_mov_b64 exec, -1
L2_join:
s_barrier
s_mul_i32 s51, s76, 49152
s_mul_i32 s52, s3, 12288
s_add_u32 s51, s51, s52
s_add_u32 s53, s51, 4096
s_add_u32 s54, s51, 8192
buffer_load_dwordx4 v[64:67], v14, s[40:43], s51 offen sc1
buffer_load_dwordx4 v[76:79], v14, s[40:43], s51 offen offset:3072 sc1
buffer_load_dwordx4 v[88:91], v14, s[40:43], s53 offen offset:2048 sc1
buffer_load_dwordx4 v[100:103], v14, s[40:43], s54 offen offset:1024 sc1
buffer_load_dwordx4 v[68:71], v14, s[40:43], s51 offen offset:1024 sc1
buffer_load_dwordx4 v[80:83], v14, s[40:43], s53 offen sc1
buffer_load_dwordx4 v[92:95], v14, s[40:43], s53 offen offset:3072 sc1
buffer_load_dwordx4 v[104:107], v14, s[40:43], s54 offen offset:2048 sc1
buffer_load_dwordx4 v[72:75], v14, s[40:43], s51 offen offset:2048 sc1
buffer_load_dwordx4 v[84:87], v14, s[40:43], s53 offen offset:1024 sc1
buffer_load_dwordx4 v[96:99], v14, s[40:43], s54 offen sc1
buffer_load_dwordx4 v[108:111], v14, s[40:43], s54 offen offset:3072 sc1
s_waitcnt vmcnt(11)
v_add_f32 v160, v160, v64
v_add_f32 v161, v161, v65
v_add_f32 v162, v162, v66
v_add_f32 v163, v163, v67
v_cvt_pk_bf16_f32 v112, v160, v161
v_cvt_pk_bf16_f32 v113, v162, v163
s_waitcnt vmcnt(10)
v_add_f32 v172, v172, v76
v_add_f32 v173, v173, v77
v_add_f32 v174, v174, v78
v_add_f32 v175, v175, v79
v_cvt_pk_bf16_f32 v114, v172, v173
v_cvt_pk_bf16_f32 v115, v174, v175
s_nop 0
v_permlane16_swap_b32 v112, v114
v_permlane16_swap_b32 v113, v115
s_mov_b32 s55, 0
buffer_store_dwordx4 v[112:115], v15, s[36:39], s55 offen
s_waitcnt vmcnt(10)
v_add_f32 v184, v184, v88
v_add_f32 v185, v185, v89
v_add_f32 v186, v186, v90
v_add_f32 v187, v187, v91
v_cvt_pk_bf16_f32 v116, v184, v185
v_cvt_pk_bf16_f32 v117, v186, v187
s_waitcnt vmcnt(9)
v_add_f32 v196, v196, v100
v_add_f32 v197, v197, v101
v_add_f32 v198, v198, v102
v_add_f32 v199, v199, v103
v_cvt_pk_bf16_f32 v118, v196, v197
v_cvt_pk_bf16_f32 v119, v198, v199
s_nop 0
v_permlane16_swap_b32 v116, v118
v_permlane16_swap_b32 v117, v119
s_mov_b32 s55, 0
buffer_store_dwordx4 v[116:119], v15, s[36:39], s55 offen offset:64
s_waitcnt vmcnt(9)
v_add_f32 v164, v164, v68
v_add_f32 v165, v165, v69
v_add_f32 v166, v166, v70
v_add_f32 v167, v167, v71
v_cvt_pk_bf16_f32 v120, v164, v165
v_cvt_pk_bf16_f32 v121, v166, v167
s_waitcnt vmcnt(8)
v_add_f32 v176, v176, v80
v_add_f32 v177, v177, v81
v_add_f32 v178, v178, v82
v_add_f32 v179, v179, v83
v_cvt_pk_bf16_f32 v122, v176, v177
v_cvt_pk_bf16_f32 v123, v178, v179
s_nop 0
v_permlane16_swap_b32 v120, v122
v_permlane16_swap_b32 v121, v123
s_mov_b32 s55, 40960
buffer_store_dwordx4 v[120:123], v15, s[36:39], s55 offen
s_waitcnt vmcnt(8)
v_add_f32 v188, v188, v92
v_add_f32 v189, v189, v93
v_add_f32 v190, v190, v94
v_add_f32 v191, v191, v95
v_cvt_pk_bf16_f32 v124, v188, v189
v_cvt_pk_bf16_f32 v125, v190, v191
s_waitcnt vmcnt(7)
v_add_f32 v200, v200, v104
v_add_f32 v201, v201, v105
v_add_f32 v202, v202, v106
v_add_f32 v203, v203, v107
v_cvt_pk_bf16_f32 v126, v200, v201
v_cvt_pk_bf16_f32 v127, v202, v203
s_nop 0
v_permlane16_swap_b32 v124, v126
v_permlane16_swap_b32 v125, v127
s_mov_b32 s55, 40960
buffer_store_dwordx4 v[124:127], v15, s[36:39], s55 offen offset:64
s_waitcnt vmcnt(7)
v_add_f32 v168, v168, v72
v_add_f32 v169, v169, v73
v_add_f32 v170, v170, v74
v_add_f32 v171, v171, v75
v_cvt_pk_bf16_f32 v128, v168, v169
v_cvt_pk_bf16_f32 v129, v170, v171
s_waitcnt vmcnt(6)
v_add_f32 v180, v180, v84
v_add_f32 v181, v181, v85
v_add_f32 v182, v182, v86
v_add_f32 v183, v183, v87
v_cvt_pk_bf16_f32 v130, v180, v181
v_cvt_pk_bf16_f32 v131, v182, v183
s_nop 0
v_permlane16_swap_b32 v128, v130
v_permlane16_swap_b32 v129, v131
s_mov_b32 s55, 81920
buffer_store_dwordx4 v[128:131], v15, s[36:39], s55 offen
s_waitcnt vmcnt(6)
v_add_f32 v192, v192, v96
v_add_f32 v193, v193, v97
v_add_f32 v194, v194, v98
v_add_f32 v195, v195, v99
v_cvt_pk_bf16_f32 v132, v192, v193
v_cvt_pk_bf16_f32 v133, v194, v195
s_waitcnt vmcnt(5)
v_add_f32 v204, v204, v108
v_add_f32 v205, v205, v109
v_add_f32 v206, v206, v110
v_add_f32 v207, v207, v111
v_cvt_pk_bf16_f32 v134, v204, v205
v_cvt_pk_bf16_f32 v135, v206, v207
s_nop 0
v_permlane16_swap_b32 v132, v134
v_permlane16_swap_b32 v133, v135
s_mov_b32 s55, 81920
buffer_store_dwordx4 v[132:135], v15, s[36:39], s55 offen offset:64
L2_end:
s_endpgm
.section .rodata,"a"
.p2align 6
.amdhsa_kernel concat_heads__mha_block_cached__gqa_block_cached__near_ridge_kernel
  .amdhsa_next_free_vgpr 512
  .amdhsa_next_free_sgpr 102
  .amdhsa_accum_offset 256
  .amdhsa_group_segment_fixed_size 0
  .amdhsa_kernarg_size 104
  .amdhsa_user_sgpr_count 2
  .amdhsa_user_sgpr_kernarg_segment_ptr 1
  .amdhsa_system_sgpr_workgroup_id_x 1
.end_amdhsa_kernel
```
